```python
import torch

def _softmax(x, axis=-1):
    return torch.softmax(x, dim=axis)
def _gelu(x):
    return torch.nn.functional.gelu(x, approximate="tanh")
def _silu(x):
    return torch.nn.functional.silu(x)
def _sigmoid(x):
    return torch.sigmoid(x)
def _layernorm(x, axis=-1, eps=1e-5):
    m = x.mean(dim=axis, keepdim=True)
    v = x.var(dim=axis, keepdim=True, unbiased=False)
    return (x - m) / torch.sqrt(v + eps)
def _scatter_add(tgt, idx, src, axis=0):
    return tgt.clone().index_add_(axis, idx, src)
def _segment_sum(src, seg, n):
    out = torch.zeros((n,) + src.shape[1:], dtype=src.dtype)
    return out.index_add_(0, seg, src)
def _pad(x, pw):
    flat = tuple(v for pair in reversed(pw) for v in pair)
    return torch.nn.functional.pad(x, flat)

kernel_name = 'recurrent_scan__ssm_conv_h3__mixer_s_mlp__prompt'

def setup_inputs():

    _w = (lambda a: (lambda t: t.to(torch.bfloat16) if t.is_floating_point() else t)(torch.as_tensor(a)))
    def _A_setup():
        B, S, D = 1, 2048, 1024
        ks = 4
        return {
            "q": _w((lambda *s: torch.randn(*s, dtype=torch.bfloat16) * 0.05)(B, S, D)),
            "k": _w((lambda *s: torch.randn(*s, dtype=torch.bfloat16) * 0.2)(B, S, D)),
            "v": _w((lambda *s: torch.randn(*s, dtype=torch.bfloat16) * 0.2)(B, S, D)),
            "shift_k": _w((lambda *s: torch.randn(*s, dtype=torch.bfloat16) * 0.2)(D, ks) * 0.5),
            "ssm_k": _w((lambda *s: torch.randn(*s, dtype=torch.bfloat16) * 0.2)(D, S) * (1.0 / S ** 0.5)),
            "ssm_D": _w((lambda *s: torch.randn(*s, dtype=torch.bfloat16) * 0.2)(D)),
        }
    _A_in = _A_setup()

    def _B_setup():
        B, S, D, F = 1, 2048, 1024, 3584
        return {
            "x":  _w((lambda *s: torch.randn(*s, dtype=torch.bfloat16) * 0.05)(B, S, D)),
            "w1": _w((lambda *s: torch.randn(*s, dtype=torch.bfloat16) * 1.6)(D, D) * (D ** -0.5)),
            "w2": _w((lambda *s: torch.randn(*s, dtype=torch.bfloat16) * 1.6)(D, D) * (D ** -0.5)),
            "w3": _w((lambda *s: torch.randn(*s, dtype=torch.bfloat16) * 1.6)(D, F) * (D ** -0.5)),
            "w4": _w((lambda *s: torch.randn(*s, dtype=torch.bfloat16) * 1.6)(F, D) * (F ** -0.5)),
        }
    _B_in = _B_setup()

    return {
        "A_q": _A_in["q"],
        "A_k": _A_in["k"],
        "A_v": _A_in["v"],
        "A_shift_k": _A_in["shift_k"],
        "A_ssm_k": _A_in["ssm_k"],
        "A_ssm_D": _A_in["ssm_D"],
        "B_x": _B_in["x"],
        "B_w1": _B_in["w1"],
        "B_w2": _B_in["w2"],
        "B_w3": _B_in["w3"],
        "B_w4": _B_in["w4"],
    }

def reference(A_q, A_k, A_v, A_shift_k, A_ssm_k, A_ssm_D, B_x, B_w1, B_w2, B_w3, B_w4):
    def _A_ref(q, k, v, shift_k, ssm_k, ssm_D):
        B, S, D = q.shape
        ks = shift_k.shape[-1]
        k_pad = _pad(k, ((0, 0), (ks - 1, 0), (0, 0)))
        k_shift = torch.zeros_like(k)
        for t in range(ks):
            k_shift = k_shift + k_pad[:, t:t + S, :] * shift_k[:, ks - 1 - t][None, None, :]
        kv = k_shift * v
        L = 2 * S
        kv_pad = _pad(kv, ((0, 0), (0, S), (0, 0)))
        kf_pad = _pad(ssm_k, ((0, 0), (0, S)))
        kv_f = (lambda x, axes=(-2,-1): torch.fft.rfft2(x.float(), dim=axes))(kv_pad[:, None, :, :], axes=(1, 2))
        kf_f = (lambda x, axes=(-2,-1): torch.fft.rfft2(x.float(), dim=axes))(kf_pad[:, None, :], axes=(1, 2))
        kf_f = (lambda x, *d: x.permute(*d))(kf_f, 1, 2, 0)
        y_f = kv_f * kf_f[None, :, :, :]
        y = (lambda x, s, axes=(-2,-1): torch.fft.irfft2(x, s=s, dim=axes).to(torch.bfloat16))(y_f, (1, L), axes=(1, 2))[:, 0, :S, :]
        y = y + kv * ssm_D[None, None, :]
        return q * y

    def _B_ref(x, w1, w2, w3, w4):
        B, S, D = x.shape
        h = _gelu(_layernorm(x, axis=-1) @ w1)
        c = D // 4
        g0 = _pad(h[:, :, 0*c:1*c], ((0, 0), (1, 0), (0, 0)))[:, :S, :]
        g1 = _pad(h[:, :, 1*c:2*c], ((0, 0), (0, 1), (0, 0)))[:, 1:, :]
        g2 = _pad(h[:, :, 2*c:3*c], ((0, 0), (2, 0), (0, 0)))[:, :S, :]
        g3 = _pad(h[:, :, 3*c:   ], ((0, 0), (0, 2), (0, 0)))[:, 2:, :]
        hs = torch.concatenate([g0, g1, g2, g3], axis=-1) @ w2
        x1 = x + hs
        h2 = _gelu(_layernorm(x1, axis=-1) @ w3) @ w4
        return x1 + h2

    x = A_q
    xn = _layernorm(x, axis=-1)
    s = _A_ref(xn, A_k, A_v, A_shift_k, A_ssm_k, A_ssm_D)
    g = _silu(_B_ref(xn, B_w1, B_w2, B_w3, B_w4))
    return x + s * g
```

```asm
; @launch grid=(256,1,1) block=(512,1,1) lds=163840
.amdgcn_target "amdgcn-amd-amdhsa--gfx950"
.text
.globl recurrent_scan__ssm_conv_h3__mixer_s_mlp__prompt_kernel
.p2align 8
.type recurrent_scan__ssm_conv_h3__mixer_s_mlp__prompt_kernel,@function
recurrent_scan__ssm_conv_h3__mixer_s_mlp__prompt_kernel:
  s_cmp_ge_u32 s2, 256
  s_cbranch_scc1 L_end
  s_cmp_ge_u32 s2, 128
  s_cbranch_scc0 s1_c
  v_lshrrev_b32 v2, 8, v0
  s_nop 0
  v_readfirstlane_b32 s3, v2
  s_nop 0
  s_cmp_eq_u32 s3, 1
  s_cbranch_scc1 g1_l
  s_branch g1_c
L_end:
  s_endpgm
s1_c:
  s_load_dwordx4 s[28:31], s[0:1], 0
  s_load_dwordx4 s[32:35], s[0:1], 16
  s_load_dwordx4 s[36:39], s[0:1], 56
  s_load_dwordx4 s[40:43], s[0:1], 96
  s_load_dwordx2 s[44:45], s[0:1], 32
  v_lshrrev_b32 v2, 6, v0
  v_and_b32 v3, 63, v0
  v_readfirstlane_b32 s100, v2
  s_nop 0
  s_and_b32 s20, s100, 3
  s_lshr_b32 s3, s100, 2
  s_and_b32 s21, s2, 7
  s_lshr_b32 s22, s2, 3
  s_lshl_b32 s23, s21, 8
  s_lshl_b32 s24, s22, 4
  s_add_u32 s23, s23, s24
  s_lshl_b32 s24, s100, 1
  s_add_u32 s23, s23, s24
  s_lshl_b32 s24, s23, 11
  v_lshl_add_u32 v6, v3, 4, s24
  s_and_b32 s25, s21, 1
  s_lshl_b32 s25, s25, 2
  s_lshr_b32 s24, s21, 1
  s_add_u32 s25, s25, s24
  s_lshl_b32 s24, s22, 6
  s_lshl_b32 s26, s100, 3
  s_add_u32 s24, s24, s26
  v_lshrrev_b32 v7, 4, v3
  v_add_u32 v7, s24, v7
  v_lshlrev_b32 v7, 11, v7
  v_and_b32 v8, 15, v3
  v_lshl_add_u32 v7, v8, 4, v7
  s_lshl_b32 s24, s25, 8
  v_add_u32 v7, s24, v7
  s_waitcnt lgkmcnt(0)
  s_mov_b32 s4, s28
  s_mov_b32 s5, s29
  s_mov_b32 s6, 4194304
  s_mov_b32 s7, 0x20000
  s_mov_b32 s8, s36
  s_mov_b32 s9, s37
  s_mov_b32 s10, 2097152
  s_mov_b32 s11, 0x20000
  s_getpc_b64 s[72:73]
sd_pc1:
  s_add_u32 s72, s72, recurrent_scan__ssm_conv_h3__mixer_s_mlp__prompt_kernel-sd_pc1
  s_addc_u32 s73, s73, -1
  s_mov_b32 s74, code_end-recurrent_scan__ssm_conv_h3__mixer_s_mlp__prompt_kernel
  s_mov_b32 s75, 0x20000
  s_lshr_b32 s24, s2, 3
  s_and_b32 s24, s24, 31
  s_mul_i32 s24, s24, 4096
  s_cmp_lg_u32 s20, 3
  s_cselect_b32 s74, 0, s74
  v_cmp_gt_u32 vcc, 32, v3
  v_lshlrev_b32 v252, 7, v3
  v_mov_b32 v253, 0x80000000
  v_cndmask_b32 v252, v253, v252, vcc
  buffer_load_dword v255, v252, s[72:75], s24 offen
  buffer_load_dwordx4 v[32:35], v6, s[4:7], 0 offen offset:0
  buffer_load_dwordx4 v[36:39], v6, s[4:7], 0 offen offset:1024
  buffer_load_dwordx4 v[40:43], v6, s[4:7], 0 offen offset:2048
  buffer_load_dwordx4 v[44:47], v6, s[4:7], 0 offen offset:3072
  s_movk_i32 s27, 8192
  buffer_load_dwordx4 v[64:67], v7, s[8:11], 0 offen
  buffer_load_dwordx4 v[68:71], v7, s[8:11], s27 offen
  s_add_u32 s12, s42, 33554432
  s_addc_u32 s13, s43, 0
  s_mov_b32 s14, 4194304
  s_mov_b32 s15, 0x20000
  s_mov_b32 s16, s40
  s_mov_b32 s17, s41
  s_mov_b32 s18, 256
  s_mov_b32 s19, 0x20000
  s_mov_b32 s48, s30
  s_mov_b32 s49, s31
  s_mov_b32 s50, 4194304
  s_mov_b32 s51, 0x20000
  s_mov_b32 s52, s32
  s_mov_b32 s53, s33
  s_mov_b32 s54, 4194304
  s_mov_b32 s55, 0x20000
  s_mov_b32 s56, s34
  s_mov_b32 s57, s35
  s_mov_b32 s58, 8192
  s_mov_b32 s59, 0x20000
  s_add_u32 s60, s42, 25165824
  s_addc_u32 s61, s43, 0
  s_mov_b32 s62, 4194304
  s_mov_b32 s63, 0x20000
  s_mov_b32 s64, s38
  s_mov_b32 s65, s39
  s_mov_b32 s66, 2097152
  s_mov_b32 s67, 0x20000
  s_mov_b32 s68, s44
  s_mov_b32 s69, s45
  s_mov_b32 s70, 4194304
  s_mov_b32 s71, 0x20000
  s_lshl_b32 s24, s2, 11
  s_add_u32 s24, s24, 786432
  v_lshl_add_u32 v12, v0, 2, s24
  v_mov_b32 v14, 0
  buffer_store_dword v14, v12, s[12:15], 0 offen sc1
  s_lshl_b32 s47, s21, 1
  s_add_u32 s47, s47, s3
  v_and_b32 v26, 7, v3
  v_lshrrev_b32 v27, 3, v3
  s_lshl_b32 s26, s22, 7
  s_lshl_b32 s27, s20, 5
  s_add_u32 s26, s26, s27
  v_lshl_add_u32 v28, v27, 2, s26
  v_lshlrev_b32 v29, 11, v28
  v_lshl_add_u32 v29, v26, 4, v29
  s_lshl_b32 s26, s47, 7
  v_add_u32 v29, s26, v29
  v_subrev_u32 v30, 6144, v29
  v_cmp_eq_u32 vcc, 0, v28
  v_mov_b32 v28, 0x80000000
  s_lshl_b32 s26, s47, 9
  v_lshl_add_u32 v31, v26, 6, s26
  v_cndmask_b32 v30, v30, v28, vcc
  s_movk_i32 s46, 4096
  s_waitcnt vmcnt(5)
  v_lshlrev_b32 v96, 16, v32
  v_and_b32 v97, 0xffff0000, v32
  v_lshlrev_b32 v98, 16, v33
  v_and_b32 v99, 0xffff0000, v33
  v_lshlrev_b32 v100, 16, v34
  v_and_b32 v101, 0xffff0000, v34
  v_lshlrev_b32 v102, 16, v35
  v_and_b32 v103, 0xffff0000, v35
  v_lshlrev_b32 v104, 16, v36
  v_and_b32 v105, 0xffff0000, v36
  v_lshlrev_b32 v106, 16, v37
  v_and_b32 v107, 0xffff0000, v37
  v_lshlrev_b32 v108, 16, v38
  v_and_b32 v109, 0xffff0000, v38
  v_lshlrev_b32 v110, 16, v39
  v_and_b32 v111, 0xffff0000, v39
  v_pk_add_f32 v[160:161], v[96:97], v[98:99]
  v_pk_add_f32 v[160:161], v[160:161], v[100:101]
  v_pk_add_f32 v[160:161], v[160:161], v[102:103]
  v_pk_add_f32 v[160:161], v[160:161], v[104:105]
  v_pk_add_f32 v[160:161], v[160:161], v[106:107]
  v_pk_add_f32 v[160:161], v[160:161], v[108:109]
  v_pk_add_f32 v[160:161], v[160:161], v[110:111]
  s_waitcnt vmcnt(3)
  v_lshlrev_b32 v112, 16, v40
  v_and_b32 v113, 0xffff0000, v40
  v_lshlrev_b32 v114, 16, v41
  v_and_b32 v115, 0xffff0000, v41
  v_lshlrev_b32 v116, 16, v42
  v_and_b32 v117, 0xffff0000, v42
  v_lshlrev_b32 v118, 16, v43
  v_and_b32 v119, 0xffff0000, v43
  v_lshlrev_b32 v120, 16, v44
  v_and_b32 v121, 0xffff0000, v44
  v_lshlrev_b32 v122, 16, v45
  v_and_b32 v123, 0xffff0000, v45
  v_lshlrev_b32 v124, 16, v46
  v_and_b32 v125, 0xffff0000, v46
  v_lshlrev_b32 v126, 16, v47
  v_and_b32 v127, 0xffff0000, v47
  v_pk_add_f32 v[162:163], v[112:113], v[114:115]
  v_pk_add_f32 v[162:163], v[162:163], v[116:117]
  v_pk_add_f32 v[162:163], v[162:163], v[118:119]
  v_pk_add_f32 v[162:163], v[162:163], v[120:121]
  v_pk_add_f32 v[162:163], v[162:163], v[122:123]
  v_pk_add_f32 v[162:163], v[162:163], v[124:125]
  v_pk_add_f32 v[162:163], v[162:163], v[126:127]
  v_add_f32 v16, v160, v161
  v_add_f32 v17, v162, v163
  s_nop 1
  v_add_f32_dpp v16, v16, v16 quad_perm:[1,0,3,2] row_mask:0xf bank_mask:0xf
  v_add_f32_dpp v17, v17, v17 quad_perm:[1,0,3,2] row_mask:0xf bank_mask:0xf
  s_nop 0
  v_add_f32_dpp v16, v16, v16 quad_perm:[2,3,0,1] row_mask:0xf bank_mask:0xf
  v_add_f32_dpp v17, v17, v17 quad_perm:[2,3,0,1] row_mask:0xf bank_mask:0xf
  s_nop 0
  v_add_f32_dpp v16, v16, v16 row_half_mirror row_mask:0xf bank_mask:0xf
  v_add_f32_dpp v17, v17, v17 row_half_mirror row_mask:0xf bank_mask:0xf
  s_nop 0
  v_add_f32_dpp v16, v16, v16 row_mirror row_mask:0xf bank_mask:0xf
  v_add_f32_dpp v17, v17, v17 row_mirror row_mask:0xf bank_mask:0xf
  s_nop 0
  v_mov_b32 v18, v16
  v_mov_b32 v19, v17
  s_nop 1
  v_permlane16_swap_b32 v16, v18
  v_permlane16_swap_b32 v17, v19
  s_nop 1
  v_add_f32 v16, v16, v18
  v_add_f32 v17, v17, v19
  s_nop 1
  v_mov_b32 v18, v16
  v_mov_b32 v19, v17
  s_nop 1
  v_permlane32_swap_b32 v16, v18
  v_permlane32_swap_b32 v17, v19
  s_nop 1
  v_add_f32 v16, v16, v18
  v_add_f32 v17, v17, v19
  s_nop 1
  v_mul_f32 v168, 0xba800000, v16
  v_mul_f32 v170, 0xba800000, v17
  v_pk_add_f32 v[96:97], v[96:97], v[168:169] op_sel_hi:[1,0]
  v_pk_add_f32 v[98:99], v[98:99], v[168:169] op_sel_hi:[1,0]
  v_pk_add_f32 v[100:101], v[100:101], v[168:169] op_sel_hi:[1,0]
  v_pk_add_f32 v[102:103], v[102:103], v[168:169] op_sel_hi:[1,0]
  v_pk_add_f32 v[104:105], v[104:105], v[168:169] op_sel_hi:[1,0]
  v_pk_add_f32 v[106:107], v[106:107], v[168:169] op_sel_hi:[1,0]
  v_pk_add_f32 v[108:109], v[108:109], v[168:169] op_sel_hi:[1,0]
  v_pk_add_f32 v[110:111], v[110:111], v[168:169] op_sel_hi:[1,0]
  v_pk_mul_f32 v[160:161], v[96:97], v[96:97]
  v_pk_fma_f32 v[160:161], v[98:99], v[98:99], v[160:161]
  v_pk_fma_f32 v[160:161], v[100:101], v[100:101], v[160:161]
  v_pk_fma_f32 v[160:161], v[102:103], v[102:103], v[160:161]
  v_pk_fma_f32 v[160:161], v[104:105], v[104:105], v[160:161]
  v_pk_fma_f32 v[160:161], v[106:107], v[106:107], v[160:161]
  v_pk_fma_f32 v[160:161], v[108:109], v[108:109], v[160:161]
  v_pk_fma_f32 v[160:161], v[110:111], v[110:111], v[160:161]
  v_pk_add_f32 v[112:113], v[112:113], v[170:171] op_sel_hi:[1,0]
  v_pk_add_f32 v[114:115], v[114:115], v[170:171] op_sel_hi:[1,0]
  v_pk_add_f32 v[116:117], v[116:117], v[170:171] op_sel_hi:[1,0]
  v_pk_add_f32 v[118:119], v[118:119], v[170:171] op_sel_hi:[1,0]
  v_pk_add_f32 v[120:121], v[120:121], v[170:171] op_sel_hi:[1,0]
  v_pk_add_f32 v[122:123], v[122:123], v[170:171] op_sel_hi:[1,0]
  v_pk_add_f32 v[124:125], v[124:125], v[170:171] op_sel_hi:[1,0]
  v_pk_add_f32 v[126:127], v[126:127], v[170:171] op_sel_hi:[1,0]
  v_pk_mul_f32 v[162:163], v[112:113], v[112:113]
  v_pk_fma_f32 v[162:163], v[114:115], v[114:115], v[162:163]
  v_pk_fma_f32 v[162:163], v[116:117], v[116:117], v[162:163]
  v_pk_fma_f32 v[162:163], v[118:119], v[118:119], v[162:163]
  v_pk_fma_f32 v[162:163], v[120:121], v[120:121], v[162:163]
  v_pk_fma_f32 v[162:163], v[122:123], v[122:123], v[162:163]
  v_pk_fma_f32 v[162:163], v[124:125], v[124:125], v[162:163]
  v_pk_fma_f32 v[162:163], v[126:127], v[126:127], v[162:163]
  v_add_f32 v20, v160, v161
  v_add_f32 v21, v162, v163
  s_nop 1
  v_add_f32_dpp v20, v20, v20 quad_perm:[1,0,3,2] row_mask:0xf bank_mask:0xf
  v_add_f32_dpp v21, v21, v21 quad_perm:[1,0,3,2] row_mask:0xf bank_mask:0xf
  s_nop 0
  v_add_f32_dpp v20, v20, v20 quad_perm:[2,3,0,1] row_mask:0xf bank_mask:0xf
  v_add_f32_dpp v21, v21, v21 quad_perm:[2,3,0,1] row_mask:0xf bank_mask:0xf
  s_nop 0
  v_add_f32_dpp v20, v20, v20 row_half_mirror row_mask:0xf bank_mask:0xf
  v_add_f32_dpp v21, v21, v21 row_half_mirror row_mask:0xf bank_mask:0xf
  s_nop 0
  v_add_f32_dpp v20, v20, v20 row_mirror row_mask:0xf bank_mask:0xf
  v_add_f32_dpp v21, v21, v21 row_mirror row_mask:0xf bank_mask:0xf
  s_nop 0
  v_mov_b32 v22, v20
  v_mov_b32 v23, v21
  s_nop 1
  v_permlane16_swap_b32 v20, v22
  v_permlane16_swap_b32 v21, v23
  s_nop 1
  v_add_f32 v20, v20, v22
  v_add_f32 v21, v21, v23
  s_nop 1
  v_mov_b32 v22, v20
  v_mov_b32 v23, v21
  s_nop 1
  v_permlane32_swap_b32 v20, v22
  v_permlane32_swap_b32 v21, v23
  s_nop 1
  v_add_f32 v20, v20, v22
  v_add_f32 v21, v21, v23
  s_nop 1
  v_cmp_eq_u32 vcc, 1, v3
  s_nop 1
  v_cndmask_b32 v16, v16, v17, vcc
  v_cndmask_b32 v20, v20, v21, vcc
  v_mul_f32 v10, 0x3a800000, v16
  v_mov_b32 v12, 0x3727c5ac
  v_fmac_f32 v12, 0x3a800000, v20
  v_rsq_f32 v11, v12
  s_lshl_b32 s24, s23, 3
  s_add_u32 s24, s24, 262144
  v_lshrrev_b32 v8, 1, v3
  v_lshlrev_b32 v8, 22, v8
  v_lshl_add_u32 v8, v3, 3, v8
  buffer_store_dwordx2 v[10:11], v8, s[12:15], s24 offen sc1
  s_lshl_b32 s24, s22, 12
  s_lshl_b32 s26, s25, 9
  s_add_u32 s24, s24, s26
  s_add_u32 s24, s24, 655360
  s_waitcnt vmcnt(3)
  v_lshlrev_b32 v128, 16, v64
  v_and_b32 v129, 0xffff0000, v64
  v_lshlrev_b32 v130, 16, v65
  v_and_b32 v131, 0xffff0000, v65
  v_lshlrev_b32 v132, 16, v66
  v_and_b32 v133, 0xffff0000, v66
  v_lshlrev_b32 v134, 16, v67
  v_and_b32 v135, 0xffff0000, v67
  s_waitcnt vmcnt(2)
  v_lshlrev_b32 v96, 16, v68
  v_and_b32 v97, 0xffff0000, v68
  v_lshlrev_b32 v98, 16, v69
  v_and_b32 v99, 0xffff0000, v69
  v_lshlrev_b32 v100, 16, v70
  v_and_b32 v101, 0xffff0000, v70
  v_lshlrev_b32 v102, 16, v71
  v_and_b32 v103, 0xffff0000, v71
  v_pk_add_f32 v[128:129], v[128:129], v[96:97]
  v_pk_add_f32 v[130:131], v[130:131], v[98:99]
  v_pk_add_f32 v[132:133], v[132:133], v[100:101]
  v_pk_add_f32 v[134:135], v[134:135], v[102:103]
  v_lshlrev_b32 v4, 5, v0
  v_add_u32 v4, 0, v4
  ds_write_b128 v4, v[128:131]
  ds_write_b128 v4, v[132:135] offset:16
  s_waitcnt lgkmcnt(0)
  s_barrier
  v_and_b32 v4, 127, v0
  v_lshlrev_b32 v4, 2, v4
  v_add_u32 v5, 0, v4
  ds_read_b32 v96, v5 offset:0
  ds_read_b32 v97, v5 offset:512
  ds_read_b32 v98, v5 offset:1024
  ds_read_b32 v99, v5 offset:1536
  ds_read_b32 v100, v5 offset:2048
  ds_read_b32 v101, v5 offset:2560
  ds_read_b32 v102, v5 offset:3072
  ds_read_b32 v103, v5 offset:3584
  ds_read_b32 v104, v5 offset:4096
  ds_read_b32 v105, v5 offset:4608
  ds_read_b32 v106, v5 offset:5120
  ds_read_b32 v107, v5 offset:5632
  ds_read_b32 v108, v5 offset:6144
  ds_read_b32 v109, v5 offset:6656
  ds_read_b32 v110, v5 offset:7168
  ds_read_b32 v111, v5 offset:7680
  ds_read_b32 v112, v5 offset:8192
  ds_read_b32 v113, v5 offset:8704
  ds_read_b32 v114, v5 offset:9216
  ds_read_b32 v115, v5 offset:9728
  ds_read_b32 v116, v5 offset:10240
  ds_read_b32 v117, v5 offset:10752
  ds_read_b32 v118, v5 offset:11264
  ds_read_b32 v119, v5 offset:11776
  ds_read_b32 v120, v5 offset:12288
  ds_read_b32 v121, v5 offset:12800
  ds_read_b32 v122, v5 offset:13312
  ds_read_b32 v123, v5 offset:13824
  ds_read_b32 v124, v5 offset:14336
  ds_read_b32 v125, v5 offset:14848
  ds_read_b32 v126, v5 offset:15360
  ds_read_b32 v127, v5 offset:15872
  s_waitcnt lgkmcnt(0)
  v_add_f32 v96, v96, v97
  v_add_f32 v96, v96, v98
  v_add_f32 v96, v96, v99
  v_add_f32 v96, v96, v100
  v_add_f32 v96, v96, v101
  v_add_f32 v96, v96, v102
  v_add_f32 v96, v96, v103
  v_add_f32 v96, v96, v104
  v_add_f32 v96, v96, v105
  v_add_f32 v96, v96, v106
  v_add_f32 v96, v96, v107
  v_add_f32 v96, v96, v108
  v_add_f32 v96, v96, v109
  v_add_f32 v96, v96, v110
  v_add_f32 v96, v96, v111
  v_add_f32 v96, v96, v112
  v_add_f32 v96, v96, v113
  v_add_f32 v96, v96, v114
  v_add_f32 v96, v96, v115
  v_add_f32 v96, v96, v116
  v_add_f32 v96, v96, v117
  v_add_f32 v96, v96, v118
  v_add_f32 v96, v96, v119
  v_add_f32 v96, v96, v120
  v_add_f32 v96, v96, v121
  v_add_f32 v96, v96, v122
  v_add_f32 v96, v96, v123
  v_add_f32 v96, v96, v124
  v_add_f32 v96, v96, v125
  v_add_f32 v96, v96, v126
  v_add_f32 v96, v96, v127
  buffer_store_dword v96, v4, s[12:15], s24 offen sc1
  s_waitcnt vmcnt(0)
  s_barrier
  s_cmp_lg_u32 s100, 0
  s_cbranch_scc1 sd_pub2
  v_lshlrev_b32 v4, 20, v3
  v_mov_b32 v5, 1
  buffer_atomic_add v5, v4, s[16:19], 0 offen sc1
sd_pub2:
  s_lshl_b32 s24, s2, 3
  s_add_u32 s24, s24, s100
  s_lshl_b32 s26, s22, 3
  s_add_u32 s26, s26, s100
  s_lshl_b32 s26, s26, 14
  s_and_b32 s27, s21, 1
  s_lshl_b32 s27, s27, 10
  s_add_u32 s26, s26, s27
  v_lshrrev_b32 v8, 3, v3
  v_lshlrev_b32 v8, 11, v8
  v_and_b32 v10, 7, v3
  v_lshl_add_u32 v8, v10, 7, v8
  buffer_load_dword v9, v8, s[64:67], s26 offen
  buffer_load_dwordx4 v[232:235], v31, s[56:59], 0 offen offset:0
  buffer_load_dwordx4 v[236:239], v31, s[56:59], 0 offen offset:16
  buffer_load_dwordx4 v[240:243], v31, s[56:59], 0 offen offset:32
  buffer_load_dwordx4 v[244:247], v31, s[56:59], 0 offen offset:48
  buffer_load_dwordx4 v[188:191], v30, s[48:51], 0 offen offset:0
  buffer_load_dwordx4 v[192:195], v30, s[48:51], 0 offen offset:2048
  buffer_load_dwordx4 v[196:199], v30, s[48:51], s46 offen offset:0
  buffer_load_dwordx4 v[200:203], v29, s[48:51], 0 offen offset:0
  buffer_load_dwordx4 v[204:207], v29, s[48:51], 0 offen offset:2048
  buffer_load_dwordx4 v[208:211], v29, s[48:51], s46 offen offset:0
  buffer_load_dwordx4 v[212:215], v29, s[48:51], s46 offen offset:2048
  buffer_load_dwordx4 v[216:219], v29, s[52:55], 0 offen offset:0
  buffer_load_dwordx4 v[220:223], v29, s[52:55], 0 offen offset:2048
  buffer_load_dwordx4 v[224:227], v29, s[52:55], s46 offen offset:0
  buffer_load_dwordx4 v[228:231], v29, s[52:55], s46 offen offset:2048
  s_lshl_b32 s27, s3, 14
  s_add_u32 s27, s27, 16384
  v_lshrrev_b32 v13, 1, v27
  s_lshl_b32 s26, s20, 2
  v_add_u32 v13, s26, v13
  v_xor_b32 v13, v13, v26
  v_lshlrev_b32 v13, 4, v13
  v_lshl_add_u32 v13, v26, 11, v13
  v_and_b32 v14, 1, v27
  v_lshl_add_u32 v13, v14, 3, v13
  v_add_u32 v13, s27, v13
  v_lshrrev_b32 v14, 4, v3
  s_lshl_b32 s26, s20, 4
  v_add_u32 v14, s26, v14
  v_and_b32 v15, 15, v3
  s_lshl_b32 s26, s20, 1
  v_xor_b32 v16, s26, v15
  v_lshlrev_b32 v17, 8, v14
  v_add_u32 v17, s27, v17
  v_lshl_add_u32 v18, v16, 4, v17
  v_xor_b32 v16, 1, v16
  v_lshl_add_u32 v19, v16, 4, v17
  s_lshl_b32 s26, s47, 6
  v_add_u32 v14, s26, v14
  v_lshlrev_b32 v14, 12, v14
  v_lshl_add_u32 v14, v15, 4, v14
  s_lshl_b32 s26, s22, 8
  v_add_u32 v14, s26, v14
  s_waitcnt vmcnt(11)
  v_lshlrev_b32 v32, 16, v232
  v_and_b32 v40, 0xffff0000, v232
  v_lshlrev_b32 v48, 16, v233
  v_and_b32 v56, 0xffff0000, v233
  v_lshlrev_b32 v33, 16, v234
  v_and_b32 v41, 0xffff0000, v234
  v_lshlrev_b32 v49, 16, v235
  v_and_b32 v57, 0xffff0000, v235
  v_lshlrev_b32 v34, 16, v236
  v_and_b32 v42, 0xffff0000, v236
  v_lshlrev_b32 v50, 16, v237
  v_and_b32 v58, 0xffff0000, v237
  v_lshlrev_b32 v35, 16, v238
  v_and_b32 v43, 0xffff0000, v238
  v_lshlrev_b32 v51, 16, v239
  v_and_b32 v59, 0xffff0000, v239
  v_lshlrev_b32 v36, 16, v240
  v_and_b32 v44, 0xffff0000, v240
  v_lshlrev_b32 v52, 16, v241
  v_and_b32 v60, 0xffff0000, v241
  v_lshlrev_b32 v37, 16, v242
  v_and_b32 v45, 0xffff0000, v242
  v_lshlrev_b32 v53, 16, v243
  v_and_b32 v61, 0xffff0000, v243
  v_lshlrev_b32 v38, 16, v244
  v_and_b32 v46, 0xffff0000, v244
  v_lshlrev_b32 v54, 16, v245
  v_and_b32 v62, 0xffff0000, v245
  v_lshlrev_b32 v39, 16, v246
  v_and_b32 v47, 0xffff0000, v246
  v_lshlrev_b32 v55, 16, v247
  v_and_b32 v63, 0xffff0000, v247
  s_waitcnt vmcnt(10)
  v_lshlrev_b32 v64, 16, v188
  v_and_b32 v65, 0xffff0000, v188
  v_lshlrev_b32 v66, 16, v189
  v_and_b32 v67, 0xffff0000, v189
  v_lshlrev_b32 v68, 16, v190
  v_and_b32 v69, 0xffff0000, v190
  v_lshlrev_b32 v70, 16, v191
  v_and_b32 v71, 0xffff0000, v191
  s_waitcnt vmcnt(9)
  v_lshlrev_b32 v72, 16, v192
  v_and_b32 v73, 0xffff0000, v192
  v_lshlrev_b32 v74, 16, v193
  v_and_b32 v75, 0xffff0000, v193
  v_lshlrev_b32 v76, 16, v194
  v_and_b32 v77, 0xffff0000, v194
  v_lshlrev_b32 v78, 16, v195
  v_and_b32 v79, 0xffff0000, v195
  s_waitcnt vmcnt(8)
  v_lshlrev_b32 v80, 16, v196
  v_and_b32 v81, 0xffff0000, v196
  v_lshlrev_b32 v82, 16, v197
  v_and_b32 v83, 0xffff0000, v197
  v_lshlrev_b32 v84, 16, v198
  v_and_b32 v85, 0xffff0000, v198
  v_lshlrev_b32 v86, 16, v199
  v_and_b32 v87, 0xffff0000, v199
  s_waitcnt vmcnt(7)
  v_lshlrev_b32 v88, 16, v200
  v_and_b32 v89, 0xffff0000, v200
  v_lshlrev_b32 v90, 16, v201
  v_and_b32 v91, 0xffff0000, v201
  v_lshlrev_b32 v92, 16, v202
  v_and_b32 v93, 0xffff0000, v202
  v_lshlrev_b32 v94, 16, v203
  v_and_b32 v95, 0xffff0000, v203
  s_waitcnt vmcnt(6)
  v_lshlrev_b32 v96, 16, v204
  v_and_b32 v97, 0xffff0000, v204
  v_lshlrev_b32 v98, 16, v205
  v_and_b32 v99, 0xffff0000, v205
  v_lshlrev_b32 v100, 16, v206
  v_and_b32 v101, 0xffff0000, v206
  v_lshlrev_b32 v102, 16, v207
  v_and_b32 v103, 0xffff0000, v207
  s_waitcnt vmcnt(5)
  v_lshlrev_b32 v104, 16, v208
  v_and_b32 v105, 0xffff0000, v208
  v_lshlrev_b32 v106, 16, v209
  v_and_b32 v107, 0xffff0000, v209
  v_lshlrev_b32 v108, 16, v210
  v_and_b32 v109, 0xffff0000, v210
  v_lshlrev_b32 v110, 16, v211
  v_and_b32 v111, 0xffff0000, v211
  s_waitcnt vmcnt(4)
  v_lshlrev_b32 v112, 16, v212
  v_and_b32 v113, 0xffff0000, v212
  v_lshlrev_b32 v114, 16, v213
  v_and_b32 v115, 0xffff0000, v213
  v_lshlrev_b32 v116, 16, v214
  v_and_b32 v117, 0xffff0000, v214
  v_lshlrev_b32 v118, 16, v215
  v_and_b32 v119, 0xffff0000, v215
  v_pk_mul_f32 v[152:153], v[88:89], v[32:33]
  v_pk_mul_f32 v[154:155], v[90:91], v[34:35]
  v_pk_mul_f32 v[156:157], v[92:93], v[36:37]
  v_pk_mul_f32 v[158:159], v[94:95], v[38:39]
  v_pk_fma_f32 v[152:153], v[80:81], v[40:41], v[152:153]
  v_pk_fma_f32 v[154:155], v[82:83], v[42:43], v[154:155]
  v_pk_fma_f32 v[156:157], v[84:85], v[44:45], v[156:157]
  v_pk_fma_f32 v[158:159], v[86:87], v[46:47], v[158:159]
  v_pk_fma_f32 v[152:153], v[72:73], v[48:49], v[152:153]
  v_pk_fma_f32 v[154:155], v[74:75], v[50:51], v[154:155]
  v_pk_fma_f32 v[156:157], v[76:77], v[52:53], v[156:157]
  v_pk_fma_f32 v[158:159], v[78:79], v[54:55], v[158:159]
  v_pk_fma_f32 v[152:153], v[64:65], v[56:57], v[152:153]
  v_pk_fma_f32 v[154:155], v[66:67], v[58:59], v[154:155]
  v_pk_fma_f32 v[156:157], v[68:69], v[60:61], v[156:157]
  v_pk_fma_f32 v[158:159], v[70:71], v[62:63], v[158:159]
  v_pk_mul_f32 v[160:161], v[96:97], v[32:33]
  v_pk_mul_f32 v[162:163], v[98:99], v[34:35]
  v_pk_mul_f32 v[164:165], v[100:101], v[36:37]
  v_pk_mul_f32 v[166:167], v[102:103], v[38:39]
  v_pk_fma_f32 v[160:161], v[88:89], v[40:41], v[160:161]
  v_pk_fma_f32 v[162:163], v[90:91], v[42:43], v[162:163]
  v_pk_fma_f32 v[164:165], v[92:93], v[44:45], v[164:165]
  v_pk_fma_f32 v[166:167], v[94:95], v[46:47], v[166:167]
  v_pk_fma_f32 v[160:161], v[80:81], v[48:49], v[160:161]
  v_pk_fma_f32 v[162:163], v[82:83], v[50:51], v[162:163]
  v_pk_fma_f32 v[164:165], v[84:85], v[52:53], v[164:165]
  v_pk_fma_f32 v[166:167], v[86:87], v[54:55], v[166:167]
  v_pk_fma_f32 v[160:161], v[72:73], v[56:57], v[160:161]
  v_pk_fma_f32 v[162:163], v[74:75], v[58:59], v[162:163]
  v_pk_fma_f32 v[164:165], v[76:77], v[60:61], v[164:165]
  v_pk_fma_f32 v[166:167], v[78:79], v[62:63], v[166:167]
  v_pk_mul_f32 v[168:169], v[104:105], v[32:33]
  v_pk_mul_f32 v[170:171], v[106:107], v[34:35]
  v_pk_mul_f32 v[172:173], v[108:109], v[36:37]
  v_pk_mul_f32 v[174:175], v[110:111], v[38:39]
  v_pk_fma_f32 v[168:169], v[96:97], v[40:41], v[168:169]
  v_pk_fma_f32 v[170:171], v[98:99], v[42:43], v[170:171]
  v_pk_fma_f32 v[172:173], v[100:101], v[44:45], v[172:173]
  v_pk_fma_f32 v[174:175], v[102:103], v[46:47], v[174:175]
  v_pk_fma_f32 v[168:169], v[88:89], v[48:49], v[168:169]
  v_pk_fma_f32 v[170:171], v[90:91], v[50:51], v[170:171]
  v_pk_fma_f32 v[172:173], v[92:93], v[52:53], v[172:173]
  v_pk_fma_f32 v[174:175], v[94:95], v[54:55], v[174:175]
  v_pk_fma_f32 v[168:169], v[80:81], v[56:57], v[168:169]
  v_pk_fma_f32 v[170:171], v[82:83], v[58:59], v[170:171]
  v_pk_fma_f32 v[172:173], v[84:85], v[60:61], v[172:173]
  v_pk_fma_f32 v[174:175], v[86:87], v[62:63], v[174:175]
  v_pk_mul_f32 v[176:177], v[112:113], v[32:33]
  v_pk_mul_f32 v[178:179], v[114:115], v[34:35]
  v_pk_mul_f32 v[180:181], v[116:117], v[36:37]
  v_pk_mul_f32 v[182:183], v[118:119], v[38:39]
  v_pk_fma_f32 v[176:177], v[104:105], v[40:41], v[176:177]
  v_pk_fma_f32 v[178:179], v[106:107], v[42:43], v[178:179]
  v_pk_fma_f32 v[180:181], v[108:109], v[44:45], v[180:181]
  v_pk_fma_f32 v[182:183], v[110:111], v[46:47], v[182:183]
  v_pk_fma_f32 v[176:177], v[96:97], v[48:49], v[176:177]
  v_pk_fma_f32 v[178:179], v[98:99], v[50:51], v[178:179]
  v_pk_fma_f32 v[180:181], v[100:101], v[52:53], v[180:181]
  v_pk_fma_f32 v[182:183], v[102:103], v[54:55], v[182:183]
  v_pk_fma_f32 v[176:177], v[88:89], v[56:57], v[176:177]
  v_pk_fma_f32 v[178:179], v[90:91], v[58:59], v[178:179]
  v_pk_fma_f32 v[180:181], v[92:93], v[60:61], v[180:181]
  v_pk_fma_f32 v[182:183], v[94:95], v[62:63], v[182:183]
  s_waitcnt vmcnt(3)
  v_lshlrev_b32 v120, 16, v216
  v_and_b32 v121, 0xffff0000, v216
  v_lshlrev_b32 v122, 16, v217
  v_and_b32 v123, 0xffff0000, v217
  v_lshlrev_b32 v124, 16, v218
  v_and_b32 v125, 0xffff0000, v218
  v_lshlrev_b32 v126, 16, v219
  v_and_b32 v127, 0xffff0000, v219
  v_pk_mul_f32 v[152:153], v[152:153], v[120:121]
  v_pk_mul_f32 v[154:155], v[154:155], v[122:123]
  v_pk_mul_f32 v[156:157], v[156:157], v[124:125]
  v_pk_mul_f32 v[158:159], v[158:159], v[126:127]
  s_waitcnt vmcnt(2)
  v_lshlrev_b32 v128, 16, v220
  v_and_b32 v129, 0xffff0000, v220
  v_lshlrev_b32 v130, 16, v221
  v_and_b32 v131, 0xffff0000, v221
  v_lshlrev_b32 v132, 16, v222
  v_and_b32 v133, 0xffff0000, v222
  v_lshlrev_b32 v134, 16, v223
  v_and_b32 v135, 0xffff0000, v223
  v_pk_mul_f32 v[160:161], v[160:161], v[128:129]
  v_pk_mul_f32 v[162:163], v[162:163], v[130:131]
  v_pk_mul_f32 v[164:165], v[164:165], v[132:133]
  v_pk_mul_f32 v[166:167], v[166:167], v[134:135]
  s_waitcnt vmcnt(1)
  v_lshlrev_b32 v136, 16, v224
  v_and_b32 v137, 0xffff0000, v224
  v_lshlrev_b32 v138, 16, v225
  v_and_b32 v139, 0xffff0000, v225
  v_lshlrev_b32 v140, 16, v226
  v_and_b32 v141, 0xffff0000, v226
  v_lshlrev_b32 v142, 16, v227
  v_and_b32 v143, 0xffff0000, v227
  v_pk_mul_f32 v[168:169], v[168:169], v[136:137]
  v_pk_mul_f32 v[170:171], v[170:171], v[138:139]
  v_pk_mul_f32 v[172:173], v[172:173], v[140:141]
  v_pk_mul_f32 v[174:175], v[174:175], v[142:143]
  s_waitcnt vmcnt(0)
  v_lshlrev_b32 v144, 16, v228
  v_and_b32 v145, 0xffff0000, v228
  v_lshlrev_b32 v146, 16, v229
  v_and_b32 v147, 0xffff0000, v229
  v_lshlrev_b32 v148, 16, v230
  v_and_b32 v149, 0xffff0000, v230
  v_lshlrev_b32 v150, 16, v231
  v_and_b32 v151, 0xffff0000, v231
  v_pk_mul_f32 v[176:177], v[176:177], v[144:145]
  v_pk_mul_f32 v[178:179], v[178:179], v[146:147]
  v_pk_mul_f32 v[180:181], v[180:181], v[148:149]
  v_pk_mul_f32 v[182:183], v[182:183], v[150:151]
  v_cvt_pk_bf16_f32 v188, v152, v160
  v_cvt_pk_bf16_f32 v189, v168, v176
  ds_write_b64 v13, v[188:189] offset:0
  v_cvt_pk_bf16_f32 v190, v153, v161
  v_cvt_pk_bf16_f32 v191, v169, v177
  ds_write_b64 v13, v[190:191] offset:256
  v_cvt_pk_bf16_f32 v192, v154, v162
  v_cvt_pk_bf16_f32 v193, v170, v178
  ds_write_b64 v13, v[192:193] offset:512
  v_cvt_pk_bf16_f32 v194, v155, v163
  v_cvt_pk_bf16_f32 v195, v171, v179
  ds_write_b64 v13, v[194:195] offset:768
  v_cvt_pk_bf16_f32 v196, v156, v164
  v_cvt_pk_bf16_f32 v197, v172, v180
  ds_write_b64 v13, v[196:197] offset:1024
  v_cvt_pk_bf16_f32 v198, v157, v165
  v_cvt_pk_bf16_f32 v199, v173, v181
  ds_write_b64 v13, v[198:199] offset:1280
  v_cvt_pk_bf16_f32 v200, v158, v166
  v_cvt_pk_bf16_f32 v201, v174, v182
  ds_write_b64 v13, v[200:201] offset:1536
  v_cvt_pk_bf16_f32 v202, v159, v167
  v_cvt_pk_bf16_f32 v203, v175, v183
  ds_write_b64 v13, v[202:203] offset:1792
  v_mov_b32 v4, 0
  s_cmp_lg_u32 s100, 0
  s_cbranch_scc1 sd_np3
  s_mov_b32 s57, 0
sd_psp5:
  buffer_load_dword v5, v4, s[16:19], 0 offen sc1
  s_waitcnt vmcnt(0)
  v_readfirstlane_b32 s56, v5
  s_add_u32 s57, s57, 1
  s_cmp_ge_u32 s56, 128
  s_cbranch_scc1 sd_pok4
  s_cmp_ge_u32 s57, 262144
  s_cbranch_scc1 sd_pok4
  s_sleep 1
  s_branch sd_psp5
sd_pok4:
sd_np3:
  s_waitcnt lgkmcnt(0)
  s_barrier
  ds_read_b128 v[216:219], v18 offset:0
  ds_read_b128 v[220:223], v18 offset:1024
  ds_read_b128 v[224:227], v19 offset:2048
  ds_read_b128 v[228:231], v19 offset:3072
  s_waitcnt lgkmcnt(3)
  s_mov_b32 s26, 0
  buffer_store_dwordx4 v[216:219], v14, s[60:63], s26 offen sc1
  s_waitcnt lgkmcnt(2)
  s_mov_b32 s26, 16384
  buffer_store_dwordx4 v[220:223], v14, s[60:63], s26 offen sc1
  s_waitcnt lgkmcnt(1)
  s_mov_b32 s26, 32768
  buffer_store_dwordx4 v[224:227], v14, s[60:63], s26 offen sc1
  s_waitcnt lgkmcnt(0)
  s_mov_b32 s26, 49152
  buffer_store_dwordx4 v[228:231], v14, s[60:63], s26 offen sc1
  s_lshl_b32 s26, s47, 2
  s_add_u32 s26, s26, s20
  s_lshl_b32 s26, s26, 7
  s_add_u32 s26, s26, 819200
  s_waitcnt vmcnt(0)
  v_lshlrev_b32 v30, 22, v3
  v_mov_b32 v31, 1
  buffer_atomic_add v31, v30, s[12:15], s26 offen sc1
  s_barrier
  s_load_dwordx4 s[28:31], s[0:1], 32
  s_load_dwordx4 s[32:35], s[0:1], 72
  s_load_dwordx2 s[42:43], s[0:1], 104
  v_lshrrev_b32 v2, 6, v0
  v_and_b32 v3, 63, v0
  v_readfirstlane_b32 s100, v2
  s_nop 0
  s_and_b32 s20, s100, 3
  s_lshr_b32 s3, s100, 2
  s_lshl_b32 s21, s2, 3
  s_add_u32 s21, s21, s100
  s_lshl_b32 s24, s21, 12
  v_lshl_add_u32 v1, v3, 4, s24
  s_mul_i32 s26, s100, 8480
  s_lshl_b32 s24, s21, 1
  v_mov_b32 v4, s24
  v_mov_b32 v6, 0
  v_mov_b32 v5, 0
  s_waitcnt lgkmcnt(0)
  s_add_u32 s4, s42, 25165824
  s_addc_u32 s5, s43, 0
  s_mov_b32 s6, 4194304
  s_mov_b32 s7, 0x20000
  s_mov_b32 s8, s28
  s_mov_b32 s9, s29
  s_mov_b32 s10, 4194304
  s_mov_b32 s11, 0x20000
  s_mov_b32 s12, s30
  s_mov_b32 s13, s31
  s_mov_b32 s14, 2048
  s_mov_b32 s15, 0x20000
  s_add_u32 s64, s42, 33554432
  s_addc_u32 s65, s43, 0
  s_mov_b32 s66, 4194304
  s_mov_b32 s67, 0x20000
  s_add_u32 s60, s42, 29360128
  s_addc_u32 s61, s43, 0
  s_mov_b32 s62, 4194304
  s_mov_b32 s63, 0x20000
  s_add_u32 m0, s26, 4384
  s_nop 0
  buffer_load_dwordx4 v1, s[8:11], 0 offen offset:0 lds
  buffer_load_dwordx4 v1, s[8:11], 0 offen offset:1024 lds
  buffer_load_dwordx4 v1, s[8:11], 0 offen offset:2048 lds
  buffer_load_dwordx4 v1, s[8:11], 0 offen offset:3072 lds
  buffer_load_short_d16_hi v6, v4, s[12:15], 0 offen
  s_mov_b32 s16, s32
  s_mov_b32 s17, s33
  s_mov_b32 s18, 7340032
  s_mov_b32 s19, 0x20000
  s_add_u32 s52, s42, 34078720
  s_addc_u32 s53, s43, 0
  s_mov_b32 s54, 114688
  s_mov_b32 s55, 0x20000
  v_lshl_add_u32 v8, v3, 2, s26
  ds_write_b32 v8, v5
  v_and_b32 v8, 7, v3
  v_lshl_add_u32 v8, v8, 2, s26
  ds_write_b32 v8, v5 offset:4352
  s_lshl_b32 s24, s3, 7
  s_add_u32 s24, s24, s2
  s_mul_i32 s25, s24, 2341
  s_lshr_b32 s58, s25, 16
  s_mul_i32 s25, s58, 28
  s_sub_u32 s59, s24, s25
  s_lshl_b32 s24, s58, 7
  s_lshl_b32 s25, s20, 5
  s_add_u32 s24, s24, s25
  s_lshl_b32 s25, s59, 8
  v_lshrrev_b32 v8, 4, v3
  v_add_u32 v8, s24, v8
  v_mul_u32_u24 v8, 7168, v8
  v_and_b32 v9, 15, v3
  v_lshl_add_u32 v8, v9, 4, v8
  v_add_u32 v20, s25, v8
  s_lshl_b32 s27, s100, 13
  s_add_u32 s27, s27, 67840
  v_lshl_add_u32 v21, v3, 4, s27
  v_lshrrev_b32 v12, 4, v3
  v_lshlrev_b32 v12, 3, v12
  v_bfe_u32 v13, v3, 2, 2
  v_add_u32 v12, v12, v13
  v_lshlrev_b32 v12, 3, v12
  v_and_b32 v13, 3, v3
  v_lshlrev_b32 v14, 5, v13
  v_sub_u32 v14, v14, v12
  s_add_u32 s24, s26, 248
  v_add_u32 v14, s24, v14
  v_lshl_add_u32 v15, v13, 3, v12
  s_add_u32 s24, s26, 4360
  v_add_u32 v15, s24, v15
  v_lshl_add_u32 v16, v3, 1, s26
  v_lshl_add_u32 v19, v3, 4, s26
  v_cmp_lt_u32 s[44:45], 62, v3
  v_cmp_lt_u32 s[46:47], 61, v3
  v_cmp_lt_u32 s[48:49], 60, v3
  v_mov_b32 v17, 0
  v_mov_b32 v18, 0
  v_mov_b32 v44, 0
  v_mov_b32 v45, 0
  v_mov_b32 v46, 0
  v_mov_b32 v47, 0
  s_lshr_b32 s24, s21, 4
  s_lshl_b32 s24, s24, 7
  s_add_u32 s24, s24, 819200
  s_mov_b32 s57, 0
sd_psp7:
  buffer_load_dword v22, v5, s[64:67], s24 offen sc1
  s_waitcnt vmcnt(0)
  v_readfirstlane_b32 s56, v22
  s_add_u32 s57, s57, 1
  s_cmp_ge_u32 s56, 16
  s_cbranch_scc1 sd_pok6
  s_cmp_ge_u32 s57, 262144
  s_cbranch_scc1 sd_pok6
  s_sleep 1
  s_branch sd_psp7
sd_pok6:
  s_add_u32 m0, s26, 256
  s_nop 0
  buffer_load_dwordx4 v1, s[4:7], 0 offen offset:0 sc1 lds
  buffer_load_dwordx4 v1, s[4:7], 0 offen offset:1024 sc1 lds
  buffer_load_dwordx4 v1, s[4:7], 0 offen offset:2048 sc1 lds
  buffer_load_dwordx4 v1, s[4:7], 0 offen offset:3072 sc1 lds
  ds_read_b64_tr_b16 v[192:193], v15 offset:0
  ds_read_b64_tr_b16 v[194:195], v15 offset:32
  s_waitcnt vmcnt(3)
  ds_read_b64_tr_b16 v[64:65], v14 offset:32
  ds_read_b64_tr_b16 v[66:67], v14 offset:0
  ds_read_b64_tr_b16 v[68:69], v14 offset:160
  ds_read_b64_tr_b16 v[70:71], v14 offset:128
  ds_read_b64_tr_b16 v[196:197], v15 offset:256
  ds_read_b64_tr_b16 v[198:199], v15 offset:288
  ds_read_b64_tr_b16 v[72:73], v14 offset:288
  ds_read_b64_tr_b16 v[74:75], v14 offset:256
  ds_read_u16_d16_hi v17, v16 offset:256
  ds_read_u16_d16_hi v18, v16 offset:384
  ds_read_b64_tr_b16 v[76:77], v14 offset:416
  ds_read_b64_tr_b16 v[78:79], v14 offset:384
  ds_read_b64_tr_b16 v[200:201], v15 offset:512
  ds_read_b64_tr_b16 v[202:203], v15 offset:544
  s_waitcnt lgkmcnt(12)
  v_mfma_f32_16x16x32_bf16 v[32:35], v[64:67], v[192:195], 0
  ds_read_b64_tr_b16 v[80:81], v14 offset:544
  ds_read_b64_tr_b16 v[82:83], v14 offset:512
  s_waitcnt lgkmcnt(12)
  v_mfma_f32_16x16x32_bf16 v[36:39], v[68:71], v[192:195], 0
  ds_read_b64_tr_b16 v[84:85], v14 offset:672
  ds_read_b64_tr_b16 v[86:87], v14 offset:640
  ds_read_b64_tr_b16 v[204:205], v15 offset:768
  ds_read_b64_tr_b16 v[206:207], v15 offset:800
  s_nop 7
  s_waitcnt lgkmcnt(12)
  v_mfma_f32_16x16x32_bf16 v[40:43], v[72:75], v[192:195], 0
  v_cndmask_b32 v10, v35, v47, s[48:49]
  v_cndmask_b32 v9, v34, v46, s[46:47]
  v_mfma_f32_16x16x32_bf16 v[40:43], v[64:67], v[196:199], v[40:43]
  v_cndmask_b32 v8, v33, v45, s[44:45]
  v_add_f32_dpp v9, v10, v9 wave_ror:1 row_mask:0xf bank_mask:0xf
  s_waitcnt lgkmcnt(11)
  v_fma_f32 v10, v17, v6, v32
  ds_read_u16_d16_hi v17, v16 offset:512
  v_add_f32_dpp v8, v9, v8 wave_ror:1 row_mask:0xf bank_mask:0xf
  s_nop 1
  v_add_f32_dpp v10, v8, v10 wave_ror:1 row_mask:0xf bank_mask:0xf
  v_cvt_pk_bf16_f32 v10, v10, v10
  ds_write_b16 v16, v10 offset:256
  ds_read_b64_tr_b16 v[88:89], v14 offset:800
  ds_read_b64_tr_b16 v[90:91], v14 offset:768
  s_waitcnt lgkmcnt(12)
  v_mfma_f32_16x16x32_bf16 v[44:47], v[76:79], v[192:195], 0
  v_cndmask_b32 v13, v39, v35, s[48:49]
  v_cndmask_b32 v12, v38, v34, s[46:47]
  v_mfma_f32_16x16x32_bf16 v[44:47], v[68:71], v[196:199], v[44:47]
  v_cndmask_b32 v11, v37, v33, s[44:45]
  v_add_f32_dpp v12, v13, v12 wave_ror:1 row_mask:0xf bank_mask:0xf
  v_fma_f32 v13, v18, v6, v36
  ds_read_u16_d16_hi v18, v16 offset:640
  v_add_f32_dpp v11, v12, v11 wave_ror:1 row_mask:0xf bank_mask:0xf
  s_nop 1
  v_add_f32_dpp v13, v11, v13 wave_ror:1 row_mask:0xf bank_mask:0xf
  v_cvt_pk_bf16_f32 v13, v13, v13
  ds_write_b16 v16, v13 offset:384
  ds_read_b64_tr_b16 v[92:93], v14 offset:928
  ds_read_b64_tr_b16 v[94:95], v14 offset:896
  ds_read_b64_tr_b16 v[208:209], v15 offset:1024
  ds_read_b64_tr_b16 v[210:211], v15 offset:1056
  s_waitcnt lgkmcnt(14)
  v_mfma_f32_16x16x32_bf16 v[32:35], v[80:83], v[192:195], 0
  v_cndmask_b32 v10, v43, v39, s[48:49]
  v_cndmask_b32 v9, v42, v38, s[46:47]
  v_mfma_f32_16x16x32_bf16 v[32:35], v[72:75], v[196:199], v[32:35]
  v_cndmask_b32 v8, v41, v37, s[44:45]
  v_add_f32_dpp v9, v10, v9 wave_ror:1 row_mask:0xf bank_mask:0xf
  v_mfma_f32_16x16x32_bf16 v[32:35], v[64:67], v[200:203], v[32:35]
  s_waitcnt lgkmcnt(9)
  v_fma_f32 v10, v17, v6, v40
  ds_read_u16_d16_hi v17, v16 offset:768
  v_add_f32_dpp v8, v9, v8 wave_ror:1 row_mask:0xf bank_mask:0xf
  s_nop 1
  v_add_f32_dpp v10, v8, v10 wave_ror:1 row_mask:0xf bank_mask:0xf
  v_cvt_pk_bf16_f32 v10, v10, v10
  ds_write_b16 v16, v10 offset:512
  s_waitcnt vmcnt(2)
  ds_read_b64_tr_b16 v[96:97], v14 offset:1056
  ds_read_b64_tr_b16 v[98:99], v14 offset:1024
  v_mfma_f32_16x16x32_bf16 v[36:39], v[84:87], v[192:195], 0
  v_cndmask_b32 v13, v47, v43, s[48:49]
  v_cndmask_b32 v12, v46, v42, s[46:47]
  v_mfma_f32_16x16x32_bf16 v[36:39], v[76:79], v[196:199], v[36:39]
  v_cndmask_b32 v11, v45, v41, s[44:45]
  v_add_f32_dpp v12, v13, v12 wave_ror:1 row_mask:0xf bank_mask:0xf
  v_mfma_f32_16x16x32_bf16 v[36:39], v[68:71], v[200:203], v[36:39]
  s_waitcnt lgkmcnt(9)
  v_fma_f32 v13, v18, v6, v44
  ds_read_u16_d16_hi v18, v16 offset:896
  v_add_f32_dpp v11, v12, v11 wave_ror:1 row_mask:0xf bank_mask:0xf
  s_nop 1
  v_add_f32_dpp v13, v11, v13 wave_ror:1 row_mask:0xf bank_mask:0xf
  v_cvt_pk_bf16_f32 v13, v13, v13
  ds_write_b16 v16, v13 offset:640
  ds_read_b64_tr_b16 v[100:101], v14 offset:1184
  ds_read_b64_tr_b16 v[102:103], v14 offset:1152
  ds_read_b64_tr_b16 v[212:213], v15 offset:1280
  ds_read_b64_tr_b16 v[214:215], v15 offset:1312
  v_mfma_f32_16x16x32_bf16 v[40:43], v[88:91], v[192:195], 0
  v_cndmask_b32 v10, v35, v47, s[48:49]
  v_cndmask_b32 v9, v34, v46, s[46:47]
  v_mfma_f32_16x16x32_bf16 v[40:43], v[80:83], v[196:199], v[40:43]
  v_cndmask_b32 v8, v33, v45, s[44:45]
  v_add_f32_dpp v9, v10, v9 wave_ror:1 row_mask:0xf bank_mask:0xf
  v_mfma_f32_16x16x32_bf16 v[40:43], v[72:75], v[200:203], v[40:43]
  s_waitcnt lgkmcnt(9)
  v_fma_f32 v10, v17, v6, v32
  ds_read_u16_d16_hi v17, v16 offset:1024
  v_add_f32_dpp v8, v9, v8 wave_ror:1 row_mask:0xf bank_mask:0xf
  v_mfma_f32_16x16x32_bf16 v[40:43], v[64:67], v[204:207], v[40:43]
  s_nop 1
  v_add_f32_dpp v10, v8, v10 wave_ror:1 row_mask:0xf bank_mask:0xf
  v_cvt_pk_bf16_f32 v10, v10, v10
  ds_write_b16 v16, v10 offset:768
  ds_read_b64_tr_b16 v[104:105], v14 offset:1312
  ds_read_b64_tr_b16 v[106:107], v14 offset:1280
  v_mfma_f32_16x16x32_bf16 v[44:47], v[92:95], v[192:195], 0
  v_cndmask_b32 v13, v39, v35, s[48:49]
  v_cndmask_b32 v12, v38, v34, s[46:47]
  v_mfma_f32_16x16x32_bf16 v[44:47], v[84:87], v[196:199], v[44:47]
  v_cndmask_b32 v11, v37, v33, s[44:45]
  v_add_f32_dpp v12, v13, v12 wave_ror:1 row_mask:0xf bank_mask:0xf
  v_mfma_f32_16x16x32_bf16 v[44:47], v[76:79], v[200:203], v[44:47]
  s_waitcnt lgkmcnt(9)
  v_fma_f32 v13, v18, v6, v36
  ds_read_u16_d16_hi v18, v16 offset:1152
  v_add_f32_dpp v11, v12, v11 wave_ror:1 row_mask:0xf bank_mask:0xf
  v_mfma_f32_16x16x32_bf16 v[44:47], v[68:71], v[204:207], v[44:47]
  s_nop 1
  v_add_f32_dpp v13, v11, v13 wave_ror:1 row_mask:0xf bank_mask:0xf
  v_cvt_pk_bf16_f32 v13, v13, v13
  ds_write_b16 v16, v13 offset:896
  ds_read_b64_tr_b16 v[108:109], v14 offset:1440
  ds_read_b64_tr_b16 v[110:111], v14 offset:1408
  ds_read_b64_tr_b16 v[216:217], v15 offset:1536
  ds_read_b64_tr_b16 v[218:219], v15 offset:1568
  v_mfma_f32_16x16x32_bf16 v[32:35], v[96:99], v[192:195], 0
  v_cndmask_b32 v10, v43, v39, s[48:49]
  v_cndmask_b32 v9, v42, v38, s[46:47]
  v_mfma_f32_16x16x32_bf16 v[32:35], v[88:91], v[196:199], v[32:35]
  v_cndmask_b32 v8, v41, v37, s[44:45]
  v_add_f32_dpp v9, v10, v9 wave_ror:1 row_mask:0xf bank_mask:0xf
  v_mfma_f32_16x16x32_bf16 v[32:35], v[80:83], v[200:203], v[32:35]
  s_waitcnt lgkmcnt(9)
  v_fma_f32 v10, v17, v6, v40
  ds_read_u16_d16_hi v17, v16 offset:1280
  v_add_f32_dpp v8, v9, v8 wave_ror:1 row_mask:0xf bank_mask:0xf
  v_mfma_f32_16x16x32_bf16 v[32:35], v[72:75], v[204:207], v[32:35]
  s_nop 1
  v_add_f32_dpp v10, v8, v10 wave_ror:1 row_mask:0xf bank_mask:0xf
  v_mfma_f32_16x16x32_bf16 v[32:35], v[64:67], v[208:211], v[32:35]
  v_cvt_pk_bf16_f32 v10, v10, v10
  ds_write_b16 v16, v10 offset:1024
  ds_read_b64_tr_b16 v[112:113], v14 offset:1568
  ds_read_b64_tr_b16 v[114:115], v14 offset:1536
  v_mfma_f32_16x16x32_bf16 v[36:39], v[100:103], v[192:195], 0
  v_cndmask_b32 v13, v47, v43, s[48:49]
  v_cndmask_b32 v12, v46, v42, s[46:47]
  v_mfma_f32_16x16x32_bf16 v[36:39], v[92:95], v[196:199], v[36:39]
  v_cndmask_b32 v11, v45, v41, s[44:45]
  v_add_f32_dpp v12, v13, v12 wave_ror:1 row_mask:0xf bank_mask:0xf
  v_mfma_f32_16x16x32_bf16 v[36:39], v[84:87], v[200:203], v[36:39]
  s_waitcnt lgkmcnt(9)
  v_fma_f32 v13, v18, v6, v44
  ds_read_u16_d16_hi v18, v16 offset:1408
  v_add_f32_dpp v11, v12, v11 wave_ror:1 row_mask:0xf bank_mask:0xf
  v_mfma_f32_16x16x32_bf16 v[36:39], v[76:79], v[204:207], v[36:39]
  s_nop 1
  v_add_f32_dpp v13, v11, v13 wave_ror:1 row_mask:0xf bank_mask:0xf
  v_mfma_f32_16x16x32_bf16 v[36:39], v[68:71], v[208:211], v[36:39]
  v_cvt_pk_bf16_f32 v13, v13, v13
  ds_write_b16 v16, v13 offset:1152
  ds_read_b64_tr_b16 v[116:117], v14 offset:1696
  ds_read_b64_tr_b16 v[118:119], v14 offset:1664
  ds_read_b64_tr_b16 v[220:221], v15 offset:1792
  ds_read_b64_tr_b16 v[222:223], v15 offset:1824
  v_mfma_f32_16x16x32_bf16 v[40:43], v[104:107], v[192:195], 0
  v_cndmask_b32 v10, v35, v47, s[48:49]
  v_cndmask_b32 v9, v34, v46, s[46:47]
  v_mfma_f32_16x16x32_bf16 v[40:43], v[96:99], v[196:199], v[40:43]
  v_cndmask_b32 v8, v33, v45, s[44:45]
  v_add_f32_dpp v9, v10, v9 wave_ror:1 row_mask:0xf bank_mask:0xf
  v_mfma_f32_16x16x32_bf16 v[40:43], v[88:91], v[200:203], v[40:43]
  s_waitcnt lgkmcnt(9)
  v_fma_f32 v10, v17, v6, v32
  ds_read_u16_d16_hi v17, v16 offset:1536
  v_add_f32_dpp v8, v9, v8 wave_ror:1 row_mask:0xf bank_mask:0xf
  v_mfma_f32_16x16x32_bf16 v[40:43], v[80:83], v[204:207], v[40:43]
  s_nop 1
  v_add_f32_dpp v10, v8, v10 wave_ror:1 row_mask:0xf bank_mask:0xf
  v_mfma_f32_16x16x32_bf16 v[40:43], v[72:75], v[208:211], v[40:43]
  v_cvt_pk_bf16_f32 v10, v10, v10
  ds_write_b16 v16, v10 offset:1280
  v_mfma_f32_16x16x32_bf16 v[40:43], v[64:67], v[212:215], v[40:43]
  ds_read_b64_tr_b16 v[120:121], v14 offset:1824
  ds_read_b64_tr_b16 v[122:123], v14 offset:1792
  v_mfma_f32_16x16x32_bf16 v[44:47], v[108:111], v[192:195], 0
  v_cndmask_b32 v13, v39, v35, s[48:49]
  v_cndmask_b32 v12, v38, v34, s[46:47]
  v_mfma_f32_16x16x32_bf16 v[44:47], v[100:103], v[196:199], v[44:47]
  v_cndmask_b32 v11, v37, v33, s[44:45]
  v_add_f32_dpp v12, v13, v12 wave_ror:1 row_mask:0xf bank_mask:0xf
  v_mfma_f32_16x16x32_bf16 v[44:47], v[92:95], v[200:203], v[44:47]
  s_waitcnt lgkmcnt(9)
  v_fma_f32 v13, v18, v6, v36
  ds_read_u16_d16_hi v18, v16 offset:1664
  v_add_f32_dpp v11, v12, v11 wave_ror:1 row_mask:0xf bank_mask:0xf
  v_mfma_f32_16x16x32_bf16 v[44:47], v[84:87], v[204:207], v[44:47]
  s_nop 1
  v_add_f32_dpp v13, v11, v13 wave_ror:1 row_mask:0xf bank_mask:0xf
  v_mfma_f32_16x16x32_bf16 v[44:47], v[76:79], v[208:211], v[44:47]
  v_cvt_pk_bf16_f32 v13, v13, v13
  ds_write_b16 v16, v13 offset:1408
  v_mfma_f32_16x16x32_bf16 v[44:47], v[68:71], v[212:215], v[44:47]
  ds_read_b64_tr_b16 v[124:125], v14 offset:1952
  ds_read_b64_tr_b16 v[126:127], v14 offset:1920
  ds_read_b64_tr_b16 v[224:225], v15 offset:2048
  ds_read_b64_tr_b16 v[226:227], v15 offset:2080
  v_mfma_f32_16x16x32_bf16 v[32:35], v[112:115], v[192:195], 0
  v_cndmask_b32 v10, v43, v39, s[48:49]
  v_cndmask_b32 v9, v42, v38, s[46:47]
  v_mfma_f32_16x16x32_bf16 v[32:35], v[104:107], v[196:199], v[32:35]
  v_cndmask_b32 v8, v41, v37, s[44:45]
  v_add_f32_dpp v9, v10, v9 wave_ror:1 row_mask:0xf bank_mask:0xf
  v_mfma_f32_16x16x32_bf16 v[32:35], v[96:99], v[200:203], v[32:35]
  s_waitcnt lgkmcnt(9)
  v_fma_f32 v10, v17, v6, v40
  ds_read_u16_d16_hi v17, v16 offset:1792
  v_add_f32_dpp v8, v9, v8 wave_ror:1 row_mask:0xf bank_mask:0xf
  v_mfma_f32_16x16x32_bf16 v[32:35], v[88:91], v[204:207], v[32:35]
  s_nop 1
  v_add_f32_dpp v10, v8, v10 wave_ror:1 row_mask:0xf bank_mask:0xf
  v_mfma_f32_16x16x32_bf16 v[32:35], v[80:83], v[208:211], v[32:35]
  v_cvt_pk_bf16_f32 v10, v10, v10
  ds_write_b16 v16, v10 offset:1536
  v_mfma_f32_16x16x32_bf16 v[32:35], v[72:75], v[212:215], v[32:35]
  v_mfma_f32_16x16x32_bf16 v[32:35], v[64:67], v[216:219], v[32:35]
  s_waitcnt vmcnt(1)
  ds_read_b64_tr_b16 v[128:129], v14 offset:2080
  ds_read_b64_tr_b16 v[130:131], v14 offset:2048
  v_mfma_f32_16x16x32_bf16 v[36:39], v[116:119], v[192:195], 0
  v_cndmask_b32 v13, v47, v43, s[48:49]
  v_cndmask_b32 v12, v46, v42, s[46:47]
  v_mfma_f32_16x16x32_bf16 v[36:39], v[108:111], v[196:199], v[36:39]
  v_cndmask_b32 v11, v45, v41, s[44:45]
  v_add_f32_dpp v12, v13, v12 wave_ror:1 row_mask:0xf bank_mask:0xf
  v_mfma_f32_16x16x32_bf16 v[36:39], v[100:103], v[200:203], v[36:39]
  s_waitcnt lgkmcnt(9)
  v_fma_f32 v13, v18, v6, v44
  ds_read_u16_d16_hi v18, v16 offset:1920
  v_add_f32_dpp v11, v12, v11 wave_ror:1 row_mask:0xf bank_mask:0xf
  v_mfma_f32_16x16x32_bf16 v[36:39], v[92:95], v[204:207], v[36:39]
  s_nop 1
  v_add_f32_dpp v13, v11, v13 wave_ror:1 row_mask:0xf bank_mask:0xf
  v_mfma_f32_16x16x32_bf16 v[36:39], v[84:87], v[208:211], v[36:39]
  v_cvt_pk_bf16_f32 v13, v13, v13
  ds_write_b16 v16, v13 offset:1664
  v_mfma_f32_16x16x32_bf16 v[36:39], v[76:79], v[212:215], v[36:39]
  v_mfma_f32_16x16x32_bf16 v[36:39], v[68:71], v[216:219], v[36:39]
  s_add_u32 m0, s27, 0
  s_mov_b32 s24, 0
  buffer_load_dwordx4 v20, s[16:19], s24 offen lds
  ds_read_b64_tr_b16 v[132:133], v14 offset:2208
  ds_read_b64_tr_b16 v[134:135], v14 offset:2176
  ds_read_b64_tr_b16 v[228:229], v15 offset:2304
  ds_read_b64_tr_b16 v[230:231], v15 offset:2336
  v_mfma_f32_16x16x32_bf16 v[40:43], v[120:123], v[192:195], 0
  v_cndmask_b32 v10, v35, v47, s[48:49]
  v_cndmask_b32 v9, v34, v46, s[46:47]
  v_mfma_f32_16x16x32_bf16 v[40:43], v[112:115], v[196:199], v[40:43]
  v_cndmask_b32 v8, v33, v45, s[44:45]
  v_add_f32_dpp v9, v10, v9 wave_ror:1 row_mask:0xf bank_mask:0xf
  v_mfma_f32_16x16x32_bf16 v[40:43], v[104:107], v[200:203], v[40:43]
  s_waitcnt lgkmcnt(9)
  v_fma_f32 v10, v17, v6, v32
  ds_read_u16_d16_hi v17, v16 offset:2048
  v_add_f32_dpp v8, v9, v8 wave_ror:1 row_mask:0xf bank_mask:0xf
  v_mfma_f32_16x16x32_bf16 v[40:43], v[96:99], v[204:207], v[40:43]
  s_nop 1
  v_add_f32_dpp v10, v8, v10 wave_ror:1 row_mask:0xf bank_mask:0xf
  v_mfma_f32_16x16x32_bf16 v[40:43], v[88:91], v[208:211], v[40:43]
  v_cvt_pk_bf16_f32 v10, v10, v10
  ds_write_b16 v16, v10 offset:1792
  v_mfma_f32_16x16x32_bf16 v[40:43], v[80:83], v[212:215], v[40:43]
  v_mfma_f32_16x16x32_bf16 v[40:43], v[72:75], v[216:219], v[40:43]
  v_mfma_f32_16x16x32_bf16 v[40:43], v[64:67], v[220:223], v[40:43]
  s_add_u32 m0, s27, 1024
  s_mov_b32 s24, 28672
  buffer_load_dwordx4 v20, s[16:19], s24 offen lds
  ds_read_b64_tr_b16 v[136:137], v14 offset:2336
  ds_read_b64_tr_b16 v[138:139], v14 offset:2304
  v_mfma_f32_16x16x32_bf16 v[44:47], v[124:127], v[192:195], 0
  v_cndmask_b32 v13, v39, v35, s[48:49]
  v_cndmask_b32 v12, v38, v34, s[46:47]
  v_mfma_f32_16x16x32_bf16 v[44:47], v[116:119], v[196:199], v[44:47]
  v_cndmask_b32 v11, v37, v33, s[44:45]
  v_add_f32_dpp v12, v13, v12 wave_ror:1 row_mask:0xf bank_mask:0xf
  v_mfma_f32_16x16x32_bf16 v[44:47], v[108:111], v[200:203], v[44:47]
  s_waitcnt lgkmcnt(9)
  v_fma_f32 v13, v18, v6, v36
  ds_read_u16_d16_hi v18, v16 offset:2176
  v_add_f32_dpp v11, v12, v11 wave_ror:1 row_mask:0xf bank_mask:0xf
  v_mfma_f32_16x16x32_bf16 v[44:47], v[100:103], v[204:207], v[44:47]
  s_nop 1
  v_add_f32_dpp v13, v11, v13 wave_ror:1 row_mask:0xf bank_mask:0xf
  v_mfma_f32_16x16x32_bf16 v[44:47], v[92:95], v[208:211], v[44:47]
  v_cvt_pk_bf16_f32 v13, v13, v13
  ds_write_b16 v16, v13 offset:1920
  v_mfma_f32_16x16x32_bf16 v[44:47], v[84:87], v[212:215], v[44:47]
  v_mfma_f32_16x16x32_bf16 v[44:47], v[76:79], v[216:219], v[44:47]
  v_mfma_f32_16x16x32_bf16 v[44:47], v[68:71], v[220:223], v[44:47]
  s_add_u32 m0, s27, 2048
  s_mov_b32 s24, 57344
  buffer_load_dwordx4 v20, s[16:19], s24 offen lds
  ds_read_b64_tr_b16 v[140:141], v14 offset:2464
  ds_read_b64_tr_b16 v[142:143], v14 offset:2432
  ds_read_b64_tr_b16 v[232:233], v15 offset:2560
  ds_read_b64_tr_b16 v[234:235], v15 offset:2592
  v_mfma_f32_16x16x32_bf16 v[32:35], v[128:131], v[192:195], 0
  v_cndmask_b32 v10, v43, v39, s[48:49]
  v_cndmask_b32 v9, v42, v38, s[46:47]
  v_mfma_f32_16x16x32_bf16 v[32:35], v[120:123], v[196:199], v[32:35]
  v_cndmask_b32 v8, v41, v37, s[44:45]
  v_add_f32_dpp v9, v10, v9 wave_ror:1 row_mask:0xf bank_mask:0xf
  v_mfma_f32_16x16x32_bf16 v[32:35], v[112:115], v[200:203], v[32:35]
  s_waitcnt lgkmcnt(9)
  v_fma_f32 v10, v17, v6, v40
  ds_read_u16_d16_hi v17, v16 offset:2304
  v_add_f32_dpp v8, v9, v8 wave_ror:1 row_mask:0xf bank_mask:0xf
  v_mfma_f32_16x16x32_bf16 v[32:35], v[104:107], v[204:207], v[32:35]
  s_nop 1
  v_add_f32_dpp v10, v8, v10 wave_ror:1 row_mask:0xf bank_mask:0xf
  v_mfma_f32_16x16x32_bf16 v[32:35], v[96:99], v[208:211], v[32:35]
  v_cvt_pk_bf16_f32 v10, v10, v10
  ds_write_b16 v16, v10 offset:2048
  v_mfma_f32_16x16x32_bf16 v[32:35], v[88:91], v[212:215], v[32:35]
  v_mfma_f32_16x16x32_bf16 v[32:35], v[80:83], v[216:219], v[32:35]
  v_mfma_f32_16x16x32_bf16 v[32:35], v[72:75], v[220:223], v[32:35]
  v_mfma_f32_16x16x32_bf16 v[32:35], v[64:67], v[224:227], v[32:35]
  s_add_u32 m0, s27, 3072
  s_mov_b32 s24, 86016
  buffer_load_dwordx4 v20, s[16:19], s24 offen lds
  ds_read_b64_tr_b16 v[144:145], v14 offset:2592
  ds_read_b64_tr_b16 v[146:147], v14 offset:2560
  v_mfma_f32_16x16x32_bf16 v[36:39], v[132:135], v[192:195], 0
  v_cndmask_b32 v13, v47, v43, s[48:49]
  v_cndmask_b32 v12, v46, v42, s[46:47]
  v_mfma_f32_16x16x32_bf16 v[36:39], v[124:127], v[196:199], v[36:39]
  v_cndmask_b32 v11, v45, v41, s[44:45]
  v_add_f32_dpp v12, v13, v12 wave_ror:1 row_mask:0xf bank_mask:0xf
  v_mfma_f32_16x16x32_bf16 v[36:39], v[116:119], v[200:203], v[36:39]
  s_waitcnt lgkmcnt(9)
  v_fma_f32 v13, v18, v6, v44
  ds_read_u16_d16_hi v18, v16 offset:2432
  v_add_f32_dpp v11, v12, v11 wave_ror:1 row_mask:0xf bank_mask:0xf
  v_mfma_f32_16x16x32_bf16 v[36:39], v[108:111], v[204:207], v[36:39]
  s_nop 1
  v_add_f32_dpp v13, v11, v13 wave_ror:1 row_mask:0xf bank_mask:0xf
  v_mfma_f32_16x16x32_bf16 v[36:39], v[100:103], v[208:211], v[36:39]
  v_cvt_pk_bf16_f32 v13, v13, v13
  ds_write_b16 v16, v13 offset:2176
  v_mfma_f32_16x16x32_bf16 v[36:39], v[92:95], v[212:215], v[36:39]
  v_mfma_f32_16x16x32_bf16 v[36:39], v[84:87], v[216:219], v[36:39]
  v_mfma_f32_16x16x32_bf16 v[36:39], v[76:79], v[220:223], v[36:39]
  v_mfma_f32_16x16x32_bf16 v[36:39], v[68:71], v[224:227], v[36:39]
  s_add_u32 m0, s27, 4096
  s_mov_b32 s24, 114688
  buffer_load_dwordx4 v20, s[16:19], s24 offen lds
  ds_read_b64_tr_b16 v[148:149], v14 offset:2720
  ds_read_b64_tr_b16 v[150:151], v14 offset:2688
  ds_read_b64_tr_b16 v[236:237], v15 offset:2816
  ds_read_b64_tr_b16 v[238:239], v15 offset:2848
  v_mfma_f32_16x16x32_bf16 v[40:43], v[136:139], v[192:195], 0
  v_cndmask_b32 v10, v35, v47, s[48:49]
  v_mfma_f32_16x16x32_bf16 v[40:43], v[128:131], v[196:199], v[40:43]
  v_cndmask_b32 v9, v34, v46, s[46:47]
  v_mfma_f32_16x16x32_bf16 v[40:43], v[120:123], v[200:203], v[40:43]
  v_cndmask_b32 v8, v33, v45, s[44:45]
  v_mfma_f32_16x16x32_bf16 v[40:43], v[112:115], v[204:207], v[40:43]
  v_add_f32_dpp v9, v10, v9 wave_ror:1 row_mask:0xf bank_mask:0xf
  v_mfma_f32_16x16x32_bf16 v[40:43], v[104:107], v[208:211], v[40:43]
  s_waitcnt lgkmcnt(9)
  v_fma_f32 v10, v17, v6, v32
  ds_read_u16_d16_hi v17, v16 offset:2560
  v_mfma_f32_16x16x32_bf16 v[40:43], v[96:99], v[212:215], v[40:43]
  v_add_f32_dpp v8, v9, v8 wave_ror:1 row_mask:0xf bank_mask:0xf
  v_mfma_f32_16x16x32_bf16 v[40:43], v[88:91], v[216:219], v[40:43]
  s_nop 1
  v_mfma_f32_16x16x32_bf16 v[40:43], v[80:83], v[220:223], v[40:43]
  v_add_f32_dpp v10, v8, v10 wave_ror:1 row_mask:0xf bank_mask:0xf
  v_mfma_f32_16x16x32_bf16 v[40:43], v[72:75], v[224:227], v[40:43]
  v_cvt_pk_bf16_f32 v10, v10, v10
  v_mfma_f32_16x16x32_bf16 v[40:43], v[64:67], v[228:231], v[40:43]
  ds_write_b16 v16, v10 offset:2304
  s_add_u32 m0, s27, 5120
  s_mov_b32 s24, 143360
  buffer_load_dwordx4 v20, s[16:19], s24 offen lds
  ds_read_b64_tr_b16 v[152:153], v14 offset:2848
  ds_read_b64_tr_b16 v[154:155], v14 offset:2816
  v_mfma_f32_16x16x32_bf16 v[44:47], v[140:143], v[192:195], 0
  v_cndmask_b32 v13, v39, v35, s[48:49]
  v_mfma_f32_16x16x32_bf16 v[44:47], v[132:135], v[196:199], v[44:47]
  v_cndmask_b32 v12, v38, v34, s[46:47]
  v_mfma_f32_16x16x32_bf16 v[44:47], v[124:127], v[200:203], v[44:47]
  v_cndmask_b32 v11, v37, v33, s[44:45]
  v_mfma_f32_16x16x32_bf16 v[44:47], v[116:119], v[204:207], v[44:47]
  v_add_f32_dpp v12, v13, v12 wave_ror:1 row_mask:0xf bank_mask:0xf
  v_mfma_f32_16x16x32_bf16 v[44:47], v[108:111], v[208:211], v[44:47]
  s_waitcnt lgkmcnt(9)
  v_fma_f32 v13, v18, v6, v36
  ds_read_u16_d16_hi v18, v16 offset:2688
  v_mfma_f32_16x16x32_bf16 v[44:47], v[100:103], v[212:215], v[44:47]
  v_add_f32_dpp v11, v12, v11 wave_ror:1 row_mask:0xf bank_mask:0xf
  v_mfma_f32_16x16x32_bf16 v[44:47], v[92:95], v[216:219], v[44:47]
  s_nop 1
  v_mfma_f32_16x16x32_bf16 v[44:47], v[84:87], v[220:223], v[44:47]
  v_add_f32_dpp v13, v11, v13 wave_ror:1 row_mask:0xf bank_mask:0xf
  v_mfma_f32_16x16x32_bf16 v[44:47], v[76:79], v[224:227], v[44:47]
  v_cvt_pk_bf16_f32 v13, v13, v13
  v_mfma_f32_16x16x32_bf16 v[44:47], v[68:71], v[228:231], v[44:47]
  ds_write_b16 v16, v13 offset:2432
  s_add_u32 m0, s27, 6144
  s_mov_b32 s24, 172032
  buffer_load_dwordx4 v20, s[16:19], s24 offen lds
  ds_read_b64_tr_b16 v[156:157], v14 offset:2976
  ds_read_b64_tr_b16 v[158:159], v14 offset:2944
  ds_read_b64_tr_b16 v[240:241], v15 offset:3072
  ds_read_b64_tr_b16 v[242:243], v15 offset:3104
  v_mfma_f32_16x16x32_bf16 v[32:35], v[144:147], v[192:195], 0
  v_cndmask_b32 v10, v43, v39, s[48:49]
  v_mfma_f32_16x16x32_bf16 v[32:35], v[136:139], v[196:199], v[32:35]
  v_cndmask_b32 v9, v42, v38, s[46:47]
  v_mfma_f32_16x16x32_bf16 v[32:35], v[128:131], v[200:203], v[32:35]
  v_cndmask_b32 v8, v41, v37, s[44:45]
  v_mfma_f32_16x16x32_bf16 v[32:35], v[120:123], v[204:207], v[32:35]
  v_add_f32_dpp v9, v10, v9 wave_ror:1 row_mask:0xf bank_mask:0xf
  v_mfma_f32_16x16x32_bf16 v[32:35], v[112:115], v[208:211], v[32:35]
  s_waitcnt lgkmcnt(9)
  v_fma_f32 v10, v17, v6, v40
  ds_read_u16_d16_hi v17, v16 offset:2816
  v_mfma_f32_16x16x32_bf16 v[32:35], v[104:107], v[212:215], v[32:35]
  v_add_f32_dpp v8, v9, v8 wave_ror:1 row_mask:0xf bank_mask:0xf
  v_mfma_f32_16x16x32_bf16 v[32:35], v[96:99], v[216:219], v[32:35]
  s_nop 1
  v_mfma_f32_16x16x32_bf16 v[32:35], v[88:91], v[220:223], v[32:35]
  v_add_f32_dpp v10, v8, v10 wave_ror:1 row_mask:0xf bank_mask:0xf
  v_mfma_f32_16x16x32_bf16 v[32:35], v[80:83], v[224:227], v[32:35]
  v_cvt_pk_bf16_f32 v10, v10, v10
  v_mfma_f32_16x16x32_bf16 v[32:35], v[72:75], v[228:231], v[32:35]
  ds_write_b16 v16, v10 offset:2560
  v_mfma_f32_16x16x32_bf16 v[32:35], v[64:67], v[232:235], v[32:35]
  s_add_u32 m0, s27, 7168
  s_mov_b32 s24, 200704
  buffer_load_dwordx4 v20, s[16:19], s24 offen lds
  s_waitcnt vmcnt(8)
  ds_read_b64_tr_b16 v[160:161], v14 offset:3104
  ds_read_b64_tr_b16 v[162:163], v14 offset:3072
  v_mfma_f32_16x16x32_bf16 v[36:39], v[148:151], v[192:195], 0
  v_cndmask_b32 v13, v47, v43, s[48:49]
  v_mfma_f32_16x16x32_bf16 v[36:39], v[140:143], v[196:199], v[36:39]
  v_cndmask_b32 v12, v46, v42, s[46:47]
  v_mfma_f32_16x16x32_bf16 v[36:39], v[132:135], v[200:203], v[36:39]
  v_cndmask_b32 v11, v45, v41, s[44:45]
  v_mfma_f32_16x16x32_bf16 v[36:39], v[124:127], v[204:207], v[36:39]
  v_add_f32_dpp v12, v13, v12 wave_ror:1 row_mask:0xf bank_mask:0xf
  v_mfma_f32_16x16x32_bf16 v[36:39], v[116:119], v[208:211], v[36:39]
  s_waitcnt lgkmcnt(9)
  v_fma_f32 v13, v18, v6, v44
  ds_read_u16_d16_hi v18, v16 offset:2944
  v_mfma_f32_16x16x32_bf16 v[36:39], v[108:111], v[212:215], v[36:39]
  v_add_f32_dpp v11, v12, v11 wave_ror:1 row_mask:0xf bank_mask:0xf
  v_mfma_f32_16x16x32_bf16 v[36:39], v[100:103], v[216:219], v[36:39]
  s_nop 1
  v_mfma_f32_16x16x32_bf16 v[36:39], v[92:95], v[220:223], v[36:39]
  v_add_f32_dpp v13, v11, v13 wave_ror:1 row_mask:0xf bank_mask:0xf
  v_mfma_f32_16x16x32_bf16 v[36:39], v[84:87], v[224:227], v[36:39]
  v_cvt_pk_bf16_f32 v13, v13, v13
  v_mfma_f32_16x16x32_bf16 v[36:39], v[76:79], v[228:231], v[36:39]
  ds_write_b16 v16, v13 offset:2688
  v_mfma_f32_16x16x32_bf16 v[36:39], v[68:71], v[232:235], v[36:39]
  ds_read_b64_tr_b16 v[164:165], v14 offset:3232
  ds_read_b64_tr_b16 v[166:167], v14 offset:3200
  ds_read_b64_tr_b16 v[244:245], v15 offset:3328
  ds_read_b64_tr_b16 v[246:247], v15 offset:3360
  v_mfma_f32_16x16x32_bf16 v[40:43], v[152:155], v[192:195], 0
  v_cndmask_b32 v10, v35, v47, s[48:49]
  v_mfma_f32_16x16x32_bf16 v[40:43], v[144:147], v[196:199], v[40:43]
  v_cndmask_b32 v9, v34, v46, s[46:47]
  v_mfma_f32_16x16x32_bf16 v[40:43], v[136:139], v[200:203], v[40:43]
  v_cndmask_b32 v8, v33, v45, s[44:45]
  v_mfma_f32_16x16x32_bf16 v[40:43], v[128:131], v[204:207], v[40:43]
  v_add_f32_dpp v9, v10, v9 wave_ror:1 row_mask:0xf bank_mask:0xf
  v_mfma_f32_16x16x32_bf16 v[40:43], v[120:123], v[208:211], v[40:43]
  s_waitcnt lgkmcnt(9)
  v_fma_f32 v10, v17, v6, v32
  ds_read_u16_d16_hi v17, v16 offset:3072
  v_mfma_f32_16x16x32_bf16 v[40:43], v[112:115], v[212:215], v[40:43]
  v_add_f32_dpp v8, v9, v8 wave_ror:1 row_mask:0xf bank_mask:0xf
  v_mfma_f32_16x16x32_bf16 v[40:43], v[104:107], v[216:219], v[40:43]
  s_nop 1
  v_mfma_f32_16x16x32_bf16 v[40:43], v[96:99], v[220:223], v[40:43]
  v_add_f32_dpp v10, v8, v10 wave_ror:1 row_mask:0xf bank_mask:0xf
  v_mfma_f32_16x16x32_bf16 v[40:43], v[88:91], v[224:227], v[40:43]
  v_cvt_pk_bf16_f32 v10, v10, v10
  v_mfma_f32_16x16x32_bf16 v[40:43], v[80:83], v[228:231], v[40:43]
  ds_write_b16 v16, v10 offset:2816
  v_mfma_f32_16x16x32_bf16 v[40:43], v[72:75], v[232:235], v[40:43]
  v_mfma_f32_16x16x32_bf16 v[40:43], v[64:67], v[236:239], v[40:43]
  ds_read_b64_tr_b16 v[168:169], v14 offset:3360
  ds_read_b64_tr_b16 v[170:171], v14 offset:3328
  v_mfma_f32_16x16x32_bf16 v[44:47], v[156:159], v[192:195], 0
  v_cndmask_b32 v13, v39, v35, s[48:49]
  v_mfma_f32_16x16x32_bf16 v[44:47], v[148:151], v[196:199], v[44:47]
  v_cndmask_b32 v12, v38, v34, s[46:47]
  v_mfma_f32_16x16x32_bf16 v[44:47], v[140:143], v[200:203], v[44:47]
  v_cndmask_b32 v11, v37, v33, s[44:45]
  v_mfma_f32_16x16x32_bf16 v[44:47], v[132:135], v[204:207], v[44:47]
  v_add_f32_dpp v12, v13, v12 wave_ror:1 row_mask:0xf bank_mask:0xf
  v_mfma_f32_16x16x32_bf16 v[44:47], v[124:127], v[208:211], v[44:47]
  s_waitcnt lgkmcnt(9)
  v_fma_f32 v13, v18, v6, v36
  ds_read_u16_d16_hi v18, v16 offset:3200
  v_mfma_f32_16x16x32_bf16 v[44:47], v[116:119], v[212:215], v[44:47]
  v_add_f32_dpp v11, v12, v11 wave_ror:1 row_mask:0xf bank_mask:0xf
  v_mfma_f32_16x16x32_bf16 v[44:47], v[108:111], v[216:219], v[44:47]
  s_nop 1
  v_mfma_f32_16x16x32_bf16 v[44:47], v[100:103], v[220:223], v[44:47]
  v_add_f32_dpp v13, v11, v13 wave_ror:1 row_mask:0xf bank_mask:0xf
  v_mfma_f32_16x16x32_bf16 v[44:47], v[92:95], v[224:227], v[44:47]
  v_cvt_pk_bf16_f32 v13, v13, v13
  v_mfma_f32_16x16x32_bf16 v[44:47], v[84:87], v[228:231], v[44:47]
  ds_write_b16 v16, v13 offset:2944
  v_mfma_f32_16x16x32_bf16 v[44:47], v[76:79], v[232:235], v[44:47]
  v_mfma_f32_16x16x32_bf16 v[44:47], v[68:71], v[236:239], v[44:47]
  ds_read_b64_tr_b16 v[172:173], v14 offset:3488
  ds_read_b64_tr_b16 v[174:175], v14 offset:3456
  ds_read_b64_tr_b16 v[248:249], v15 offset:3584
  ds_read_b64_tr_b16 v[250:251], v15 offset:3616
  v_mfma_f32_16x16x32_bf16 v[32:35], v[160:163], v[192:195], 0
  v_cndmask_b32 v10, v43, v39, s[48:49]
  v_mfma_f32_16x16x32_bf16 v[32:35], v[152:155], v[196:199], v[32:35]
  v_cndmask_b32 v9, v42, v38, s[46:47]
  v_mfma_f32_16x16x32_bf16 v[32:35], v[144:147], v[200:203], v[32:35]
  v_cndmask_b32 v8, v41, v37, s[44:45]
  v_mfma_f32_16x16x32_bf16 v[32:35], v[136:139], v[204:207], v[32:35]
  v_add_f32_dpp v9, v10, v9 wave_ror:1 row_mask:0xf bank_mask:0xf
  v_mfma_f32_16x16x32_bf16 v[32:35], v[128:131], v[208:211], v[32:35]
  s_waitcnt lgkmcnt(9)
  v_fma_f32 v10, v17, v6, v40
  ds_read_u16_d16_hi v17, v16 offset:3328
  v_mfma_f32_16x16x32_bf16 v[32:35], v[120:123], v[212:215], v[32:35]
  v_add_f32_dpp v8, v9, v8 wave_ror:1 row_mask:0xf bank_mask:0xf
  v_mfma_f32_16x16x32_bf16 v[32:35], v[112:115], v[216:219], v[32:35]
  s_nop 1
  v_mfma_f32_16x16x32_bf16 v[32:35], v[104:107], v[220:223], v[32:35]
  v_add_f32_dpp v10, v8, v10 wave_ror:1 row_mask:0xf bank_mask:0xf
  v_mfma_f32_16x16x32_bf16 v[32:35], v[96:99], v[224:227], v[32:35]
  v_cvt_pk_bf16_f32 v10, v10, v10
  v_mfma_f32_16x16x32_bf16 v[32:35], v[88:91], v[228:231], v[32:35]
  ds_write_b16 v16, v10 offset:3072
  v_mfma_f32_16x16x32_bf16 v[32:35], v[80:83], v[232:235], v[32:35]
  v_mfma_f32_16x16x32_bf16 v[32:35], v[72:75], v[236:239], v[32:35]
  v_mfma_f32_16x16x32_bf16 v[32:35], v[64:67], v[240:243], v[32:35]
  ds_read_b64_tr_b16 v[176:177], v14 offset:3616
  ds_read_b64_tr_b16 v[178:179], v14 offset:3584
  v_mfma_f32_16x16x32_bf16 v[36:39], v[164:167], v[192:195], 0
  v_cndmask_b32 v13, v47, v43, s[48:49]
  v_mfma_f32_16x16x32_bf16 v[36:39], v[156:159], v[196:199], v[36:39]
  v_cndmask_b32 v12, v46, v42, s[46:47]
  v_mfma_f32_16x16x32_bf16 v[36:39], v[148:151], v[200:203], v[36:39]
  v_cndmask_b32 v11, v45, v41, s[44:45]
  v_mfma_f32_16x16x32_bf16 v[36:39], v[140:143], v[204:207], v[36:39]
  v_add_f32_dpp v12, v13, v12 wave_ror:1 row_mask:0xf bank_mask:0xf
  v_mfma_f32_16x16x32_bf16 v[36:39], v[132:135], v[208:211], v[36:39]
  s_waitcnt lgkmcnt(9)
  v_fma_f32 v13, v18, v6, v44
  ds_read_u16_d16_hi v18, v16 offset:3456
  v_mfma_f32_16x16x32_bf16 v[36:39], v[124:127], v[212:215], v[36:39]
  v_add_f32_dpp v11, v12, v11 wave_ror:1 row_mask:0xf bank_mask:0xf
  v_mfma_f32_16x16x32_bf16 v[36:39], v[116:119], v[216:219], v[36:39]
  s_nop 1
  v_mfma_f32_16x16x32_bf16 v[36:39], v[108:111], v[220:223], v[36:39]
  v_add_f32_dpp v13, v11, v13 wave_ror:1 row_mask:0xf bank_mask:0xf
  v_mfma_f32_16x16x32_bf16 v[36:39], v[100:103], v[224:227], v[36:39]
  v_cvt_pk_bf16_f32 v13, v13, v13
  v_mfma_f32_16x16x32_bf16 v[36:39], v[92:95], v[228:231], v[36:39]
  ds_write_b16 v16, v13 offset:3200
  v_mfma_f32_16x16x32_bf16 v[36:39], v[84:87], v[232:235], v[36:39]
  v_mfma_f32_16x16x32_bf16 v[36:39], v[76:79], v[236:239], v[36:39]
  v_mfma_f32_16x16x32_bf16 v[36:39], v[68:71], v[240:243], v[36:39]
  ds_read_b64_tr_b16 v[180:181], v14 offset:3744
  ds_read_b64_tr_b16 v[182:183], v14 offset:3712
  ds_read_b64_tr_b16 v[252:253], v15 offset:3840
  ds_read_b64_tr_b16 v[254:255], v15 offset:3872
  v_mfma_f32_16x16x32_bf16 v[40:43], v[168:171], v[192:195], 0
  v_cndmask_b32 v10, v35, v47, s[48:49]
  v_mfma_f32_16x16x32_bf16 v[40:43], v[160:163], v[196:199], v[40:43]
  v_cndmask_b32 v9, v34, v46, s[46:47]
  v_mfma_f32_16x16x32_bf16 v[40:43], v[152:155], v[200:203], v[40:43]
  v_cndmask_b32 v8, v33, v45, s[44:45]
  v_mfma_f32_16x16x32_bf16 v[40:43], v[144:147], v[204:207], v[40:43]
  v_add_f32_dpp v9, v10, v9 wave_ror:1 row_mask:0xf bank_mask:0xf
  v_mfma_f32_16x16x32_bf16 v[40:43], v[136:139], v[208:211], v[40:43]
  s_waitcnt lgkmcnt(9)
  v_fma_f32 v10, v17, v6, v32
  ds_read_u16_d16_hi v17, v16 offset:3584
  v_mfma_f32_16x16x32_bf16 v[40:43], v[128:131], v[212:215], v[40:43]
  v_add_f32_dpp v8, v9, v8 wave_ror:1 row_mask:0xf bank_mask:0xf
  v_mfma_f32_16x16x32_bf16 v[40:43], v[120:123], v[216:219], v[40:43]
  s_nop 1
  v_mfma_f32_16x16x32_bf16 v[40:43], v[112:115], v[220:223], v[40:43]
  v_add_f32_dpp v10, v8, v10 wave_ror:1 row_mask:0xf bank_mask:0xf
  v_mfma_f32_16x16x32_bf16 v[40:43], v[104:107], v[224:227], v[40:43]
  v_cvt_pk_bf16_f32 v10, v10, v10
  v_mfma_f32_16x16x32_bf16 v[40:43], v[96:99], v[228:231], v[40:43]
  ds_write_b16 v16, v10 offset:3328
  v_mfma_f32_16x16x32_bf16 v[40:43], v[88:91], v[232:235], v[40:43]
  v_mfma_f32_16x16x32_bf16 v[40:43], v[80:83], v[236:239], v[40:43]
  v_mfma_f32_16x16x32_bf16 v[40:43], v[72:75], v[240:243], v[40:43]
  v_mfma_f32_16x16x32_bf16 v[40:43], v[64:67], v[244:247], v[40:43]
  ds_read_b64_tr_b16 v[184:185], v14 offset:3872
  ds_read_b64_tr_b16 v[186:187], v14 offset:3840
  v_mfma_f32_16x16x32_bf16 v[44:47], v[172:175], v[192:195], 0
  v_cndmask_b32 v13, v39, v35, s[48:49]
  v_mfma_f32_16x16x32_bf16 v[44:47], v[164:167], v[196:199], v[44:47]
  v_cndmask_b32 v12, v38, v34, s[46:47]
  v_mfma_f32_16x16x32_bf16 v[44:47], v[156:159], v[200:203], v[44:47]
  v_cndmask_b32 v11, v37, v33, s[44:45]
  v_mfma_f32_16x16x32_bf16 v[44:47], v[148:151], v[204:207], v[44:47]
  v_add_f32_dpp v12, v13, v12 wave_ror:1 row_mask:0xf bank_mask:0xf
  v_mfma_f32_16x16x32_bf16 v[44:47], v[140:143], v[208:211], v[44:47]
  s_waitcnt lgkmcnt(9)
  v_fma_f32 v13, v18, v6, v36
  ds_read_u16_d16_hi v18, v16 offset:3712
  v_mfma_f32_16x16x32_bf16 v[44:47], v[132:135], v[212:215], v[44:47]
  v_add_f32_dpp v11, v12, v11 wave_ror:1 row_mask:0xf bank_mask:0xf
  v_mfma_f32_16x16x32_bf16 v[44:47], v[124:127], v[216:219], v[44:47]
  s_nop 1
  v_mfma_f32_16x16x32_bf16 v[44:47], v[116:119], v[220:223], v[44:47]
  v_add_f32_dpp v13, v11, v13 wave_ror:1 row_mask:0xf bank_mask:0xf
  v_mfma_f32_16x16x32_bf16 v[44:47], v[108:111], v[224:227], v[44:47]
  v_cvt_pk_bf16_f32 v13, v13, v13
  v_mfma_f32_16x16x32_bf16 v[44:47], v[100:103], v[228:231], v[44:47]
  ds_write_b16 v16, v13 offset:3456
  v_mfma_f32_16x16x32_bf16 v[44:47], v[92:95], v[232:235], v[44:47]
  v_mfma_f32_16x16x32_bf16 v[44:47], v[84:87], v[236:239], v[44:47]
  v_mfma_f32_16x16x32_bf16 v[44:47], v[76:79], v[240:243], v[44:47]
  v_mfma_f32_16x16x32_bf16 v[44:47], v[68:71], v[244:247], v[44:47]
  ds_read_b64_tr_b16 v[188:189], v14 offset:4000
  ds_read_b64_tr_b16 v[190:191], v14 offset:3968
  v_mfma_f32_16x16x32_bf16 v[32:35], v[176:179], v[192:195], 0
  v_cndmask_b32 v10, v43, v39, s[48:49]
  v_mfma_f32_16x16x32_bf16 v[32:35], v[168:171], v[196:199], v[32:35]
  v_cndmask_b32 v9, v42, v38, s[46:47]
  v_mfma_f32_16x16x32_bf16 v[32:35], v[160:163], v[200:203], v[32:35]
  v_cndmask_b32 v8, v41, v37, s[44:45]
  v_mfma_f32_16x16x32_bf16 v[32:35], v[152:155], v[204:207], v[32:35]
  v_add_f32_dpp v9, v10, v9 wave_ror:1 row_mask:0xf bank_mask:0xf
  v_mfma_f32_16x16x32_bf16 v[32:35], v[144:147], v[208:211], v[32:35]
  s_waitcnt lgkmcnt(7)
  v_fma_f32 v10, v17, v6, v40
  ds_read_u16_d16_hi v17, v16 offset:3840
  v_mfma_f32_16x16x32_bf16 v[32:35], v[136:139], v[212:215], v[32:35]
  v_add_f32_dpp v8, v9, v8 wave_ror:1 row_mask:0xf bank_mask:0xf
  v_mfma_f32_16x16x32_bf16 v[32:35], v[128:131], v[216:219], v[32:35]
  s_nop 1
  v_mfma_f32_16x16x32_bf16 v[32:35], v[120:123], v[220:223], v[32:35]
  v_add_f32_dpp v10, v8, v10 wave_ror:1 row_mask:0xf bank_mask:0xf
  v_mfma_f32_16x16x32_bf16 v[32:35], v[112:115], v[224:227], v[32:35]
  v_cvt_pk_bf16_f32 v10, v10, v10
  v_mfma_f32_16x16x32_bf16 v[32:35], v[104:107], v[228:231], v[32:35]
  ds_write_b16 v16, v10 offset:3584
  v_mfma_f32_16x16x32_bf16 v[32:35], v[96:99], v[232:235], v[32:35]
  v_mfma_f32_16x16x32_bf16 v[32:35], v[88:91], v[236:239], v[32:35]
  v_mfma_f32_16x16x32_bf16 v[32:35], v[80:83], v[240:243], v[32:35]
  v_mfma_f32_16x16x32_bf16 v[32:35], v[72:75], v[244:247], v[32:35]
  v_mfma_f32_16x16x32_bf16 v[32:35], v[64:67], v[248:251], v[32:35]
  v_mfma_f32_16x16x32_bf16 v[36:39], v[180:183], v[192:195], 0
  v_cndmask_b32 v13, v47, v43, s[48:49]
  v_mfma_f32_16x16x32_bf16 v[36:39], v[172:175], v[196:199], v[36:39]
  v_cndmask_b32 v12, v46, v42, s[46:47]
  v_mfma_f32_16x16x32_bf16 v[36:39], v[164:167], v[200:203], v[36:39]
  v_cndmask_b32 v11, v45, v41, s[44:45]
  v_mfma_f32_16x16x32_bf16 v[36:39], v[156:159], v[204:207], v[36:39]
  v_add_f32_dpp v12, v13, v12 wave_ror:1 row_mask:0xf bank_mask:0xf
  v_mfma_f32_16x16x32_bf16 v[36:39], v[148:151], v[208:211], v[36:39]
  s_waitcnt lgkmcnt(5)
  v_fma_f32 v13, v18, v6, v44
  ds_read_u16_d16_hi v18, v16 offset:3968
  v_mfma_f32_16x16x32_bf16 v[36:39], v[140:143], v[212:215], v[36:39]
  v_add_f32_dpp v11, v12, v11 wave_ror:1 row_mask:0xf bank_mask:0xf
  v_mfma_f32_16x16x32_bf16 v[36:39], v[132:135], v[216:219], v[36:39]
  s_nop 1
  v_mfma_f32_16x16x32_bf16 v[36:39], v[124:127], v[220:223], v[36:39]
  v_add_f32_dpp v13, v11, v13 wave_ror:1 row_mask:0xf bank_mask:0xf
  v_mfma_f32_16x16x32_bf16 v[36:39], v[116:119], v[224:227], v[36:39]
  v_cvt_pk_bf16_f32 v13, v13, v13
  v_mfma_f32_16x16x32_bf16 v[36:39], v[108:111], v[228:231], v[36:39]
  ds_write_b16 v16, v13 offset:3712
  v_mfma_f32_16x16x32_bf16 v[36:39], v[100:103], v[232:235], v[36:39]
  v_mfma_f32_16x16x32_bf16 v[36:39], v[92:95], v[236:239], v[36:39]
  v_mfma_f32_16x16x32_bf16 v[36:39], v[84:87], v[240:243], v[36:39]
  v_mfma_f32_16x16x32_bf16 v[36:39], v[76:79], v[244:247], v[36:39]
  v_mfma_f32_16x16x32_bf16 v[36:39], v[68:71], v[248:251], v[36:39]
  v_mfma_f32_16x16x32_bf16 v[40:43], v[184:187], v[192:195], 0
  v_cndmask_b32 v10, v35, v47, s[48:49]
  v_mfma_f32_16x16x32_bf16 v[40:43], v[176:179], v[196:199], v[40:43]
  v_cndmask_b32 v9, v34, v46, s[46:47]
  v_mfma_f32_16x16x32_bf16 v[40:43], v[168:171], v[200:203], v[40:43]
  v_cndmask_b32 v8, v33, v45, s[44:45]
  v_mfma_f32_16x16x32_bf16 v[40:43], v[160:163], v[204:207], v[40:43]
  v_add_f32_dpp v9, v10, v9 wave_ror:1 row_mask:0xf bank_mask:0xf
  v_mfma_f32_16x16x32_bf16 v[40:43], v[152:155], v[208:211], v[40:43]
  s_waitcnt lgkmcnt(3)
  v_fma_f32 v10, v17, v6, v32
  ds_read_u16_d16_hi v17, v16 offset:4096
  v_mfma_f32_16x16x32_bf16 v[40:43], v[144:147], v[212:215], v[40:43]
  v_add_f32_dpp v8, v9, v8 wave_ror:1 row_mask:0xf bank_mask:0xf
  v_mfma_f32_16x16x32_bf16 v[40:43], v[136:139], v[216:219], v[40:43]
  s_nop 1
  v_mfma_f32_16x16x32_bf16 v[40:43], v[128:131], v[220:223], v[40:43]
  v_add_f32_dpp v10, v8, v10 wave_ror:1 row_mask:0xf bank_mask:0xf
  v_mfma_f32_16x16x32_bf16 v[40:43], v[120:123], v[224:227], v[40:43]
  v_cvt_pk_bf16_f32 v10, v10, v10
  v_mfma_f32_16x16x32_bf16 v[40:43], v[112:115], v[228:231], v[40:43]
  ds_write_b16 v16, v10 offset:3840
  v_mfma_f32_16x16x32_bf16 v[40:43], v[104:107], v[232:235], v[40:43]
  v_mfma_f32_16x16x32_bf16 v[40:43], v[96:99], v[236:239], v[40:43]
  v_mfma_f32_16x16x32_bf16 v[40:43], v[88:91], v[240:243], v[40:43]
  v_mfma_f32_16x16x32_bf16 v[40:43], v[80:83], v[244:247], v[40:43]
  v_mfma_f32_16x16x32_bf16 v[40:43], v[72:75], v[248:251], v[40:43]
  v_mfma_f32_16x16x32_bf16 v[40:43], v[64:67], v[252:255], v[40:43]
  v_mfma_f32_16x16x32_bf16 v[44:47], v[188:191], v[192:195], 0
  v_cndmask_b32 v13, v39, v35, s[48:49]
  v_mfma_f32_16x16x32_bf16 v[44:47], v[180:183], v[196:199], v[44:47]
  v_cndmask_b32 v12, v38, v34, s[46:47]
  v_mfma_f32_16x16x32_bf16 v[44:47], v[172:175], v[200:203], v[44:47]
  v_cndmask_b32 v11, v37, v33, s[44:45]
  v_mfma_f32_16x16x32_bf16 v[44:47], v[164:167], v[204:207], v[44:47]
  v_add_f32_dpp v12, v13, v12 wave_ror:1 row_mask:0xf bank_mask:0xf
  v_mfma_f32_16x16x32_bf16 v[44:47], v[156:159], v[208:211], v[44:47]
  s_waitcnt lgkmcnt(3)
  v_fma_f32 v13, v18, v6, v36
  ds_read_u16_d16_hi v18, v16 offset:4224
  v_mfma_f32_16x16x32_bf16 v[44:47], v[148:151], v[212:215], v[44:47]
  v_add_f32_dpp v11, v12, v11 wave_ror:1 row_mask:0xf bank_mask:0xf
  v_mfma_f32_16x16x32_bf16 v[44:47], v[140:143], v[216:219], v[44:47]
  s_nop 1
  v_mfma_f32_16x16x32_bf16 v[44:47], v[132:135], v[220:223], v[44:47]
  v_add_f32_dpp v13, v11, v13 wave_ror:1 row_mask:0xf bank_mask:0xf
  v_mfma_f32_16x16x32_bf16 v[44:47], v[124:127], v[224:227], v[44:47]
  v_cvt_pk_bf16_f32 v13, v13, v13
  v_mfma_f32_16x16x32_bf16 v[44:47], v[116:119], v[228:231], v[44:47]
  ds_write_b16 v16, v13 offset:3968
  v_mfma_f32_16x16x32_bf16 v[44:47], v[108:111], v[232:235], v[44:47]
  v_mfma_f32_16x16x32_bf16 v[44:47], v[100:103], v[236:239], v[44:47]
  v_mfma_f32_16x16x32_bf16 v[44:47], v[92:95], v[240:243], v[44:47]
  v_mfma_f32_16x16x32_bf16 v[44:47], v[84:87], v[244:247], v[44:47]
  v_mfma_f32_16x16x32_bf16 v[44:47], v[76:79], v[248:251], v[44:47]
  v_mfma_f32_16x16x32_bf16 v[44:47], v[68:71], v[252:255], v[44:47]
  v_cndmask_b32 v10, v43, v39, s[48:49]
  v_cndmask_b32 v9, v42, v38, s[46:47]
  v_cndmask_b32 v8, v41, v37, s[44:45]
  v_add_f32_dpp v9, v10, v9 wave_ror:1 row_mask:0xf bank_mask:0xf
  s_waitcnt lgkmcnt(3)
  v_fma_f32 v10, v17, v6, v40
  s_nop 0
  v_add_f32_dpp v8, v9, v8 wave_ror:1 row_mask:0xf bank_mask:0xf
  s_nop 1
  v_add_f32_dpp v10, v8, v10 wave_ror:1 row_mask:0xf bank_mask:0xf
  v_cvt_pk_bf16_f32 v10, v10, v10
  ds_write_b16 v16, v10 offset:4096
  v_cndmask_b32 v13, v47, v43, s[48:49]
  v_cndmask_b32 v12, v46, v42, s[46:47]
  v_cndmask_b32 v11, v45, v41, s[44:45]
  v_add_f32_dpp v12, v13, v12 wave_ror:1 row_mask:0xf bank_mask:0xf
  s_waitcnt lgkmcnt(2)
  v_fma_f32 v13, v18, v6, v44
  s_nop 0
  v_add_f32_dpp v11, v12, v11 wave_ror:1 row_mask:0xf bank_mask:0xf
  s_nop 1
  v_add_f32_dpp v13, v11, v13 wave_ror:1 row_mask:0xf bank_mask:0xf
  v_cvt_pk_bf16_f32 v13, v13, v13
  ds_write_b16 v16, v13 offset:4224
  ds_read_b128 v[48:51], v19 offset:256
  ds_read_b128 v[52:55], v19 offset:1280
  ds_read_b128 v[56:59], v19 offset:2304
  ds_read_b128 v[60:63], v19 offset:3328
  s_waitcnt lgkmcnt(3)
  buffer_store_dwordx4 v[48:51], v1, s[60:63], 0 offen offset:0 sc1
  s_waitcnt lgkmcnt(2)
  buffer_store_dwordx4 v[52:55], v1, s[60:63], 0 offen offset:1024 sc1
  s_waitcnt lgkmcnt(1)
  buffer_store_dwordx4 v[56:59], v1, s[60:63], 0 offen offset:2048 sc1
  s_waitcnt lgkmcnt(0)
  buffer_store_dwordx4 v[60:63], v1, s[60:63], 0 offen offset:3072 sc1
  s_lshr_b32 s24, s21, 6
  s_lshl_b32 s24, s24, 7
  s_add_u32 s24, s24, 827392
  s_waitcnt vmcnt(0)
  v_lshlrev_b32 v30, 22, v3
  v_mov_b32 v31, 1
  buffer_atomic_add v31, v30, s[64:67], s24 offen sc1
  ds_read_b128 v[64:67], v21 offset:0
  ds_read_b128 v[68:71], v21 offset:1024
  ds_read_b128 v[72:75], v21 offset:2048
  ds_read_b128 v[76:79], v21 offset:3072
  ds_read_b128 v[80:83], v21 offset:4096
  ds_read_b128 v[84:87], v21 offset:5120
  ds_read_b128 v[88:91], v21 offset:6144
  ds_read_b128 v[92:95], v21 offset:7168
  s_mul_i32 s24, s58, 14336
  s_lshl_b32 s25, s59, 9
  s_add_u32 s24, s24, s25
  s_waitcnt lgkmcnt(7)
  v_lshlrev_b32 v176, 16, v64
  v_and_b32 v177, 0xffff0000, v64
  v_lshlrev_b32 v178, 16, v65
  v_and_b32 v179, 0xffff0000, v65
  v_lshlrev_b32 v180, 16, v66
  v_and_b32 v181, 0xffff0000, v66
  v_lshlrev_b32 v182, 16, v67
  v_and_b32 v183, 0xffff0000, v67
  s_waitcnt lgkmcnt(6)
  v_lshlrev_b32 v160, 16, v68
  v_and_b32 v161, 0xffff0000, v68
  v_lshlrev_b32 v162, 16, v69
  v_and_b32 v163, 0xffff0000, v69
  v_lshlrev_b32 v164, 16, v70
  v_and_b32 v165, 0xffff0000, v70
  v_lshlrev_b32 v166, 16, v71
  v_and_b32 v167, 0xffff0000, v71
  v_pk_add_f32 v[176:177], v[176:177], v[160:161]
  v_pk_add_f32 v[178:179], v[178:179], v[162:163]
  v_pk_add_f32 v[180:181], v[180:181], v[164:165]
  v_pk_add_f32 v[182:183], v[182:183], v[166:167]
  s_waitcnt lgkmcnt(5)
  v_lshlrev_b32 v160, 16, v72
  v_and_b32 v161, 0xffff0000, v72
  v_lshlrev_b32 v162, 16, v73
  v_and_b32 v163, 0xffff0000, v73
  v_lshlrev_b32 v164, 16, v74
  v_and_b32 v165, 0xffff0000, v74
  v_lshlrev_b32 v166, 16, v75
  v_and_b32 v167, 0xffff0000, v75
  v_pk_add_f32 v[176:177], v[176:177], v[160:161]
  v_pk_add_f32 v[178:179], v[178:179], v[162:163]
  v_pk_add_f32 v[180:181], v[180:181], v[164:165]
  v_pk_add_f32 v[182:183], v[182:183], v[166:167]
  s_waitcnt lgkmcnt(4)
  v_lshlrev_b32 v160, 16, v76
  v_and_b32 v161, 0xffff0000, v76
  v_lshlrev_b32 v162, 16, v77
  v_and_b32 v163, 0xffff0000, v77
  v_lshlrev_b32 v164, 16, v78
  v_and_b32 v165, 0xffff0000, v78
  v_lshlrev_b32 v166, 16, v79
  v_and_b32 v167, 0xffff0000, v79
  v_pk_add_f32 v[176:177], v[176:177], v[160:161]
  v_pk_add_f32 v[178:179], v[178:179], v[162:163]
  v_pk_add_f32 v[180:181], v[180:181], v[164:165]
  v_pk_add_f32 v[182:183], v[182:183], v[166:167]
  s_waitcnt lgkmcnt(3)
  v_lshlrev_b32 v160, 16, v80
  v_and_b32 v161, 0xffff0000, v80
  v_lshlrev_b32 v162, 16, v81
  v_and_b32 v163, 0xffff0000, v81
  v_lshlrev_b32 v164, 16, v82
  v_and_b32 v165, 0xffff0000, v82
  v_lshlrev_b32 v166, 16, v83
  v_and_b32 v167, 0xffff0000, v83
  v_pk_add_f32 v[176:177], v[176:177], v[160:161]
  v_pk_add_f32 v[178:179], v[178:179], v[162:163]
  v_pk_add_f32 v[180:181], v[180:181], v[164:165]
  v_pk_add_f32 v[182:183], v[182:183], v[166:167]
  s_waitcnt lgkmcnt(2)
  v_lshlrev_b32 v160, 16, v84
  v_and_b32 v161, 0xffff0000, v84
  v_lshlrev_b32 v162, 16, v85
  v_and_b32 v163, 0xffff0000, v85
  v_lshlrev_b32 v164, 16, v86
  v_and_b32 v165, 0xffff0000, v86
  v_lshlrev_b32 v166, 16, v87
  v_and_b32 v167, 0xffff0000, v87
  v_pk_add_f32 v[176:177], v[176:177], v[160:161]
  v_pk_add_f32 v[178:179], v[178:179], v[162:163]
  v_pk_add_f32 v[180:181], v[180:181], v[164:165]
  v_pk_add_f32 v[182:183], v[182:183], v[166:167]
  s_waitcnt lgkmcnt(1)
  v_lshlrev_b32 v160, 16, v88
  v_and_b32 v161, 0xffff0000, v88
  v_lshlrev_b32 v162, 16, v89
  v_and_b32 v163, 0xffff0000, v89
  v_lshlrev_b32 v164, 16, v90
  v_and_b32 v165, 0xffff0000, v90
  v_lshlrev_b32 v166, 16, v91
  v_and_b32 v167, 0xffff0000, v91
  v_pk_add_f32 v[176:177], v[176:177], v[160:161]
  v_pk_add_f32 v[178:179], v[178:179], v[162:163]
  v_pk_add_f32 v[180:181], v[180:181], v[164:165]
  v_pk_add_f32 v[182:183], v[182:183], v[166:167]
  s_waitcnt lgkmcnt(0)
  v_lshlrev_b32 v160, 16, v92
  v_and_b32 v161, 0xffff0000, v92
  v_lshlrev_b32 v162, 16, v93
  v_and_b32 v163, 0xffff0000, v93
  v_lshlrev_b32 v164, 16, v94
  v_and_b32 v165, 0xffff0000, v94
  v_lshlrev_b32 v166, 16, v95
  v_and_b32 v167, 0xffff0000, v95
  v_pk_add_f32 v[176:177], v[176:177], v[160:161]
  v_pk_add_f32 v[178:179], v[178:179], v[162:163]
  v_pk_add_f32 v[180:181], v[180:181], v[164:165]
  v_pk_add_f32 v[182:183], v[182:183], v[166:167]
  v_lshlrev_b32 v4, 5, v0
  v_add_u32 v4, 133376, v4
  ds_write_b128 v4, v[176:179]
  ds_write_b128 v4, v[180:183] offset:16
  s_waitcnt lgkmcnt(0)
  s_barrier
  v_and_b32 v4, 127, v0
  v_lshlrev_b32 v4, 2, v4
  v_add_u32 v5, 133376, v4
  s_lshl_b32 s101, s3, 13
  v_add_u32 v5, s101, v5
  ds_read_b32 v160, v5 offset:0
  ds_read_b32 v161, v5 offset:512
  ds_read_b32 v162, v5 offset:1024
  ds_read_b32 v163, v5 offset:1536
  ds_read_b32 v164, v5 offset:2048
  ds_read_b32 v165, v5 offset:2560
  ds_read_b32 v166, v5 offset:3072
  ds_read_b32 v167, v5 offset:3584
  ds_read_b32 v168, v5 offset:4096
  ds_read_b32 v169, v5 offset:4608
  ds_read_b32 v170, v5 offset:5120
  ds_read_b32 v171, v5 offset:5632
  ds_read_b32 v172, v5 offset:6144
  ds_read_b32 v173, v5 offset:6656
  ds_read_b32 v174, v5 offset:7168
  ds_read_b32 v175, v5 offset:7680
  s_waitcnt lgkmcnt(0)
  v_add_f32 v160, v160, v161
  v_add_f32 v160, v160, v162
  v_add_f32 v160, v160, v163
  v_add_f32 v160, v160, v164
  v_add_f32 v160, v160, v165
  v_add_f32 v160, v160, v166
  v_add_f32 v160, v160, v167
  v_add_f32 v160, v160, v168
  v_add_f32 v160, v160, v169
  v_add_f32 v160, v160, v170
  v_add_f32 v160, v160, v171
  v_add_f32 v160, v160, v172
  v_add_f32 v160, v160, v173
  v_add_f32 v160, v160, v174
  v_add_f32 v160, v160, v175
  buffer_store_dword v160, v4, s[52:55], s24 offen sc1
  s_add_u32 s68, s42, 34383872
  s_addc_u32 s69, s43, 0
  s_mov_b32 s70, 128
  s_mov_b32 s71, 0x20000
  s_waitcnt vmcnt(0)
  s_barrier
  s_cmp_lg_u32 s100, 0
  s_cbranch_scc1 sd_pub8
  v_lshlrev_b32 v4, 20, v3
  v_mov_b32 v5, 1
  buffer_atomic_add v5, v4, s[68:71], 0 offen sc1
sd_pub8:
  s_cmp_eq_u32 s3, 1
  s_cbranch_scc1 g3_l
  s_branch g3_c
g1_c:
  s_load_dwordx4 s[28:31], s[0:1], 56
  s_load_dwordx4 s[40:43], s[0:1], 96
  s_load_dwordx2 s[32:33], s[0:1], 0
  s_and_b32 s24, s2, 7
  s_lshr_b32 s25, s2, 3
  s_and_b32 s25, s25, 15
  s_lshr_b32 s21, s24, 1
  s_lshl_b32 s21, s21, 2
  s_lshr_b32 s22, s25, 2
  s_add_u32 s21, s21, s22
  s_and_b32 s22, s24, 1
  s_lshl_b32 s22, s22, 2
  s_and_b32 s25, s25, 3
  s_add_u32 s22, s22, s25
  v_lshrrev_b32 v2, 6, v0
  v_and_b32 v3, 63, v0
  v_readfirstlane_b32 s100, v2
  s_nop 0
  s_and_b32 s20, s100, 3
  s_lshr_b32 s3, s100, 2
  s_lshl_b32 s23, s21, 3
  s_lshl_b32 s24, s20, 1
  s_add_u32 s23, s23, s24
  s_lshr_b32 s24, s22, 2
  s_add_u32 s24, s24, 1
  s_sub_u32 s25, 0, s24
  s_bitcmp1_b32 s22, 1
  s_cselect_b32 s34, s24, s25
  s_lshl_b32 s24, s23, 4
  s_add_u32 s35, s24, s34
  s_mul_i32 s26, s20, 16384
  s_add_u32 s26, s26, 65536
  s_add_u32 s24, s21, s22
  s_and_b32 s24, s24, 3
  s_lshl_b32 s47, s24, 19
  s_lshl_b32 s46, s24, 9
  s_waitcnt lgkmcnt(0)
  s_mov_b32 s12, s42
  s_mov_b32 s13, s43
  s_mov_b32 s14, 4194304
  s_mov_b32 s15, 0x20000
  s_add_u32 s16, s42, 33554432
  s_addc_u32 s17, s43, 0
  s_mov_b32 s18, 4194304
  s_mov_b32 s19, 0x20000
  v_lshrrev_b32 v28, 4, v3
  v_lshlrev_b32 v28, 3, v28
  v_bfe_u32 v29, v3, 2, 2
  v_add_u32 v29, v28, v29
  v_lshlrev_b32 v29, 8, v29
  v_and_b32 v30, 3, v3
  v_lshl_add_u32 v29, v30, 3, v29
  v_bfe_u32 v28, v3, 2, 3
  v_xor_b32 v30, 0, v28
  v_lshl_add_u32 v8, v30, 5, v29
  v_add_u32 v16, 65536, v8
  v_xor_b32 v30, 1, v28
  v_lshl_add_u32 v9, v30, 5, v29
  v_add_u32 v17, 65536, v9
  v_xor_b32 v30, 2, v28
  v_lshl_add_u32 v10, v30, 5, v29
  v_add_u32 v18, 65536, v10
  v_xor_b32 v30, 3, v28
  v_lshl_add_u32 v11, v30, 5, v29
  v_add_u32 v19, 65536, v11
  v_xor_b32 v30, 4, v28
  v_lshl_add_u32 v12, v30, 5, v29
  v_add_u32 v20, 65536, v12
  v_xor_b32 v30, 5, v28
  v_lshl_add_u32 v13, v30, 5, v29
  v_add_u32 v21, 65536, v13
  v_xor_b32 v30, 6, v28
  v_lshl_add_u32 v14, v30, 5, v29
  v_add_u32 v22, 65536, v14
  v_xor_b32 v30, 7, v28
  v_lshl_add_u32 v15, v30, 5, v29
  v_add_u32 v23, 65536, v15
  s_lshl_b32 s24, s23, 15
  s_lshl_b32 s25, s22, 12
  s_add_u32 s24, s24, s25
  v_lshl_add_u32 v6, v3, 4, s24
  v_add_u32 v7, 32768, v6
  v_mov_b32 v1, 0
  s_mov_b32 s36, s40
  s_mov_b32 s37, s41
  s_mov_b32 s38, 256
  s_mov_b32 s39, 0x20000
  s_add_u32 s48, s42, 33816576
  s_addc_u32 s49, s43, 0
  s_mov_b32 s50, 16384
  s_mov_b32 s51, 0x20000
  v_and_b32 v28, 15, v3
  v_lshlrev_b32 v29, 7, v28
  v_add_u32 v29, s26, v29
  v_add_u32 v24, s35, v28
  v_add_u32 v25, 16, v24
  v_lshlrev_b32 v24, 3, v24
  v_lshlrev_b32 v25, 3, v25
  v_lshrrev_b32 v28, 1, v28
  v_lshrrev_b32 v30, 4, v3
  v_xor_b32 v28, v28, v30
  v_lshl_add_u32 v26, v28, 4, v29
  v_xor_b32 v28, 4, v28
  v_lshl_add_u32 v27, v28, 4, v29
  s_barrier
  ds_read_b128 v[128:131], v26 offset:0
  ds_read_b128 v[132:135], v26 offset:2048
  ds_read_b128 v[136:139], v27 offset:0
  ds_read_b128 v[140:143], v27 offset:2048
  ds_read_b64_tr_b16 v[96:97], v8 offset:0
  ds_read_b64_tr_b16 v[98:99], v8 offset:1024
  ds_read_b64_tr_b16 v[100:101], v9 offset:0
  ds_read_b64_tr_b16 v[102:103], v9 offset:1024
  ds_read_b64_tr_b16 v[104:105], v10 offset:0
  ds_read_b64_tr_b16 v[106:107], v10 offset:1024
  ds_read_b64_tr_b16 v[108:109], v11 offset:0
  ds_read_b64_tr_b16 v[110:111], v11 offset:1024
  ds_read_b64_tr_b16 v[112:113], v12 offset:0
  ds_read_b64_tr_b16 v[114:115], v12 offset:1024
  ds_read_b64_tr_b16 v[116:117], v13 offset:0
  ds_read_b64_tr_b16 v[118:119], v13 offset:1024
  ds_read_b64_tr_b16 v[120:121], v14 offset:0
  ds_read_b64_tr_b16 v[122:123], v14 offset:1024
  s_waitcnt lgkmcnt(12)
  v_mfma_f32_16x16x32_bf16 v[32:35], v[96:99], v[128:131], 0
  ds_read_b64_tr_b16 v[124:125], v15 offset:0
  ds_read_b64_tr_b16 v[126:127], v15 offset:1024
  v_mfma_f32_16x16x32_bf16 v[36:39], v[96:99], v[132:135], 0
  s_waitcnt lgkmcnt(12)
  v_mfma_f32_16x16x32_bf16 v[40:43], v[100:103], v[128:131], 0
  ds_read_b64_tr_b16 v[96:97], v8 offset:8192
  ds_read_b64_tr_b16 v[98:99], v8 offset:9216
  v_mfma_f32_16x16x32_bf16 v[44:47], v[100:103], v[132:135], 0
  s_waitcnt lgkmcnt(12)
  v_mfma_f32_16x16x32_bf16 v[48:51], v[104:107], v[128:131], 0
  ds_read_b64_tr_b16 v[100:101], v9 offset:8192
  ds_read_b64_tr_b16 v[102:103], v9 offset:9216
  v_mfma_f32_16x16x32_bf16 v[52:55], v[104:107], v[132:135], 0
  s_waitcnt lgkmcnt(12)
  v_mfma_f32_16x16x32_bf16 v[56:59], v[108:111], v[128:131], 0
  ds_read_b64_tr_b16 v[104:105], v10 offset:8192
  ds_read_b64_tr_b16 v[106:107], v10 offset:9216
  v_mfma_f32_16x16x32_bf16 v[60:63], v[108:111], v[132:135], 0
  s_waitcnt lgkmcnt(12)
  v_mfma_f32_16x16x32_bf16 v[64:67], v[112:115], v[128:131], 0
  ds_read_b64_tr_b16 v[108:109], v11 offset:8192
  ds_read_b64_tr_b16 v[110:111], v11 offset:9216
  v_mfma_f32_16x16x32_bf16 v[68:71], v[112:115], v[132:135], 0
  s_waitcnt lgkmcnt(12)
  v_mfma_f32_16x16x32_bf16 v[72:75], v[116:119], v[128:131], 0
  ds_read_b64_tr_b16 v[112:113], v12 offset:8192
  ds_read_b64_tr_b16 v[114:115], v12 offset:9216
  v_mfma_f32_16x16x32_bf16 v[76:79], v[116:119], v[132:135], 0
  s_waitcnt lgkmcnt(12)
  v_mfma_f32_16x16x32_bf16 v[80:83], v[120:123], v[128:131], 0
  ds_read_b64_tr_b16 v[116:117], v13 offset:8192
  ds_read_b64_tr_b16 v[118:119], v13 offset:9216
  v_mfma_f32_16x16x32_bf16 v[84:87], v[120:123], v[132:135], 0
  s_waitcnt lgkmcnt(12)
  v_mfma_f32_16x16x32_bf16 v[88:91], v[124:127], v[128:131], 0
  ds_read_b64_tr_b16 v[120:121], v14 offset:8192
  ds_read_b64_tr_b16 v[122:123], v14 offset:9216
  v_mfma_f32_16x16x32_bf16 v[92:95], v[124:127], v[132:135], 0
  s_waitcnt lgkmcnt(12)
  v_mfma_f32_16x16x32_bf16 v[32:35], v[96:99], v[136:139], v[32:35]
  ds_read_b64_tr_b16 v[124:125], v15 offset:8192
  ds_read_b64_tr_b16 v[126:127], v15 offset:9216
  v_mfma_f32_16x16x32_bf16 v[36:39], v[96:99], v[140:143], v[36:39]
  s_waitcnt lgkmcnt(12)
  v_mfma_f32_16x16x32_bf16 v[40:43], v[100:103], v[136:139], v[40:43]
  s_mov_b32 s101, 3
lp_c1:
  s_barrier
  ds_read_b128 v[144:147], v26 offset:4096
  ds_read_b128 v[148:151], v26 offset:6144
  ds_read_b128 v[152:155], v27 offset:4096
  ds_read_b128 v[156:159], v27 offset:6144
  ds_read_b64_tr_b16 v[96:97], v8 offset:16384
  ds_read_b64_tr_b16 v[98:99], v8 offset:17408
  v_mfma_f32_16x16x32_bf16 v[44:47], v[100:103], v[140:143], v[44:47]
  s_waitcnt lgkmcnt(15)
  v_mfma_f32_16x16x32_bf16 v[48:51], v[104:107], v[136:139], v[48:51]
  ds_read_b64_tr_b16 v[100:101], v9 offset:16384
  ds_read_b64_tr_b16 v[102:103], v9 offset:17408
  v_mfma_f32_16x16x32_bf16 v[52:55], v[104:107], v[140:143], v[52:55]
  s_waitcnt lgkmcnt(15)
  v_mfma_f32_16x16x32_bf16 v[56:59], v[108:111], v[136:139], v[56:59]
  ds_read_b64_tr_b16 v[104:105], v10 offset:16384
  ds_read_b64_tr_b16 v[106:107], v10 offset:17408
  v_mfma_f32_16x16x32_bf16 v[60:63], v[108:111], v[140:143], v[60:63]
  s_waitcnt lgkmcnt(15)
  v_mfma_f32_16x16x32_bf16 v[64:67], v[112:115], v[136:139], v[64:67]
  ds_read_b64_tr_b16 v[108:109], v11 offset:16384
  ds_read_b64_tr_b16 v[110:111], v11 offset:17408
  v_mfma_f32_16x16x32_bf16 v[68:71], v[112:115], v[140:143], v[68:71]
  s_waitcnt lgkmcnt(15)
  v_mfma_f32_16x16x32_bf16 v[72:75], v[116:119], v[136:139], v[72:75]
  ds_read_b64_tr_b16 v[112:113], v12 offset:16384
  ds_read_b64_tr_b16 v[114:115], v12 offset:17408
  v_mfma_f32_16x16x32_bf16 v[76:79], v[116:119], v[140:143], v[76:79]
  s_waitcnt lgkmcnt(15)
  v_mfma_f32_16x16x32_bf16 v[80:83], v[120:123], v[136:139], v[80:83]
  ds_read_b64_tr_b16 v[116:117], v13 offset:16384
  ds_read_b64_tr_b16 v[118:119], v13 offset:17408
  v_mfma_f32_16x16x32_bf16 v[84:87], v[120:123], v[140:143], v[84:87]
  s_waitcnt lgkmcnt(15)
  v_mfma_f32_16x16x32_bf16 v[88:91], v[124:127], v[136:139], v[88:91]
  ds_read_b64_tr_b16 v[120:121], v14 offset:16384
  ds_read_b64_tr_b16 v[122:123], v14 offset:17408
  v_mfma_f32_16x16x32_bf16 v[92:95], v[124:127], v[140:143], v[92:95]
  s_waitcnt lgkmcnt(12)
  v_mfma_f32_16x16x32_bf16 v[32:35], v[96:99], v[144:147], v[32:35]
  ds_read_b64_tr_b16 v[124:125], v15 offset:16384
  ds_read_b64_tr_b16 v[126:127], v15 offset:17408
  v_mfma_f32_16x16x32_bf16 v[36:39], v[96:99], v[148:151], v[36:39]
  s_waitcnt lgkmcnt(12)
  v_mfma_f32_16x16x32_bf16 v[40:43], v[100:103], v[144:147], v[40:43]
  ds_read_b64_tr_b16 v[96:97], v8 offset:24576
  ds_read_b64_tr_b16 v[98:99], v8 offset:25600
  v_mfma_f32_16x16x32_bf16 v[44:47], v[100:103], v[148:151], v[44:47]
  s_waitcnt lgkmcnt(12)
  v_mfma_f32_16x16x32_bf16 v[48:51], v[104:107], v[144:147], v[48:51]
  ds_read_b64_tr_b16 v[100:101], v9 offset:24576
  ds_read_b64_tr_b16 v[102:103], v9 offset:25600
  v_mfma_f32_16x16x32_bf16 v[52:55], v[104:107], v[148:151], v[52:55]
  s_waitcnt lgkmcnt(12)
  v_mfma_f32_16x16x32_bf16 v[56:59], v[108:111], v[144:147], v[56:59]
  ds_read_b64_tr_b16 v[104:105], v10 offset:24576
  ds_read_b64_tr_b16 v[106:107], v10 offset:25600
  v_mfma_f32_16x16x32_bf16 v[60:63], v[108:111], v[148:151], v[60:63]
  s_waitcnt lgkmcnt(12)
  v_mfma_f32_16x16x32_bf16 v[64:67], v[112:115], v[144:147], v[64:67]
  ds_read_b64_tr_b16 v[108:109], v11 offset:24576
  ds_read_b64_tr_b16 v[110:111], v11 offset:25600
  v_mfma_f32_16x16x32_bf16 v[68:71], v[112:115], v[148:151], v[68:71]
  s_waitcnt lgkmcnt(12)
  v_mfma_f32_16x16x32_bf16 v[72:75], v[116:119], v[144:147], v[72:75]
  ds_read_b64_tr_b16 v[112:113], v12 offset:24576
  ds_read_b64_tr_b16 v[114:115], v12 offset:25600
  v_mfma_f32_16x16x32_bf16 v[76:79], v[116:119], v[148:151], v[76:79]
  s_waitcnt lgkmcnt(12)
  v_mfma_f32_16x16x32_bf16 v[80:83], v[120:123], v[144:147], v[80:83]
  ds_read_b64_tr_b16 v[116:117], v13 offset:24576
  ds_read_b64_tr_b16 v[118:119], v13 offset:25600
  v_mfma_f32_16x16x32_bf16 v[84:87], v[120:123], v[148:151], v[84:87]
  s_waitcnt lgkmcnt(12)
  v_mfma_f32_16x16x32_bf16 v[88:91], v[124:127], v[144:147], v[88:91]
  ds_read_b64_tr_b16 v[120:121], v14 offset:24576
  ds_read_b64_tr_b16 v[122:123], v14 offset:25600
  v_mfma_f32_16x16x32_bf16 v[92:95], v[124:127], v[148:151], v[92:95]
  s_waitcnt lgkmcnt(12)
  v_mfma_f32_16x16x32_bf16 v[32:35], v[96:99], v[152:155], v[32:35]
  ds_read_b64_tr_b16 v[124:125], v15 offset:24576
  ds_read_b64_tr_b16 v[126:127], v15 offset:25600
  v_mfma_f32_16x16x32_bf16 v[36:39], v[96:99], v[156:159], v[36:39]
  s_waitcnt lgkmcnt(12)
  v_mfma_f32_16x16x32_bf16 v[40:43], v[100:103], v[152:155], v[40:43]
  s_barrier
  ds_read_b128 v[128:131], v26 offset:8192
  ds_read_b128 v[132:135], v26 offset:10240
  ds_read_b128 v[136:139], v27 offset:8192
  ds_read_b128 v[140:143], v27 offset:10240
  ds_read_b64_tr_b16 v[96:97], v8 offset:32768
  ds_read_b64_tr_b16 v[98:99], v8 offset:33792
  v_mfma_f32_16x16x32_bf16 v[44:47], v[100:103], v[156:159], v[44:47]
  s_waitcnt lgkmcnt(15)
  v_mfma_f32_16x16x32_bf16 v[48:51], v[104:107], v[152:155], v[48:51]
  ds_read_b64_tr_b16 v[100:101], v9 offset:32768
  ds_read_b64_tr_b16 v[102:103], v9 offset:33792
  v_mfma_f32_16x16x32_bf16 v[52:55], v[104:107], v[156:159], v[52:55]
  s_waitcnt lgkmcnt(15)
  v_mfma_f32_16x16x32_bf16 v[56:59], v[108:111], v[152:155], v[56:59]
  ds_read_b64_tr_b16 v[104:105], v10 offset:32768
  ds_read_b64_tr_b16 v[106:107], v10 offset:33792
  v_mfma_f32_16x16x32_bf16 v[60:63], v[108:111], v[156:159], v[60:63]
  s_waitcnt lgkmcnt(15)
  v_mfma_f32_16x16x32_bf16 v[64:67], v[112:115], v[152:155], v[64:67]
  ds_read_b64_tr_b16 v[108:109], v11 offset:32768
  ds_read_b64_tr_b16 v[110:111], v11 offset:33792
  v_mfma_f32_16x16x32_bf16 v[68:71], v[112:115], v[156:159], v[68:71]
  s_waitcnt lgkmcnt(15)
  v_mfma_f32_16x16x32_bf16 v[72:75], v[116:119], v[152:155], v[72:75]
  ds_read_b64_tr_b16 v[112:113], v12 offset:32768
  ds_read_b64_tr_b16 v[114:115], v12 offset:33792
  v_mfma_f32_16x16x32_bf16 v[76:79], v[116:119], v[156:159], v[76:79]
  s_waitcnt lgkmcnt(15)
  v_mfma_f32_16x16x32_bf16 v[80:83], v[120:123], v[152:155], v[80:83]
  ds_read_b64_tr_b16 v[116:117], v13 offset:32768
  ds_read_b64_tr_b16 v[118:119], v13 offset:33792
  v_mfma_f32_16x16x32_bf16 v[84:87], v[120:123], v[156:159], v[84:87]
  s_waitcnt lgkmcnt(15)
  v_mfma_f32_16x16x32_bf16 v[88:91], v[124:127], v[152:155], v[88:91]
  ds_read_b64_tr_b16 v[120:121], v14 offset:32768
  ds_read_b64_tr_b16 v[122:123], v14 offset:33792
  v_mfma_f32_16x16x32_bf16 v[92:95], v[124:127], v[156:159], v[92:95]
  s_waitcnt lgkmcnt(12)
  v_mfma_f32_16x16x32_bf16 v[32:35], v[96:99], v[128:131], v[32:35]
  ds_read_b64_tr_b16 v[124:125], v15 offset:32768
  ds_read_b64_tr_b16 v[126:127], v15 offset:33792
  v_mfma_f32_16x16x32_bf16 v[36:39], v[96:99], v[132:135], v[36:39]
  s_waitcnt lgkmcnt(12)
  v_mfma_f32_16x16x32_bf16 v[40:43], v[100:103], v[128:131], v[40:43]
  ds_read_b64_tr_b16 v[96:97], v8 offset:40960
  ds_read_b64_tr_b16 v[98:99], v8 offset:41984
  v_mfma_f32_16x16x32_bf16 v[44:47], v[100:103], v[132:135], v[44:47]
  s_waitcnt lgkmcnt(12)
  v_mfma_f32_16x16x32_bf16 v[48:51], v[104:107], v[128:131], v[48:51]
  ds_read_b64_tr_b16 v[100:101], v9 offset:40960
  ds_read_b64_tr_b16 v[102:103], v9 offset:41984
  v_mfma_f32_16x16x32_bf16 v[52:55], v[104:107], v[132:135], v[52:55]
  s_waitcnt lgkmcnt(12)
  v_mfma_f32_16x16x32_bf16 v[56:59], v[108:111], v[128:131], v[56:59]
  ds_read_b64_tr_b16 v[104:105], v10 offset:40960
  ds_read_b64_tr_b16 v[106:107], v10 offset:41984
  v_mfma_f32_16x16x32_bf16 v[60:63], v[108:111], v[132:135], v[60:63]
  s_waitcnt lgkmcnt(12)
  v_mfma_f32_16x16x32_bf16 v[64:67], v[112:115], v[128:131], v[64:67]
  ds_read_b64_tr_b16 v[108:109], v11 offset:40960
  ds_read_b64_tr_b16 v[110:111], v11 offset:41984
  v_mfma_f32_16x16x32_bf16 v[68:71], v[112:115], v[132:135], v[68:71]
  s_waitcnt lgkmcnt(12)
  v_mfma_f32_16x16x32_bf16 v[72:75], v[116:119], v[128:131], v[72:75]
  ds_read_b64_tr_b16 v[112:113], v12 offset:40960
  ds_read_b64_tr_b16 v[114:115], v12 offset:41984
  v_mfma_f32_16x16x32_bf16 v[76:79], v[116:119], v[132:135], v[76:79]
  s_waitcnt lgkmcnt(12)
  v_mfma_f32_16x16x32_bf16 v[80:83], v[120:123], v[128:131], v[80:83]
  ds_read_b64_tr_b16 v[116:117], v13 offset:40960
  ds_read_b64_tr_b16 v[118:119], v13 offset:41984
  v_mfma_f32_16x16x32_bf16 v[84:87], v[120:123], v[132:135], v[84:87]
  s_waitcnt lgkmcnt(12)
  v_mfma_f32_16x16x32_bf16 v[88:91], v[124:127], v[128:131], v[88:91]
  ds_read_b64_tr_b16 v[120:121], v14 offset:40960
  ds_read_b64_tr_b16 v[122:123], v14 offset:41984
  v_mfma_f32_16x16x32_bf16 v[92:95], v[124:127], v[132:135], v[92:95]
  s_waitcnt lgkmcnt(12)
  v_mfma_f32_16x16x32_bf16 v[32:35], v[96:99], v[136:139], v[32:35]
  ds_read_b64_tr_b16 v[124:125], v15 offset:40960
  ds_read_b64_tr_b16 v[126:127], v15 offset:41984
  v_mfma_f32_16x16x32_bf16 v[36:39], v[96:99], v[140:143], v[36:39]
  s_waitcnt lgkmcnt(12)
  v_mfma_f32_16x16x32_bf16 v[40:43], v[100:103], v[136:139], v[40:43]
  s_barrier
  ds_read_b128 v[144:147], v26 offset:12288
  ds_read_b128 v[148:151], v26 offset:14336
  ds_read_b128 v[152:155], v27 offset:12288
  ds_read_b128 v[156:159], v27 offset:14336
  ds_read_b64_tr_b16 v[96:97], v8 offset:49152
  ds_read_b64_tr_b16 v[98:99], v8 offset:50176
  v_mfma_f32_16x16x32_bf16 v[44:47], v[100:103], v[140:143], v[44:47]
  s_waitcnt lgkmcnt(15)
  v_mfma_f32_16x16x32_bf16 v[48:51], v[104:107], v[136:139], v[48:51]
  ds_read_b64_tr_b16 v[100:101], v9 offset:49152
  ds_read_b64_tr_b16 v[102:103], v9 offset:50176
  v_mfma_f32_16x16x32_bf16 v[52:55], v[104:107], v[140:143], v[52:55]
  s_waitcnt lgkmcnt(15)
  v_mfma_f32_16x16x32_bf16 v[56:59], v[108:111], v[136:139], v[56:59]
  ds_read_b64_tr_b16 v[104:105], v10 offset:49152
  ds_read_b64_tr_b16 v[106:107], v10 offset:50176
  v_mfma_f32_16x16x32_bf16 v[60:63], v[108:111], v[140:143], v[60:63]
  s_waitcnt lgkmcnt(15)
  v_mfma_f32_16x16x32_bf16 v[64:67], v[112:115], v[136:139], v[64:67]
  ds_read_b64_tr_b16 v[108:109], v11 offset:49152
  ds_read_b64_tr_b16 v[110:111], v11 offset:50176
  v_mfma_f32_16x16x32_bf16 v[68:71], v[112:115], v[140:143], v[68:71]
  s_waitcnt lgkmcnt(15)
  v_mfma_f32_16x16x32_bf16 v[72:75], v[116:119], v[136:139], v[72:75]
  ds_read_b64_tr_b16 v[112:113], v12 offset:49152
  ds_read_b64_tr_b16 v[114:115], v12 offset:50176
  v_mfma_f32_16x16x32_bf16 v[76:79], v[116:119], v[140:143], v[76:79]
  s_waitcnt lgkmcnt(15)
  v_mfma_f32_16x16x32_bf16 v[80:83], v[120:123], v[136:139], v[80:83]
  ds_read_b64_tr_b16 v[116:117], v13 offset:49152
  ds_read_b64_tr_b16 v[118:119], v13 offset:50176
  v_mfma_f32_16x16x32_bf16 v[84:87], v[120:123], v[140:143], v[84:87]
  s_waitcnt lgkmcnt(15)
  v_mfma_f32_16x16x32_bf16 v[88:91], v[124:127], v[136:139], v[88:91]
  ds_read_b64_tr_b16 v[120:121], v14 offset:49152
  ds_read_b64_tr_b16 v[122:123], v14 offset:50176
  v_mfma_f32_16x16x32_bf16 v[92:95], v[124:127], v[140:143], v[92:95]
  s_waitcnt lgkmcnt(12)
  v_mfma_f32_16x16x32_bf16 v[32:35], v[96:99], v[144:147], v[32:35]
  ds_read_b64_tr_b16 v[124:125], v15 offset:49152
  ds_read_b64_tr_b16 v[126:127], v15 offset:50176
  v_mfma_f32_16x16x32_bf16 v[36:39], v[96:99], v[148:151], v[36:39]
  s_waitcnt lgkmcnt(12)
  v_mfma_f32_16x16x32_bf16 v[40:43], v[100:103], v[144:147], v[40:43]
  ds_read_b64_tr_b16 v[96:97], v8 offset:57344
  ds_read_b64_tr_b16 v[98:99], v8 offset:58368
  v_mfma_f32_16x16x32_bf16 v[44:47], v[100:103], v[148:151], v[44:47]
  s_waitcnt lgkmcnt(12)
  v_mfma_f32_16x16x32_bf16 v[48:51], v[104:107], v[144:147], v[48:51]
  ds_read_b64_tr_b16 v[100:101], v9 offset:57344
  ds_read_b64_tr_b16 v[102:103], v9 offset:58368
  v_mfma_f32_16x16x32_bf16 v[52:55], v[104:107], v[148:151], v[52:55]
  s_waitcnt lgkmcnt(12)
  v_mfma_f32_16x16x32_bf16 v[56:59], v[108:111], v[144:147], v[56:59]
  ds_read_b64_tr_b16 v[104:105], v10 offset:57344
  ds_read_b64_tr_b16 v[106:107], v10 offset:58368
  v_mfma_f32_16x16x32_bf16 v[60:63], v[108:111], v[148:151], v[60:63]
  s_waitcnt lgkmcnt(12)
  v_mfma_f32_16x16x32_bf16 v[64:67], v[112:115], v[144:147], v[64:67]
  ds_read_b64_tr_b16 v[108:109], v11 offset:57344
  ds_read_b64_tr_b16 v[110:111], v11 offset:58368
  v_mfma_f32_16x16x32_bf16 v[68:71], v[112:115], v[148:151], v[68:71]
  s_waitcnt lgkmcnt(12)
  v_mfma_f32_16x16x32_bf16 v[72:75], v[116:119], v[144:147], v[72:75]
  ds_read_b64_tr_b16 v[112:113], v12 offset:57344
  ds_read_b64_tr_b16 v[114:115], v12 offset:58368
  v_mfma_f32_16x16x32_bf16 v[76:79], v[116:119], v[148:151], v[76:79]
  s_waitcnt lgkmcnt(12)
  v_mfma_f32_16x16x32_bf16 v[80:83], v[120:123], v[144:147], v[80:83]
  ds_read_b64_tr_b16 v[116:117], v13 offset:57344
  ds_read_b64_tr_b16 v[118:119], v13 offset:58368
  v_mfma_f32_16x16x32_bf16 v[84:87], v[120:123], v[148:151], v[84:87]
  s_waitcnt lgkmcnt(12)
  v_mfma_f32_16x16x32_bf16 v[88:91], v[124:127], v[144:147], v[88:91]
  ds_read_b64_tr_b16 v[120:121], v14 offset:57344
  ds_read_b64_tr_b16 v[122:123], v14 offset:58368
  v_mfma_f32_16x16x32_bf16 v[92:95], v[124:127], v[148:151], v[92:95]
  s_waitcnt lgkmcnt(12)
  v_mfma_f32_16x16x32_bf16 v[32:35], v[96:99], v[152:155], v[32:35]
  ds_read_b64_tr_b16 v[124:125], v15 offset:57344
  ds_read_b64_tr_b16 v[126:127], v15 offset:58368
  v_mfma_f32_16x16x32_bf16 v[36:39], v[96:99], v[156:159], v[36:39]
  s_waitcnt lgkmcnt(12)
  v_mfma_f32_16x16x32_bf16 v[40:43], v[100:103], v[152:155], v[40:43]
  s_barrier
  ds_read_b128 v[128:131], v26 offset:0
  ds_read_b128 v[132:135], v26 offset:2048
  ds_read_b128 v[136:139], v27 offset:0
  ds_read_b128 v[140:143], v27 offset:2048
  ds_read_b64_tr_b16 v[96:97], v8 offset:0
  ds_read_b64_tr_b16 v[98:99], v8 offset:1024
  v_mfma_f32_16x16x32_bf16 v[44:47], v[100:103], v[156:159], v[44:47]
  s_waitcnt lgkmcnt(15)
  v_mfma_f32_16x16x32_bf16 v[48:51], v[104:107], v[152:155], v[48:51]
  ds_read_b64_tr_b16 v[100:101], v9 offset:0
  ds_read_b64_tr_b16 v[102:103], v9 offset:1024
  v_mfma_f32_16x16x32_bf16 v[52:55], v[104:107], v[156:159], v[52:55]
  s_waitcnt lgkmcnt(15)
  v_mfma_f32_16x16x32_bf16 v[56:59], v[108:111], v[152:155], v[56:59]
  ds_read_b64_tr_b16 v[104:105], v10 offset:0
  ds_read_b64_tr_b16 v[106:107], v10 offset:1024
  v_mfma_f32_16x16x32_bf16 v[60:63], v[108:111], v[156:159], v[60:63]
  s_waitcnt lgkmcnt(15)
  v_mfma_f32_16x16x32_bf16 v[64:67], v[112:115], v[152:155], v[64:67]
  ds_read_b64_tr_b16 v[108:109], v11 offset:0
  ds_read_b64_tr_b16 v[110:111], v11 offset:1024
  v_mfma_f32_16x16x32_bf16 v[68:71], v[112:115], v[156:159], v[68:71]
  s_waitcnt lgkmcnt(15)
  v_mfma_f32_16x16x32_bf16 v[72:75], v[116:119], v[152:155], v[72:75]
  ds_read_b64_tr_b16 v[112:113], v12 offset:0
  ds_read_b64_tr_b16 v[114:115], v12 offset:1024
  v_mfma_f32_16x16x32_bf16 v[76:79], v[116:119], v[156:159], v[76:79]
  s_waitcnt lgkmcnt(15)
  v_mfma_f32_16x16x32_bf16 v[80:83], v[120:123], v[152:155], v[80:83]
  ds_read_b64_tr_b16 v[116:117], v13 offset:0
  ds_read_b64_tr_b16 v[118:119], v13 offset:1024
  v_mfma_f32_16x16x32_bf16 v[84:87], v[120:123], v[156:159], v[84:87]
  s_waitcnt lgkmcnt(15)
  v_mfma_f32_16x16x32_bf16 v[88:91], v[124:127], v[152:155], v[88:91]
  ds_read_b64_tr_b16 v[120:121], v14 offset:0
  ds_read_b64_tr_b16 v[122:123], v14 offset:1024
  v_mfma_f32_16x16x32_bf16 v[92:95], v[124:127], v[156:159], v[92:95]
  s_waitcnt lgkmcnt(12)
  v_mfma_f32_16x16x32_bf16 v[32:35], v[96:99], v[128:131], v[32:35]
  ds_read_b64_tr_b16 v[124:125], v15 offset:0
  ds_read_b64_tr_b16 v[126:127], v15 offset:1024
  v_mfma_f32_16x16x32_bf16 v[36:39], v[96:99], v[132:135], v[36:39]
  s_waitcnt lgkmcnt(12)
  v_mfma_f32_16x16x32_bf16 v[40:43], v[100:103], v[128:131], v[40:43]
  ds_read_b64_tr_b16 v[96:97], v8 offset:8192
  ds_read_b64_tr_b16 v[98:99], v8 offset:9216
  v_mfma_f32_16x16x32_bf16 v[44:47], v[100:103], v[132:135], v[44:47]
  s_waitcnt lgkmcnt(12)
  v_mfma_f32_16x16x32_bf16 v[48:51], v[104:107], v[128:131], v[48:51]
  ds_read_b64_tr_b16 v[100:101], v9 offset:8192
  ds_read_b64_tr_b16 v[102:103], v9 offset:9216
  v_mfma_f32_16x16x32_bf16 v[52:55], v[104:107], v[132:135], v[52:55]
  s_waitcnt lgkmcnt(12)
  v_mfma_f32_16x16x32_bf16 v[56:59], v[108:111], v[128:131], v[56:59]
  ds_read_b64_tr_b16 v[104:105], v10 offset:8192
  ds_read_b64_tr_b16 v[106:107], v10 offset:9216
  v_mfma_f32_16x16x32_bf16 v[60:63], v[108:111], v[132:135], v[60:63]
  s_waitcnt lgkmcnt(12)
  v_mfma_f32_16x16x32_bf16 v[64:67], v[112:115], v[128:131], v[64:67]
  ds_read_b64_tr_b16 v[108:109], v11 offset:8192
  ds_read_b64_tr_b16 v[110:111], v11 offset:9216
  v_mfma_f32_16x16x32_bf16 v[68:71], v[112:115], v[132:135], v[68:71]
  s_waitcnt lgkmcnt(12)
  v_mfma_f32_16x16x32_bf16 v[72:75], v[116:119], v[128:131], v[72:75]
  ds_read_b64_tr_b16 v[112:113], v12 offset:8192
  ds_read_b64_tr_b16 v[114:115], v12 offset:9216
  v_mfma_f32_16x16x32_bf16 v[76:79], v[116:119], v[132:135], v[76:79]
  s_waitcnt lgkmcnt(12)
  v_mfma_f32_16x16x32_bf16 v[80:83], v[120:123], v[128:131], v[80:83]
  ds_read_b64_tr_b16 v[116:117], v13 offset:8192
  ds_read_b64_tr_b16 v[118:119], v13 offset:9216
  v_mfma_f32_16x16x32_bf16 v[84:87], v[120:123], v[132:135], v[84:87]
  s_waitcnt lgkmcnt(12)
  v_mfma_f32_16x16x32_bf16 v[88:91], v[124:127], v[128:131], v[88:91]
  ds_read_b64_tr_b16 v[120:121], v14 offset:8192
  ds_read_b64_tr_b16 v[122:123], v14 offset:9216
  v_mfma_f32_16x16x32_bf16 v[92:95], v[124:127], v[132:135], v[92:95]
  s_waitcnt lgkmcnt(12)
  v_mfma_f32_16x16x32_bf16 v[32:35], v[96:99], v[136:139], v[32:35]
  ds_read_b64_tr_b16 v[124:125], v15 offset:8192
  ds_read_b64_tr_b16 v[126:127], v15 offset:9216
  v_mfma_f32_16x16x32_bf16 v[36:39], v[96:99], v[140:143], v[36:39]
  s_waitcnt lgkmcnt(12)
  v_mfma_f32_16x16x32_bf16 v[40:43], v[100:103], v[136:139], v[40:43]
  s_sub_u32 s101, s101, 1
  s_cmp_lg_u32 s101, 0
  s_cbranch_scc1 lp_c1
  s_barrier
  ds_read_b128 v[144:147], v26 offset:4096
  ds_read_b128 v[148:151], v26 offset:6144
  ds_read_b128 v[152:155], v27 offset:4096
  ds_read_b128 v[156:159], v27 offset:6144
  ds_read_b64_tr_b16 v[96:97], v8 offset:16384
  ds_read_b64_tr_b16 v[98:99], v8 offset:17408
  v_mfma_f32_16x16x32_bf16 v[44:47], v[100:103], v[140:143], v[44:47]
  s_waitcnt lgkmcnt(15)
  v_mfma_f32_16x16x32_bf16 v[48:51], v[104:107], v[136:139], v[48:51]
  ds_read_b64_tr_b16 v[100:101], v9 offset:16384
  ds_read_b64_tr_b16 v[102:103], v9 offset:17408
  v_mfma_f32_16x16x32_bf16 v[52:55], v[104:107], v[140:143], v[52:55]
  s_waitcnt lgkmcnt(15)
  v_mfma_f32_16x16x32_bf16 v[56:59], v[108:111], v[136:139], v[56:59]
  ds_read_b64_tr_b16 v[104:105], v10 offset:16384
  ds_read_b64_tr_b16 v[106:107], v10 offset:17408
  v_mfma_f32_16x16x32_bf16 v[60:63], v[108:111], v[140:143], v[60:63]
  s_waitcnt lgkmcnt(15)
  v_mfma_f32_16x16x32_bf16 v[64:67], v[112:115], v[136:139], v[64:67]
  ds_read_b64_tr_b16 v[108:109], v11 offset:16384
  ds_read_b64_tr_b16 v[110:111], v11 offset:17408
  v_mfma_f32_16x16x32_bf16 v[68:71], v[112:115], v[140:143], v[68:71]
  s_waitcnt lgkmcnt(15)
  v_mfma_f32_16x16x32_bf16 v[72:75], v[116:119], v[136:139], v[72:75]
  ds_read_b64_tr_b16 v[112:113], v12 offset:16384
  ds_read_b64_tr_b16 v[114:115], v12 offset:17408
  v_mfma_f32_16x16x32_bf16 v[76:79], v[116:119], v[140:143], v[76:79]
  s_waitcnt lgkmcnt(15)
  v_mfma_f32_16x16x32_bf16 v[80:83], v[120:123], v[136:139], v[80:83]
  ds_read_b64_tr_b16 v[116:117], v13 offset:16384
  ds_read_b64_tr_b16 v[118:119], v13 offset:17408
  v_mfma_f32_16x16x32_bf16 v[84:87], v[120:123], v[140:143], v[84:87]
  s_waitcnt lgkmcnt(15)
  v_mfma_f32_16x16x32_bf16 v[88:91], v[124:127], v[136:139], v[88:91]
  ds_read_b64_tr_b16 v[120:121], v14 offset:16384
  ds_read_b64_tr_b16 v[122:123], v14 offset:17408
  v_mfma_f32_16x16x32_bf16 v[92:95], v[124:127], v[140:143], v[92:95]
  s_waitcnt lgkmcnt(12)
  v_mfma_f32_16x16x32_bf16 v[32:35], v[96:99], v[144:147], v[32:35]
  ds_read_b64_tr_b16 v[124:125], v15 offset:16384
  ds_read_b64_tr_b16 v[126:127], v15 offset:17408
  v_mfma_f32_16x16x32_bf16 v[36:39], v[96:99], v[148:151], v[36:39]
  s_waitcnt lgkmcnt(12)
  v_mfma_f32_16x16x32_bf16 v[40:43], v[100:103], v[144:147], v[40:43]
  ds_read_b64_tr_b16 v[96:97], v8 offset:24576
  ds_read_b64_tr_b16 v[98:99], v8 offset:25600
  v_mfma_f32_16x16x32_bf16 v[44:47], v[100:103], v[148:151], v[44:47]
  s_waitcnt lgkmcnt(12)
  v_mfma_f32_16x16x32_bf16 v[48:51], v[104:107], v[144:147], v[48:51]
  ds_read_b64_tr_b16 v[100:101], v9 offset:24576
  ds_read_b64_tr_b16 v[102:103], v9 offset:25600
  v_mfma_f32_16x16x32_bf16 v[52:55], v[104:107], v[148:151], v[52:55]
  s_waitcnt lgkmcnt(12)
  v_mfma_f32_16x16x32_bf16 v[56:59], v[108:111], v[144:147], v[56:59]
  ds_read_b64_tr_b16 v[104:105], v10 offset:24576
  ds_read_b64_tr_b16 v[106:107], v10 offset:25600
  v_mfma_f32_16x16x32_bf16 v[60:63], v[108:111], v[148:151], v[60:63]
  s_waitcnt lgkmcnt(12)
  v_mfma_f32_16x16x32_bf16 v[64:67], v[112:115], v[144:147], v[64:67]
  ds_read_b64_tr_b16 v[108:109], v11 offset:24576
  ds_read_b64_tr_b16 v[110:111], v11 offset:25600
  v_mfma_f32_16x16x32_bf16 v[68:71], v[112:115], v[148:151], v[68:71]
  s_waitcnt lgkmcnt(12)
  v_mfma_f32_16x16x32_bf16 v[72:75], v[116:119], v[144:147], v[72:75]
  ds_read_b64_tr_b16 v[112:113], v12 offset:24576
  ds_read_b64_tr_b16 v[114:115], v12 offset:25600
  v_mfma_f32_16x16x32_bf16 v[76:79], v[116:119], v[148:151], v[76:79]
  s_waitcnt lgkmcnt(12)
  v_mfma_f32_16x16x32_bf16 v[80:83], v[120:123], v[144:147], v[80:83]
  ds_read_b64_tr_b16 v[116:117], v13 offset:24576
  ds_read_b64_tr_b16 v[118:119], v13 offset:25600
  v_mfma_f32_16x16x32_bf16 v[84:87], v[120:123], v[148:151], v[84:87]
  s_waitcnt lgkmcnt(12)
  v_mfma_f32_16x16x32_bf16 v[88:91], v[124:127], v[144:147], v[88:91]
  ds_read_b64_tr_b16 v[120:121], v14 offset:24576
  ds_read_b64_tr_b16 v[122:123], v14 offset:25600
  v_mfma_f32_16x16x32_bf16 v[92:95], v[124:127], v[148:151], v[92:95]
  s_waitcnt lgkmcnt(12)
  v_mfma_f32_16x16x32_bf16 v[32:35], v[96:99], v[152:155], v[32:35]
  ds_read_b64_tr_b16 v[124:125], v15 offset:24576
  ds_read_b64_tr_b16 v[126:127], v15 offset:25600
  v_mfma_f32_16x16x32_bf16 v[36:39], v[96:99], v[156:159], v[36:39]
  s_waitcnt lgkmcnt(12)
  v_mfma_f32_16x16x32_bf16 v[40:43], v[100:103], v[152:155], v[40:43]
  s_barrier
  ds_read_b128 v[128:131], v26 offset:8192
  ds_read_b128 v[132:135], v26 offset:10240
  ds_read_b128 v[136:139], v27 offset:8192
  ds_read_b128 v[140:143], v27 offset:10240
  ds_read_b64_tr_b16 v[96:97], v8 offset:32768
  ds_read_b64_tr_b16 v[98:99], v8 offset:33792
  v_mfma_f32_16x16x32_bf16 v[44:47], v[100:103], v[156:159], v[44:47]
  buffer_load_dwordx2 v[160:161], v24, s[48:51], 0 offen sc1
  buffer_load_dwordx2 v[162:163], v25, s[48:51], 0 offen sc1
  s_waitcnt lgkmcnt(15)
  v_mfma_f32_16x16x32_bf16 v[48:51], v[104:107], v[152:155], v[48:51]
  ds_read_b64_tr_b16 v[100:101], v9 offset:32768
  ds_read_b64_tr_b16 v[102:103], v9 offset:33792
  v_mfma_f32_16x16x32_bf16 v[52:55], v[104:107], v[156:159], v[52:55]
  s_waitcnt lgkmcnt(15)
  v_mfma_f32_16x16x32_bf16 v[56:59], v[108:111], v[152:155], v[56:59]
  ds_read_b64_tr_b16 v[104:105], v10 offset:32768
  ds_read_b64_tr_b16 v[106:107], v10 offset:33792
  v_mfma_f32_16x16x32_bf16 v[60:63], v[108:111], v[156:159], v[60:63]
  s_waitcnt lgkmcnt(15)
  v_mfma_f32_16x16x32_bf16 v[64:67], v[112:115], v[152:155], v[64:67]
  ds_read_b64_tr_b16 v[108:109], v11 offset:32768
  ds_read_b64_tr_b16 v[110:111], v11 offset:33792
  v_mfma_f32_16x16x32_bf16 v[68:71], v[112:115], v[156:159], v[68:71]
  s_waitcnt lgkmcnt(15)
  v_mfma_f32_16x16x32_bf16 v[72:75], v[116:119], v[152:155], v[72:75]
  ds_read_b64_tr_b16 v[112:113], v12 offset:32768
  ds_read_b64_tr_b16 v[114:115], v12 offset:33792
  v_mfma_f32_16x16x32_bf16 v[76:79], v[116:119], v[156:159], v[76:79]
  s_waitcnt lgkmcnt(15)
  v_mfma_f32_16x16x32_bf16 v[80:83], v[120:123], v[152:155], v[80:83]
  ds_read_b64_tr_b16 v[116:117], v13 offset:32768
  ds_read_b64_tr_b16 v[118:119], v13 offset:33792
  v_mfma_f32_16x16x32_bf16 v[84:87], v[120:123], v[156:159], v[84:87]
  s_waitcnt lgkmcnt(15)
  v_mfma_f32_16x16x32_bf16 v[88:91], v[124:127], v[152:155], v[88:91]
  ds_read_b64_tr_b16 v[120:121], v14 offset:32768
  ds_read_b64_tr_b16 v[122:123], v14 offset:33792
  v_mfma_f32_16x16x32_bf16 v[92:95], v[124:127], v[156:159], v[92:95]
  s_waitcnt lgkmcnt(12)
  v_mfma_f32_16x16x32_bf16 v[32:35], v[96:99], v[128:131], v[32:35]
  ds_read_b64_tr_b16 v[124:125], v15 offset:32768
  ds_read_b64_tr_b16 v[126:127], v15 offset:33792
  v_mfma_f32_16x16x32_bf16 v[36:39], v[96:99], v[132:135], v[36:39]
  s_waitcnt lgkmcnt(12)
  v_mfma_f32_16x16x32_bf16 v[40:43], v[100:103], v[128:131], v[40:43]
  ds_read_b64_tr_b16 v[96:97], v8 offset:40960
  ds_read_b64_tr_b16 v[98:99], v8 offset:41984
  v_mfma_f32_16x16x32_bf16 v[44:47], v[100:103], v[132:135], v[44:47]
  s_waitcnt lgkmcnt(12)
  v_mfma_f32_16x16x32_bf16 v[48:51], v[104:107], v[128:131], v[48:51]
  ds_read_b64_tr_b16 v[100:101], v9 offset:40960
  ds_read_b64_tr_b16 v[102:103], v9 offset:41984
  v_mfma_f32_16x16x32_bf16 v[52:55], v[104:107], v[132:135], v[52:55]
  s_waitcnt lgkmcnt(12)
  v_mfma_f32_16x16x32_bf16 v[56:59], v[108:111], v[128:131], v[56:59]
  ds_read_b64_tr_b16 v[104:105], v10 offset:40960
  ds_read_b64_tr_b16 v[106:107], v10 offset:41984
  v_mfma_f32_16x16x32_bf16 v[60:63], v[108:111], v[132:135], v[60:63]
  s_waitcnt lgkmcnt(12)
  v_mfma_f32_16x16x32_bf16 v[64:67], v[112:115], v[128:131], v[64:67]
  ds_read_b64_tr_b16 v[108:109], v11 offset:40960
  ds_read_b64_tr_b16 v[110:111], v11 offset:41984
  v_mfma_f32_16x16x32_bf16 v[68:71], v[112:115], v[132:135], v[68:71]
  s_waitcnt lgkmcnt(12)
  v_mfma_f32_16x16x32_bf16 v[72:75], v[116:119], v[128:131], v[72:75]
  ds_read_b64_tr_b16 v[112:113], v12 offset:40960
  ds_read_b64_tr_b16 v[114:115], v12 offset:41984
  v_mfma_f32_16x16x32_bf16 v[76:79], v[116:119], v[132:135], v[76:79]
  s_waitcnt lgkmcnt(12)
  v_mfma_f32_16x16x32_bf16 v[80:83], v[120:123], v[128:131], v[80:83]
  ds_read_b64_tr_b16 v[116:117], v13 offset:40960
  ds_read_b64_tr_b16 v[118:119], v13 offset:41984
  v_mfma_f32_16x16x32_bf16 v[84:87], v[120:123], v[132:135], v[84:87]
  s_waitcnt lgkmcnt(12)
  v_mfma_f32_16x16x32_bf16 v[88:91], v[124:127], v[128:131], v[88:91]
  ds_read_b64_tr_b16 v[120:121], v14 offset:40960
  ds_read_b64_tr_b16 v[122:123], v14 offset:41984
  v_mfma_f32_16x16x32_bf16 v[92:95], v[124:127], v[132:135], v[92:95]
  s_waitcnt lgkmcnt(12)
  v_mfma_f32_16x16x32_bf16 v[32:35], v[96:99], v[136:139], v[32:35]
  ds_read_b64_tr_b16 v[124:125], v15 offset:40960
  ds_read_b64_tr_b16 v[126:127], v15 offset:41984
  v_mfma_f32_16x16x32_bf16 v[36:39], v[96:99], v[140:143], v[36:39]
  s_waitcnt lgkmcnt(12)
  v_mfma_f32_16x16x32_bf16 v[40:43], v[100:103], v[136:139], v[40:43]
  s_barrier
  ds_read_b128 v[144:147], v26 offset:12288
  ds_read_b128 v[148:151], v26 offset:14336
  ds_read_b128 v[152:155], v27 offset:12288
  ds_read_b128 v[156:159], v27 offset:14336
  ds_read_b64_tr_b16 v[96:97], v8 offset:49152
  ds_read_b64_tr_b16 v[98:99], v8 offset:50176
  v_mfma_f32_16x16x32_bf16 v[44:47], v[100:103], v[140:143], v[44:47]
  s_waitcnt lgkmcnt(15)
  v_mfma_f32_16x16x32_bf16 v[48:51], v[104:107], v[136:139], v[48:51]
  ds_read_b64_tr_b16 v[100:101], v9 offset:49152
  ds_read_b64_tr_b16 v[102:103], v9 offset:50176
  v_mfma_f32_16x16x32_bf16 v[52:55], v[104:107], v[140:143], v[52:55]
  s_waitcnt lgkmcnt(15)
  v_mfma_f32_16x16x32_bf16 v[56:59], v[108:111], v[136:139], v[56:59]
  ds_read_b64_tr_b16 v[104:105], v10 offset:49152
  ds_read_b64_tr_b16 v[106:107], v10 offset:50176
  v_mfma_f32_16x16x32_bf16 v[60:63], v[108:111], v[140:143], v[60:63]
  s_waitcnt lgkmcnt(15)
  v_mfma_f32_16x16x32_bf16 v[64:67], v[112:115], v[136:139], v[64:67]
  ds_read_b64_tr_b16 v[108:109], v11 offset:49152
  ds_read_b64_tr_b16 v[110:111], v11 offset:50176
  v_mfma_f32_16x16x32_bf16 v[68:71], v[112:115], v[140:143], v[68:71]
  s_waitcnt lgkmcnt(15)
  v_mfma_f32_16x16x32_bf16 v[72:75], v[116:119], v[136:139], v[72:75]
  ds_read_b64_tr_b16 v[112:113], v12 offset:49152
  ds_read_b64_tr_b16 v[114:115], v12 offset:50176
  v_mfma_f32_16x16x32_bf16 v[76:79], v[116:119], v[140:143], v[76:79]
  s_waitcnt lgkmcnt(15)
  v_mfma_f32_16x16x32_bf16 v[80:83], v[120:123], v[136:139], v[80:83]
  ds_read_b64_tr_b16 v[116:117], v13 offset:49152
  ds_read_b64_tr_b16 v[118:119], v13 offset:50176
  v_mfma_f32_16x16x32_bf16 v[84:87], v[120:123], v[140:143], v[84:87]
  s_waitcnt lgkmcnt(15)
  v_mfma_f32_16x16x32_bf16 v[88:91], v[124:127], v[136:139], v[88:91]
  ds_read_b64_tr_b16 v[120:121], v14 offset:49152
  ds_read_b64_tr_b16 v[122:123], v14 offset:50176
  v_mfma_f32_16x16x32_bf16 v[92:95], v[124:127], v[140:143], v[92:95]
  s_waitcnt lgkmcnt(12)
  v_mfma_f32_16x16x32_bf16 v[32:35], v[96:99], v[144:147], v[32:35]
  ds_read_b64_tr_b16 v[124:125], v15 offset:49152
  ds_read_b64_tr_b16 v[126:127], v15 offset:50176
  v_mfma_f32_16x16x32_bf16 v[36:39], v[96:99], v[148:151], v[36:39]
  s_waitcnt lgkmcnt(12)
  v_mfma_f32_16x16x32_bf16 v[40:43], v[100:103], v[144:147], v[40:43]
  ds_read_b64_tr_b16 v[96:97], v8 offset:57344
  ds_read_b64_tr_b16 v[98:99], v8 offset:58368
  v_mfma_f32_16x16x32_bf16 v[44:47], v[100:103], v[148:151], v[44:47]
  s_waitcnt lgkmcnt(12)
  v_mfma_f32_16x16x32_bf16 v[48:51], v[104:107], v[144:147], v[48:51]
  ds_read_b64_tr_b16 v[100:101], v9 offset:57344
  ds_read_b64_tr_b16 v[102:103], v9 offset:58368
  v_mfma_f32_16x16x32_bf16 v[52:55], v[104:107], v[148:151], v[52:55]
  s_waitcnt lgkmcnt(12)
  v_mfma_f32_16x16x32_bf16 v[56:59], v[108:111], v[144:147], v[56:59]
  ds_read_b64_tr_b16 v[104:105], v10 offset:57344
  ds_read_b64_tr_b16 v[106:107], v10 offset:58368
  v_mfma_f32_16x16x32_bf16 v[60:63], v[108:111], v[148:151], v[60:63]
  s_waitcnt lgkmcnt(12)
  v_mfma_f32_16x16x32_bf16 v[64:67], v[112:115], v[144:147], v[64:67]
  ds_read_b64_tr_b16 v[108:109], v11 offset:57344
  ds_read_b64_tr_b16 v[110:111], v11 offset:58368
  v_mfma_f32_16x16x32_bf16 v[68:71], v[112:115], v[148:151], v[68:71]
  s_waitcnt lgkmcnt(12)
  v_mfma_f32_16x16x32_bf16 v[72:75], v[116:119], v[144:147], v[72:75]
  ds_read_b64_tr_b16 v[112:113], v12 offset:57344
  ds_read_b64_tr_b16 v[114:115], v12 offset:58368
  v_mfma_f32_16x16x32_bf16 v[76:79], v[116:119], v[148:151], v[76:79]
  s_waitcnt lgkmcnt(12)
  v_mfma_f32_16x16x32_bf16 v[80:83], v[120:123], v[144:147], v[80:83]
  ds_read_b64_tr_b16 v[116:117], v13 offset:57344
  ds_read_b64_tr_b16 v[118:119], v13 offset:58368
  v_mfma_f32_16x16x32_bf16 v[84:87], v[120:123], v[148:151], v[84:87]
  s_waitcnt lgkmcnt(12)
  v_mfma_f32_16x16x32_bf16 v[88:91], v[124:127], v[144:147], v[88:91]
  ds_read_b64_tr_b16 v[120:121], v14 offset:57344
  ds_read_b64_tr_b16 v[122:123], v14 offset:58368
  v_mfma_f32_16x16x32_bf16 v[92:95], v[124:127], v[148:151], v[92:95]
  s_waitcnt lgkmcnt(12)
  v_mfma_f32_16x16x32_bf16 v[32:35], v[96:99], v[152:155], v[32:35]
  ds_read_b64_tr_b16 v[124:125], v15 offset:57344
  ds_read_b64_tr_b16 v[126:127], v15 offset:58368
  v_mfma_f32_16x16x32_bf16 v[36:39], v[96:99], v[156:159], v[36:39]
  s_waitcnt lgkmcnt(12)
  v_mfma_f32_16x16x32_bf16 v[40:43], v[100:103], v[152:155], v[40:43]
  v_mfma_f32_16x16x32_bf16 v[44:47], v[100:103], v[156:159], v[44:47]
  s_waitcnt lgkmcnt(10)
  v_mfma_f32_16x16x32_bf16 v[48:51], v[104:107], v[152:155], v[48:51]
  v_mfma_f32_16x16x32_bf16 v[52:55], v[104:107], v[156:159], v[52:55]
  s_waitcnt lgkmcnt(8)
  v_mfma_f32_16x16x32_bf16 v[56:59], v[108:111], v[152:155], v[56:59]
  v_mfma_f32_16x16x32_bf16 v[60:63], v[108:111], v[156:159], v[60:63]
  s_waitcnt lgkmcnt(6)
  v_mfma_f32_16x16x32_bf16 v[64:67], v[112:115], v[152:155], v[64:67]
  v_mfma_f32_16x16x32_bf16 v[68:71], v[112:115], v[156:159], v[68:71]
  s_waitcnt lgkmcnt(4)
  v_mfma_f32_16x16x32_bf16 v[72:75], v[116:119], v[152:155], v[72:75]
  v_mfma_f32_16x16x32_bf16 v[76:79], v[116:119], v[156:159], v[76:79]
  s_waitcnt lgkmcnt(2)
  v_mfma_f32_16x16x32_bf16 v[80:83], v[120:123], v[152:155], v[80:83]
  v_mfma_f32_16x16x32_bf16 v[84:87], v[120:123], v[156:159], v[84:87]
  s_waitcnt lgkmcnt(0)
  v_mfma_f32_16x16x32_bf16 v[88:91], v[124:127], v[152:155], v[88:91]
  v_mfma_f32_16x16x32_bf16 v[92:95], v[124:127], v[156:159], v[92:95]
g1_epi:
  v_lshrrev_b32 v4, 4, v3
  v_lshlrev_b32 v4, 4, v4
  v_add_u32 v4, 162816, v4
  ds_read_b128 v[176:179], v4 offset:0
  ds_read_b128 v[180:183], v4 offset:64
  ds_read_b128 v[184:187], v4 offset:128
  ds_read_b128 v[188:191], v4 offset:192
  ds_read_b128 v[192:195], v4 offset:256
  ds_read_b128 v[196:199], v4 offset:320
  ds_read_b128 v[200:203], v4 offset:384
  ds_read_b128 v[204:207], v4 offset:448
  s_waitcnt vmcnt(0)
  v_mul_f32 v28, v161, v161
  v_mul_f32 v28, 0xb727c5ac, v28
  v_add_f32 v28, 0x3f800054, v28
  v_rsq_f32 v28, v28
  s_nop 0
  v_mul_f32 v28, v28, v161
  v_sub_f32 v168, 0, v160
  v_rcp_f32 v169, v28
  v_mul_f32 v29, v28, v28
  v_mul_f32 v171, 0xc0135761, v28
  v_mul_f32 v29, 0x3d372713, v29
  v_mul_f32 v170, v29, v171
  v_mul_f32 v28, v163, v163
  v_mul_f32 v28, 0xb727c5ac, v28
  v_add_f32 v28, 0x3f800054, v28
  v_rsq_f32 v28, v28
  s_nop 0
  v_mul_f32 v28, v28, v163
  v_sub_f32 v172, 0, v162
  v_rcp_f32 v173, v28
  v_mul_f32 v29, v28, v28
  v_mul_f32 v175, 0xc0135761, v28
  v_mul_f32 v29, 0x3d372713, v29
  v_mul_f32 v174, v29, v175
  s_waitcnt lgkmcnt(6)
  v_pk_fma_f32 v[32:33], v[176:177], v[168:169], v[32:33] op_sel_hi:[1,0,1]
  v_pk_fma_f32 v[34:35], v[178:179], v[168:169], v[34:35] op_sel_hi:[1,0,1]
  v_pk_fma_f32 v[40:41], v[180:181], v[168:169], v[40:41] op_sel_hi:[1,0,1]
  v_pk_fma_f32 v[42:43], v[182:183], v[168:169], v[42:43] op_sel_hi:[1,0,1]
  v_pk_fma_f32 v[36:37], v[176:177], v[172:173], v[36:37] op_sel_hi:[1,0,1]
  v_pk_fma_f32 v[38:39], v[178:179], v[172:173], v[38:39] op_sel_hi:[1,0,1]
  v_pk_fma_f32 v[44:45], v[180:181], v[172:173], v[44:45] op_sel_hi:[1,0,1]
  v_pk_fma_f32 v[46:47], v[182:183], v[172:173], v[46:47] op_sel_hi:[1,0,1]
  v_pk_mul_f32 v[208:209], v[32:33], v[32:33]
  v_pk_mul_f32 v[210:211], v[34:35], v[34:35]
  v_pk_mul_f32 v[212:213], v[40:41], v[40:41]
  v_pk_mul_f32 v[214:215], v[42:43], v[42:43]
  v_pk_mul_f32 v[216:217], v[36:37], v[36:37]
  v_pk_mul_f32 v[218:219], v[38:39], v[38:39]
  v_pk_mul_f32 v[220:221], v[44:45], v[44:45]
  v_pk_mul_f32 v[222:223], v[46:47], v[46:47]
  v_pk_fma_f32 v[208:209], v[208:209], v[170:171], v[170:171] op_sel:[0,0,1] op_sel_hi:[1,0,1]
  v_pk_fma_f32 v[210:211], v[210:211], v[170:171], v[170:171] op_sel:[0,0,1] op_sel_hi:[1,0,1]
  v_pk_fma_f32 v[212:213], v[212:213], v[170:171], v[170:171] op_sel:[0,0,1] op_sel_hi:[1,0,1]
  v_pk_fma_f32 v[214:215], v[214:215], v[170:171], v[170:171] op_sel:[0,0,1] op_sel_hi:[1,0,1]
  v_pk_fma_f32 v[216:217], v[216:217], v[174:175], v[174:175] op_sel:[0,0,1] op_sel_hi:[1,0,1]
  v_pk_fma_f32 v[218:219], v[218:219], v[174:175], v[174:175] op_sel:[0,0,1] op_sel_hi:[1,0,1]
  v_pk_fma_f32 v[220:221], v[220:221], v[174:175], v[174:175] op_sel:[0,0,1] op_sel_hi:[1,0,1]
  v_pk_fma_f32 v[222:223], v[222:223], v[174:175], v[174:175] op_sel:[0,0,1] op_sel_hi:[1,0,1]
  v_pk_mul_f32 v[208:209], v[208:209], v[32:33]
  v_pk_mul_f32 v[210:211], v[210:211], v[34:35]
  v_pk_mul_f32 v[212:213], v[212:213], v[40:41]
  v_pk_mul_f32 v[214:215], v[214:215], v[42:43]
  v_pk_mul_f32 v[216:217], v[216:217], v[36:37]
  v_pk_mul_f32 v[218:219], v[218:219], v[38:39]
  v_pk_mul_f32 v[220:221], v[220:221], v[44:45]
  v_pk_mul_f32 v[222:223], v[222:223], v[46:47]
  v_exp_f32 v208, v208
  v_exp_f32 v209, v209
  v_exp_f32 v210, v210
  v_exp_f32 v211, v211
  v_exp_f32 v212, v212
  v_exp_f32 v213, v213
  v_exp_f32 v214, v214
  v_exp_f32 v215, v215
  v_exp_f32 v216, v216
  v_exp_f32 v217, v217
  v_exp_f32 v218, v218
  v_exp_f32 v219, v219
  v_exp_f32 v220, v220
  v_exp_f32 v221, v221
  v_exp_f32 v222, v222
  v_exp_f32 v223, v223
  v_pk_fma_f32 v[208:209], v[208:209], v[168:169], v[168:169] op_sel:[0,1,1] op_sel_hi:[1,1,1]
  v_pk_fma_f32 v[210:211], v[210:211], v[168:169], v[168:169] op_sel:[0,1,1] op_sel_hi:[1,1,1]
  v_pk_fma_f32 v[212:213], v[212:213], v[168:169], v[168:169] op_sel:[0,1,1] op_sel_hi:[1,1,1]
  v_pk_fma_f32 v[214:215], v[214:215], v[168:169], v[168:169] op_sel:[0,1,1] op_sel_hi:[1,1,1]
  v_pk_fma_f32 v[216:217], v[216:217], v[172:173], v[172:173] op_sel:[0,1,1] op_sel_hi:[1,1,1]
  v_pk_fma_f32 v[218:219], v[218:219], v[172:173], v[172:173] op_sel:[0,1,1] op_sel_hi:[1,1,1]
  v_pk_fma_f32 v[220:221], v[220:221], v[172:173], v[172:173] op_sel:[0,1,1] op_sel_hi:[1,1,1]
  v_pk_fma_f32 v[222:223], v[222:223], v[172:173], v[172:173] op_sel:[0,1,1] op_sel_hi:[1,1,1]
  v_rcp_f32 v208, v208
  v_rcp_f32 v209, v209
  v_rcp_f32 v210, v210
  v_rcp_f32 v211, v211
  v_rcp_f32 v212, v212
  v_rcp_f32 v213, v213
  v_rcp_f32 v214, v214
  v_rcp_f32 v215, v215
  v_rcp_f32 v216, v216
  v_rcp_f32 v217, v217
  v_rcp_f32 v218, v218
  v_rcp_f32 v219, v219
  v_rcp_f32 v220, v220
  v_rcp_f32 v221, v221
  v_rcp_f32 v222, v222
  v_rcp_f32 v223, v223
  v_pk_mul_f32 v[32:33], v[32:33], v[208:209]
  v_pk_mul_f32 v[34:35], v[34:35], v[210:211]
  v_pk_mul_f32 v[40:41], v[40:41], v[212:213]
  v_pk_mul_f32 v[42:43], v[42:43], v[214:215]
  v_pk_mul_f32 v[36:37], v[36:37], v[216:217]
  v_pk_mul_f32 v[38:39], v[38:39], v[218:219]
  v_pk_mul_f32 v[44:45], v[44:45], v[220:221]
  v_pk_mul_f32 v[46:47], v[46:47], v[222:223]
  v_cvt_pk_bf16_f32 v224, v32, v33
  v_cvt_pk_bf16_f32 v225, v34, v35
  v_cvt_pk_bf16_f32 v226, v40, v41
  v_cvt_pk_bf16_f32 v227, v42, v43
  v_cvt_pk_bf16_f32 v228, v36, v37
  v_cvt_pk_bf16_f32 v229, v38, v39
  v_cvt_pk_bf16_f32 v230, v44, v45
  v_cvt_pk_bf16_f32 v231, v46, v47
  buffer_store_dwordx4 v[224:227], v6, s[12:15], 0 offen offset:0 sc1
  buffer_store_dwordx4 v[228:231], v7, s[12:15], 0 offen offset:0 sc1
  s_waitcnt lgkmcnt(4)
  v_pk_fma_f32 v[48:49], v[184:185], v[168:169], v[48:49] op_sel_hi:[1,0,1]
  v_pk_fma_f32 v[50:51], v[186:187], v[168:169], v[50:51] op_sel_hi:[1,0,1]
  v_pk_fma_f32 v[56:57], v[188:189], v[168:169], v[56:57] op_sel_hi:[1,0,1]
  v_pk_fma_f32 v[58:59], v[190:191], v[168:169], v[58:59] op_sel_hi:[1,0,1]
  v_pk_fma_f32 v[52:53], v[184:185], v[172:173], v[52:53] op_sel_hi:[1,0,1]
  v_pk_fma_f32 v[54:55], v[186:187], v[172:173], v[54:55] op_sel_hi:[1,0,1]
  v_pk_fma_f32 v[60:61], v[188:189], v[172:173], v[60:61] op_sel_hi:[1,0,1]
  v_pk_fma_f32 v[62:63], v[190:191], v[172:173], v[62:63] op_sel_hi:[1,0,1]
  v_pk_mul_f32 v[208:209], v[48:49], v[48:49]
  v_pk_mul_f32 v[210:211], v[50:51], v[50:51]
  v_pk_mul_f32 v[212:213], v[56:57], v[56:57]
  v_pk_mul_f32 v[214:215], v[58:59], v[58:59]
  v_pk_mul_f32 v[216:217], v[52:53], v[52:53]
  v_pk_mul_f32 v[218:219], v[54:55], v[54:55]
  v_pk_mul_f32 v[220:221], v[60:61], v[60:61]
  v_pk_mul_f32 v[222:223], v[62:63], v[62:63]
  v_pk_fma_f32 v[208:209], v[208:209], v[170:171], v[170:171] op_sel:[0,0,1] op_sel_hi:[1,0,1]
  v_pk_fma_f32 v[210:211], v[210:211], v[170:171], v[170:171] op_sel:[0,0,1] op_sel_hi:[1,0,1]
  v_pk_fma_f32 v[212:213], v[212:213], v[170:171], v[170:171] op_sel:[0,0,1] op_sel_hi:[1,0,1]
  v_pk_fma_f32 v[214:215], v[214:215], v[170:171], v[170:171] op_sel:[0,0,1] op_sel_hi:[1,0,1]
  v_pk_fma_f32 v[216:217], v[216:217], v[174:175], v[174:175] op_sel:[0,0,1] op_sel_hi:[1,0,1]
  v_pk_fma_f32 v[218:219], v[218:219], v[174:175], v[174:175] op_sel:[0,0,1] op_sel_hi:[1,0,1]
  v_pk_fma_f32 v[220:221], v[220:221], v[174:175], v[174:175] op_sel:[0,0,1] op_sel_hi:[1,0,1]
  v_pk_fma_f32 v[222:223], v[222:223], v[174:175], v[174:175] op_sel:[0,0,1] op_sel_hi:[1,0,1]
  v_pk_mul_f32 v[208:209], v[208:209], v[48:49]
  v_pk_mul_f32 v[210:211], v[210:211], v[50:51]
  v_pk_mul_f32 v[212:213], v[212:213], v[56:57]
  v_pk_mul_f32 v[214:215], v[214:215], v[58:59]
  v_pk_mul_f32 v[216:217], v[216:217], v[52:53]
  v_pk_mul_f32 v[218:219], v[218:219], v[54:55]
  v_pk_mul_f32 v[220:221], v[220:221], v[60:61]
  v_pk_mul_f32 v[222:223], v[222:223], v[62:63]
  v_exp_f32 v208, v208
  v_exp_f32 v209, v209
  v_exp_f32 v210, v210
  v_exp_f32 v211, v211
  v_exp_f32 v212, v212
  v_exp_f32 v213, v213
  v_exp_f32 v214, v214
  v_exp_f32 v215, v215
  v_exp_f32 v216, v216
  v_exp_f32 v217, v217
  v_exp_f32 v218, v218
  v_exp_f32 v219, v219
  v_exp_f32 v220, v220
  v_exp_f32 v221, v221
  v_exp_f32 v222, v222
  v_exp_f32 v223, v223
  v_pk_fma_f32 v[208:209], v[208:209], v[168:169], v[168:169] op_sel:[0,1,1] op_sel_hi:[1,1,1]
  v_pk_fma_f32 v[210:211], v[210:211], v[168:169], v[168:169] op_sel:[0,1,1] op_sel_hi:[1,1,1]
  v_pk_fma_f32 v[212:213], v[212:213], v[168:169], v[168:169] op_sel:[0,1,1] op_sel_hi:[1,1,1]
  v_pk_fma_f32 v[214:215], v[214:215], v[168:169], v[168:169] op_sel:[0,1,1] op_sel_hi:[1,1,1]
  v_pk_fma_f32 v[216:217], v[216:217], v[172:173], v[172:173] op_sel:[0,1,1] op_sel_hi:[1,1,1]
  v_pk_fma_f32 v[218:219], v[218:219], v[172:173], v[172:173] op_sel:[0,1,1] op_sel_hi:[1,1,1]
  v_pk_fma_f32 v[220:221], v[220:221], v[172:173], v[172:173] op_sel:[0,1,1] op_sel_hi:[1,1,1]
  v_pk_fma_f32 v[222:223], v[222:223], v[172:173], v[172:173] op_sel:[0,1,1] op_sel_hi:[1,1,1]
  v_rcp_f32 v208, v208
  v_rcp_f32 v209, v209
  v_rcp_f32 v210, v210
  v_rcp_f32 v211, v211
  v_rcp_f32 v212, v212
  v_rcp_f32 v213, v213
  v_rcp_f32 v214, v214
  v_rcp_f32 v215, v215
  v_rcp_f32 v216, v216
  v_rcp_f32 v217, v217
  v_rcp_f32 v218, v218
  v_rcp_f32 v219, v219
  v_rcp_f32 v220, v220
  v_rcp_f32 v221, v221
  v_rcp_f32 v222, v222
  v_rcp_f32 v223, v223
  v_pk_mul_f32 v[48:49], v[48:49], v[208:209]
  v_pk_mul_f32 v[50:51], v[50:51], v[210:211]
  v_pk_mul_f32 v[56:57], v[56:57], v[212:213]
  v_pk_mul_f32 v[58:59], v[58:59], v[214:215]
  v_pk_mul_f32 v[52:53], v[52:53], v[216:217]
  v_pk_mul_f32 v[54:55], v[54:55], v[218:219]
  v_pk_mul_f32 v[60:61], v[60:61], v[220:221]
  v_pk_mul_f32 v[62:63], v[62:63], v[222:223]
  v_cvt_pk_bf16_f32 v232, v48, v49
  v_cvt_pk_bf16_f32 v233, v50, v51
  v_cvt_pk_bf16_f32 v234, v56, v57
  v_cvt_pk_bf16_f32 v235, v58, v59
  v_cvt_pk_bf16_f32 v236, v52, v53
  v_cvt_pk_bf16_f32 v237, v54, v55
  v_cvt_pk_bf16_f32 v238, v60, v61
  v_cvt_pk_bf16_f32 v239, v62, v63
  buffer_store_dwordx4 v[232:235], v6, s[12:15], 0 offen offset:1024 sc1
  buffer_store_dwordx4 v[236:239], v7, s[12:15], 0 offen offset:1024 sc1
  s_waitcnt lgkmcnt(2)
  v_pk_fma_f32 v[64:65], v[192:193], v[168:169], v[64:65] op_sel_hi:[1,0,1]
  v_pk_fma_f32 v[66:67], v[194:195], v[168:169], v[66:67] op_sel_hi:[1,0,1]
  v_pk_fma_f32 v[72:73], v[196:197], v[168:169], v[72:73] op_sel_hi:[1,0,1]
  v_pk_fma_f32 v[74:75], v[198:199], v[168:169], v[74:75] op_sel_hi:[1,0,1]
  v_pk_fma_f32 v[68:69], v[192:193], v[172:173], v[68:69] op_sel_hi:[1,0,1]
  v_pk_fma_f32 v[70:71], v[194:195], v[172:173], v[70:71] op_sel_hi:[1,0,1]
  v_pk_fma_f32 v[76:77], v[196:197], v[172:173], v[76:77] op_sel_hi:[1,0,1]
  v_pk_fma_f32 v[78:79], v[198:199], v[172:173], v[78:79] op_sel_hi:[1,0,1]
  v_pk_mul_f32 v[208:209], v[64:65], v[64:65]
  v_pk_mul_f32 v[210:211], v[66:67], v[66:67]
  v_pk_mul_f32 v[212:213], v[72:73], v[72:73]
  v_pk_mul_f32 v[214:215], v[74:75], v[74:75]
  v_pk_mul_f32 v[216:217], v[68:69], v[68:69]
  v_pk_mul_f32 v[218:219], v[70:71], v[70:71]
  v_pk_mul_f32 v[220:221], v[76:77], v[76:77]
  v_pk_mul_f32 v[222:223], v[78:79], v[78:79]
  v_pk_fma_f32 v[208:209], v[208:209], v[170:171], v[170:171] op_sel:[0,0,1] op_sel_hi:[1,0,1]
  v_pk_fma_f32 v[210:211], v[210:211], v[170:171], v[170:171] op_sel:[0,0,1] op_sel_hi:[1,0,1]
  v_pk_fma_f32 v[212:213], v[212:213], v[170:171], v[170:171] op_sel:[0,0,1] op_sel_hi:[1,0,1]
  v_pk_fma_f32 v[214:215], v[214:215], v[170:171], v[170:171] op_sel:[0,0,1] op_sel_hi:[1,0,1]
  v_pk_fma_f32 v[216:217], v[216:217], v[174:175], v[174:175] op_sel:[0,0,1] op_sel_hi:[1,0,1]
  v_pk_fma_f32 v[218:219], v[218:219], v[174:175], v[174:175] op_sel:[0,0,1] op_sel_hi:[1,0,1]
  v_pk_fma_f32 v[220:221], v[220:221], v[174:175], v[174:175] op_sel:[0,0,1] op_sel_hi:[1,0,1]
  v_pk_fma_f32 v[222:223], v[222:223], v[174:175], v[174:175] op_sel:[0,0,1] op_sel_hi:[1,0,1]
  v_pk_mul_f32 v[208:209], v[208:209], v[64:65]
  v_pk_mul_f32 v[210:211], v[210:211], v[66:67]
  v_pk_mul_f32 v[212:213], v[212:213], v[72:73]
  v_pk_mul_f32 v[214:215], v[214:215], v[74:75]
  v_pk_mul_f32 v[216:217], v[216:217], v[68:69]
  v_pk_mul_f32 v[218:219], v[218:219], v[70:71]
  v_pk_mul_f32 v[220:221], v[220:221], v[76:77]
  v_pk_mul_f32 v[222:223], v[222:223], v[78:79]
  v_exp_f32 v208, v208
  v_exp_f32 v209, v209
  v_exp_f32 v210, v210
  v_exp_f32 v211, v211
  v_exp_f32 v212, v212
  v_exp_f32 v213, v213
  v_exp_f32 v214, v214
  v_exp_f32 v215, v215
  v_exp_f32 v216, v216
  v_exp_f32 v217, v217
  v_exp_f32 v218, v218
  v_exp_f32 v219, v219
  v_exp_f32 v220, v220
  v_exp_f32 v221, v221
  v_exp_f32 v222, v222
  v_exp_f32 v223, v223
  v_pk_fma_f32 v[208:209], v[208:209], v[168:169], v[168:169] op_sel:[0,1,1] op_sel_hi:[1,1,1]
  v_pk_fma_f32 v[210:211], v[210:211], v[168:169], v[168:169] op_sel:[0,1,1] op_sel_hi:[1,1,1]
  v_pk_fma_f32 v[212:213], v[212:213], v[168:169], v[168:169] op_sel:[0,1,1] op_sel_hi:[1,1,1]
  v_pk_fma_f32 v[214:215], v[214:215], v[168:169], v[168:169] op_sel:[0,1,1] op_sel_hi:[1,1,1]
  v_pk_fma_f32 v[216:217], v[216:217], v[172:173], v[172:173] op_sel:[0,1,1] op_sel_hi:[1,1,1]
  v_pk_fma_f32 v[218:219], v[218:219], v[172:173], v[172:173] op_sel:[0,1,1] op_sel_hi:[1,1,1]
  v_pk_fma_f32 v[220:221], v[220:221], v[172:173], v[172:173] op_sel:[0,1,1] op_sel_hi:[1,1,1]
  v_pk_fma_f32 v[222:223], v[222:223], v[172:173], v[172:173] op_sel:[0,1,1] op_sel_hi:[1,1,1]
  v_rcp_f32 v208, v208
  v_rcp_f32 v209, v209
  v_rcp_f32 v210, v210
  v_rcp_f32 v211, v211
  v_rcp_f32 v212, v212
  v_rcp_f32 v213, v213
  v_rcp_f32 v214, v214
  v_rcp_f32 v215, v215
  v_rcp_f32 v216, v216
  v_rcp_f32 v217, v217
  v_rcp_f32 v218, v218
  v_rcp_f32 v219, v219
  v_rcp_f32 v220, v220
  v_rcp_f32 v221, v221
  v_rcp_f32 v222, v222
  v_rcp_f32 v223, v223
  v_pk_mul_f32 v[64:65], v[64:65], v[208:209]
  v_pk_mul_f32 v[66:67], v[66:67], v[210:211]
  v_pk_mul_f32 v[72:73], v[72:73], v[212:213]
  v_pk_mul_f32 v[74:75], v[74:75], v[214:215]
  v_pk_mul_f32 v[68:69], v[68:69], v[216:217]
  v_pk_mul_f32 v[70:71], v[70:71], v[218:219]
  v_pk_mul_f32 v[76:77], v[76:77], v[220:221]
  v_pk_mul_f32 v[78:79], v[78:79], v[222:223]
  v_cvt_pk_bf16_f32 v224, v64, v65
  v_cvt_pk_bf16_f32 v225, v66, v67
  v_cvt_pk_bf16_f32 v226, v72, v73
  v_cvt_pk_bf16_f32 v227, v74, v75
  v_cvt_pk_bf16_f32 v228, v68, v69
  v_cvt_pk_bf16_f32 v229, v70, v71
  v_cvt_pk_bf16_f32 v230, v76, v77
  v_cvt_pk_bf16_f32 v231, v78, v79
  buffer_store_dwordx4 v[224:227], v6, s[12:15], 0 offen offset:2048 sc1
  buffer_store_dwordx4 v[228:231], v7, s[12:15], 0 offen offset:2048 sc1
  s_waitcnt lgkmcnt(0)
  v_pk_fma_f32 v[80:81], v[200:201], v[168:169], v[80:81] op_sel_hi:[1,0,1]
  v_pk_fma_f32 v[82:83], v[202:203], v[168:169], v[82:83] op_sel_hi:[1,0,1]
  v_pk_fma_f32 v[88:89], v[204:205], v[168:169], v[88:89] op_sel_hi:[1,0,1]
  v_pk_fma_f32 v[90:91], v[206:207], v[168:169], v[90:91] op_sel_hi:[1,0,1]
  v_pk_fma_f32 v[84:85], v[200:201], v[172:173], v[84:85] op_sel_hi:[1,0,1]
  v_pk_fma_f32 v[86:87], v[202:203], v[172:173], v[86:87] op_sel_hi:[1,0,1]
  v_pk_fma_f32 v[92:93], v[204:205], v[172:173], v[92:93] op_sel_hi:[1,0,1]
  v_pk_fma_f32 v[94:95], v[206:207], v[172:173], v[94:95] op_sel_hi:[1,0,1]
  v_pk_mul_f32 v[208:209], v[80:81], v[80:81]
  v_pk_mul_f32 v[210:211], v[82:83], v[82:83]
  v_pk_mul_f32 v[212:213], v[88:89], v[88:89]
  v_pk_mul_f32 v[214:215], v[90:91], v[90:91]
  v_pk_mul_f32 v[216:217], v[84:85], v[84:85]
  v_pk_mul_f32 v[218:219], v[86:87], v[86:87]
  v_pk_mul_f32 v[220:221], v[92:93], v[92:93]
  v_pk_mul_f32 v[222:223], v[94:95], v[94:95]
  v_pk_fma_f32 v[208:209], v[208:209], v[170:171], v[170:171] op_sel:[0,0,1] op_sel_hi:[1,0,1]
  v_pk_fma_f32 v[210:211], v[210:211], v[170:171], v[170:171] op_sel:[0,0,1] op_sel_hi:[1,0,1]
  v_pk_fma_f32 v[212:213], v[212:213], v[170:171], v[170:171] op_sel:[0,0,1] op_sel_hi:[1,0,1]
  v_pk_fma_f32 v[214:215], v[214:215], v[170:171], v[170:171] op_sel:[0,0,1] op_sel_hi:[1,0,1]
  v_pk_fma_f32 v[216:217], v[216:217], v[174:175], v[174:175] op_sel:[0,0,1] op_sel_hi:[1,0,1]
  v_pk_fma_f32 v[218:219], v[218:219], v[174:175], v[174:175] op_sel:[0,0,1] op_sel_hi:[1,0,1]
  v_pk_fma_f32 v[220:221], v[220:221], v[174:175], v[174:175] op_sel:[0,0,1] op_sel_hi:[1,0,1]
  v_pk_fma_f32 v[222:223], v[222:223], v[174:175], v[174:175] op_sel:[0,0,1] op_sel_hi:[1,0,1]
  v_pk_mul_f32 v[208:209], v[208:209], v[80:81]
  v_pk_mul_f32 v[210:211], v[210:211], v[82:83]
  v_pk_mul_f32 v[212:213], v[212:213], v[88:89]
  v_pk_mul_f32 v[214:215], v[214:215], v[90:91]
  v_pk_mul_f32 v[216:217], v[216:217], v[84:85]
  v_pk_mul_f32 v[218:219], v[218:219], v[86:87]
  v_pk_mul_f32 v[220:221], v[220:221], v[92:93]
  v_pk_mul_f32 v[222:223], v[222:223], v[94:95]
  v_exp_f32 v208, v208
  v_exp_f32 v209, v209
  v_exp_f32 v210, v210
  v_exp_f32 v211, v211
  v_exp_f32 v212, v212
  v_exp_f32 v213, v213
  v_exp_f32 v214, v214
  v_exp_f32 v215, v215
  v_exp_f32 v216, v216
  v_exp_f32 v217, v217
  v_exp_f32 v218, v218
  v_exp_f32 v219, v219
  v_exp_f32 v220, v220
  v_exp_f32 v221, v221
  v_exp_f32 v222, v222
  v_exp_f32 v223, v223
  v_pk_fma_f32 v[208:209], v[208:209], v[168:169], v[168:169] op_sel:[0,1,1] op_sel_hi:[1,1,1]
  v_pk_fma_f32 v[210:211], v[210:211], v[168:169], v[168:169] op_sel:[0,1,1] op_sel_hi:[1,1,1]
  v_pk_fma_f32 v[212:213], v[212:213], v[168:169], v[168:169] op_sel:[0,1,1] op_sel_hi:[1,1,1]
  v_pk_fma_f32 v[214:215], v[214:215], v[168:169], v[168:169] op_sel:[0,1,1] op_sel_hi:[1,1,1]
  v_pk_fma_f32 v[216:217], v[216:217], v[172:173], v[172:173] op_sel:[0,1,1] op_sel_hi:[1,1,1]
  v_pk_fma_f32 v[218:219], v[218:219], v[172:173], v[172:173] op_sel:[0,1,1] op_sel_hi:[1,1,1]
  v_pk_fma_f32 v[220:221], v[220:221], v[172:173], v[172:173] op_sel:[0,1,1] op_sel_hi:[1,1,1]
  v_pk_fma_f32 v[222:223], v[222:223], v[172:173], v[172:173] op_sel:[0,1,1] op_sel_hi:[1,1,1]
  v_rcp_f32 v208, v208
  v_rcp_f32 v209, v209
  v_rcp_f32 v210, v210
  v_rcp_f32 v211, v211
  v_rcp_f32 v212, v212
  v_rcp_f32 v213, v213
  v_rcp_f32 v214, v214
  v_rcp_f32 v215, v215
  v_rcp_f32 v216, v216
  v_rcp_f32 v217, v217
  v_rcp_f32 v218, v218
  v_rcp_f32 v219, v219
  v_rcp_f32 v220, v220
  v_rcp_f32 v221, v221
  v_rcp_f32 v222, v222
  v_rcp_f32 v223, v223
  v_pk_mul_f32 v[80:81], v[80:81], v[208:209]
  v_pk_mul_f32 v[82:83], v[82:83], v[210:211]
  v_pk_mul_f32 v[88:89], v[88:89], v[212:213]
  v_pk_mul_f32 v[90:91], v[90:91], v[214:215]
  v_pk_mul_f32 v[84:85], v[84:85], v[216:217]
  v_pk_mul_f32 v[86:87], v[86:87], v[218:219]
  v_pk_mul_f32 v[92:93], v[92:93], v[220:221]
  v_pk_mul_f32 v[94:95], v[94:95], v[222:223]
  v_cvt_pk_bf16_f32 v232, v80, v81
  v_cvt_pk_bf16_f32 v233, v82, v83
  v_cvt_pk_bf16_f32 v234, v88, v89
  v_cvt_pk_bf16_f32 v235, v90, v91
  v_cvt_pk_bf16_f32 v236, v84, v85
  v_cvt_pk_bf16_f32 v237, v86, v87
  v_cvt_pk_bf16_f32 v238, v92, v93
  v_cvt_pk_bf16_f32 v239, v94, v95
  buffer_store_dwordx4 v[232:235], v6, s[12:15], 0 offen offset:3072 sc1
  buffer_store_dwordx4 v[236:239], v7, s[12:15], 0 offen offset:3072 sc1
  s_lshr_b32 s24, s23, 1
  s_lshl_b32 s24, s24, 7
  s_add_u32 s24, s24, 786432
  s_waitcnt vmcnt(0)
  v_lshlrev_b32 v30, 22, v3
  v_mov_b32 v31, 1
  buffer_atomic_add v31, v30, s[16:19], s24 offen sc1
  s_barrier
g2_c:
  s_load_dwordx4 s[28:31], s[0:1], 64
  s_load_dwordx4 s[40:43], s[0:1], 96
  s_load_dwordx2 s[32:33], s[0:1], 0
  s_and_b32 s24, s2, 7
  s_lshr_b32 s25, s2, 3
  s_and_b32 s25, s25, 15
  s_lshr_b32 s21, s24, 1
  s_lshl_b32 s21, s21, 2
  s_lshr_b32 s22, s25, 2
  s_add_u32 s21, s21, s22
  s_and_b32 s22, s24, 1
  s_lshl_b32 s22, s22, 2
  s_and_b32 s25, s25, 3
  s_add_u32 s22, s22, s25
  v_lshrrev_b32 v2, 6, v0
  v_and_b32 v3, 63, v0
  v_readfirstlane_b32 s100, v2
  s_nop 0
  s_and_b32 s20, s100, 3
  s_lshr_b32 s3, s100, 2
  s_lshl_b32 s23, s21, 3
  s_lshl_b32 s24, s20, 1
  s_add_u32 s23, s23, s24
  s_lshl_b32 s26, s20, 13
  s_add_u32 s26, s26, 131072
  s_mov_b32 s46, 0
  s_mov_b32 s47, 0
  s_mul_i32 s24, s23, 32768
  v_lshl_add_u32 v4, v3, 4, s24
  v_add_u32 v5, 32768, v4
  s_waitcnt lgkmcnt(0)
  s_add_u32 s12, s42, 4194304
  s_addc_u32 s13, s43, 0
  s_mov_b32 s14, 4194304
  s_mov_b32 s15, 0x20000
  s_add_u32 s16, s42, 33554432
  s_addc_u32 s17, s43, 0
  s_mov_b32 s18, 4194304
  s_mov_b32 s19, 0x20000
  v_lshrrev_b32 v29, 2, v3
  v_lshlrev_b32 v29, 8, v29
  v_and_b32 v30, 3, v3
  v_lshl_add_u32 v29, v30, 3, v29
  v_bfe_u32 v28, v3, 2, 3
  v_xor_b32 v30, 0, v28
  v_lshl_add_u32 v8, v30, 5, v29
  v_add_u32 v16, 65536, v8
  v_xor_b32 v30, 1, v28
  v_lshl_add_u32 v9, v30, 5, v29
  v_add_u32 v17, 65536, v9
  v_xor_b32 v30, 2, v28
  v_lshl_add_u32 v10, v30, 5, v29
  v_add_u32 v18, 65536, v10
  v_xor_b32 v30, 3, v28
  v_lshl_add_u32 v11, v30, 5, v29
  v_add_u32 v19, 65536, v11
  v_xor_b32 v30, 4, v28
  v_lshl_add_u32 v12, v30, 5, v29
  v_add_u32 v20, 65536, v12
  v_xor_b32 v30, 5, v28
  v_lshl_add_u32 v13, v30, 5, v29
  v_add_u32 v21, 65536, v13
  v_xor_b32 v30, 6, v28
  v_lshl_add_u32 v14, v30, 5, v29
  v_add_u32 v22, 65536, v14
  v_xor_b32 v30, 7, v28
  v_lshl_add_u32 v15, v30, 5, v29
  v_add_u32 v23, 65536, v15
  s_lshl_b32 s24, s23, 15
  s_lshl_b32 s25, s22, 12
  s_add_u32 s24, s24, s25
  v_lshl_add_u32 v6, v3, 4, s24
  v_add_u32 v7, 32768, v6
  v_mov_b32 v1, 0
  v_and_b32 v28, 15, v3
  s_lshl_b32 s24, s23, 7
  v_lshl_add_u32 v24, v28, 3, s24
  s_mov_b32 s4, s42
  s_mov_b32 s5, s43
  s_mov_b32 s6, 4194304
  s_mov_b32 s7, 0x20000
  s_lshr_b32 s24, s23, 1
  s_lshl_b32 s24, s24, 7
  s_add_u32 s24, s24, 786432
  s_mov_b32 s57, 0
gc_psp2:
  buffer_load_dword v2, v1, s[16:19], s24 offen sc1
  s_waitcnt vmcnt(0)
  v_readfirstlane_b32 s56, v2
  s_add_u32 s57, s57, 1
  s_cmp_ge_u32 s56, 8
  s_cbranch_scc1 gc_pok1
  s_cmp_ge_u32 s57, 262144
  s_cbranch_scc1 gc_pok1
  s_sleep 1
  s_branch gc_psp2
gc_pok1:
  buffer_load_dwordx4 v[128:131], v4, s[4:7], s46 offen offset:0 sc1
  buffer_load_dwordx4 v[132:135], v5, s[4:7], s46 offen offset:0 sc1
  buffer_load_dwordx4 v[136:139], v4, s[4:7], s46 offen offset:1024 sc1
  buffer_load_dwordx4 v[140:143], v5, s[4:7], s46 offen offset:1024 sc1
  s_add_u32 s46, s46, 2048
  buffer_load_dwordx4 v[144:147], v4, s[4:7], s46 offen offset:0 sc1
  buffer_load_dwordx4 v[148:151], v5, s[4:7], s46 offen offset:0 sc1
  buffer_load_dwordx4 v[152:155], v4, s[4:7], s46 offen offset:1024 sc1
  buffer_load_dwordx4 v[156:159], v5, s[4:7], s46 offen offset:1024 sc1
  s_add_u32 s46, s46, 2048
  buffer_load_dwordx4 v[160:163], v4, s[4:7], s46 offen offset:0 sc1
  buffer_load_dwordx4 v[164:167], v5, s[4:7], s46 offen offset:0 sc1
  buffer_load_dwordx4 v[168:171], v4, s[4:7], s46 offen offset:1024 sc1
  buffer_load_dwordx4 v[172:175], v5, s[4:7], s46 offen offset:1024 sc1
  s_add_u32 s46, s46, 2048
  s_barrier
  ds_read_b64_tr_b16 v[96:97], v8 offset:0
  ds_read_b64_tr_b16 v[98:99], v8 offset:4096
  ds_read_b64_tr_b16 v[100:101], v9 offset:0
  ds_read_b64_tr_b16 v[102:103], v9 offset:4096
  ds_read_b64_tr_b16 v[104:105], v10 offset:0
  ds_read_b64_tr_b16 v[106:107], v10 offset:4096
  ds_read_b64_tr_b16 v[108:109], v11 offset:0
  ds_read_b64_tr_b16 v[110:111], v11 offset:4096
  ds_read_b64_tr_b16 v[112:113], v12 offset:0
  ds_read_b64_tr_b16 v[114:115], v12 offset:4096
  ds_read_b64_tr_b16 v[116:117], v13 offset:0
  ds_read_b64_tr_b16 v[118:119], v13 offset:4096
  ds_read_b64_tr_b16 v[120:121], v14 offset:0
  ds_read_b64_tr_b16 v[122:123], v14 offset:4096
  s_waitcnt lgkmcnt(12)
  s_waitcnt vmcnt(10)
  v_mfma_f32_16x16x32_bf16 v[32:35], v[96:99], v[128:131], 0
  ds_read_b64_tr_b16 v[124:125], v15 offset:0
  ds_read_b64_tr_b16 v[126:127], v15 offset:4096
  v_mfma_f32_16x16x32_bf16 v[36:39], v[96:99], v[132:135], 0
  s_waitcnt lgkmcnt(12)
  v_mfma_f32_16x16x32_bf16 v[40:43], v[100:103], v[128:131], 0
  ds_read_b64_tr_b16 v[96:97], v8 offset:8192
  ds_read_b64_tr_b16 v[98:99], v8 offset:12288
  v_mfma_f32_16x16x32_bf16 v[44:47], v[100:103], v[132:135], 0
  buffer_load_dwordx4 v[176:179], v4, s[4:7], s46 offen offset:0 sc1
  buffer_load_dwordx4 v[180:183], v5, s[4:7], s46 offen offset:0 sc1
  s_waitcnt lgkmcnt(12)
  v_mfma_f32_16x16x32_bf16 v[48:51], v[104:107], v[128:131], 0
  ds_read_b64_tr_b16 v[100:101], v9 offset:8192
  ds_read_b64_tr_b16 v[102:103], v9 offset:12288
  v_mfma_f32_16x16x32_bf16 v[52:55], v[104:107], v[132:135], 0
  s_waitcnt lgkmcnt(12)
  v_mfma_f32_16x16x32_bf16 v[56:59], v[108:111], v[128:131], 0
  ds_read_b64_tr_b16 v[104:105], v10 offset:8192
  ds_read_b64_tr_b16 v[106:107], v10 offset:12288
  v_mfma_f32_16x16x32_bf16 v[60:63], v[108:111], v[132:135], 0
  buffer_load_dwordx4 v[184:187], v4, s[4:7], s46 offen offset:1024 sc1
  buffer_load_dwordx4 v[188:191], v5, s[4:7], s46 offen offset:1024 sc1
  s_add_u32 s46, s46, 2048
  s_waitcnt lgkmcnt(12)
  v_mfma_f32_16x16x32_bf16 v[64:67], v[112:115], v[128:131], 0
  ds_read_b64_tr_b16 v[108:109], v11 offset:8192
  ds_read_b64_tr_b16 v[110:111], v11 offset:12288
  v_mfma_f32_16x16x32_bf16 v[68:71], v[112:115], v[132:135], 0
  s_waitcnt lgkmcnt(12)
  v_mfma_f32_16x16x32_bf16 v[72:75], v[116:119], v[128:131], 0
  ds_read_b64_tr_b16 v[112:113], v12 offset:8192
  ds_read_b64_tr_b16 v[114:115], v12 offset:12288
  v_mfma_f32_16x16x32_bf16 v[76:79], v[116:119], v[132:135], 0
  buffer_load_dwordx4 v[192:195], v4, s[4:7], s46 offen offset:0 sc1
  buffer_load_dwordx4 v[196:199], v5, s[4:7], s46 offen offset:0 sc1
  s_waitcnt lgkmcnt(12)
  v_mfma_f32_16x16x32_bf16 v[80:83], v[120:123], v[128:131], 0
  ds_read_b64_tr_b16 v[116:117], v13 offset:8192
  ds_read_b64_tr_b16 v[118:119], v13 offset:12288
  v_mfma_f32_16x16x32_bf16 v[84:87], v[120:123], v[132:135], 0
  s_waitcnt lgkmcnt(12)
  v_mfma_f32_16x16x32_bf16 v[88:91], v[124:127], v[128:131], 0
  ds_read_b64_tr_b16 v[120:121], v14 offset:8192
  ds_read_b64_tr_b16 v[122:123], v14 offset:12288
  v_mfma_f32_16x16x32_bf16 v[92:95], v[124:127], v[132:135], 0
  buffer_load_dwordx4 v[200:203], v4, s[4:7], s46 offen offset:1024 sc1
  buffer_load_dwordx4 v[204:207], v5, s[4:7], s46 offen offset:1024 sc1
  s_add_u32 s46, s46, 2048
  s_waitcnt lgkmcnt(12)
  s_waitcnt vmcnt(16)
  v_mfma_f32_16x16x32_bf16 v[32:35], v[96:99], v[136:139], v[32:35]
  ds_read_b64_tr_b16 v[124:125], v15 offset:8192
  ds_read_b64_tr_b16 v[126:127], v15 offset:12288
  v_mfma_f32_16x16x32_bf16 v[36:39], v[96:99], v[140:143], v[36:39]
  s_waitcnt lgkmcnt(12)
  v_mfma_f32_16x16x32_bf16 v[40:43], v[100:103], v[136:139], v[40:43]
  s_barrier
  ds_read_b64_tr_b16 v[96:97], v8 offset:16384
  ds_read_b64_tr_b16 v[98:99], v8 offset:20480
  v_mfma_f32_16x16x32_bf16 v[44:47], v[100:103], v[140:143], v[44:47]
  buffer_load_dwordx4 v[128:131], v4, s[4:7], s46 offen offset:0 sc1
  buffer_load_dwordx4 v[132:135], v5, s[4:7], s46 offen offset:0 sc1
  s_waitcnt lgkmcnt(12)
  v_mfma_f32_16x16x32_bf16 v[48:51], v[104:107], v[136:139], v[48:51]
  ds_read_b64_tr_b16 v[100:101], v9 offset:16384
  ds_read_b64_tr_b16 v[102:103], v9 offset:20480
  v_mfma_f32_16x16x32_bf16 v[52:55], v[104:107], v[140:143], v[52:55]
  s_waitcnt lgkmcnt(12)
  v_mfma_f32_16x16x32_bf16 v[56:59], v[108:111], v[136:139], v[56:59]
  ds_read_b64_tr_b16 v[104:105], v10 offset:16384
  ds_read_b64_tr_b16 v[106:107], v10 offset:20480
  v_mfma_f32_16x16x32_bf16 v[60:63], v[108:111], v[140:143], v[60:63]
  s_waitcnt lgkmcnt(12)
  v_mfma_f32_16x16x32_bf16 v[64:67], v[112:115], v[136:139], v[64:67]
  ds_read_b64_tr_b16 v[108:109], v11 offset:16384
  ds_read_b64_tr_b16 v[110:111], v11 offset:20480
  v_mfma_f32_16x16x32_bf16 v[68:71], v[112:115], v[140:143], v[68:71]
  s_waitcnt lgkmcnt(12)
  v_mfma_f32_16x16x32_bf16 v[72:75], v[116:119], v[136:139], v[72:75]
  ds_read_b64_tr_b16 v[112:113], v12 offset:16384
  ds_read_b64_tr_b16 v[114:115], v12 offset:20480
  v_mfma_f32_16x16x32_bf16 v[76:79], v[116:119], v[140:143], v[76:79]
  s_waitcnt lgkmcnt(12)
  v_mfma_f32_16x16x32_bf16 v[80:83], v[120:123], v[136:139], v[80:83]
  ds_read_b64_tr_b16 v[116:117], v13 offset:16384
  ds_read_b64_tr_b16 v[118:119], v13 offset:20480
  v_mfma_f32_16x16x32_bf16 v[84:87], v[120:123], v[140:143], v[84:87]
  s_waitcnt lgkmcnt(12)
  v_mfma_f32_16x16x32_bf16 v[88:91], v[124:127], v[136:139], v[88:91]
  ds_read_b64_tr_b16 v[120:121], v14 offset:16384
  ds_read_b64_tr_b16 v[122:123], v14 offset:20480
  v_mfma_f32_16x16x32_bf16 v[92:95], v[124:127], v[140:143], v[92:95]
  s_waitcnt lgkmcnt(12)
  s_waitcnt vmcnt(16)
  v_mfma_f32_16x16x32_bf16 v[32:35], v[96:99], v[144:147], v[32:35]
  ds_read_b64_tr_b16 v[124:125], v15 offset:16384
  ds_read_b64_tr_b16 v[126:127], v15 offset:20480
  v_mfma_f32_16x16x32_bf16 v[36:39], v[96:99], v[148:151], v[36:39]
  s_waitcnt lgkmcnt(12)
  v_mfma_f32_16x16x32_bf16 v[40:43], v[100:103], v[144:147], v[40:43]
  ds_read_b64_tr_b16 v[96:97], v8 offset:24576
  ds_read_b64_tr_b16 v[98:99], v8 offset:28672
  v_mfma_f32_16x16x32_bf16 v[44:47], v[100:103], v[148:151], v[44:47]
  buffer_load_dwordx4 v[136:139], v4, s[4:7], s46 offen offset:1024 sc1
  buffer_load_dwordx4 v[140:143], v5, s[4:7], s46 offen offset:1024 sc1
  s_add_u32 s46, s46, 2048
  s_waitcnt lgkmcnt(12)
  v_mfma_f32_16x16x32_bf16 v[48:51], v[104:107], v[144:147], v[48:51]
  ds_read_b64_tr_b16 v[100:101], v9 offset:24576
  ds_read_b64_tr_b16 v[102:103], v9 offset:28672
  v_mfma_f32_16x16x32_bf16 v[52:55], v[104:107], v[148:151], v[52:55]
  s_waitcnt lgkmcnt(12)
  v_mfma_f32_16x16x32_bf16 v[56:59], v[108:111], v[144:147], v[56:59]
  ds_read_b64_tr_b16 v[104:105], v10 offset:24576
  ds_read_b64_tr_b16 v[106:107], v10 offset:28672
  v_mfma_f32_16x16x32_bf16 v[60:63], v[108:111], v[148:151], v[60:63]
  s_waitcnt lgkmcnt(12)
  v_mfma_f32_16x16x32_bf16 v[64:67], v[112:115], v[144:147], v[64:67]
  ds_read_b64_tr_b16 v[108:109], v11 offset:24576
  ds_read_b64_tr_b16 v[110:111], v11 offset:28672
  v_mfma_f32_16x16x32_bf16 v[68:71], v[112:115], v[148:151], v[68:71]
  s_waitcnt lgkmcnt(12)
  v_mfma_f32_16x16x32_bf16 v[72:75], v[116:119], v[144:147], v[72:75]
  ds_read_b64_tr_b16 v[112:113], v12 offset:24576
  ds_read_b64_tr_b16 v[114:115], v12 offset:28672
  v_mfma_f32_16x16x32_bf16 v[76:79], v[116:119], v[148:151], v[76:79]
  s_waitcnt lgkmcnt(12)
  v_mfma_f32_16x16x32_bf16 v[80:83], v[120:123], v[144:147], v[80:83]
  ds_read_b64_tr_b16 v[116:117], v13 offset:24576
  ds_read_b64_tr_b16 v[118:119], v13 offset:28672
  v_mfma_f32_16x16x32_bf16 v[84:87], v[120:123], v[148:151], v[84:87]
  s_waitcnt lgkmcnt(12)
  v_mfma_f32_16x16x32_bf16 v[88:91], v[124:127], v[144:147], v[88:91]
  ds_read_b64_tr_b16 v[120:121], v14 offset:24576
  ds_read_b64_tr_b16 v[122:123], v14 offset:28672
  v_mfma_f32_16x16x32_bf16 v[92:95], v[124:127], v[148:151], v[92:95]
  s_waitcnt lgkmcnt(12)
  s_waitcnt vmcnt(16)
  v_mfma_f32_16x16x32_bf16 v[32:35], v[96:99], v[152:155], v[32:35]
  ds_read_b64_tr_b16 v[124:125], v15 offset:24576
  ds_read_b64_tr_b16 v[126:127], v15 offset:28672
  v_mfma_f32_16x16x32_bf16 v[36:39], v[96:99], v[156:159], v[36:39]
  s_waitcnt lgkmcnt(12)
  v_mfma_f32_16x16x32_bf16 v[40:43], v[100:103], v[152:155], v[40:43]
  s_barrier
  ds_read_b64_tr_b16 v[96:97], v8 offset:32768
  ds_read_b64_tr_b16 v[98:99], v8 offset:36864
  v_mfma_f32_16x16x32_bf16 v[44:47], v[100:103], v[156:159], v[44:47]
  buffer_load_dwordx4 v[144:147], v4, s[4:7], s46 offen offset:0 sc1
  buffer_load_dwordx4 v[148:151], v5, s[4:7], s46 offen offset:0 sc1
  s_waitcnt lgkmcnt(12)
  v_mfma_f32_16x16x32_bf16 v[48:51], v[104:107], v[152:155], v[48:51]
  ds_read_b64_tr_b16 v[100:101], v9 offset:32768
  ds_read_b64_tr_b16 v[102:103], v9 offset:36864
  v_mfma_f32_16x16x32_bf16 v[52:55], v[104:107], v[156:159], v[52:55]
  s_waitcnt lgkmcnt(12)
  v_mfma_f32_16x16x32_bf16 v[56:59], v[108:111], v[152:155], v[56:59]
  ds_read_b64_tr_b16 v[104:105], v10 offset:32768
  ds_read_b64_tr_b16 v[106:107], v10 offset:36864
  v_mfma_f32_16x16x32_bf16 v[60:63], v[108:111], v[156:159], v[60:63]
  s_waitcnt lgkmcnt(12)
  v_mfma_f32_16x16x32_bf16 v[64:67], v[112:115], v[152:155], v[64:67]
  ds_read_b64_tr_b16 v[108:109], v11 offset:32768
  ds_read_b64_tr_b16 v[110:111], v11 offset:36864
  v_mfma_f32_16x16x32_bf16 v[68:71], v[112:115], v[156:159], v[68:71]
  s_waitcnt lgkmcnt(12)
  v_mfma_f32_16x16x32_bf16 v[72:75], v[116:119], v[152:155], v[72:75]
  ds_read_b64_tr_b16 v[112:113], v12 offset:32768
  ds_read_b64_tr_b16 v[114:115], v12 offset:36864
  v_mfma_f32_16x16x32_bf16 v[76:79], v[116:119], v[156:159], v[76:79]
  s_waitcnt lgkmcnt(12)
  v_mfma_f32_16x16x32_bf16 v[80:83], v[120:123], v[152:155], v[80:83]
  ds_read_b64_tr_b16 v[116:117], v13 offset:32768
  ds_read_b64_tr_b16 v[118:119], v13 offset:36864
  v_mfma_f32_16x16x32_bf16 v[84:87], v[120:123], v[156:159], v[84:87]
  s_waitcnt lgkmcnt(12)
  v_mfma_f32_16x16x32_bf16 v[88:91], v[124:127], v[152:155], v[88:91]
  ds_read_b64_tr_b16 v[120:121], v14 offset:32768
  ds_read_b64_tr_b16 v[122:123], v14 offset:36864
  v_mfma_f32_16x16x32_bf16 v[92:95], v[124:127], v[156:159], v[92:95]
  s_waitcnt lgkmcnt(12)
  s_waitcnt vmcnt(16)
  v_mfma_f32_16x16x32_bf16 v[32:35], v[96:99], v[160:163], v[32:35]
  ds_read_b64_tr_b16 v[124:125], v15 offset:32768
  ds_read_b64_tr_b16 v[126:127], v15 offset:36864
  v_mfma_f32_16x16x32_bf16 v[36:39], v[96:99], v[164:167], v[36:39]
  s_waitcnt lgkmcnt(12)
  v_mfma_f32_16x16x32_bf16 v[40:43], v[100:103], v[160:163], v[40:43]
  ds_read_b64_tr_b16 v[96:97], v8 offset:40960
  ds_read_b64_tr_b16 v[98:99], v8 offset:45056
  v_mfma_f32_16x16x32_bf16 v[44:47], v[100:103], v[164:167], v[44:47]
  buffer_load_dwordx4 v[152:155], v4, s[4:7], s46 offen offset:1024 sc1
  buffer_load_dwordx4 v[156:159], v5, s[4:7], s46 offen offset:1024 sc1
  s_add_u32 s46, s46, 2048
  s_waitcnt lgkmcnt(12)
  v_mfma_f32_16x16x32_bf16 v[48:51], v[104:107], v[160:163], v[48:51]
  ds_read_b64_tr_b16 v[100:101], v9 offset:40960
  ds_read_b64_tr_b16 v[102:103], v9 offset:45056
  v_mfma_f32_16x16x32_bf16 v[52:55], v[104:107], v[164:167], v[52:55]
  s_waitcnt lgkmcnt(12)
  v_mfma_f32_16x16x32_bf16 v[56:59], v[108:111], v[160:163], v[56:59]
  ds_read_b64_tr_b16 v[104:105], v10 offset:40960
  ds_read_b64_tr_b16 v[106:107], v10 offset:45056
  v_mfma_f32_16x16x32_bf16 v[60:63], v[108:111], v[164:167], v[60:63]
  s_waitcnt lgkmcnt(12)
  v_mfma_f32_16x16x32_bf16 v[64:67], v[112:115], v[160:163], v[64:67]
  ds_read_b64_tr_b16 v[108:109], v11 offset:40960
  ds_read_b64_tr_b16 v[110:111], v11 offset:45056
  v_mfma_f32_16x16x32_bf16 v[68:71], v[112:115], v[164:167], v[68:71]
  s_waitcnt lgkmcnt(12)
  v_mfma_f32_16x16x32_bf16 v[72:75], v[116:119], v[160:163], v[72:75]
  ds_read_b64_tr_b16 v[112:113], v12 offset:40960
  ds_read_b64_tr_b16 v[114:115], v12 offset:45056
  v_mfma_f32_16x16x32_bf16 v[76:79], v[116:119], v[164:167], v[76:79]
  s_waitcnt lgkmcnt(12)
  v_mfma_f32_16x16x32_bf16 v[80:83], v[120:123], v[160:163], v[80:83]
  ds_read_b64_tr_b16 v[116:117], v13 offset:40960
  ds_read_b64_tr_b16 v[118:119], v13 offset:45056
  v_mfma_f32_16x16x32_bf16 v[84:87], v[120:123], v[164:167], v[84:87]
  s_waitcnt lgkmcnt(12)
  v_mfma_f32_16x16x32_bf16 v[88:91], v[124:127], v[160:163], v[88:91]
  ds_read_b64_tr_b16 v[120:121], v14 offset:40960
  ds_read_b64_tr_b16 v[122:123], v14 offset:45056
  v_mfma_f32_16x16x32_bf16 v[92:95], v[124:127], v[164:167], v[92:95]
  s_waitcnt lgkmcnt(12)
  s_waitcnt vmcnt(16)
  v_mfma_f32_16x16x32_bf16 v[32:35], v[96:99], v[168:171], v[32:35]
  ds_read_b64_tr_b16 v[124:125], v15 offset:40960
  ds_read_b64_tr_b16 v[126:127], v15 offset:45056
  v_mfma_f32_16x16x32_bf16 v[36:39], v[96:99], v[172:175], v[36:39]
  s_waitcnt lgkmcnt(12)
  v_mfma_f32_16x16x32_bf16 v[40:43], v[100:103], v[168:171], v[40:43]
  s_barrier
  ds_read_b64_tr_b16 v[96:97], v8 offset:49152
  ds_read_b64_tr_b16 v[98:99], v8 offset:53248
  v_mfma_f32_16x16x32_bf16 v[44:47], v[100:103], v[172:175], v[44:47]
  buffer_load_dwordx4 v[160:163], v4, s[4:7], s46 offen offset:0 sc1
  buffer_load_dwordx4 v[164:167], v5, s[4:7], s46 offen offset:0 sc1
  s_waitcnt lgkmcnt(12)
  v_mfma_f32_16x16x32_bf16 v[48:51], v[104:107], v[168:171], v[48:51]
  ds_read_b64_tr_b16 v[100:101], v9 offset:49152
  ds_read_b64_tr_b16 v[102:103], v9 offset:53248
  v_mfma_f32_16x16x32_bf16 v[52:55], v[104:107], v[172:175], v[52:55]
  s_waitcnt lgkmcnt(12)
  v_mfma_f32_16x16x32_bf16 v[56:59], v[108:111], v[168:171], v[56:59]
  ds_read_b64_tr_b16 v[104:105], v10 offset:49152
  ds_read_b64_tr_b16 v[106:107], v10 offset:53248
  v_mfma_f32_16x16x32_bf16 v[60:63], v[108:111], v[172:175], v[60:63]
  s_waitcnt lgkmcnt(12)
  v_mfma_f32_16x16x32_bf16 v[64:67], v[112:115], v[168:171], v[64:67]
  ds_read_b64_tr_b16 v[108:109], v11 offset:49152
  ds_read_b64_tr_b16 v[110:111], v11 offset:53248
  v_mfma_f32_16x16x32_bf16 v[68:71], v[112:115], v[172:175], v[68:71]
  s_waitcnt lgkmcnt(12)
  v_mfma_f32_16x16x32_bf16 v[72:75], v[116:119], v[168:171], v[72:75]
  ds_read_b64_tr_b16 v[112:113], v12 offset:49152
  ds_read_b64_tr_b16 v[114:115], v12 offset:53248
  v_mfma_f32_16x16x32_bf16 v[76:79], v[116:119], v[172:175], v[76:79]
  s_waitcnt lgkmcnt(12)
  v_mfma_f32_16x16x32_bf16 v[80:83], v[120:123], v[168:171], v[80:83]
  ds_read_b64_tr_b16 v[116:117], v13 offset:49152
  ds_read_b64_tr_b16 v[118:119], v13 offset:53248
  v_mfma_f32_16x16x32_bf16 v[84:87], v[120:123], v[172:175], v[84:87]
  s_waitcnt lgkmcnt(12)
  v_mfma_f32_16x16x32_bf16 v[88:91], v[124:127], v[168:171], v[88:91]
  ds_read_b64_tr_b16 v[120:121], v14 offset:49152
  ds_read_b64_tr_b16 v[122:123], v14 offset:53248
  v_mfma_f32_16x16x32_bf16 v[92:95], v[124:127], v[172:175], v[92:95]
  s_waitcnt lgkmcnt(12)
  s_waitcnt vmcnt(16)
  v_mfma_f32_16x16x32_bf16 v[32:35], v[96:99], v[176:179], v[32:35]
  ds_read_b64_tr_b16 v[124:125], v15 offset:49152
  ds_read_b64_tr_b16 v[126:127], v15 offset:53248
  v_mfma_f32_16x16x32_bf16 v[36:39], v[96:99], v[180:183], v[36:39]
  s_waitcnt lgkmcnt(12)
  v_mfma_f32_16x16x32_bf16 v[40:43], v[100:103], v[176:179], v[40:43]
  ds_read_b64_tr_b16 v[96:97], v8 offset:57344
  ds_read_b64_tr_b16 v[98:99], v8 offset:61440
  v_mfma_f32_16x16x32_bf16 v[44:47], v[100:103], v[180:183], v[44:47]
  buffer_load_dwordx4 v[168:171], v4, s[4:7], s46 offen offset:1024 sc1
  buffer_load_dwordx4 v[172:175], v5, s[4:7], s46 offen offset:1024 sc1
  s_add_u32 s46, s46, 2048
  s_waitcnt lgkmcnt(12)
  v_mfma_f32_16x16x32_bf16 v[48:51], v[104:107], v[176:179], v[48:51]
  ds_read_b64_tr_b16 v[100:101], v9 offset:57344
  ds_read_b64_tr_b16 v[102:103], v9 offset:61440
  v_mfma_f32_16x16x32_bf16 v[52:55], v[104:107], v[180:183], v[52:55]
  s_waitcnt lgkmcnt(12)
  v_mfma_f32_16x16x32_bf16 v[56:59], v[108:111], v[176:179], v[56:59]
  ds_read_b64_tr_b16 v[104:105], v10 offset:57344
  ds_read_b64_tr_b16 v[106:107], v10 offset:61440
  v_mfma_f32_16x16x32_bf16 v[60:63], v[108:111], v[180:183], v[60:63]
  s_waitcnt lgkmcnt(12)
  v_mfma_f32_16x16x32_bf16 v[64:67], v[112:115], v[176:179], v[64:67]
  ds_read_b64_tr_b16 v[108:109], v11 offset:57344
  ds_read_b64_tr_b16 v[110:111], v11 offset:61440
  v_mfma_f32_16x16x32_bf16 v[68:71], v[112:115], v[180:183], v[68:71]
  s_waitcnt lgkmcnt(12)
  v_mfma_f32_16x16x32_bf16 v[72:75], v[116:119], v[176:179], v[72:75]
  ds_read_b64_tr_b16 v[112:113], v12 offset:57344
  ds_read_b64_tr_b16 v[114:115], v12 offset:61440
  v_mfma_f32_16x16x32_bf16 v[76:79], v[116:119], v[180:183], v[76:79]
  s_waitcnt lgkmcnt(12)
  v_mfma_f32_16x16x32_bf16 v[80:83], v[120:123], v[176:179], v[80:83]
  ds_read_b64_tr_b16 v[116:117], v13 offset:57344
  ds_read_b64_tr_b16 v[118:119], v13 offset:61440
  v_mfma_f32_16x16x32_bf16 v[84:87], v[120:123], v[180:183], v[84:87]
  s_waitcnt lgkmcnt(12)
  v_mfma_f32_16x16x32_bf16 v[88:91], v[124:127], v[176:179], v[88:91]
  ds_read_b64_tr_b16 v[120:121], v14 offset:57344
  ds_read_b64_tr_b16 v[122:123], v14 offset:61440
  v_mfma_f32_16x16x32_bf16 v[92:95], v[124:127], v[180:183], v[92:95]
  s_waitcnt lgkmcnt(12)
  s_waitcnt vmcnt(16)
  v_mfma_f32_16x16x32_bf16 v[32:35], v[96:99], v[184:187], v[32:35]
  ds_read_b64_tr_b16 v[124:125], v15 offset:57344
  ds_read_b64_tr_b16 v[126:127], v15 offset:61440
  v_mfma_f32_16x16x32_bf16 v[36:39], v[96:99], v[188:191], v[36:39]
  s_waitcnt lgkmcnt(12)
  v_mfma_f32_16x16x32_bf16 v[40:43], v[100:103], v[184:187], v[40:43]
  s_barrier
  ds_read_b64_tr_b16 v[96:97], v16 offset:0
  ds_read_b64_tr_b16 v[98:99], v16 offset:4096
  v_mfma_f32_16x16x32_bf16 v[44:47], v[100:103], v[188:191], v[44:47]
  buffer_load_dwordx4 v[176:179], v4, s[4:7], s46 offen offset:0 sc1
  buffer_load_dwordx4 v[180:183], v5, s[4:7], s46 offen offset:0 sc1
  s_waitcnt lgkmcnt(12)
  v_mfma_f32_16x16x32_bf16 v[48:51], v[104:107], v[184:187], v[48:51]
  ds_read_b64_tr_b16 v[100:101], v17 offset:0
  ds_read_b64_tr_b16 v[102:103], v17 offset:4096
  v_mfma_f32_16x16x32_bf16 v[52:55], v[104:107], v[188:191], v[52:55]
  s_waitcnt lgkmcnt(12)
  v_mfma_f32_16x16x32_bf16 v[56:59], v[108:111], v[184:187], v[56:59]
  ds_read_b64_tr_b16 v[104:105], v18 offset:0
  ds_read_b64_tr_b16 v[106:107], v18 offset:4096
  v_mfma_f32_16x16x32_bf16 v[60:63], v[108:111], v[188:191], v[60:63]
  s_waitcnt lgkmcnt(12)
  v_mfma_f32_16x16x32_bf16 v[64:67], v[112:115], v[184:187], v[64:67]
  ds_read_b64_tr_b16 v[108:109], v19 offset:0
  ds_read_b64_tr_b16 v[110:111], v19 offset:4096
  v_mfma_f32_16x16x32_bf16 v[68:71], v[112:115], v[188:191], v[68:71]
  s_waitcnt lgkmcnt(12)
  v_mfma_f32_16x16x32_bf16 v[72:75], v[116:119], v[184:187], v[72:75]
  ds_read_b64_tr_b16 v[112:113], v20 offset:0
  ds_read_b64_tr_b16 v[114:115], v20 offset:4096
  v_mfma_f32_16x16x32_bf16 v[76:79], v[116:119], v[188:191], v[76:79]
  s_waitcnt lgkmcnt(12)
  v_mfma_f32_16x16x32_bf16 v[80:83], v[120:123], v[184:187], v[80:83]
  ds_read_b64_tr_b16 v[116:117], v21 offset:0
  ds_read_b64_tr_b16 v[118:119], v21 offset:4096
  v_mfma_f32_16x16x32_bf16 v[84:87], v[120:123], v[188:191], v[84:87]
  s_waitcnt lgkmcnt(12)
  v_mfma_f32_16x16x32_bf16 v[88:91], v[124:127], v[184:187], v[88:91]
  ds_read_b64_tr_b16 v[120:121], v22 offset:0
  ds_read_b64_tr_b16 v[122:123], v22 offset:4096
  v_mfma_f32_16x16x32_bf16 v[92:95], v[124:127], v[188:191], v[92:95]
  s_waitcnt lgkmcnt(12)
  s_waitcnt vmcnt(16)
  v_mfma_f32_16x16x32_bf16 v[32:35], v[96:99], v[192:195], v[32:35]
  ds_read_b64_tr_b16 v[124:125], v23 offset:0
  ds_read_b64_tr_b16 v[126:127], v23 offset:4096
  v_mfma_f32_16x16x32_bf16 v[36:39], v[96:99], v[196:199], v[36:39]
  s_waitcnt lgkmcnt(12)
  v_mfma_f32_16x16x32_bf16 v[40:43], v[100:103], v[192:195], v[40:43]
  ds_read_b64_tr_b16 v[96:97], v16 offset:8192
  ds_read_b64_tr_b16 v[98:99], v16 offset:12288
  v_mfma_f32_16x16x32_bf16 v[44:47], v[100:103], v[196:199], v[44:47]
  buffer_load_dwordx4 v[184:187], v4, s[4:7], s46 offen offset:1024 sc1
  buffer_load_dwordx4 v[188:191], v5, s[4:7], s46 offen offset:1024 sc1
  s_add_u32 s46, s46, 2048
  s_waitcnt lgkmcnt(12)
  v_mfma_f32_16x16x32_bf16 v[48:51], v[104:107], v[192:195], v[48:51]
  ds_read_b64_tr_b16 v[100:101], v17 offset:8192
  ds_read_b64_tr_b16 v[102:103], v17 offset:12288
  v_mfma_f32_16x16x32_bf16 v[52:55], v[104:107], v[196:199], v[52:55]
  s_waitcnt lgkmcnt(12)
  v_mfma_f32_16x16x32_bf16 v[56:59], v[108:111], v[192:195], v[56:59]
  ds_read_b64_tr_b16 v[104:105], v18 offset:8192
  ds_read_b64_tr_b16 v[106:107], v18 offset:12288
  v_mfma_f32_16x16x32_bf16 v[60:63], v[108:111], v[196:199], v[60:63]
  s_waitcnt lgkmcnt(12)
  v_mfma_f32_16x16x32_bf16 v[64:67], v[112:115], v[192:195], v[64:67]
  ds_read_b64_tr_b16 v[108:109], v19 offset:8192
  ds_read_b64_tr_b16 v[110:111], v19 offset:12288
  v_mfma_f32_16x16x32_bf16 v[68:71], v[112:115], v[196:199], v[68:71]
  s_waitcnt lgkmcnt(12)
  v_mfma_f32_16x16x32_bf16 v[72:75], v[116:119], v[192:195], v[72:75]
  ds_read_b64_tr_b16 v[112:113], v20 offset:8192
  ds_read_b64_tr_b16 v[114:115], v20 offset:12288
  v_mfma_f32_16x16x32_bf16 v[76:79], v[116:119], v[196:199], v[76:79]
  s_waitcnt lgkmcnt(12)
  v_mfma_f32_16x16x32_bf16 v[80:83], v[120:123], v[192:195], v[80:83]
  ds_read_b64_tr_b16 v[116:117], v21 offset:8192
  ds_read_b64_tr_b16 v[118:119], v21 offset:12288
  v_mfma_f32_16x16x32_bf16 v[84:87], v[120:123], v[196:199], v[84:87]
  s_waitcnt lgkmcnt(12)
  v_mfma_f32_16x16x32_bf16 v[88:91], v[124:127], v[192:195], v[88:91]
  ds_read_b64_tr_b16 v[120:121], v22 offset:8192
  ds_read_b64_tr_b16 v[122:123], v22 offset:12288
  v_mfma_f32_16x16x32_bf16 v[92:95], v[124:127], v[196:199], v[92:95]
  s_waitcnt lgkmcnt(12)
  s_waitcnt vmcnt(16)
  v_mfma_f32_16x16x32_bf16 v[32:35], v[96:99], v[200:203], v[32:35]
  ds_read_b64_tr_b16 v[124:125], v23 offset:8192
  ds_read_b64_tr_b16 v[126:127], v23 offset:12288
  v_mfma_f32_16x16x32_bf16 v[36:39], v[96:99], v[204:207], v[36:39]
  s_waitcnt lgkmcnt(12)
  v_mfma_f32_16x16x32_bf16 v[40:43], v[100:103], v[200:203], v[40:43]
  s_barrier
  ds_read_b64_tr_b16 v[96:97], v16 offset:16384
  ds_read_b64_tr_b16 v[98:99], v16 offset:20480
  v_mfma_f32_16x16x32_bf16 v[44:47], v[100:103], v[204:207], v[44:47]
  buffer_load_dwordx4 v[192:195], v4, s[4:7], s46 offen offset:0 sc1
  buffer_load_dwordx4 v[196:199], v5, s[4:7], s46 offen offset:0 sc1
  s_waitcnt lgkmcnt(12)
  v_mfma_f32_16x16x32_bf16 v[48:51], v[104:107], v[200:203], v[48:51]
  ds_read_b64_tr_b16 v[100:101], v17 offset:16384
  ds_read_b64_tr_b16 v[102:103], v17 offset:20480
  v_mfma_f32_16x16x32_bf16 v[52:55], v[104:107], v[204:207], v[52:55]
  s_waitcnt lgkmcnt(12)
  v_mfma_f32_16x16x32_bf16 v[56:59], v[108:111], v[200:203], v[56:59]
  ds_read_b64_tr_b16 v[104:105], v18 offset:16384
  ds_read_b64_tr_b16 v[106:107], v18 offset:20480
  v_mfma_f32_16x16x32_bf16 v[60:63], v[108:111], v[204:207], v[60:63]
  s_waitcnt lgkmcnt(12)
  v_mfma_f32_16x16x32_bf16 v[64:67], v[112:115], v[200:203], v[64:67]
  ds_read_b64_tr_b16 v[108:109], v19 offset:16384
  ds_read_b64_tr_b16 v[110:111], v19 offset:20480
  v_mfma_f32_16x16x32_bf16 v[68:71], v[112:115], v[204:207], v[68:71]
  s_waitcnt lgkmcnt(12)
  v_mfma_f32_16x16x32_bf16 v[72:75], v[116:119], v[200:203], v[72:75]
  ds_read_b64_tr_b16 v[112:113], v20 offset:16384
  ds_read_b64_tr_b16 v[114:115], v20 offset:20480
  v_mfma_f32_16x16x32_bf16 v[76:79], v[116:119], v[204:207], v[76:79]
  s_waitcnt lgkmcnt(12)
  v_mfma_f32_16x16x32_bf16 v[80:83], v[120:123], v[200:203], v[80:83]
  ds_read_b64_tr_b16 v[116:117], v21 offset:16384
  ds_read_b64_tr_b16 v[118:119], v21 offset:20480
  v_mfma_f32_16x16x32_bf16 v[84:87], v[120:123], v[204:207], v[84:87]
  s_waitcnt lgkmcnt(12)
  v_mfma_f32_16x16x32_bf16 v[88:91], v[124:127], v[200:203], v[88:91]
  ds_read_b64_tr_b16 v[120:121], v22 offset:16384
  ds_read_b64_tr_b16 v[122:123], v22 offset:20480
  v_mfma_f32_16x16x32_bf16 v[92:95], v[124:127], v[204:207], v[92:95]
  s_waitcnt lgkmcnt(12)
  s_waitcnt vmcnt(16)
  v_mfma_f32_16x16x32_bf16 v[32:35], v[96:99], v[128:131], v[32:35]
  ds_read_b64_tr_b16 v[124:125], v23 offset:16384
  ds_read_b64_tr_b16 v[126:127], v23 offset:20480
  v_mfma_f32_16x16x32_bf16 v[36:39], v[96:99], v[132:135], v[36:39]
  s_waitcnt lgkmcnt(12)
  v_mfma_f32_16x16x32_bf16 v[40:43], v[100:103], v[128:131], v[40:43]
  ds_read_b64_tr_b16 v[96:97], v16 offset:24576
  ds_read_b64_tr_b16 v[98:99], v16 offset:28672
  v_mfma_f32_16x16x32_bf16 v[44:47], v[100:103], v[132:135], v[44:47]
  buffer_load_dwordx4 v[200:203], v4, s[4:7], s46 offen offset:1024 sc1
  buffer_load_dwordx4 v[204:207], v5, s[4:7], s46 offen offset:1024 sc1
  s_add_u32 s46, s46, 2048
  s_waitcnt lgkmcnt(12)
  v_mfma_f32_16x16x32_bf16 v[48:51], v[104:107], v[128:131], v[48:51]
  ds_read_b64_tr_b16 v[100:101], v17 offset:24576
  ds_read_b64_tr_b16 v[102:103], v17 offset:28672
  v_mfma_f32_16x16x32_bf16 v[52:55], v[104:107], v[132:135], v[52:55]
  s_waitcnt lgkmcnt(12)
  v_mfma_f32_16x16x32_bf16 v[56:59], v[108:111], v[128:131], v[56:59]
  ds_read_b64_tr_b16 v[104:105], v18 offset:24576
  ds_read_b64_tr_b16 v[106:107], v18 offset:28672
  v_mfma_f32_16x16x32_bf16 v[60:63], v[108:111], v[132:135], v[60:63]
  s_waitcnt lgkmcnt(12)
  v_mfma_f32_16x16x32_bf16 v[64:67], v[112:115], v[128:131], v[64:67]
  ds_read_b64_tr_b16 v[108:109], v19 offset:24576
  ds_read_b64_tr_b16 v[110:111], v19 offset:28672
  v_mfma_f32_16x16x32_bf16 v[68:71], v[112:115], v[132:135], v[68:71]
  s_waitcnt lgkmcnt(12)
  v_mfma_f32_16x16x32_bf16 v[72:75], v[116:119], v[128:131], v[72:75]
  ds_read_b64_tr_b16 v[112:113], v20 offset:24576
  ds_read_b64_tr_b16 v[114:115], v20 offset:28672
  v_mfma_f32_16x16x32_bf16 v[76:79], v[116:119], v[132:135], v[76:79]
  s_waitcnt lgkmcnt(12)
  v_mfma_f32_16x16x32_bf16 v[80:83], v[120:123], v[128:131], v[80:83]
  ds_read_b64_tr_b16 v[116:117], v21 offset:24576
  ds_read_b64_tr_b16 v[118:119], v21 offset:28672
  v_mfma_f32_16x16x32_bf16 v[84:87], v[120:123], v[132:135], v[84:87]
  s_waitcnt lgkmcnt(12)
  v_mfma_f32_16x16x32_bf16 v[88:91], v[124:127], v[128:131], v[88:91]
  ds_read_b64_tr_b16 v[120:121], v22 offset:24576
  ds_read_b64_tr_b16 v[122:123], v22 offset:28672
  v_mfma_f32_16x16x32_bf16 v[92:95], v[124:127], v[132:135], v[92:95]
  s_waitcnt lgkmcnt(12)
  s_waitcnt vmcnt(16)
  v_mfma_f32_16x16x32_bf16 v[32:35], v[96:99], v[136:139], v[32:35]
  ds_read_b64_tr_b16 v[124:125], v23 offset:24576
  ds_read_b64_tr_b16 v[126:127], v23 offset:28672
  v_mfma_f32_16x16x32_bf16 v[36:39], v[96:99], v[140:143], v[36:39]
  s_waitcnt lgkmcnt(12)
  v_mfma_f32_16x16x32_bf16 v[40:43], v[100:103], v[136:139], v[40:43]
  s_barrier
  ds_read_b64_tr_b16 v[96:97], v8 offset:0
  ds_read_b64_tr_b16 v[98:99], v8 offset:4096
  v_mfma_f32_16x16x32_bf16 v[44:47], v[100:103], v[140:143], v[44:47]
  buffer_load_dwordx4 v[128:131], v4, s[4:7], s46 offen offset:0 sc1
  buffer_load_dwordx4 v[132:135], v5, s[4:7], s46 offen offset:0 sc1
  s_waitcnt lgkmcnt(12)
  v_mfma_f32_16x16x32_bf16 v[48:51], v[104:107], v[136:139], v[48:51]
  ds_read_b64_tr_b16 v[100:101], v9 offset:0
  ds_read_b64_tr_b16 v[102:103], v9 offset:4096
  v_mfma_f32_16x16x32_bf16 v[52:55], v[104:107], v[140:143], v[52:55]
  s_waitcnt lgkmcnt(12)
  v_mfma_f32_16x16x32_bf16 v[56:59], v[108:111], v[136:139], v[56:59]
  ds_read_b64_tr_b16 v[104:105], v10 offset:0
  ds_read_b64_tr_b16 v[106:107], v10 offset:4096
  v_mfma_f32_16x16x32_bf16 v[60:63], v[108:111], v[140:143], v[60:63]
  s_waitcnt lgkmcnt(12)
  v_mfma_f32_16x16x32_bf16 v[64:67], v[112:115], v[136:139], v[64:67]
  ds_read_b64_tr_b16 v[108:109], v11 offset:0
  ds_read_b64_tr_b16 v[110:111], v11 offset:4096
  v_mfma_f32_16x16x32_bf16 v[68:71], v[112:115], v[140:143], v[68:71]
  s_waitcnt lgkmcnt(12)
  v_mfma_f32_16x16x32_bf16 v[72:75], v[116:119], v[136:139], v[72:75]
  ds_read_b64_tr_b16 v[112:113], v12 offset:0
  ds_read_b64_tr_b16 v[114:115], v12 offset:4096
  v_mfma_f32_16x16x32_bf16 v[76:79], v[116:119], v[140:143], v[76:79]
  s_waitcnt lgkmcnt(12)
  v_mfma_f32_16x16x32_bf16 v[80:83], v[120:123], v[136:139], v[80:83]
  ds_read_b64_tr_b16 v[116:117], v13 offset:0
  ds_read_b64_tr_b16 v[118:119], v13 offset:4096
  v_mfma_f32_16x16x32_bf16 v[84:87], v[120:123], v[140:143], v[84:87]
  s_waitcnt lgkmcnt(12)
  v_mfma_f32_16x16x32_bf16 v[88:91], v[124:127], v[136:139], v[88:91]
  ds_read_b64_tr_b16 v[120:121], v14 offset:0
  ds_read_b64_tr_b16 v[122:123], v14 offset:4096
  v_mfma_f32_16x16x32_bf16 v[92:95], v[124:127], v[140:143], v[92:95]
  s_waitcnt lgkmcnt(12)
  s_waitcnt vmcnt(16)
  v_mfma_f32_16x16x32_bf16 v[32:35], v[96:99], v[144:147], v[32:35]
  ds_read_b64_tr_b16 v[124:125], v15 offset:0
  ds_read_b64_tr_b16 v[126:127], v15 offset:4096
  v_mfma_f32_16x16x32_bf16 v[36:39], v[96:99], v[148:151], v[36:39]
  s_waitcnt lgkmcnt(12)
  v_mfma_f32_16x16x32_bf16 v[40:43], v[100:103], v[144:147], v[40:43]
  ds_read_b64_tr_b16 v[96:97], v8 offset:8192
  ds_read_b64_tr_b16 v[98:99], v8 offset:12288
  v_mfma_f32_16x16x32_bf16 v[44:47], v[100:103], v[148:151], v[44:47]
  buffer_load_dwordx4 v[136:139], v4, s[4:7], s46 offen offset:1024 sc1
  buffer_load_dwordx4 v[140:143], v5, s[4:7], s46 offen offset:1024 sc1
  s_add_u32 s46, s46, 2048
  s_waitcnt lgkmcnt(12)
  v_mfma_f32_16x16x32_bf16 v[48:51], v[104:107], v[144:147], v[48:51]
  ds_read_b64_tr_b16 v[100:101], v9 offset:8192
  ds_read_b64_tr_b16 v[102:103], v9 offset:12288
  v_mfma_f32_16x16x32_bf16 v[52:55], v[104:107], v[148:151], v[52:55]
  s_waitcnt lgkmcnt(12)
  v_mfma_f32_16x16x32_bf16 v[56:59], v[108:111], v[144:147], v[56:59]
  ds_read_b64_tr_b16 v[104:105], v10 offset:8192
  ds_read_b64_tr_b16 v[106:107], v10 offset:12288
  v_mfma_f32_16x16x32_bf16 v[60:63], v[108:111], v[148:151], v[60:63]
  s_waitcnt lgkmcnt(12)
  v_mfma_f32_16x16x32_bf16 v[64:67], v[112:115], v[144:147], v[64:67]
  ds_read_b64_tr_b16 v[108:109], v11 offset:8192
  ds_read_b64_tr_b16 v[110:111], v11 offset:12288
  v_mfma_f32_16x16x32_bf16 v[68:71], v[112:115], v[148:151], v[68:71]
  s_waitcnt lgkmcnt(12)
  v_mfma_f32_16x16x32_bf16 v[72:75], v[116:119], v[144:147], v[72:75]
  ds_read_b64_tr_b16 v[112:113], v12 offset:8192
  ds_read_b64_tr_b16 v[114:115], v12 offset:12288
  v_mfma_f32_16x16x32_bf16 v[76:79], v[116:119], v[148:151], v[76:79]
  s_waitcnt lgkmcnt(12)
  v_mfma_f32_16x16x32_bf16 v[80:83], v[120:123], v[144:147], v[80:83]
  ds_read_b64_tr_b16 v[116:117], v13 offset:8192
  ds_read_b64_tr_b16 v[118:119], v13 offset:12288
  v_mfma_f32_16x16x32_bf16 v[84:87], v[120:123], v[148:151], v[84:87]
  s_waitcnt lgkmcnt(12)
  v_mfma_f32_16x16x32_bf16 v[88:91], v[124:127], v[144:147], v[88:91]
  ds_read_b64_tr_b16 v[120:121], v14 offset:8192
  ds_read_b64_tr_b16 v[122:123], v14 offset:12288
  v_mfma_f32_16x16x32_bf16 v[92:95], v[124:127], v[148:151], v[92:95]
  s_waitcnt lgkmcnt(12)
  s_waitcnt vmcnt(16)
  v_mfma_f32_16x16x32_bf16 v[32:35], v[96:99], v[152:155], v[32:35]
  ds_read_b64_tr_b16 v[124:125], v15 offset:8192
  ds_read_b64_tr_b16 v[126:127], v15 offset:12288
  v_mfma_f32_16x16x32_bf16 v[36:39], v[96:99], v[156:159], v[36:39]
  s_waitcnt lgkmcnt(12)
  v_mfma_f32_16x16x32_bf16 v[40:43], v[100:103], v[152:155], v[40:43]
  s_barrier
  ds_read_b64_tr_b16 v[96:97], v8 offset:16384
  ds_read_b64_tr_b16 v[98:99], v8 offset:20480
  v_mfma_f32_16x16x32_bf16 v[44:47], v[100:103], v[156:159], v[44:47]
  buffer_load_dwordx4 v[144:147], v4, s[4:7], s46 offen offset:0 sc1
  buffer_load_dwordx4 v[148:151], v5, s[4:7], s46 offen offset:0 sc1
  s_waitcnt lgkmcnt(12)
  v_mfma_f32_16x16x32_bf16 v[48:51], v[104:107], v[152:155], v[48:51]
  ds_read_b64_tr_b16 v[100:101], v9 offset:16384
  ds_read_b64_tr_b16 v[102:103], v9 offset:20480
  v_mfma_f32_16x16x32_bf16 v[52:55], v[104:107], v[156:159], v[52:55]
  s_waitcnt lgkmcnt(12)
  v_mfma_f32_16x16x32_bf16 v[56:59], v[108:111], v[152:155], v[56:59]
  ds_read_b64_tr_b16 v[104:105], v10 offset:16384
  ds_read_b64_tr_b16 v[106:107], v10 offset:20480
  v_mfma_f32_16x16x32_bf16 v[60:63], v[108:111], v[156:159], v[60:63]
  s_waitcnt lgkmcnt(12)
  v_mfma_f32_16x16x32_bf16 v[64:67], v[112:115], v[152:155], v[64:67]
  ds_read_b64_tr_b16 v[108:109], v11 offset:16384
  ds_read_b64_tr_b16 v[110:111], v11 offset:20480
  v_mfma_f32_16x16x32_bf16 v[68:71], v[112:115], v[156:159], v[68:71]
  s_waitcnt lgkmcnt(12)
  v_mfma_f32_16x16x32_bf16 v[72:75], v[116:119], v[152:155], v[72:75]
  ds_read_b64_tr_b16 v[112:113], v12 offset:16384
  ds_read_b64_tr_b16 v[114:115], v12 offset:20480
  v_mfma_f32_16x16x32_bf16 v[76:79], v[116:119], v[156:159], v[76:79]
  s_waitcnt lgkmcnt(12)
  v_mfma_f32_16x16x32_bf16 v[80:83], v[120:123], v[152:155], v[80:83]
  ds_read_b64_tr_b16 v[116:117], v13 offset:16384
  ds_read_b64_tr_b16 v[118:119], v13 offset:20480
  v_mfma_f32_16x16x32_bf16 v[84:87], v[120:123], v[156:159], v[84:87]
  s_waitcnt lgkmcnt(12)
  v_mfma_f32_16x16x32_bf16 v[88:91], v[124:127], v[152:155], v[88:91]
  ds_read_b64_tr_b16 v[120:121], v14 offset:16384
  ds_read_b64_tr_b16 v[122:123], v14 offset:20480
  v_mfma_f32_16x16x32_bf16 v[92:95], v[124:127], v[156:159], v[92:95]
  s_waitcnt lgkmcnt(12)
  s_waitcnt vmcnt(16)
  v_mfma_f32_16x16x32_bf16 v[32:35], v[96:99], v[160:163], v[32:35]
  ds_read_b64_tr_b16 v[124:125], v15 offset:16384
  ds_read_b64_tr_b16 v[126:127], v15 offset:20480
  v_mfma_f32_16x16x32_bf16 v[36:39], v[96:99], v[164:167], v[36:39]
  s_waitcnt lgkmcnt(12)
  v_mfma_f32_16x16x32_bf16 v[40:43], v[100:103], v[160:163], v[40:43]
  ds_read_b64_tr_b16 v[96:97], v8 offset:24576
  ds_read_b64_tr_b16 v[98:99], v8 offset:28672
  v_mfma_f32_16x16x32_bf16 v[44:47], v[100:103], v[164:167], v[44:47]
  buffer_load_dwordx4 v[152:155], v4, s[4:7], s46 offen offset:1024 sc1
  buffer_load_dwordx4 v[156:159], v5, s[4:7], s46 offen offset:1024 sc1
  s_add_u32 s46, s46, 2048
  s_waitcnt lgkmcnt(12)
  v_mfma_f32_16x16x32_bf16 v[48:51], v[104:107], v[160:163], v[48:51]
  ds_read_b64_tr_b16 v[100:101], v9 offset:24576
  ds_read_b64_tr_b16 v[102:103], v9 offset:28672
  v_mfma_f32_16x16x32_bf16 v[52:55], v[104:107], v[164:167], v[52:55]
  s_waitcnt lgkmcnt(12)
  v_mfma_f32_16x16x32_bf16 v[56:59], v[108:111], v[160:163], v[56:59]
  ds_read_b64_tr_b16 v[104:105], v10 offset:24576
  ds_read_b64_tr_b16 v[106:107], v10 offset:28672
  v_mfma_f32_16x16x32_bf16 v[60:63], v[108:111], v[164:167], v[60:63]
  s_waitcnt lgkmcnt(12)
  v_mfma_f32_16x16x32_bf16 v[64:67], v[112:115], v[160:163], v[64:67]
  ds_read_b64_tr_b16 v[108:109], v11 offset:24576
  ds_read_b64_tr_b16 v[110:111], v11 offset:28672
  v_mfma_f32_16x16x32_bf16 v[68:71], v[112:115], v[164:167], v[68:71]
  s_waitcnt lgkmcnt(12)
  v_mfma_f32_16x16x32_bf16 v[72:75], v[116:119], v[160:163], v[72:75]
  ds_read_b64_tr_b16 v[112:113], v12 offset:24576
  ds_read_b64_tr_b16 v[114:115], v12 offset:28672
  v_mfma_f32_16x16x32_bf16 v[76:79], v[116:119], v[164:167], v[76:79]
  s_waitcnt lgkmcnt(12)
  v_mfma_f32_16x16x32_bf16 v[80:83], v[120:123], v[160:163], v[80:83]
  ds_read_b64_tr_b16 v[116:117], v13 offset:24576
  ds_read_b64_tr_b16 v[118:119], v13 offset:28672
  v_mfma_f32_16x16x32_bf16 v[84:87], v[120:123], v[164:167], v[84:87]
  s_waitcnt lgkmcnt(12)
  v_mfma_f32_16x16x32_bf16 v[88:91], v[124:127], v[160:163], v[88:91]
  ds_read_b64_tr_b16 v[120:121], v14 offset:24576
  ds_read_b64_tr_b16 v[122:123], v14 offset:28672
  v_mfma_f32_16x16x32_bf16 v[92:95], v[124:127], v[164:167], v[92:95]
  s_waitcnt lgkmcnt(12)
  s_waitcnt vmcnt(16)
  v_mfma_f32_16x16x32_bf16 v[32:35], v[96:99], v[168:171], v[32:35]
  ds_read_b64_tr_b16 v[124:125], v15 offset:24576
  ds_read_b64_tr_b16 v[126:127], v15 offset:28672
  v_mfma_f32_16x16x32_bf16 v[36:39], v[96:99], v[172:175], v[36:39]
  s_waitcnt lgkmcnt(12)
  v_mfma_f32_16x16x32_bf16 v[40:43], v[100:103], v[168:171], v[40:43]
  s_barrier
  ds_read_b64_tr_b16 v[96:97], v8 offset:32768
  ds_read_b64_tr_b16 v[98:99], v8 offset:36864
  v_mfma_f32_16x16x32_bf16 v[44:47], v[100:103], v[172:175], v[44:47]
  buffer_load_dwordx4 v[160:163], v4, s[4:7], s46 offen offset:0 sc1
  buffer_load_dwordx4 v[164:167], v5, s[4:7], s46 offen offset:0 sc1
  s_waitcnt lgkmcnt(12)
  v_mfma_f32_16x16x32_bf16 v[48:51], v[104:107], v[168:171], v[48:51]
  ds_read_b64_tr_b16 v[100:101], v9 offset:32768
  ds_read_b64_tr_b16 v[102:103], v9 offset:36864
  v_mfma_f32_16x16x32_bf16 v[52:55], v[104:107], v[172:175], v[52:55]
  s_waitcnt lgkmcnt(12)
  v_mfma_f32_16x16x32_bf16 v[56:59], v[108:111], v[168:171], v[56:59]
  ds_read_b64_tr_b16 v[104:105], v10 offset:32768
  ds_read_b64_tr_b16 v[106:107], v10 offset:36864
  v_mfma_f32_16x16x32_bf16 v[60:63], v[108:111], v[172:175], v[60:63]
  s_waitcnt lgkmcnt(12)
  v_mfma_f32_16x16x32_bf16 v[64:67], v[112:115], v[168:171], v[64:67]
  ds_read_b64_tr_b16 v[108:109], v11 offset:32768
  ds_read_b64_tr_b16 v[110:111], v11 offset:36864
  v_mfma_f32_16x16x32_bf16 v[68:71], v[112:115], v[172:175], v[68:71]
  s_waitcnt lgkmcnt(12)
  v_mfma_f32_16x16x32_bf16 v[72:75], v[116:119], v[168:171], v[72:75]
  ds_read_b64_tr_b16 v[112:113], v12 offset:32768
  ds_read_b64_tr_b16 v[114:115], v12 offset:36864
  v_mfma_f32_16x16x32_bf16 v[76:79], v[116:119], v[172:175], v[76:79]
  s_waitcnt lgkmcnt(12)
  v_mfma_f32_16x16x32_bf16 v[80:83], v[120:123], v[168:171], v[80:83]
  ds_read_b64_tr_b16 v[116:117], v13 offset:32768
  ds_read_b64_tr_b16 v[118:119], v13 offset:36864
  v_mfma_f32_16x16x32_bf16 v[84:87], v[120:123], v[172:175], v[84:87]
  s_waitcnt lgkmcnt(12)
  v_mfma_f32_16x16x32_bf16 v[88:91], v[124:127], v[168:171], v[88:91]
  ds_read_b64_tr_b16 v[120:121], v14 offset:32768
  ds_read_b64_tr_b16 v[122:123], v14 offset:36864
  v_mfma_f32_16x16x32_bf16 v[92:95], v[124:127], v[172:175], v[92:95]
  s_waitcnt lgkmcnt(12)
  s_waitcnt vmcnt(16)
  v_mfma_f32_16x16x32_bf16 v[32:35], v[96:99], v[176:179], v[32:35]
  ds_read_b64_tr_b16 v[124:125], v15 offset:32768
  ds_read_b64_tr_b16 v[126:127], v15 offset:36864
  v_mfma_f32_16x16x32_bf16 v[36:39], v[96:99], v[180:183], v[36:39]
  s_waitcnt lgkmcnt(12)
  v_mfma_f32_16x16x32_bf16 v[40:43], v[100:103], v[176:179], v[40:43]
  ds_read_b64_tr_b16 v[96:97], v8 offset:40960
  ds_read_b64_tr_b16 v[98:99], v8 offset:45056
  v_mfma_f32_16x16x32_bf16 v[44:47], v[100:103], v[180:183], v[44:47]
  buffer_load_dwordx4 v[168:171], v4, s[4:7], s46 offen offset:1024 sc1
  buffer_load_dwordx4 v[172:175], v5, s[4:7], s46 offen offset:1024 sc1
  s_add_u32 s46, s46, 2048
  s_waitcnt lgkmcnt(12)
  v_mfma_f32_16x16x32_bf16 v[48:51], v[104:107], v[176:179], v[48:51]
  ds_read_b64_tr_b16 v[100:101], v9 offset:40960
  ds_read_b64_tr_b16 v[102:103], v9 offset:45056
  v_mfma_f32_16x16x32_bf16 v[52:55], v[104:107], v[180:183], v[52:55]
  s_waitcnt lgkmcnt(12)
  v_mfma_f32_16x16x32_bf16 v[56:59], v[108:111], v[176:179], v[56:59]
  ds_read_b64_tr_b16 v[104:105], v10 offset:40960
  ds_read_b64_tr_b16 v[106:107], v10 offset:45056
  v_mfma_f32_16x16x32_bf16 v[60:63], v[108:111], v[180:183], v[60:63]
  s_waitcnt lgkmcnt(12)
  v_mfma_f32_16x16x32_bf16 v[64:67], v[112:115], v[176:179], v[64:67]
  ds_read_b64_tr_b16 v[108:109], v11 offset:40960
  ds_read_b64_tr_b16 v[110:111], v11 offset:45056
  v_mfma_f32_16x16x32_bf16 v[68:71], v[112:115], v[180:183], v[68:71]
  s_waitcnt lgkmcnt(12)
  v_mfma_f32_16x16x32_bf16 v[72:75], v[116:119], v[176:179], v[72:75]
  ds_read_b64_tr_b16 v[112:113], v12 offset:40960
  ds_read_b64_tr_b16 v[114:115], v12 offset:45056
  v_mfma_f32_16x16x32_bf16 v[76:79], v[116:119], v[180:183], v[76:79]
  s_waitcnt lgkmcnt(12)
  v_mfma_f32_16x16x32_bf16 v[80:83], v[120:123], v[176:179], v[80:83]
  ds_read_b64_tr_b16 v[116:117], v13 offset:40960
  ds_read_b64_tr_b16 v[118:119], v13 offset:45056
  v_mfma_f32_16x16x32_bf16 v[84:87], v[120:123], v[180:183], v[84:87]
  s_waitcnt lgkmcnt(12)
  v_mfma_f32_16x16x32_bf16 v[88:91], v[124:127], v[176:179], v[88:91]
  ds_read_b64_tr_b16 v[120:121], v14 offset:40960
  ds_read_b64_tr_b16 v[122:123], v14 offset:45056
  v_mfma_f32_16x16x32_bf16 v[92:95], v[124:127], v[180:183], v[92:95]
  s_waitcnt lgkmcnt(12)
  s_waitcnt vmcnt(16)
  v_mfma_f32_16x16x32_bf16 v[32:35], v[96:99], v[184:187], v[32:35]
  ds_read_b64_tr_b16 v[124:125], v15 offset:40960
  ds_read_b64_tr_b16 v[126:127], v15 offset:45056
  v_mfma_f32_16x16x32_bf16 v[36:39], v[96:99], v[188:191], v[36:39]
  s_waitcnt lgkmcnt(12)
  v_mfma_f32_16x16x32_bf16 v[40:43], v[100:103], v[184:187], v[40:43]
  s_barrier
  ds_read_b64_tr_b16 v[96:97], v8 offset:49152
  ds_read_b64_tr_b16 v[98:99], v8 offset:53248
  v_mfma_f32_16x16x32_bf16 v[44:47], v[100:103], v[188:191], v[44:47]
  buffer_load_dwordx4 v[176:179], v4, s[4:7], s46 offen offset:0 sc1
  buffer_load_dwordx4 v[180:183], v5, s[4:7], s46 offen offset:0 sc1
  s_waitcnt lgkmcnt(12)
  v_mfma_f32_16x16x32_bf16 v[48:51], v[104:107], v[184:187], v[48:51]
  ds_read_b64_tr_b16 v[100:101], v9 offset:49152
  ds_read_b64_tr_b16 v[102:103], v9 offset:53248
  v_mfma_f32_16x16x32_bf16 v[52:55], v[104:107], v[188:191], v[52:55]
  s_waitcnt lgkmcnt(12)
  v_mfma_f32_16x16x32_bf16 v[56:59], v[108:111], v[184:187], v[56:59]
  ds_read_b64_tr_b16 v[104:105], v10 offset:49152
  ds_read_b64_tr_b16 v[106:107], v10 offset:53248
  v_mfma_f32_16x16x32_bf16 v[60:63], v[108:111], v[188:191], v[60:63]
  s_waitcnt lgkmcnt(12)
  v_mfma_f32_16x16x32_bf16 v[64:67], v[112:115], v[184:187], v[64:67]
  ds_read_b64_tr_b16 v[108:109], v11 offset:49152
  ds_read_b64_tr_b16 v[110:111], v11 offset:53248
  v_mfma_f32_16x16x32_bf16 v[68:71], v[112:115], v[188:191], v[68:71]
  s_waitcnt lgkmcnt(12)
  v_mfma_f32_16x16x32_bf16 v[72:75], v[116:119], v[184:187], v[72:75]
  ds_read_b64_tr_b16 v[112:113], v12 offset:49152
  ds_read_b64_tr_b16 v[114:115], v12 offset:53248
  v_mfma_f32_16x16x32_bf16 v[76:79], v[116:119], v[188:191], v[76:79]
  s_waitcnt lgkmcnt(12)
  v_mfma_f32_16x16x32_bf16 v[80:83], v[120:123], v[184:187], v[80:83]
  ds_read_b64_tr_b16 v[116:117], v13 offset:49152
  ds_read_b64_tr_b16 v[118:119], v13 offset:53248
  v_mfma_f32_16x16x32_bf16 v[84:87], v[120:123], v[188:191], v[84:87]
  s_waitcnt lgkmcnt(12)
  v_mfma_f32_16x16x32_bf16 v[88:91], v[124:127], v[184:187], v[88:91]
  ds_read_b64_tr_b16 v[120:121], v14 offset:49152
  ds_read_b64_tr_b16 v[122:123], v14 offset:53248
  v_mfma_f32_16x16x32_bf16 v[92:95], v[124:127], v[188:191], v[92:95]
  s_waitcnt lgkmcnt(12)
  s_waitcnt vmcnt(16)
  v_mfma_f32_16x16x32_bf16 v[32:35], v[96:99], v[192:195], v[32:35]
  ds_read_b64_tr_b16 v[124:125], v15 offset:49152
  ds_read_b64_tr_b16 v[126:127], v15 offset:53248
  v_mfma_f32_16x16x32_bf16 v[36:39], v[96:99], v[196:199], v[36:39]
  s_waitcnt lgkmcnt(12)
  v_mfma_f32_16x16x32_bf16 v[40:43], v[100:103], v[192:195], v[40:43]
  ds_read_b64_tr_b16 v[96:97], v8 offset:57344
  ds_read_b64_tr_b16 v[98:99], v8 offset:61440
  v_mfma_f32_16x16x32_bf16 v[44:47], v[100:103], v[196:199], v[44:47]
  buffer_load_dwordx4 v[184:187], v4, s[4:7], s46 offen offset:1024 sc1
  buffer_load_dwordx4 v[188:191], v5, s[4:7], s46 offen offset:1024 sc1
  s_add_u32 s46, s46, 2048
  s_waitcnt lgkmcnt(12)
  v_mfma_f32_16x16x32_bf16 v[48:51], v[104:107], v[192:195], v[48:51]
  ds_read_b64_tr_b16 v[100:101], v9 offset:57344
  ds_read_b64_tr_b16 v[102:103], v9 offset:61440
  v_mfma_f32_16x16x32_bf16 v[52:55], v[104:107], v[196:199], v[52:55]
  s_waitcnt lgkmcnt(12)
  v_mfma_f32_16x16x32_bf16 v[56:59], v[108:111], v[192:195], v[56:59]
  ds_read_b64_tr_b16 v[104:105], v10 offset:57344
  ds_read_b64_tr_b16 v[106:107], v10 offset:61440
  v_mfma_f32_16x16x32_bf16 v[60:63], v[108:111], v[196:199], v[60:63]
  s_waitcnt lgkmcnt(12)
  v_mfma_f32_16x16x32_bf16 v[64:67], v[112:115], v[192:195], v[64:67]
  ds_read_b64_tr_b16 v[108:109], v11 offset:57344
  ds_read_b64_tr_b16 v[110:111], v11 offset:61440
  v_mfma_f32_16x16x32_bf16 v[68:71], v[112:115], v[196:199], v[68:71]
  s_waitcnt lgkmcnt(12)
  v_mfma_f32_16x16x32_bf16 v[72:75], v[116:119], v[192:195], v[72:75]
  ds_read_b64_tr_b16 v[112:113], v12 offset:57344
  ds_read_b64_tr_b16 v[114:115], v12 offset:61440
  v_mfma_f32_16x16x32_bf16 v[76:79], v[116:119], v[196:199], v[76:79]
  s_waitcnt lgkmcnt(12)
  v_mfma_f32_16x16x32_bf16 v[80:83], v[120:123], v[192:195], v[80:83]
  ds_read_b64_tr_b16 v[116:117], v13 offset:57344
  ds_read_b64_tr_b16 v[118:119], v13 offset:61440
  v_mfma_f32_16x16x32_bf16 v[84:87], v[120:123], v[196:199], v[84:87]
  s_waitcnt lgkmcnt(12)
  v_mfma_f32_16x16x32_bf16 v[88:91], v[124:127], v[192:195], v[88:91]
  ds_read_b64_tr_b16 v[120:121], v14 offset:57344
  ds_read_b64_tr_b16 v[122:123], v14 offset:61440
  v_mfma_f32_16x16x32_bf16 v[92:95], v[124:127], v[196:199], v[92:95]
  s_waitcnt lgkmcnt(12)
  s_waitcnt vmcnt(16)
  v_mfma_f32_16x16x32_bf16 v[32:35], v[96:99], v[200:203], v[32:35]
  ds_read_b64_tr_b16 v[124:125], v15 offset:57344
  ds_read_b64_tr_b16 v[126:127], v15 offset:61440
  v_mfma_f32_16x16x32_bf16 v[36:39], v[96:99], v[204:207], v[36:39]
  s_waitcnt lgkmcnt(12)
  v_mfma_f32_16x16x32_bf16 v[40:43], v[100:103], v[200:203], v[40:43]
  s_barrier
  ds_read_b64_tr_b16 v[96:97], v16 offset:0
  ds_read_b64_tr_b16 v[98:99], v16 offset:4096
  v_mfma_f32_16x16x32_bf16 v[44:47], v[100:103], v[204:207], v[44:47]
  buffer_load_dwordx4 v[192:195], v4, s[4:7], s46 offen offset:0 sc1
  buffer_load_dwordx4 v[196:199], v5, s[4:7], s46 offen offset:0 sc1
  s_waitcnt lgkmcnt(12)
  v_mfma_f32_16x16x32_bf16 v[48:51], v[104:107], v[200:203], v[48:51]
  ds_read_b64_tr_b16 v[100:101], v17 offset:0
  ds_read_b64_tr_b16 v[102:103], v17 offset:4096
  v_mfma_f32_16x16x32_bf16 v[52:55], v[104:107], v[204:207], v[52:55]
  s_waitcnt lgkmcnt(12)
  v_mfma_f32_16x16x32_bf16 v[56:59], v[108:111], v[200:203], v[56:59]
  ds_read_b64_tr_b16 v[104:105], v18 offset:0
  ds_read_b64_tr_b16 v[106:107], v18 offset:4096
  v_mfma_f32_16x16x32_bf16 v[60:63], v[108:111], v[204:207], v[60:63]
  s_waitcnt lgkmcnt(12)
  v_mfma_f32_16x16x32_bf16 v[64:67], v[112:115], v[200:203], v[64:67]
  ds_read_b64_tr_b16 v[108:109], v19 offset:0
  ds_read_b64_tr_b16 v[110:111], v19 offset:4096
  v_mfma_f32_16x16x32_bf16 v[68:71], v[112:115], v[204:207], v[68:71]
  s_waitcnt lgkmcnt(12)
  v_mfma_f32_16x16x32_bf16 v[72:75], v[116:119], v[200:203], v[72:75]
  ds_read_b64_tr_b16 v[112:113], v20 offset:0
  ds_read_b64_tr_b16 v[114:115], v20 offset:4096
  v_mfma_f32_16x16x32_bf16 v[76:79], v[116:119], v[204:207], v[76:79]
  s_waitcnt lgkmcnt(12)
  v_mfma_f32_16x16x32_bf16 v[80:83], v[120:123], v[200:203], v[80:83]
  ds_read_b64_tr_b16 v[116:117], v21 offset:0
  ds_read_b64_tr_b16 v[118:119], v21 offset:4096
  v_mfma_f32_16x16x32_bf16 v[84:87], v[120:123], v[204:207], v[84:87]
  s_waitcnt lgkmcnt(12)
  v_mfma_f32_16x16x32_bf16 v[88:91], v[124:127], v[200:203], v[88:91]
  ds_read_b64_tr_b16 v[120:121], v22 offset:0
  ds_read_b64_tr_b16 v[122:123], v22 offset:4096
  v_mfma_f32_16x16x32_bf16 v[92:95], v[124:127], v[204:207], v[92:95]
  s_waitcnt lgkmcnt(12)
  s_waitcnt vmcnt(16)
  v_mfma_f32_16x16x32_bf16 v[32:35], v[96:99], v[128:131], v[32:35]
  ds_read_b64_tr_b16 v[124:125], v23 offset:0
  ds_read_b64_tr_b16 v[126:127], v23 offset:4096
  v_mfma_f32_16x16x32_bf16 v[36:39], v[96:99], v[132:135], v[36:39]
  s_waitcnt lgkmcnt(12)
  v_mfma_f32_16x16x32_bf16 v[40:43], v[100:103], v[128:131], v[40:43]
  ds_read_b64_tr_b16 v[96:97], v16 offset:8192
  ds_read_b64_tr_b16 v[98:99], v16 offset:12288
  v_mfma_f32_16x16x32_bf16 v[44:47], v[100:103], v[132:135], v[44:47]
  buffer_load_dwordx4 v[200:203], v4, s[4:7], s46 offen offset:1024 sc1
  buffer_load_dwordx4 v[204:207], v5, s[4:7], s46 offen offset:1024 sc1
  s_add_u32 s46, s46, 2048
  s_waitcnt lgkmcnt(12)
  v_mfma_f32_16x16x32_bf16 v[48:51], v[104:107], v[128:131], v[48:51]
  ds_read_b64_tr_b16 v[100:101], v17 offset:8192
  ds_read_b64_tr_b16 v[102:103], v17 offset:12288
  v_mfma_f32_16x16x32_bf16 v[52:55], v[104:107], v[132:135], v[52:55]
  s_waitcnt lgkmcnt(12)
  v_mfma_f32_16x16x32_bf16 v[56:59], v[108:111], v[128:131], v[56:59]
  ds_read_b64_tr_b16 v[104:105], v18 offset:8192
  ds_read_b64_tr_b16 v[106:107], v18 offset:12288
  v_mfma_f32_16x16x32_bf16 v[60:63], v[108:111], v[132:135], v[60:63]
  s_waitcnt lgkmcnt(12)
  v_mfma_f32_16x16x32_bf16 v[64:67], v[112:115], v[128:131], v[64:67]
  ds_read_b64_tr_b16 v[108:109], v19 offset:8192
  ds_read_b64_tr_b16 v[110:111], v19 offset:12288
  v_mfma_f32_16x16x32_bf16 v[68:71], v[112:115], v[132:135], v[68:71]
  s_waitcnt lgkmcnt(12)
  v_mfma_f32_16x16x32_bf16 v[72:75], v[116:119], v[128:131], v[72:75]
  ds_read_b64_tr_b16 v[112:113], v20 offset:8192
  ds_read_b64_tr_b16 v[114:115], v20 offset:12288
  v_mfma_f32_16x16x32_bf16 v[76:79], v[116:119], v[132:135], v[76:79]
  s_waitcnt lgkmcnt(12)
  v_mfma_f32_16x16x32_bf16 v[80:83], v[120:123], v[128:131], v[80:83]
  ds_read_b64_tr_b16 v[116:117], v21 offset:8192
  ds_read_b64_tr_b16 v[118:119], v21 offset:12288
  v_mfma_f32_16x16x32_bf16 v[84:87], v[120:123], v[132:135], v[84:87]
  s_waitcnt lgkmcnt(12)
  v_mfma_f32_16x16x32_bf16 v[88:91], v[124:127], v[128:131], v[88:91]
  ds_read_b64_tr_b16 v[120:121], v22 offset:8192
  ds_read_b64_tr_b16 v[122:123], v22 offset:12288
  v_mfma_f32_16x16x32_bf16 v[92:95], v[124:127], v[132:135], v[92:95]
  s_waitcnt lgkmcnt(12)
  s_waitcnt vmcnt(16)
  v_mfma_f32_16x16x32_bf16 v[32:35], v[96:99], v[136:139], v[32:35]
  ds_read_b64_tr_b16 v[124:125], v23 offset:8192
  ds_read_b64_tr_b16 v[126:127], v23 offset:12288
  v_mfma_f32_16x16x32_bf16 v[36:39], v[96:99], v[140:143], v[36:39]
  s_waitcnt lgkmcnt(12)
  v_mfma_f32_16x16x32_bf16 v[40:43], v[100:103], v[136:139], v[40:43]
  s_barrier
  ds_read_b64_tr_b16 v[96:97], v16 offset:16384
  ds_read_b64_tr_b16 v[98:99], v16 offset:20480
  v_mfma_f32_16x16x32_bf16 v[44:47], v[100:103], v[140:143], v[44:47]
  buffer_load_dwordx4 v[128:131], v4, s[4:7], s46 offen offset:0 sc1
  buffer_load_dwordx4 v[132:135], v5, s[4:7], s46 offen offset:0 sc1
  s_waitcnt lgkmcnt(12)
  v_mfma_f32_16x16x32_bf16 v[48:51], v[104:107], v[136:139], v[48:51]
  ds_read_b64_tr_b16 v[100:101], v17 offset:16384
  ds_read_b64_tr_b16 v[102:103], v17 offset:20480
  v_mfma_f32_16x16x32_bf16 v[52:55], v[104:107], v[140:143], v[52:55]
  s_waitcnt lgkmcnt(12)
  v_mfma_f32_16x16x32_bf16 v[56:59], v[108:111], v[136:139], v[56:59]
  ds_read_b64_tr_b16 v[104:105], v18 offset:16384
  ds_read_b64_tr_b16 v[106:107], v18 offset:20480
  v_mfma_f32_16x16x32_bf16 v[60:63], v[108:111], v[140:143], v[60:63]
  s_waitcnt lgkmcnt(12)
  v_mfma_f32_16x16x32_bf16 v[64:67], v[112:115], v[136:139], v[64:67]
  ds_read_b64_tr_b16 v[108:109], v19 offset:16384
  ds_read_b64_tr_b16 v[110:111], v19 offset:20480
  v_mfma_f32_16x16x32_bf16 v[68:71], v[112:115], v[140:143], v[68:71]
  s_waitcnt lgkmcnt(12)
  v_mfma_f32_16x16x32_bf16 v[72:75], v[116:119], v[136:139], v[72:75]
  ds_read_b64_tr_b16 v[112:113], v20 offset:16384
  ds_read_b64_tr_b16 v[114:115], v20 offset:20480
  v_mfma_f32_16x16x32_bf16 v[76:79], v[116:119], v[140:143], v[76:79]
  s_waitcnt lgkmcnt(12)
  v_mfma_f32_16x16x32_bf16 v[80:83], v[120:123], v[136:139], v[80:83]
  ds_read_b64_tr_b16 v[116:117], v21 offset:16384
  ds_read_b64_tr_b16 v[118:119], v21 offset:20480
  v_mfma_f32_16x16x32_bf16 v[84:87], v[120:123], v[140:143], v[84:87]
  s_waitcnt lgkmcnt(12)
  v_mfma_f32_16x16x32_bf16 v[88:91], v[124:127], v[136:139], v[88:91]
  ds_read_b64_tr_b16 v[120:121], v22 offset:16384
  ds_read_b64_tr_b16 v[122:123], v22 offset:20480
  v_mfma_f32_16x16x32_bf16 v[92:95], v[124:127], v[140:143], v[92:95]
  s_waitcnt lgkmcnt(12)
  s_waitcnt vmcnt(16)
  v_mfma_f32_16x16x32_bf16 v[32:35], v[96:99], v[144:147], v[32:35]
  ds_read_b64_tr_b16 v[124:125], v23 offset:16384
  ds_read_b64_tr_b16 v[126:127], v23 offset:20480
  v_mfma_f32_16x16x32_bf16 v[36:39], v[96:99], v[148:151], v[36:39]
  s_waitcnt lgkmcnt(12)
  v_mfma_f32_16x16x32_bf16 v[40:43], v[100:103], v[144:147], v[40:43]
  ds_read_b64_tr_b16 v[96:97], v16 offset:24576
  ds_read_b64_tr_b16 v[98:99], v16 offset:28672
  v_mfma_f32_16x16x32_bf16 v[44:47], v[100:103], v[148:151], v[44:47]
  buffer_load_dwordx4 v[136:139], v4, s[4:7], s46 offen offset:1024 sc1
  buffer_load_dwordx4 v[140:143], v5, s[4:7], s46 offen offset:1024 sc1
  s_add_u32 s46, s46, 2048
  s_waitcnt lgkmcnt(12)
  v_mfma_f32_16x16x32_bf16 v[48:51], v[104:107], v[144:147], v[48:51]
  ds_read_b64_tr_b16 v[100:101], v17 offset:24576
  ds_read_b64_tr_b16 v[102:103], v17 offset:28672
  v_mfma_f32_16x16x32_bf16 v[52:55], v[104:107], v[148:151], v[52:55]
  s_waitcnt lgkmcnt(12)
  v_mfma_f32_16x16x32_bf16 v[56:59], v[108:111], v[144:147], v[56:59]
  ds_read_b64_tr_b16 v[104:105], v18 offset:24576
  ds_read_b64_tr_b16 v[106:107], v18 offset:28672
  v_mfma_f32_16x16x32_bf16 v[60:63], v[108:111], v[148:151], v[60:63]
  s_waitcnt lgkmcnt(12)
  v_mfma_f32_16x16x32_bf16 v[64:67], v[112:115], v[144:147], v[64:67]
  ds_read_b64_tr_b16 v[108:109], v19 offset:24576
  ds_read_b64_tr_b16 v[110:111], v19 offset:28672
  v_mfma_f32_16x16x32_bf16 v[68:71], v[112:115], v[148:151], v[68:71]
  s_waitcnt lgkmcnt(12)
  v_mfma_f32_16x16x32_bf16 v[72:75], v[116:119], v[144:147], v[72:75]
  ds_read_b64_tr_b16 v[112:113], v20 offset:24576
  ds_read_b64_tr_b16 v[114:115], v20 offset:28672
  v_mfma_f32_16x16x32_bf16 v[76:79], v[116:119], v[148:151], v[76:79]
  s_waitcnt lgkmcnt(12)
  v_mfma_f32_16x16x32_bf16 v[80:83], v[120:123], v[144:147], v[80:83]
  ds_read_b64_tr_b16 v[116:117], v21 offset:24576
  ds_read_b64_tr_b16 v[118:119], v21 offset:28672
  v_mfma_f32_16x16x32_bf16 v[84:87], v[120:123], v[148:151], v[84:87]
  s_waitcnt lgkmcnt(12)
  v_mfma_f32_16x16x32_bf16 v[88:91], v[124:127], v[144:147], v[88:91]
  ds_read_b64_tr_b16 v[120:121], v22 offset:24576
  ds_read_b64_tr_b16 v[122:123], v22 offset:28672
  v_mfma_f32_16x16x32_bf16 v[92:95], v[124:127], v[148:151], v[92:95]
  s_waitcnt lgkmcnt(12)
  s_waitcnt vmcnt(16)
  v_mfma_f32_16x16x32_bf16 v[32:35], v[96:99], v[152:155], v[32:35]
  ds_read_b64_tr_b16 v[124:125], v23 offset:24576
  ds_read_b64_tr_b16 v[126:127], v23 offset:28672
  v_mfma_f32_16x16x32_bf16 v[36:39], v[96:99], v[156:159], v[36:39]
  s_waitcnt lgkmcnt(12)
  v_mfma_f32_16x16x32_bf16 v[40:43], v[100:103], v[152:155], v[40:43]
  s_barrier
  ds_read_b64_tr_b16 v[96:97], v8 offset:0
  ds_read_b64_tr_b16 v[98:99], v8 offset:4096
  v_mfma_f32_16x16x32_bf16 v[44:47], v[100:103], v[156:159], v[44:47]
  s_mov_b32 s44, 262144
  buffer_load_dwordx2 v[208:209], v24, s[16:19], s44 offen offset:0 sc1
  buffer_load_dwordx2 v[210:211], v24, s[16:19], s44 offen offset:128 sc1
  s_waitcnt lgkmcnt(12)
  v_mfma_f32_16x16x32_bf16 v[48:51], v[104:107], v[152:155], v[48:51]
  ds_read_b64_tr_b16 v[100:101], v9 offset:0
  ds_read_b64_tr_b16 v[102:103], v9 offset:4096
  v_mfma_f32_16x16x32_bf16 v[52:55], v[104:107], v[156:159], v[52:55]
  s_waitcnt lgkmcnt(12)
  v_mfma_f32_16x16x32_bf16 v[56:59], v[108:111], v[152:155], v[56:59]
  ds_read_b64_tr_b16 v[104:105], v10 offset:0
  ds_read_b64_tr_b16 v[106:107], v10 offset:4096
  v_mfma_f32_16x16x32_bf16 v[60:63], v[108:111], v[156:159], v[60:63]
  s_waitcnt lgkmcnt(12)
  v_mfma_f32_16x16x32_bf16 v[64:67], v[112:115], v[152:155], v[64:67]
  ds_read_b64_tr_b16 v[108:109], v11 offset:0
  ds_read_b64_tr_b16 v[110:111], v11 offset:4096
  v_mfma_f32_16x16x32_bf16 v[68:71], v[112:115], v[156:159], v[68:71]
  s_waitcnt lgkmcnt(12)
  v_mfma_f32_16x16x32_bf16 v[72:75], v[116:119], v[152:155], v[72:75]
  ds_read_b64_tr_b16 v[112:113], v12 offset:0
  ds_read_b64_tr_b16 v[114:115], v12 offset:4096
  v_mfma_f32_16x16x32_bf16 v[76:79], v[116:119], v[156:159], v[76:79]
  s_waitcnt lgkmcnt(12)
  v_mfma_f32_16x16x32_bf16 v[80:83], v[120:123], v[152:155], v[80:83]
  ds_read_b64_tr_b16 v[116:117], v13 offset:0
  ds_read_b64_tr_b16 v[118:119], v13 offset:4096
  v_mfma_f32_16x16x32_bf16 v[84:87], v[120:123], v[156:159], v[84:87]
  s_waitcnt lgkmcnt(12)
  v_mfma_f32_16x16x32_bf16 v[88:91], v[124:127], v[152:155], v[88:91]
  ds_read_b64_tr_b16 v[120:121], v14 offset:0
  ds_read_b64_tr_b16 v[122:123], v14 offset:4096
  v_mfma_f32_16x16x32_bf16 v[92:95], v[124:127], v[156:159], v[92:95]
  s_waitcnt lgkmcnt(12)
  s_waitcnt vmcnt(16)
  v_mfma_f32_16x16x32_bf16 v[32:35], v[96:99], v[160:163], v[32:35]
  ds_read_b64_tr_b16 v[124:125], v15 offset:0
  ds_read_b64_tr_b16 v[126:127], v15 offset:4096
  v_mfma_f32_16x16x32_bf16 v[36:39], v[96:99], v[164:167], v[36:39]
  s_waitcnt lgkmcnt(12)
  v_mfma_f32_16x16x32_bf16 v[40:43], v[100:103], v[160:163], v[40:43]
  ds_read_b64_tr_b16 v[96:97], v8 offset:8192
  ds_read_b64_tr_b16 v[98:99], v8 offset:12288
  v_mfma_f32_16x16x32_bf16 v[44:47], v[100:103], v[164:167], v[44:47]
  s_waitcnt lgkmcnt(12)
  v_mfma_f32_16x16x32_bf16 v[48:51], v[104:107], v[160:163], v[48:51]
  ds_read_b64_tr_b16 v[100:101], v9 offset:8192
  ds_read_b64_tr_b16 v[102:103], v9 offset:12288
  v_mfma_f32_16x16x32_bf16 v[52:55], v[104:107], v[164:167], v[52:55]
  s_waitcnt lgkmcnt(12)
  v_mfma_f32_16x16x32_bf16 v[56:59], v[108:111], v[160:163], v[56:59]
  ds_read_b64_tr_b16 v[104:105], v10 offset:8192
  ds_read_b64_tr_b16 v[106:107], v10 offset:12288
  v_mfma_f32_16x16x32_bf16 v[60:63], v[108:111], v[164:167], v[60:63]
  s_waitcnt lgkmcnt(12)
  v_mfma_f32_16x16x32_bf16 v[64:67], v[112:115], v[160:163], v[64:67]
  ds_read_b64_tr_b16 v[108:109], v11 offset:8192
  ds_read_b64_tr_b16 v[110:111], v11 offset:12288
  v_mfma_f32_16x16x32_bf16 v[68:71], v[112:115], v[164:167], v[68:71]
  s_waitcnt lgkmcnt(12)
  v_mfma_f32_16x16x32_bf16 v[72:75], v[116:119], v[160:163], v[72:75]
  ds_read_b64_tr_b16 v[112:113], v12 offset:8192
  ds_read_b64_tr_b16 v[114:115], v12 offset:12288
  v_mfma_f32_16x16x32_bf16 v[76:79], v[116:119], v[164:167], v[76:79]
  s_waitcnt lgkmcnt(12)
  v_mfma_f32_16x16x32_bf16 v[80:83], v[120:123], v[160:163], v[80:83]
  ds_read_b64_tr_b16 v[116:117], v13 offset:8192
  ds_read_b64_tr_b16 v[118:119], v13 offset:12288
  v_mfma_f32_16x16x32_bf16 v[84:87], v[120:123], v[164:167], v[84:87]
  s_waitcnt lgkmcnt(12)
  v_mfma_f32_16x16x32_bf16 v[88:91], v[124:127], v[160:163], v[88:91]
  ds_read_b64_tr_b16 v[120:121], v14 offset:8192
  ds_read_b64_tr_b16 v[122:123], v14 offset:12288
  v_mfma_f32_16x16x32_bf16 v[92:95], v[124:127], v[164:167], v[92:95]
  s_waitcnt lgkmcnt(12)
  s_waitcnt vmcnt(14)
  v_mfma_f32_16x16x32_bf16 v[32:35], v[96:99], v[168:171], v[32:35]
  ds_read_b64_tr_b16 v[124:125], v15 offset:8192
  ds_read_b64_tr_b16 v[126:127], v15 offset:12288
  v_mfma_f32_16x16x32_bf16 v[36:39], v[96:99], v[172:175], v[36:39]
  s_waitcnt lgkmcnt(12)
  v_mfma_f32_16x16x32_bf16 v[40:43], v[100:103], v[168:171], v[40:43]
  s_barrier
  ds_read_b64_tr_b16 v[96:97], v8 offset:16384
  ds_read_b64_tr_b16 v[98:99], v8 offset:20480
  v_mfma_f32_16x16x32_bf16 v[44:47], v[100:103], v[172:175], v[44:47]
  s_waitcnt lgkmcnt(12)
  v_mfma_f32_16x16x32_bf16 v[48:51], v[104:107], v[168:171], v[48:51]
  ds_read_b64_tr_b16 v[100:101], v9 offset:16384
  ds_read_b64_tr_b16 v[102:103], v9 offset:20480
  v_mfma_f32_16x16x32_bf16 v[52:55], v[104:107], v[172:175], v[52:55]
  s_waitcnt lgkmcnt(12)
  v_mfma_f32_16x16x32_bf16 v[56:59], v[108:111], v[168:171], v[56:59]
  ds_read_b64_tr_b16 v[104:105], v10 offset:16384
  ds_read_b64_tr_b16 v[106:107], v10 offset:20480
  v_mfma_f32_16x16x32_bf16 v[60:63], v[108:111], v[172:175], v[60:63]
  s_waitcnt lgkmcnt(12)
  v_mfma_f32_16x16x32_bf16 v[64:67], v[112:115], v[168:171], v[64:67]
  ds_read_b64_tr_b16 v[108:109], v11 offset:16384
  ds_read_b64_tr_b16 v[110:111], v11 offset:20480
  v_mfma_f32_16x16x32_bf16 v[68:71], v[112:115], v[172:175], v[68:71]
  s_waitcnt lgkmcnt(12)
  v_mfma_f32_16x16x32_bf16 v[72:75], v[116:119], v[168:171], v[72:75]
  ds_read_b64_tr_b16 v[112:113], v12 offset:16384
  ds_read_b64_tr_b16 v[114:115], v12 offset:20480
  v_mfma_f32_16x16x32_bf16 v[76:79], v[116:119], v[172:175], v[76:79]
  s_waitcnt lgkmcnt(12)
  v_mfma_f32_16x16x32_bf16 v[80:83], v[120:123], v[168:171], v[80:83]
  ds_read_b64_tr_b16 v[116:117], v13 offset:16384
  ds_read_b64_tr_b16 v[118:119], v13 offset:20480
  v_mfma_f32_16x16x32_bf16 v[84:87], v[120:123], v[172:175], v[84:87]
  s_waitcnt lgkmcnt(12)
  v_mfma_f32_16x16x32_bf16 v[88:91], v[124:127], v[168:171], v[88:91]
  ds_read_b64_tr_b16 v[120:121], v14 offset:16384
  ds_read_b64_tr_b16 v[122:123], v14 offset:20480
  v_mfma_f32_16x16x32_bf16 v[92:95], v[124:127], v[172:175], v[92:95]
  s_waitcnt lgkmcnt(12)
  s_waitcnt vmcnt(12)
  v_mfma_f32_16x16x32_bf16 v[32:35], v[96:99], v[176:179], v[32:35]
  ds_read_b64_tr_b16 v[124:125], v15 offset:16384
  ds_read_b64_tr_b16 v[126:127], v15 offset:20480
  v_mfma_f32_16x16x32_bf16 v[36:39], v[96:99], v[180:183], v[36:39]
  s_waitcnt lgkmcnt(12)
  v_mfma_f32_16x16x32_bf16 v[40:43], v[100:103], v[176:179], v[40:43]
  ds_read_b64_tr_b16 v[96:97], v8 offset:24576
  ds_read_b64_tr_b16 v[98:99], v8 offset:28672
  v_mfma_f32_16x16x32_bf16 v[44:47], v[100:103], v[180:183], v[44:47]
  s_waitcnt lgkmcnt(12)
  v_mfma_f32_16x16x32_bf16 v[48:51], v[104:107], v[176:179], v[48:51]
  ds_read_b64_tr_b16 v[100:101], v9 offset:24576
  ds_read_b64_tr_b16 v[102:103], v9 offset:28672
  v_mfma_f32_16x16x32_bf16 v[52:55], v[104:107], v[180:183], v[52:55]
  s_waitcnt lgkmcnt(12)
  v_mfma_f32_16x16x32_bf16 v[56:59], v[108:111], v[176:179], v[56:59]
  ds_read_b64_tr_b16 v[104:105], v10 offset:24576
  ds_read_b64_tr_b16 v[106:107], v10 offset:28672
  v_mfma_f32_16x16x32_bf16 v[60:63], v[108:111], v[180:183], v[60:63]
  s_waitcnt lgkmcnt(12)
  v_mfma_f32_16x16x32_bf16 v[64:67], v[112:115], v[176:179], v[64:67]
  ds_read_b64_tr_b16 v[108:109], v11 offset:24576
  ds_read_b64_tr_b16 v[110:111], v11 offset:28672
  v_mfma_f32_16x16x32_bf16 v[68:71], v[112:115], v[180:183], v[68:71]
  s_waitcnt lgkmcnt(12)
  v_mfma_f32_16x16x32_bf16 v[72:75], v[116:119], v[176:179], v[72:75]
  ds_read_b64_tr_b16 v[112:113], v12 offset:24576
  ds_read_b64_tr_b16 v[114:115], v12 offset:28672
  v_mfma_f32_16x16x32_bf16 v[76:79], v[116:119], v[180:183], v[76:79]
  s_waitcnt lgkmcnt(12)
  v_mfma_f32_16x16x32_bf16 v[80:83], v[120:123], v[176:179], v[80:83]
  ds_read_b64_tr_b16 v[116:117], v13 offset:24576
  ds_read_b64_tr_b16 v[118:119], v13 offset:28672
  v_mfma_f32_16x16x32_bf16 v[84:87], v[120:123], v[180:183], v[84:87]
  s_waitcnt lgkmcnt(12)
  v_mfma_f32_16x16x32_bf16 v[88:91], v[124:127], v[176:179], v[88:91]
  ds_read_b64_tr_b16 v[120:121], v14 offset:24576
  ds_read_b64_tr_b16 v[122:123], v14 offset:28672
  v_mfma_f32_16x16x32_bf16 v[92:95], v[124:127], v[180:183], v[92:95]
  s_waitcnt lgkmcnt(12)
  s_waitcnt vmcnt(10)
  v_mfma_f32_16x16x32_bf16 v[32:35], v[96:99], v[184:187], v[32:35]
  ds_read_b64_tr_b16 v[124:125], v15 offset:24576
  ds_read_b64_tr_b16 v[126:127], v15 offset:28672
  v_mfma_f32_16x16x32_bf16 v[36:39], v[96:99], v[188:191], v[36:39]
  s_waitcnt lgkmcnt(12)
  v_mfma_f32_16x16x32_bf16 v[40:43], v[100:103], v[184:187], v[40:43]
  s_barrier
  ds_read_b64_tr_b16 v[96:97], v8 offset:32768
  ds_read_b64_tr_b16 v[98:99], v8 offset:36864
  v_mfma_f32_16x16x32_bf16 v[44:47], v[100:103], v[188:191], v[44:47]
  s_waitcnt lgkmcnt(12)
  v_mfma_f32_16x16x32_bf16 v[48:51], v[104:107], v[184:187], v[48:51]
  ds_read_b64_tr_b16 v[100:101], v9 offset:32768
  ds_read_b64_tr_b16 v[102:103], v9 offset:36864
  v_mfma_f32_16x16x32_bf16 v[52:55], v[104:107], v[188:191], v[52:55]
  s_waitcnt lgkmcnt(12)
  v_mfma_f32_16x16x32_bf16 v[56:59], v[108:111], v[184:187], v[56:59]
  ds_read_b64_tr_b16 v[104:105], v10 offset:32768
  ds_read_b64_tr_b16 v[106:107], v10 offset:36864
  v_mfma_f32_16x16x32_bf16 v[60:63], v[108:111], v[188:191], v[60:63]
  s_waitcnt lgkmcnt(12)
  v_mfma_f32_16x16x32_bf16 v[64:67], v[112:115], v[184:187], v[64:67]
  ds_read_b64_tr_b16 v[108:109], v11 offset:32768
  ds_read_b64_tr_b16 v[110:111], v11 offset:36864
  v_mfma_f32_16x16x32_bf16 v[68:71], v[112:115], v[188:191], v[68:71]
  s_waitcnt lgkmcnt(12)
  v_mfma_f32_16x16x32_bf16 v[72:75], v[116:119], v[184:187], v[72:75]
  ds_read_b64_tr_b16 v[112:113], v12 offset:32768
  ds_read_b64_tr_b16 v[114:115], v12 offset:36864
  v_mfma_f32_16x16x32_bf16 v[76:79], v[116:119], v[188:191], v[76:79]
  s_waitcnt lgkmcnt(12)
  v_mfma_f32_16x16x32_bf16 v[80:83], v[120:123], v[184:187], v[80:83]
  ds_read_b64_tr_b16 v[116:117], v13 offset:32768
  ds_read_b64_tr_b16 v[118:119], v13 offset:36864
  v_mfma_f32_16x16x32_bf16 v[84:87], v[120:123], v[188:191], v[84:87]
  s_waitcnt lgkmcnt(12)
  v_mfma_f32_16x16x32_bf16 v[88:91], v[124:127], v[184:187], v[88:91]
  ds_read_b64_tr_b16 v[120:121], v14 offset:32768
  ds_read_b64_tr_b16 v[122:123], v14 offset:36864
  v_mfma_f32_16x16x32_bf16 v[92:95], v[124:127], v[188:191], v[92:95]
  s_waitcnt lgkmcnt(12)
  s_waitcnt vmcnt(8)
  v_mfma_f32_16x16x32_bf16 v[32:35], v[96:99], v[192:195], v[32:35]
  ds_read_b64_tr_b16 v[124:125], v15 offset:32768
  ds_read_b64_tr_b16 v[126:127], v15 offset:36864
  v_mfma_f32_16x16x32_bf16 v[36:39], v[96:99], v[196:199], v[36:39]
  s_waitcnt lgkmcnt(12)
  v_mfma_f32_16x16x32_bf16 v[40:43], v[100:103], v[192:195], v[40:43]
  ds_read_b64_tr_b16 v[96:97], v8 offset:40960
  ds_read_b64_tr_b16 v[98:99], v8 offset:45056
  v_mfma_f32_16x16x32_bf16 v[44:47], v[100:103], v[196:199], v[44:47]
  s_waitcnt lgkmcnt(12)
  v_mfma_f32_16x16x32_bf16 v[48:51], v[104:107], v[192:195], v[48:51]
  ds_read_b64_tr_b16 v[100:101], v9 offset:40960
  ds_read_b64_tr_b16 v[102:103], v9 offset:45056
  v_mfma_f32_16x16x32_bf16 v[52:55], v[104:107], v[196:199], v[52:55]
  s_waitcnt lgkmcnt(12)
  v_mfma_f32_16x16x32_bf16 v[56:59], v[108:111], v[192:195], v[56:59]
  ds_read_b64_tr_b16 v[104:105], v10 offset:40960
  ds_read_b64_tr_b16 v[106:107], v10 offset:45056
  v_mfma_f32_16x16x32_bf16 v[60:63], v[108:111], v[196:199], v[60:63]
  s_waitcnt lgkmcnt(12)
  v_mfma_f32_16x16x32_bf16 v[64:67], v[112:115], v[192:195], v[64:67]
  ds_read_b64_tr_b16 v[108:109], v11 offset:40960
  ds_read_b64_tr_b16 v[110:111], v11 offset:45056
  v_mfma_f32_16x16x32_bf16 v[68:71], v[112:115], v[196:199], v[68:71]
  s_waitcnt lgkmcnt(12)
  v_mfma_f32_16x16x32_bf16 v[72:75], v[116:119], v[192:195], v[72:75]
  ds_read_b64_tr_b16 v[112:113], v12 offset:40960
  ds_read_b64_tr_b16 v[114:115], v12 offset:45056
  v_mfma_f32_16x16x32_bf16 v[76:79], v[116:119], v[196:199], v[76:79]
  s_waitcnt lgkmcnt(12)
  v_mfma_f32_16x16x32_bf16 v[80:83], v[120:123], v[192:195], v[80:83]
  ds_read_b64_tr_b16 v[116:117], v13 offset:40960
  ds_read_b64_tr_b16 v[118:119], v13 offset:45056
  v_mfma_f32_16x16x32_bf16 v[84:87], v[120:123], v[196:199], v[84:87]
  s_waitcnt lgkmcnt(12)
  v_mfma_f32_16x16x32_bf16 v[88:91], v[124:127], v[192:195], v[88:91]
  ds_read_b64_tr_b16 v[120:121], v14 offset:40960
  ds_read_b64_tr_b16 v[122:123], v14 offset:45056
  v_mfma_f32_16x16x32_bf16 v[92:95], v[124:127], v[196:199], v[92:95]
  s_waitcnt lgkmcnt(12)
  s_waitcnt vmcnt(6)
  v_mfma_f32_16x16x32_bf16 v[32:35], v[96:99], v[200:203], v[32:35]
  ds_read_b64_tr_b16 v[124:125], v15 offset:40960
  ds_read_b64_tr_b16 v[126:127], v15 offset:45056
  v_mfma_f32_16x16x32_bf16 v[36:39], v[96:99], v[204:207], v[36:39]
  s_waitcnt lgkmcnt(12)
  v_mfma_f32_16x16x32_bf16 v[40:43], v[100:103], v[200:203], v[40:43]
  s_barrier
  ds_read_b64_tr_b16 v[96:97], v8 offset:49152
  ds_read_b64_tr_b16 v[98:99], v8 offset:53248
  v_mfma_f32_16x16x32_bf16 v[44:47], v[100:103], v[204:207], v[44:47]
  s_waitcnt lgkmcnt(12)
  v_mfma_f32_16x16x32_bf16 v[48:51], v[104:107], v[200:203], v[48:51]
  ds_read_b64_tr_b16 v[100:101], v9 offset:49152
  ds_read_b64_tr_b16 v[102:103], v9 offset:53248
  v_mfma_f32_16x16x32_bf16 v[52:55], v[104:107], v[204:207], v[52:55]
  s_waitcnt lgkmcnt(12)
  v_mfma_f32_16x16x32_bf16 v[56:59], v[108:111], v[200:203], v[56:59]
  ds_read_b64_tr_b16 v[104:105], v10 offset:49152
  ds_read_b64_tr_b16 v[106:107], v10 offset:53248
  v_mfma_f32_16x16x32_bf16 v[60:63], v[108:111], v[204:207], v[60:63]
  s_waitcnt lgkmcnt(12)
  v_mfma_f32_16x16x32_bf16 v[64:67], v[112:115], v[200:203], v[64:67]
  ds_read_b64_tr_b16 v[108:109], v11 offset:49152
  ds_read_b64_tr_b16 v[110:111], v11 offset:53248
  v_mfma_f32_16x16x32_bf16 v[68:71], v[112:115], v[204:207], v[68:71]
  s_waitcnt lgkmcnt(12)
  v_mfma_f32_16x16x32_bf16 v[72:75], v[116:119], v[200:203], v[72:75]
  ds_read_b64_tr_b16 v[112:113], v12 offset:49152
  ds_read_b64_tr_b16 v[114:115], v12 offset:53248
  v_mfma_f32_16x16x32_bf16 v[76:79], v[116:119], v[204:207], v[76:79]
  s_waitcnt lgkmcnt(12)
  v_mfma_f32_16x16x32_bf16 v[80:83], v[120:123], v[200:203], v[80:83]
  ds_read_b64_tr_b16 v[116:117], v13 offset:49152
  ds_read_b64_tr_b16 v[118:119], v13 offset:53248
  v_mfma_f32_16x16x32_bf16 v[84:87], v[120:123], v[204:207], v[84:87]
  s_waitcnt lgkmcnt(12)
  v_mfma_f32_16x16x32_bf16 v[88:91], v[124:127], v[200:203], v[88:91]
  ds_read_b64_tr_b16 v[120:121], v14 offset:49152
  ds_read_b64_tr_b16 v[122:123], v14 offset:53248
  v_mfma_f32_16x16x32_bf16 v[92:95], v[124:127], v[204:207], v[92:95]
  s_waitcnt lgkmcnt(12)
  s_waitcnt vmcnt(4)
  v_mfma_f32_16x16x32_bf16 v[32:35], v[96:99], v[128:131], v[32:35]
  ds_read_b64_tr_b16 v[124:125], v15 offset:49152
  ds_read_b64_tr_b16 v[126:127], v15 offset:53248
  v_mfma_f32_16x16x32_bf16 v[36:39], v[96:99], v[132:135], v[36:39]
  s_waitcnt lgkmcnt(12)
  v_mfma_f32_16x16x32_bf16 v[40:43], v[100:103], v[128:131], v[40:43]
  ds_read_b64_tr_b16 v[96:97], v8 offset:57344
  ds_read_b64_tr_b16 v[98:99], v8 offset:61440
  v_mfma_f32_16x16x32_bf16 v[44:47], v[100:103], v[132:135], v[44:47]
  s_waitcnt lgkmcnt(12)
  v_mfma_f32_16x16x32_bf16 v[48:51], v[104:107], v[128:131], v[48:51]
  ds_read_b64_tr_b16 v[100:101], v9 offset:57344
  ds_read_b64_tr_b16 v[102:103], v9 offset:61440
  v_mfma_f32_16x16x32_bf16 v[52:55], v[104:107], v[132:135], v[52:55]
  s_waitcnt lgkmcnt(12)
  v_mfma_f32_16x16x32_bf16 v[56:59], v[108:111], v[128:131], v[56:59]
  ds_read_b64_tr_b16 v[104:105], v10 offset:57344
  ds_read_b64_tr_b16 v[106:107], v10 offset:61440
  v_mfma_f32_16x16x32_bf16 v[60:63], v[108:111], v[132:135], v[60:63]
  s_waitcnt lgkmcnt(12)
  v_mfma_f32_16x16x32_bf16 v[64:67], v[112:115], v[128:131], v[64:67]
  ds_read_b64_tr_b16 v[108:109], v11 offset:57344
  ds_read_b64_tr_b16 v[110:111], v11 offset:61440
  v_mfma_f32_16x16x32_bf16 v[68:71], v[112:115], v[132:135], v[68:71]
  s_waitcnt lgkmcnt(12)
  v_mfma_f32_16x16x32_bf16 v[72:75], v[116:119], v[128:131], v[72:75]
  ds_read_b64_tr_b16 v[112:113], v12 offset:57344
  ds_read_b64_tr_b16 v[114:115], v12 offset:61440
  v_mfma_f32_16x16x32_bf16 v[76:79], v[116:119], v[132:135], v[76:79]
  s_waitcnt lgkmcnt(12)
  v_mfma_f32_16x16x32_bf16 v[80:83], v[120:123], v[128:131], v[80:83]
  ds_read_b64_tr_b16 v[116:117], v13 offset:57344
  ds_read_b64_tr_b16 v[118:119], v13 offset:61440
  v_mfma_f32_16x16x32_bf16 v[84:87], v[120:123], v[132:135], v[84:87]
  s_waitcnt lgkmcnt(12)
  v_mfma_f32_16x16x32_bf16 v[88:91], v[124:127], v[128:131], v[88:91]
  ds_read_b64_tr_b16 v[120:121], v14 offset:57344
  ds_read_b64_tr_b16 v[122:123], v14 offset:61440
  v_mfma_f32_16x16x32_bf16 v[92:95], v[124:127], v[132:135], v[92:95]
  s_waitcnt lgkmcnt(12)
  s_waitcnt vmcnt(2)
  v_mfma_f32_16x16x32_bf16 v[32:35], v[96:99], v[136:139], v[32:35]
  ds_read_b64_tr_b16 v[124:125], v15 offset:57344
  ds_read_b64_tr_b16 v[126:127], v15 offset:61440
  v_mfma_f32_16x16x32_bf16 v[36:39], v[96:99], v[140:143], v[36:39]
  s_waitcnt lgkmcnt(12)
  v_mfma_f32_16x16x32_bf16 v[40:43], v[100:103], v[136:139], v[40:43]
  v_mfma_f32_16x16x32_bf16 v[44:47], v[100:103], v[140:143], v[44:47]
  s_waitcnt lgkmcnt(10)
  v_mfma_f32_16x16x32_bf16 v[48:51], v[104:107], v[136:139], v[48:51]
  v_mfma_f32_16x16x32_bf16 v[52:55], v[104:107], v[140:143], v[52:55]
  s_waitcnt lgkmcnt(8)
  v_mfma_f32_16x16x32_bf16 v[56:59], v[108:111], v[136:139], v[56:59]
  v_mfma_f32_16x16x32_bf16 v[60:63], v[108:111], v[140:143], v[60:63]
  s_waitcnt lgkmcnt(6)
  v_mfma_f32_16x16x32_bf16 v[64:67], v[112:115], v[136:139], v[64:67]
  v_mfma_f32_16x16x32_bf16 v[68:71], v[112:115], v[140:143], v[68:71]
  s_waitcnt lgkmcnt(4)
  v_mfma_f32_16x16x32_bf16 v[72:75], v[116:119], v[136:139], v[72:75]
  v_mfma_f32_16x16x32_bf16 v[76:79], v[116:119], v[140:143], v[76:79]
  s_waitcnt lgkmcnt(2)
  v_mfma_f32_16x16x32_bf16 v[80:83], v[120:123], v[136:139], v[80:83]
  v_mfma_f32_16x16x32_bf16 v[84:87], v[120:123], v[140:143], v[84:87]
  s_waitcnt lgkmcnt(0)
  v_mfma_f32_16x16x32_bf16 v[88:91], v[124:127], v[136:139], v[88:91]
  v_mfma_f32_16x16x32_bf16 v[92:95], v[124:127], v[140:143], v[92:95]
g1_cwend:
g2_epi:
  v_and_b32 v28, 15, v3
  v_lshlrev_b32 v29, 7, v28
  v_bfe_u32 v30, v3, 4, 1
  v_lshl_add_u32 v29, v30, 3, v29
  v_add_u32 v29, s26, v29
  v_lshrrev_b32 v28, 1, v28
  v_lshrrev_b32 v30, 5, v3
  v_xor_b32 v28, v28, v30
  v_xor_b32 v30, 0, v28
  v_lshl_add_u32 v8, v30, 4, v29
  v_xor_b32 v30, 2, v28
  v_lshl_add_u32 v9, v30, 4, v29
  v_xor_b32 v30, 4, v28
  v_lshl_add_u32 v10, v30, 4, v29
  v_xor_b32 v30, 6, v28
  v_lshl_add_u32 v11, v30, 4, v29
  ds_read_b64 v[96:97], v8 offset:0
  ds_read_b64 v[98:99], v8 offset:2048
  ds_read_b64 v[100:101], v9 offset:0
  ds_read_b64 v[102:103], v9 offset:2048
  ds_read_b64 v[104:105], v10 offset:0
  ds_read_b64 v[106:107], v10 offset:2048
  ds_read_b64 v[108:109], v11 offset:0
  ds_read_b64 v[110:111], v11 offset:2048
  ds_read_b64 v[112:113], v8 offset:4096
  ds_read_b64 v[114:115], v8 offset:6144
  ds_read_b64 v[116:117], v9 offset:4096
  ds_read_b64 v[118:119], v9 offset:6144
  ds_read_b64 v[120:121], v10 offset:4096
  ds_read_b64 v[122:123], v10 offset:6144
  ds_read_b64 v[124:125], v11 offset:4096
  ds_read_b64 v[126:127], v11 offset:6144
  s_waitcnt vmcnt(0)
  v_mul_f32 v208, v208, v209
  v_sub_f32 v208, 0, v208
  v_mul_f32 v210, v210, v211
  v_sub_f32 v210, 0, v210
  v_mov_b32 v16, 0x3f803f80
  v_mov_b32 v26, 0
  v_mov_b32 v27, 0
  v_mov_b32 v28, 0
  v_mov_b32 v29, 0
  s_waitcnt lgkmcnt(14)
  v_lshlrev_b32 v128, 16, v96
  v_and_b32 v129, 0xffff0000, v96
  v_lshlrev_b32 v130, 16, v97
  v_and_b32 v131, 0xffff0000, v97
  v_lshlrev_b32 v132, 16, v98
  v_and_b32 v133, 0xffff0000, v98
  v_lshlrev_b32 v134, 16, v99
  v_and_b32 v135, 0xffff0000, v99
  v_pk_fma_f32 v[128:129], v[128:129], v[208:209], v[208:209] op_sel:[0,1,0] op_sel_hi:[1,1,0]
  v_pk_fma_f32 v[130:131], v[130:131], v[208:209], v[208:209] op_sel:[0,1,0] op_sel_hi:[1,1,0]
  v_pk_fma_f32 v[132:133], v[132:133], v[210:211], v[210:211] op_sel:[0,1,0] op_sel_hi:[1,1,0]
  v_pk_fma_f32 v[134:135], v[134:135], v[210:211], v[210:211] op_sel:[0,1,0] op_sel_hi:[1,1,0]
  v_pk_add_f32 v[32:33], v[32:33], v[128:129]
  v_pk_add_f32 v[34:35], v[34:35], v[130:131]
  v_pk_add_f32 v[36:37], v[36:37], v[132:133]
  v_pk_add_f32 v[38:39], v[38:39], v[134:135]
  v_cvt_pk_bf16_f32 v144, v32, v33
  v_cvt_pk_bf16_f32 v145, v34, v35
  v_cvt_pk_bf16_f32 v160, v36, v37
  v_cvt_pk_bf16_f32 v161, v38, v39
  s_waitcnt lgkmcnt(12)
  v_lshlrev_b32 v136, 16, v100
  v_and_b32 v137, 0xffff0000, v100
  v_lshlrev_b32 v138, 16, v101
  v_and_b32 v139, 0xffff0000, v101
  v_lshlrev_b32 v140, 16, v102
  v_and_b32 v141, 0xffff0000, v102
  v_lshlrev_b32 v142, 16, v103
  v_and_b32 v143, 0xffff0000, v103
  v_pk_fma_f32 v[136:137], v[136:137], v[208:209], v[208:209] op_sel:[0,1,0] op_sel_hi:[1,1,0]
  v_pk_fma_f32 v[138:139], v[138:139], v[208:209], v[208:209] op_sel:[0,1,0] op_sel_hi:[1,1,0]
  v_pk_fma_f32 v[140:141], v[140:141], v[210:211], v[210:211] op_sel:[0,1,0] op_sel_hi:[1,1,0]
  v_pk_fma_f32 v[142:143], v[142:143], v[210:211], v[210:211] op_sel:[0,1,0] op_sel_hi:[1,1,0]
  v_pk_add_f32 v[40:41], v[40:41], v[136:137]
  v_pk_add_f32 v[42:43], v[42:43], v[138:139]
  v_pk_add_f32 v[44:45], v[44:45], v[140:141]
  v_pk_add_f32 v[46:47], v[46:47], v[142:143]
  v_cvt_pk_bf16_f32 v146, v40, v41
  v_cvt_pk_bf16_f32 v147, v42, v43
  v_cvt_pk_bf16_f32 v162, v44, v45
  v_cvt_pk_bf16_f32 v163, v46, v47
  buffer_store_dwordx4 v[144:147], v6, s[12:15], 0 offen offset:0 sc1
  buffer_store_dwordx4 v[160:163], v7, s[12:15], 0 offen offset:0 sc1
  s_waitcnt lgkmcnt(10)
  v_lshlrev_b32 v128, 16, v104
  v_and_b32 v129, 0xffff0000, v104
  v_lshlrev_b32 v130, 16, v105
  v_and_b32 v131, 0xffff0000, v105
  v_lshlrev_b32 v132, 16, v106
  v_and_b32 v133, 0xffff0000, v106
  v_lshlrev_b32 v134, 16, v107
  v_and_b32 v135, 0xffff0000, v107
  v_pk_fma_f32 v[128:129], v[128:129], v[208:209], v[208:209] op_sel:[0,1,0] op_sel_hi:[1,1,0]
  v_pk_fma_f32 v[130:131], v[130:131], v[208:209], v[208:209] op_sel:[0,1,0] op_sel_hi:[1,1,0]
  v_pk_fma_f32 v[132:133], v[132:133], v[210:211], v[210:211] op_sel:[0,1,0] op_sel_hi:[1,1,0]
  v_pk_fma_f32 v[134:135], v[134:135], v[210:211], v[210:211] op_sel:[0,1,0] op_sel_hi:[1,1,0]
  v_pk_add_f32 v[48:49], v[48:49], v[128:129]
  v_pk_add_f32 v[50:51], v[50:51], v[130:131]
  v_pk_add_f32 v[52:53], v[52:53], v[132:133]
  v_pk_add_f32 v[54:55], v[54:55], v[134:135]
  v_cvt_pk_bf16_f32 v148, v48, v49
  v_cvt_pk_bf16_f32 v149, v50, v51
  v_cvt_pk_bf16_f32 v164, v52, v53
  v_cvt_pk_bf16_f32 v165, v54, v55
  s_waitcnt lgkmcnt(8)
  v_lshlrev_b32 v136, 16, v108
  v_and_b32 v137, 0xffff0000, v108
  v_lshlrev_b32 v138, 16, v109
  v_and_b32 v139, 0xffff0000, v109
  v_lshlrev_b32 v140, 16, v110
  v_and_b32 v141, 0xffff0000, v110
  v_lshlrev_b32 v142, 16, v111
  v_and_b32 v143, 0xffff0000, v111
  v_pk_fma_f32 v[136:137], v[136:137], v[208:209], v[208:209] op_sel:[0,1,0] op_sel_hi:[1,1,0]
  v_pk_fma_f32 v[138:139], v[138:139], v[208:209], v[208:209] op_sel:[0,1,0] op_sel_hi:[1,1,0]
  v_pk_fma_f32 v[140:141], v[140:141], v[210:211], v[210:211] op_sel:[0,1,0] op_sel_hi:[1,1,0]
  v_pk_fma_f32 v[142:143], v[142:143], v[210:211], v[210:211] op_sel:[0,1,0] op_sel_hi:[1,1,0]
  v_pk_add_f32 v[56:57], v[56:57], v[136:137]
  v_pk_add_f32 v[58:59], v[58:59], v[138:139]
  v_pk_add_f32 v[60:61], v[60:61], v[140:141]
  v_pk_add_f32 v[62:63], v[62:63], v[142:143]
  v_cvt_pk_bf16_f32 v150, v56, v57
  v_cvt_pk_bf16_f32 v151, v58, v59
  v_cvt_pk_bf16_f32 v166, v60, v61
  v_cvt_pk_bf16_f32 v167, v62, v63
  buffer_store_dwordx4 v[148:151], v6, s[12:15], 0 offen offset:1024 sc1
  buffer_store_dwordx4 v[164:167], v7, s[12:15], 0 offen offset:1024 sc1
  s_waitcnt lgkmcnt(6)
  v_lshlrev_b32 v128, 16, v112
  v_and_b32 v129, 0xffff0000, v112
  v_lshlrev_b32 v130, 16, v113
  v_and_b32 v131, 0xffff0000, v113
  v_lshlrev_b32 v132, 16, v114
  v_and_b32 v133, 0xffff0000, v114
  v_lshlrev_b32 v134, 16, v115
  v_and_b32 v135, 0xffff0000, v115
  v_pk_fma_f32 v[128:129], v[128:129], v[208:209], v[208:209] op_sel:[0,1,0] op_sel_hi:[1,1,0]
  v_pk_fma_f32 v[130:131], v[130:131], v[208:209], v[208:209] op_sel:[0,1,0] op_sel_hi:[1,1,0]
  v_pk_fma_f32 v[132:133], v[132:133], v[210:211], v[210:211] op_sel:[0,1,0] op_sel_hi:[1,1,0]
  v_pk_fma_f32 v[134:135], v[134:135], v[210:211], v[210:211] op_sel:[0,1,0] op_sel_hi:[1,1,0]
  v_pk_add_f32 v[64:65], v[64:65], v[128:129]
  v_pk_add_f32 v[66:67], v[66:67], v[130:131]
  v_pk_add_f32 v[68:69], v[68:69], v[132:133]
  v_pk_add_f32 v[70:71], v[70:71], v[134:135]
  v_cvt_pk_bf16_f32 v152, v64, v65
  v_cvt_pk_bf16_f32 v153, v66, v67
  v_cvt_pk_bf16_f32 v168, v68, v69
  v_cvt_pk_bf16_f32 v169, v70, v71
  s_waitcnt lgkmcnt(4)
  v_lshlrev_b32 v136, 16, v116
  v_and_b32 v137, 0xffff0000, v116
  v_lshlrev_b32 v138, 16, v117
  v_and_b32 v139, 0xffff0000, v117
  v_lshlrev_b32 v140, 16, v118
  v_and_b32 v141, 0xffff0000, v118
  v_lshlrev_b32 v142, 16, v119
  v_and_b32 v143, 0xffff0000, v119
  v_pk_fma_f32 v[136:137], v[136:137], v[208:209], v[208:209] op_sel:[0,1,0] op_sel_hi:[1,1,0]
  v_pk_fma_f32 v[138:139], v[138:139], v[208:209], v[208:209] op_sel:[0,1,0] op_sel_hi:[1,1,0]
  v_pk_fma_f32 v[140:141], v[140:141], v[210:211], v[210:211] op_sel:[0,1,0] op_sel_hi:[1,1,0]
  v_pk_fma_f32 v[142:143], v[142:143], v[210:211], v[210:211] op_sel:[0,1,0] op_sel_hi:[1,1,0]
  v_pk_add_f32 v[72:73], v[72:73], v[136:137]
  v_pk_add_f32 v[74:75], v[74:75], v[138:139]
  v_pk_add_f32 v[76:77], v[76:77], v[140:141]
  v_pk_add_f32 v[78:79], v[78:79], v[142:143]
  v_cvt_pk_bf16_f32 v154, v72, v73
  v_cvt_pk_bf16_f32 v155, v74, v75
  v_cvt_pk_bf16_f32 v170, v76, v77
  v_cvt_pk_bf16_f32 v171, v78, v79
  buffer_store_dwordx4 v[152:155], v6, s[12:15], 0 offen offset:2048 sc1
  buffer_store_dwordx4 v[168:171], v7, s[12:15], 0 offen offset:2048 sc1
  s_waitcnt lgkmcnt(2)
  v_lshlrev_b32 v128, 16, v120
  v_and_b32 v129, 0xffff0000, v120
  v_lshlrev_b32 v130, 16, v121
  v_and_b32 v131, 0xffff0000, v121
  v_lshlrev_b32 v132, 16, v122
  v_and_b32 v133, 0xffff0000, v122
  v_lshlrev_b32 v134, 16, v123
  v_and_b32 v135, 0xffff0000, v123
  v_pk_fma_f32 v[128:129], v[128:129], v[208:209], v[208:209] op_sel:[0,1,0] op_sel_hi:[1,1,0]
  v_pk_fma_f32 v[130:131], v[130:131], v[208:209], v[208:209] op_sel:[0,1,0] op_sel_hi:[1,1,0]
  v_pk_fma_f32 v[132:133], v[132:133], v[210:211], v[210:211] op_sel:[0,1,0] op_sel_hi:[1,1,0]
  v_pk_fma_f32 v[134:135], v[134:135], v[210:211], v[210:211] op_sel:[0,1,0] op_sel_hi:[1,1,0]
  v_pk_add_f32 v[80:81], v[80:81], v[128:129]
  v_pk_add_f32 v[82:83], v[82:83], v[130:131]
  v_pk_add_f32 v[84:85], v[84:85], v[132:133]
  v_pk_add_f32 v[86:87], v[86:87], v[134:135]
  v_cvt_pk_bf16_f32 v156, v80, v81
  v_cvt_pk_bf16_f32 v157, v82, v83
  v_cvt_pk_bf16_f32 v172, v84, v85
  v_cvt_pk_bf16_f32 v173, v86, v87
  s_waitcnt lgkmcnt(0)
  v_lshlrev_b32 v136, 16, v124
  v_and_b32 v137, 0xffff0000, v124
  v_lshlrev_b32 v138, 16, v125
  v_and_b32 v139, 0xffff0000, v125
  v_lshlrev_b32 v140, 16, v126
  v_and_b32 v141, 0xffff0000, v126
  v_lshlrev_b32 v142, 16, v127
  v_and_b32 v143, 0xffff0000, v127
  v_pk_fma_f32 v[136:137], v[136:137], v[208:209], v[208:209] op_sel:[0,1,0] op_sel_hi:[1,1,0]
  v_pk_fma_f32 v[138:139], v[138:139], v[208:209], v[208:209] op_sel:[0,1,0] op_sel_hi:[1,1,0]
  v_pk_fma_f32 v[140:141], v[140:141], v[210:211], v[210:211] op_sel:[0,1,0] op_sel_hi:[1,1,0]
  v_pk_fma_f32 v[142:143], v[142:143], v[210:211], v[210:211] op_sel:[0,1,0] op_sel_hi:[1,1,0]
  v_pk_add_f32 v[88:89], v[88:89], v[136:137]
  v_pk_add_f32 v[90:91], v[90:91], v[138:139]
  v_pk_add_f32 v[92:93], v[92:93], v[140:141]
  v_pk_add_f32 v[94:95], v[94:95], v[142:143]
  v_cvt_pk_bf16_f32 v158, v88, v89
  v_cvt_pk_bf16_f32 v159, v90, v91
  v_cvt_pk_bf16_f32 v174, v92, v93
  v_cvt_pk_bf16_f32 v175, v94, v95
  buffer_store_dwordx4 v[156:159], v6, s[12:15], 0 offen offset:3072 sc1
  buffer_store_dwordx4 v[172:175], v7, s[12:15], 0 offen offset:3072 sc1
  v_dot2_f32_bf16 v26, v144, v16, v26
  v_dot2_f32_bf16 v27, v144, v144, v27
  v_dot2_f32_bf16 v28, v160, v16, v28
  v_dot2_f32_bf16 v29, v160, v160, v29
  v_dot2_f32_bf16 v26, v145, v16, v26
  v_dot2_f32_bf16 v27, v145, v145, v27
  v_dot2_f32_bf16 v28, v161, v16, v28
  v_dot2_f32_bf16 v29, v161, v161, v29
  v_dot2_f32_bf16 v26, v146, v16, v26
  v_dot2_f32_bf16 v27, v146, v146, v27
  v_dot2_f32_bf16 v28, v162, v16, v28
  v_dot2_f32_bf16 v29, v162, v162, v29
  v_dot2_f32_bf16 v26, v147, v16, v26
  v_dot2_f32_bf16 v27, v147, v147, v27
  v_dot2_f32_bf16 v28, v163, v16, v28
  v_dot2_f32_bf16 v29, v163, v163, v29
  v_dot2_f32_bf16 v26, v148, v16, v26
  v_dot2_f32_bf16 v27, v148, v148, v27
  v_dot2_f32_bf16 v28, v164, v16, v28
  v_dot2_f32_bf16 v29, v164, v164, v29
  v_dot2_f32_bf16 v26, v149, v16, v26
  v_dot2_f32_bf16 v27, v149, v149, v27
  v_dot2_f32_bf16 v28, v165, v16, v28
  v_dot2_f32_bf16 v29, v165, v165, v29
  v_dot2_f32_bf16 v26, v150, v16, v26
  v_dot2_f32_bf16 v27, v150, v150, v27
  v_dot2_f32_bf16 v28, v166, v16, v28
  v_dot2_f32_bf16 v29, v166, v166, v29
  v_dot2_f32_bf16 v26, v151, v16, v26
  v_dot2_f32_bf16 v27, v151, v151, v27
  v_dot2_f32_bf16 v28, v167, v16, v28
  v_dot2_f32_bf16 v29, v167, v167, v29
  v_dot2_f32_bf16 v26, v152, v16, v26
  v_dot2_f32_bf16 v27, v152, v152, v27
  v_dot2_f32_bf16 v28, v168, v16, v28
  v_dot2_f32_bf16 v29, v168, v168, v29
  v_dot2_f32_bf16 v26, v153, v16, v26
  v_dot2_f32_bf16 v27, v153, v153, v27
  v_dot2_f32_bf16 v28, v169, v16, v28
  v_dot2_f32_bf16 v29, v169, v169, v29
  v_dot2_f32_bf16 v26, v154, v16, v26
  v_dot2_f32_bf16 v27, v154, v154, v27
  v_dot2_f32_bf16 v28, v170, v16, v28
  v_dot2_f32_bf16 v29, v170, v170, v29
  v_dot2_f32_bf16 v26, v155, v16, v26
  v_dot2_f32_bf16 v27, v155, v155, v27
  v_dot2_f32_bf16 v28, v171, v16, v28
  v_dot2_f32_bf16 v29, v171, v171, v29
  v_dot2_f32_bf16 v26, v156, v16, v26
  v_dot2_f32_bf16 v27, v156, v156, v27
  v_dot2_f32_bf16 v28, v172, v16, v28
  v_dot2_f32_bf16 v29, v172, v172, v29
  v_dot2_f32_bf16 v26, v157, v16, v26
  v_dot2_f32_bf16 v27, v157, v157, v27
  v_dot2_f32_bf16 v28, v173, v16, v28
  v_dot2_f32_bf16 v29, v173, v173, v29
  v_dot2_f32_bf16 v26, v158, v16, v26
  v_dot2_f32_bf16 v27, v158, v158, v27
  v_dot2_f32_bf16 v28, v174, v16, v28
  v_dot2_f32_bf16 v29, v174, v174, v29
  v_dot2_f32_bf16 v26, v159, v16, v26
  v_dot2_f32_bf16 v27, v159, v159, v27
  v_dot2_f32_bf16 v28, v175, v16, v28
  v_dot2_f32_bf16 v29, v175, v175, v29
  s_nop 3
  v_permlane16_swap_b32 v26, v27
  v_permlane16_swap_b32 v28, v29
  s_nop 1
  v_add_f32 v26, v26, v27
  v_add_f32 v28, v28, v29
  s_nop 1
  v_permlane32_swap_b32 v26, v28
  s_nop 1
  v_add_f32 v26, v26, v28
  v_lshlrev_b32 v16, 2, v3
  s_lshl_b32 s44, s23, 10
  s_lshl_b32 s45, s22, 8
  s_add_u32 s44, s44, s45
  buffer_store_dword v26, v16, s[16:19], s44 offen sc1
  s_lshr_b32 s24, s23, 1
  s_lshl_b32 s24, s24, 7
  s_add_u32 s24, s24, 794624
  s_waitcnt vmcnt(0)
  v_lshlrev_b32 v30, 22, v3
  v_mov_b32 v31, 1
  buffer_atomic_add v31, v30, s[16:19], s24 offen sc1
  s_barrier
g3_c:
  s_load_dwordx4 s[28:31], s[0:1], 72
  s_load_dwordx2 s[42:43], s[0:1], 104
  s_and_b32 s24, s2, 7
  s_lshr_b32 s25, s2, 3
  s_and_b32 s25, s25, 31
  s_lshr_b32 s21, s24, 2
  s_lshl_b32 s21, s21, 3
  s_lshr_b32 s22, s25, 2
  s_add_u32 s21, s21, s22
  s_and_b32 s22, s24, 3
  s_lshl_b32 s22, s22, 2
  s_and_b32 s25, s25, 3
  s_add_u32 s22, s22, s25
  v_lshrrev_b32 v2, 6, v0
  v_and_b32 v3, 63, v0
  v_readfirstlane_b32 s100, v2
  s_nop 0
  s_and_b32 s20, s100, 3
  s_lshr_b32 s3, s100, 2
  s_lshl_b32 s23, s21, 3
  s_lshl_b32 s24, s20, 1
  s_add_u32 s23, s23, s24
  s_lshl_b32 s24, s23, 15
  v_lshl_add_u32 v1, v3, 4, s24
  v_add_u32 v14, 32768, v1
  s_lshl_b32 s24, s23, 10
  v_lshl_add_u32 v2, v3, 2, s24
  s_mov_b32 s46, 0
  s_waitcnt lgkmcnt(0)
  s_add_u32 s4, s42, 4194304
  s_addc_u32 s5, s43, 0
  s_mov_b32 s6, 4194304
  s_mov_b32 s7, 0x20000
  s_add_u32 s16, s42, 33554432
  s_addc_u32 s17, s43, 0
  s_mov_b32 s18, 4194304
  s_mov_b32 s19, 0x20000
  s_add_u32 s12, s42, 8388608
  s_addc_u32 s13, s43, 0
  s_mov_b32 s14, 14680064
  s_mov_b32 s15, 0x20000
  v_lshrrev_b32 v4, 2, v3
  v_mul_u32_u24 v4, 448, v4
  v_and_b32 v5, 3, v3
  v_lshl_add_u32 v4, v5, 3, v4
  v_bfe_u32 v5, v3, 4, 1
  v_lshlrev_b32 v5, 5, v5
  v_add_u32 v8, v4, v5
  v_sub_u32 v9, v4, v5
  v_add_u32 v10, 57344, v8
  v_add_u32 v11, 57344, v9
  v_add_u32 v12, 114688, v8
  v_add_u32 v13, 114688, v9
  v_lshrrev_b32 v15, 4, v3
  v_lshlrev_b32 v15, 4, v15
  v_add_u32 v15, 162816, v15
  s_mul_i32 s24, s23, 114688
  s_mul_i32 s25, s22, 7168
  s_add_u32 s24, s24, s25
  v_lshl_add_u32 v6, v3, 4, s24
  v_add_u32 v7, 114688, v6
  s_lshr_b32 s24, s23, 1
  s_lshl_b32 s24, s24, 7
  s_add_u32 s24, s24, 794624
  v_mov_b32 v4, 0
  s_mov_b32 s57, 0
gc_psp4:
  buffer_load_dword v5, v4, s[16:19], s24 offen sc1
  s_waitcnt vmcnt(0)
  v_readfirstlane_b32 s56, v5
  s_add_u32 s57, s57, 1
  s_cmp_ge_u32 s56, 8
  s_cbranch_scc1 gc_pok3
  s_cmp_ge_u32 s57, 262144
  s_cbranch_scc1 gc_pok3
  s_sleep 1
  s_branch gc_psp4
gc_pok3:
  buffer_load_dwordx4 v[184:187], v1, s[4:7], s46 offen offset:0 sc1
  buffer_load_dwordx4 v[188:191], v14, s[4:7], s46 offen offset:0 sc1
  buffer_load_dwordx4 v[192:195], v1, s[4:7], s46 offen offset:1024 sc1
  buffer_load_dwordx4 v[196:199], v14, s[4:7], s46 offen offset:1024 sc1
  s_add_u32 s46, s46, 2048
  buffer_load_dwordx4 v[200:203], v1, s[4:7], s46 offen offset:0 sc1
  buffer_load_dwordx4 v[204:207], v14, s[4:7], s46 offen offset:0 sc1
  buffer_load_dwordx4 v[208:211], v1, s[4:7], s46 offen offset:1024 sc1
  buffer_load_dwordx4 v[212:215], v14, s[4:7], s46 offen offset:1024 sc1
  s_add_u32 s46, s46, 2048
  s_barrier
  ds_read_b64_tr_b16 v[128:129], v8 offset:0
  ds_read_b64_tr_b16 v[130:131], v8 offset:7168
  ds_read_b64_tr_b16 v[132:133], v9 offset:32
  ds_read_b64_tr_b16 v[134:135], v9 offset:7200
  ds_read_b64_tr_b16 v[136:137], v8 offset:64
  ds_read_b64_tr_b16 v[138:139], v8 offset:7232
  ds_read_b64_tr_b16 v[140:141], v9 offset:96
  ds_read_b64_tr_b16 v[142:143], v9 offset:7264
  ds_read_b64_tr_b16 v[144:145], v8 offset:128
  ds_read_b64_tr_b16 v[146:147], v8 offset:7296
  ds_read_b64_tr_b16 v[148:149], v9 offset:160
  ds_read_b64_tr_b16 v[150:151], v9 offset:7328
  ds_read_b64_tr_b16 v[152:153], v8 offset:192
  ds_read_b64_tr_b16 v[154:155], v8 offset:7360
  ds_read_b64_tr_b16 v[156:157], v9 offset:224
  ds_read_b64_tr_b16 v[158:159], v9 offset:7392
  ds_read_b64_tr_b16 v[160:161], v8 offset:256
  ds_read_b64_tr_b16 v[162:163], v8 offset:7424
  ds_read_b64_tr_b16 v[164:165], v9 offset:288
  ds_read_b64_tr_b16 v[166:167], v9 offset:7456
  ds_read_b64_tr_b16 v[168:169], v8 offset:320
  ds_read_b64_tr_b16 v[170:171], v8 offset:7488
  ds_read_b64_tr_b16 v[172:173], v9 offset:352
  ds_read_b64_tr_b16 v[174:175], v9 offset:7520
  ds_read_b64_tr_b16 v[176:177], v8 offset:384
  ds_read_b64_tr_b16 v[178:179], v8 offset:7552
  ds_read_b64_tr_b16 v[180:181], v9 offset:416
  ds_read_b64_tr_b16 v[182:183], v9 offset:7584
  s_waitcnt vmcnt(6)
  s_waitcnt lgkmcnt(15)
  v_mfma_f32_16x16x32_bf16 v[16:19], v[128:131], v[184:187], 0
  v_mfma_f32_16x16x32_bf16 v[20:23], v[128:131], v[188:191], 0
  v_mfma_f32_16x16x32_bf16 v[24:27], v[132:135], v[184:187], 0
  ds_read_b64_tr_b16 v[128:129], v8 offset:14336
  v_mfma_f32_16x16x32_bf16 v[28:31], v[132:135], v[188:191], 0
  ds_read_b64_tr_b16 v[130:131], v8 offset:21504
  buffer_load_dwordx4 v[216:219], v1, s[4:7], s46 offen offset:0 sc1
  v_mfma_f32_16x16x32_bf16 v[32:35], v[136:139], v[184:187], 0
  ds_read_b64_tr_b16 v[132:133], v9 offset:14368
  v_mfma_f32_16x16x32_bf16 v[36:39], v[136:139], v[188:191], 0
  ds_read_b64_tr_b16 v[134:135], v9 offset:21536
  v_mfma_f32_16x16x32_bf16 v[40:43], v[140:143], v[184:187], 0
  ds_read_b64_tr_b16 v[136:137], v8 offset:14400
  v_mfma_f32_16x16x32_bf16 v[44:47], v[140:143], v[188:191], 0
  ds_read_b64_tr_b16 v[138:139], v8 offset:21568
  v_mfma_f32_16x16x32_bf16 v[48:51], v[144:147], v[184:187], 0
  ds_read_b64_tr_b16 v[140:141], v9 offset:14432
  v_mfma_f32_16x16x32_bf16 v[52:55], v[144:147], v[188:191], 0
  ds_read_b64_tr_b16 v[142:143], v9 offset:21600
  buffer_load_dwordx4 v[220:223], v14, s[4:7], s46 offen offset:0 sc1
  v_mfma_f32_16x16x32_bf16 v[56:59], v[148:151], v[184:187], 0
  ds_read_b64_tr_b16 v[144:145], v8 offset:14464
  v_mfma_f32_16x16x32_bf16 v[60:63], v[148:151], v[188:191], 0
  ds_read_b64_tr_b16 v[146:147], v8 offset:21632
  s_waitcnt lgkmcnt(15)
  v_mfma_f32_16x16x32_bf16 v[64:67], v[152:155], v[184:187], 0
  ds_read_b64_tr_b16 v[148:149], v9 offset:14496
  v_mfma_f32_16x16x32_bf16 v[68:71], v[152:155], v[188:191], 0
  ds_read_b64_tr_b16 v[150:151], v9 offset:21664
  v_mfma_f32_16x16x32_bf16 v[72:75], v[156:159], v[184:187], 0
  ds_read_b64_tr_b16 v[152:153], v8 offset:14528
  v_mfma_f32_16x16x32_bf16 v[76:79], v[156:159], v[188:191], 0
  ds_read_b64_tr_b16 v[154:155], v8 offset:21696
  buffer_load_dwordx4 v[224:227], v1, s[4:7], s46 offen offset:1024 sc1
  v_mfma_f32_16x16x32_bf16 v[80:83], v[160:163], v[184:187], 0
  ds_read_b64_tr_b16 v[156:157], v9 offset:14560
  v_mfma_f32_16x16x32_bf16 v[84:87], v[160:163], v[188:191], 0
  ds_read_b64_tr_b16 v[158:159], v9 offset:21728
  v_mfma_f32_16x16x32_bf16 v[88:91], v[164:167], v[184:187], 0
  ds_read_b64_tr_b16 v[160:161], v8 offset:14592
  v_mfma_f32_16x16x32_bf16 v[92:95], v[164:167], v[188:191], 0
  ds_read_b64_tr_b16 v[162:163], v8 offset:21760
  v_mfma_f32_16x16x32_bf16 v[96:99], v[168:171], v[184:187], 0
  ds_read_b64_tr_b16 v[164:165], v9 offset:14624
  v_mfma_f32_16x16x32_bf16 v[100:103], v[168:171], v[188:191], 0
  ds_read_b64_tr_b16 v[166:167], v9 offset:21792
  buffer_load_dwordx4 v[228:231], v14, s[4:7], s46 offen offset:1024 sc1
  s_add_u32 s46, s46, 2048
  s_waitcnt lgkmcnt(15)
  v_mfma_f32_16x16x32_bf16 v[104:107], v[172:175], v[184:187], 0
  ds_read_b64_tr_b16 v[168:169], v8 offset:14656
  v_mfma_f32_16x16x32_bf16 v[108:111], v[172:175], v[188:191], 0
  ds_read_b64_tr_b16 v[170:171], v8 offset:21824
  v_mfma_f32_16x16x32_bf16 v[112:115], v[176:179], v[184:187], 0
  ds_read_b64_tr_b16 v[172:173], v9 offset:14688
  v_mfma_f32_16x16x32_bf16 v[116:119], v[176:179], v[188:191], 0
  ds_read_b64_tr_b16 v[174:175], v9 offset:21856
  v_mfma_f32_16x16x32_bf16 v[120:123], v[180:183], v[184:187], 0
  ds_read_b64_tr_b16 v[176:177], v8 offset:14720
  v_mfma_f32_16x16x32_bf16 v[124:127], v[180:183], v[188:191], 0
  ds_read_b64_tr_b16 v[178:179], v8 offset:21888
  buffer_load_dwordx4 v[232:235], v1, s[4:7], s46 offen offset:0 sc1
  ds_read_b64_tr_b16 v[180:181], v9 offset:14752
  ds_read_b64_tr_b16 v[182:183], v9 offset:21920
  s_waitcnt vmcnt(9)
  s_barrier
  v_mfma_f32_16x16x32_bf16 v[16:19], v[128:131], v[192:195], v[16:19]
  v_mfma_f32_16x16x32_bf16 v[20:23], v[128:131], v[196:199], v[20:23]
  v_mfma_f32_16x16x32_bf16 v[24:27], v[132:135], v[192:195], v[24:27]
  ds_read_b64_tr_b16 v[128:129], v8 offset:28672
  v_mfma_f32_16x16x32_bf16 v[28:31], v[132:135], v[196:199], v[28:31]
  ds_read_b64_tr_b16 v[130:131], v8 offset:35840
  buffer_load_dwordx4 v[236:239], v14, s[4:7], s46 offen offset:0 sc1
  s_waitcnt lgkmcnt(15)
  v_mfma_f32_16x16x32_bf16 v[32:35], v[136:139], v[192:195], v[32:35]
  ds_read_b64_tr_b16 v[132:133], v9 offset:28704
  v_mfma_f32_16x16x32_bf16 v[36:39], v[136:139], v[196:199], v[36:39]
  ds_read_b64_tr_b16 v[134:135], v9 offset:35872
  v_mfma_f32_16x16x32_bf16 v[40:43], v[140:143], v[192:195], v[40:43]
  ds_read_b64_tr_b16 v[136:137], v8 offset:28736
  v_mfma_f32_16x16x32_bf16 v[44:47], v[140:143], v[196:199], v[44:47]
  ds_read_b64_tr_b16 v[138:139], v8 offset:35904
  v_mfma_f32_16x16x32_bf16 v[48:51], v[144:147], v[192:195], v[48:51]
  ds_read_b64_tr_b16 v[140:141], v9 offset:28768
  v_mfma_f32_16x16x32_bf16 v[52:55], v[144:147], v[196:199], v[52:55]
  ds_read_b64_tr_b16 v[142:143], v9 offset:35936
  buffer_load_dwordx4 v[240:243], v1, s[4:7], s46 offen offset:1024 sc1
  v_mfma_f32_16x16x32_bf16 v[56:59], v[148:151], v[192:195], v[56:59]
  ds_read_b64_tr_b16 v[144:145], v8 offset:28800
  v_mfma_f32_16x16x32_bf16 v[60:63], v[148:151], v[196:199], v[60:63]
  ds_read_b64_tr_b16 v[146:147], v8 offset:35968
  v_mfma_f32_16x16x32_bf16 v[64:67], v[152:155], v[192:195], v[64:67]
  ds_read_b64_tr_b16 v[148:149], v9 offset:28832
  v_mfma_f32_16x16x32_bf16 v[68:71], v[152:155], v[196:199], v[68:71]
  ds_read_b64_tr_b16 v[150:151], v9 offset:36000
  s_waitcnt lgkmcnt(15)
  v_mfma_f32_16x16x32_bf16 v[72:75], v[156:159], v[192:195], v[72:75]
  ds_read_b64_tr_b16 v[152:153], v8 offset:28864
  v_mfma_f32_16x16x32_bf16 v[76:79], v[156:159], v[196:199], v[76:79]
  ds_read_b64_tr_b16 v[154:155], v8 offset:36032
  buffer_load_dwordx4 v[244:247], v14, s[4:7], s46 offen offset:1024 sc1
  s_add_u32 s46, s46, 2048
  v_mfma_f32_16x16x32_bf16 v[80:83], v[160:163], v[192:195], v[80:83]
  ds_read_b64_tr_b16 v[156:157], v9 offset:28896
  v_mfma_f32_16x16x32_bf16 v[84:87], v[160:163], v[196:199], v[84:87]
  ds_read_b64_tr_b16 v[158:159], v9 offset:36064
  v_mfma_f32_16x16x32_bf16 v[88:91], v[164:167], v[192:195], v[88:91]
  ds_read_b64_tr_b16 v[160:161], v8 offset:28928
  v_mfma_f32_16x16x32_bf16 v[92:95], v[164:167], v[196:199], v[92:95]
  ds_read_b64_tr_b16 v[162:163], v8 offset:36096
  v_mfma_f32_16x16x32_bf16 v[96:99], v[168:171], v[192:195], v[96:99]
  ds_read_b64_tr_b16 v[164:165], v9 offset:28960
  v_mfma_f32_16x16x32_bf16 v[100:103], v[168:171], v[196:199], v[100:103]
  ds_read_b64_tr_b16 v[166:167], v9 offset:36128
  buffer_load_dword v248, v2, s[16:19], 0 offen offset:0 sc1
  v_mfma_f32_16x16x32_bf16 v[104:107], v[172:175], v[192:195], v[104:107]
  ds_read_b64_tr_b16 v[168:169], v8 offset:28992
  v_mfma_f32_16x16x32_bf16 v[108:111], v[172:175], v[196:199], v[108:111]
  ds_read_b64_tr_b16 v[170:171], v8 offset:36160
  s_waitcnt lgkmcnt(15)
  v_mfma_f32_16x16x32_bf16 v[112:115], v[176:179], v[192:195], v[112:115]
  ds_read_b64_tr_b16 v[172:173], v9 offset:29024
  v_mfma_f32_16x16x32_bf16 v[116:119], v[176:179], v[196:199], v[116:119]
  ds_read_b64_tr_b16 v[174:175], v9 offset:36192
  v_mfma_f32_16x16x32_bf16 v[120:123], v[180:183], v[192:195], v[120:123]
  ds_read_b64_tr_b16 v[176:177], v8 offset:29056
  v_mfma_f32_16x16x32_bf16 v[124:127], v[180:183], v[196:199], v[124:127]
  ds_read_b64_tr_b16 v[178:179], v8 offset:36224
  buffer_load_dword v249, v2, s[16:19], 0 offen offset:256 sc1
  ds_read_b64_tr_b16 v[180:181], v9 offset:29088
  ds_read_b64_tr_b16 v[182:183], v9 offset:36256
  s_waitcnt vmcnt(12)
  v_mfma_f32_16x16x32_bf16 v[16:19], v[128:131], v[200:203], v[16:19]
  v_mfma_f32_16x16x32_bf16 v[20:23], v[128:131], v[204:207], v[20:23]
  v_mfma_f32_16x16x32_bf16 v[24:27], v[132:135], v[200:203], v[24:27]
  ds_read_b64_tr_b16 v[128:129], v8 offset:43008
  v_mfma_f32_16x16x32_bf16 v[28:31], v[132:135], v[204:207], v[28:31]
  ds_read_b64_tr_b16 v[130:131], v8 offset:50176
  buffer_load_dword v250, v2, s[16:19], 0 offen offset:512 sc1
  v_mfma_f32_16x16x32_bf16 v[32:35], v[136:139], v[200:203], v[32:35]
  ds_read_b64_tr_b16 v[132:133], v9 offset:43040
  v_mfma_f32_16x16x32_bf16 v[36:39], v[136:139], v[204:207], v[36:39]
  ds_read_b64_tr_b16 v[134:135], v9 offset:50208
  s_waitcnt lgkmcnt(15)
  v_mfma_f32_16x16x32_bf16 v[40:43], v[140:143], v[200:203], v[40:43]
  ds_read_b64_tr_b16 v[136:137], v8 offset:43072
  v_mfma_f32_16x16x32_bf16 v[44:47], v[140:143], v[204:207], v[44:47]
  ds_read_b64_tr_b16 v[138:139], v8 offset:50240
  v_mfma_f32_16x16x32_bf16 v[48:51], v[144:147], v[200:203], v[48:51]
  ds_read_b64_tr_b16 v[140:141], v9 offset:43104
  v_mfma_f32_16x16x32_bf16 v[52:55], v[144:147], v[204:207], v[52:55]
  ds_read_b64_tr_b16 v[142:143], v9 offset:50272
  buffer_load_dword v251, v2, s[16:19], 0 offen offset:768 sc1
  v_mfma_f32_16x16x32_bf16 v[56:59], v[148:151], v[200:203], v[56:59]
  ds_read_b64_tr_b16 v[144:145], v8 offset:43136
  v_mfma_f32_16x16x32_bf16 v[60:63], v[148:151], v[204:207], v[60:63]
  ds_read_b64_tr_b16 v[146:147], v8 offset:50304
  v_mfma_f32_16x16x32_bf16 v[64:67], v[152:155], v[200:203], v[64:67]
  ds_read_b64_tr_b16 v[148:149], v9 offset:43168
  v_mfma_f32_16x16x32_bf16 v[68:71], v[152:155], v[204:207], v[68:71]
  ds_read_b64_tr_b16 v[150:151], v9 offset:50336
  v_mfma_f32_16x16x32_bf16 v[72:75], v[156:159], v[200:203], v[72:75]
  ds_read_b64_tr_b16 v[152:153], v8 offset:43200
  v_mfma_f32_16x16x32_bf16 v[76:79], v[156:159], v[204:207], v[76:79]
  ds_read_b64_tr_b16 v[154:155], v8 offset:50368
  buffer_load_dword v252, v2, s[16:19], 0 offen offset:1024 sc1
  s_waitcnt lgkmcnt(15)
  v_mfma_f32_16x16x32_bf16 v[80:83], v[160:163], v[200:203], v[80:83]
  ds_read_b64_tr_b16 v[156:157], v9 offset:43232
  v_mfma_f32_16x16x32_bf16 v[84:87], v[160:163], v[204:207], v[84:87]
  ds_read_b64_tr_b16 v[158:159], v9 offset:50400
  v_mfma_f32_16x16x32_bf16 v[88:91], v[164:167], v[200:203], v[88:91]
  ds_read_b64_tr_b16 v[160:161], v8 offset:43264
  v_mfma_f32_16x16x32_bf16 v[92:95], v[164:167], v[204:207], v[92:95]
  ds_read_b64_tr_b16 v[162:163], v8 offset:50432
  v_mfma_f32_16x16x32_bf16 v[96:99], v[168:171], v[200:203], v[96:99]
  ds_read_b64_tr_b16 v[164:165], v9 offset:43296
  v_mfma_f32_16x16x32_bf16 v[100:103], v[168:171], v[204:207], v[100:103]
  ds_read_b64_tr_b16 v[166:167], v9 offset:50464
  buffer_load_dword v253, v2, s[16:19], 0 offen offset:1280 sc1
  v_mfma_f32_16x16x32_bf16 v[104:107], v[172:175], v[200:203], v[104:107]
  ds_read_b64_tr_b16 v[168:169], v8 offset:43328
  v_mfma_f32_16x16x32_bf16 v[108:111], v[172:175], v[204:207], v[108:111]
  ds_read_b64_tr_b16 v[170:171], v8 offset:50496
  v_mfma_f32_16x16x32_bf16 v[112:115], v[176:179], v[200:203], v[112:115]
  ds_read_b64_tr_b16 v[172:173], v9 offset:43360
  v_mfma_f32_16x16x32_bf16 v[116:119], v[176:179], v[204:207], v[116:119]
  ds_read_b64_tr_b16 v[174:175], v9 offset:50528
  s_waitcnt lgkmcnt(15)
  v_mfma_f32_16x16x32_bf16 v[120:123], v[180:183], v[200:203], v[120:123]
  ds_read_b64_tr_b16 v[176:177], v8 offset:43392
  v_mfma_f32_16x16x32_bf16 v[124:127], v[180:183], v[204:207], v[124:127]
  ds_read_b64_tr_b16 v[178:179], v8 offset:50560
  buffer_load_dword v254, v2, s[16:19], 0 offen offset:1536 sc1
  ds_read_b64_tr_b16 v[180:181], v9 offset:43424
  ds_read_b64_tr_b16 v[182:183], v9 offset:50592
  s_waitcnt vmcnt(15)
  s_barrier
  v_mfma_f32_16x16x32_bf16 v[16:19], v[128:131], v[208:211], v[16:19]
  v_mfma_f32_16x16x32_bf16 v[20:23], v[128:131], v[212:215], v[20:23]
  v_mfma_f32_16x16x32_bf16 v[24:27], v[132:135], v[208:211], v[24:27]
  ds_read_b64_tr_b16 v[128:129], v10 offset:0
  v_mfma_f32_16x16x32_bf16 v[28:31], v[132:135], v[212:215], v[28:31]
  ds_read_b64_tr_b16 v[130:131], v10 offset:7168
  buffer_load_dword v255, v2, s[16:19], 0 offen offset:1792 sc1
  v_mfma_f32_16x16x32_bf16 v[32:35], v[136:139], v[208:211], v[32:35]
  ds_read_b64_tr_b16 v[132:133], v11 offset:32
  v_mfma_f32_16x16x32_bf16 v[36:39], v[136:139], v[212:215], v[36:39]
  ds_read_b64_tr_b16 v[134:135], v11 offset:7200
  v_mfma_f32_16x16x32_bf16 v[40:43], v[140:143], v[208:211], v[40:43]
  ds_read_b64_tr_b16 v[136:137], v10 offset:64
  v_mfma_f32_16x16x32_bf16 v[44:47], v[140:143], v[212:215], v[44:47]
  ds_read_b64_tr_b16 v[138:139], v10 offset:7232
  s_waitcnt lgkmcnt(15)
  v_mfma_f32_16x16x32_bf16 v[48:51], v[144:147], v[208:211], v[48:51]
  ds_read_b64_tr_b16 v[140:141], v11 offset:96
  v_mfma_f32_16x16x32_bf16 v[52:55], v[144:147], v[212:215], v[52:55]
  ds_read_b64_tr_b16 v[142:143], v11 offset:7264
  buffer_load_dwordx4 v[184:187], v1, s[4:7], s46 offen offset:0 sc1
  v_mfma_f32_16x16x32_bf16 v[56:59], v[148:151], v[208:211], v[56:59]
  ds_read_b64_tr_b16 v[144:145], v10 offset:128
  v_mfma_f32_16x16x32_bf16 v[60:63], v[148:151], v[212:215], v[60:63]
  ds_read_b64_tr_b16 v[146:147], v10 offset:7296
  v_mfma_f32_16x16x32_bf16 v[64:67], v[152:155], v[208:211], v[64:67]
  ds_read_b64_tr_b16 v[148:149], v11 offset:160
  v_mfma_f32_16x16x32_bf16 v[68:71], v[152:155], v[212:215], v[68:71]
  ds_read_b64_tr_b16 v[150:151], v11 offset:7328
  v_mfma_f32_16x16x32_bf16 v[72:75], v[156:159], v[208:211], v[72:75]
  ds_read_b64_tr_b16 v[152:153], v10 offset:192
  v_mfma_f32_16x16x32_bf16 v[76:79], v[156:159], v[212:215], v[76:79]
  ds_read_b64_tr_b16 v[154:155], v10 offset:7360
  buffer_load_dwordx4 v[188:191], v14, s[4:7], s46 offen offset:0 sc1
  v_mfma_f32_16x16x32_bf16 v[80:83], v[160:163], v[208:211], v[80:83]
  ds_read_b64_tr_b16 v[156:157], v11 offset:224
  v_mfma_f32_16x16x32_bf16 v[84:87], v[160:163], v[212:215], v[84:87]
  ds_read_b64_tr_b16 v[158:159], v11 offset:7392
  s_waitcnt lgkmcnt(15)
  v_mfma_f32_16x16x32_bf16 v[88:91], v[164:167], v[208:211], v[88:91]
  ds_read_b64_tr_b16 v[160:161], v10 offset:256
  v_mfma_f32_16x16x32_bf16 v[92:95], v[164:167], v[212:215], v[92:95]
  ds_read_b64_tr_b16 v[162:163], v10 offset:7424
  v_mfma_f32_16x16x32_bf16 v[96:99], v[168:171], v[208:211], v[96:99]
  ds_read_b64_tr_b16 v[164:165], v11 offset:288
  v_mfma_f32_16x16x32_bf16 v[100:103], v[168:171], v[212:215], v[100:103]
  ds_read_b64_tr_b16 v[166:167], v11 offset:7456
  buffer_load_dwordx4 v[192:195], v1, s[4:7], s46 offen offset:1024 sc1
  v_mfma_f32_16x16x32_bf16 v[104:107], v[172:175], v[208:211], v[104:107]
  ds_read_b64_tr_b16 v[168:169], v10 offset:320
  v_mfma_f32_16x16x32_bf16 v[108:111], v[172:175], v[212:215], v[108:111]
  ds_read_b64_tr_b16 v[170:171], v10 offset:7488
  v_mfma_f32_16x16x32_bf16 v[112:115], v[176:179], v[208:211], v[112:115]
  ds_read_b64_tr_b16 v[172:173], v11 offset:352
  v_mfma_f32_16x16x32_bf16 v[116:119], v[176:179], v[212:215], v[116:119]
  ds_read_b64_tr_b16 v[174:175], v11 offset:7520
  v_mfma_f32_16x16x32_bf16 v[120:123], v[180:183], v[208:211], v[120:123]
  ds_read_b64_tr_b16 v[176:177], v10 offset:384
  v_mfma_f32_16x16x32_bf16 v[124:127], v[180:183], v[212:215], v[124:127]
  ds_read_b64_tr_b16 v[178:179], v10 offset:7552
  buffer_load_dwordx4 v[196:199], v14, s[4:7], s46 offen offset:1024 sc1
  s_add_u32 s46, s46, 2048
  ds_read_b64_tr_b16 v[180:181], v11 offset:416
  ds_read_b64_tr_b16 v[182:183], v11 offset:7584
  s_waitcnt vmcnt(18)
  s_waitcnt lgkmcnt(15)
  v_mfma_f32_16x16x32_bf16 v[16:19], v[128:131], v[216:219], v[16:19]
  v_mfma_f32_16x16x32_bf16 v[20:23], v[128:131], v[220:223], v[20:23]
  v_mfma_f32_16x16x32_bf16 v[24:27], v[132:135], v[216:219], v[24:27]
  ds_read_b64_tr_b16 v[128:129], v10 offset:14336
  v_mfma_f32_16x16x32_bf16 v[28:31], v[132:135], v[220:223], v[28:31]
  ds_read_b64_tr_b16 v[130:131], v10 offset:21504
  buffer_load_dwordx4 v[200:203], v1, s[4:7], s46 offen offset:0 sc1
  v_mfma_f32_16x16x32_bf16 v[32:35], v[136:139], v[216:219], v[32:35]
  ds_read_b64_tr_b16 v[132:133], v11 offset:14368
  v_mfma_f32_16x16x32_bf16 v[36:39], v[136:139], v[220:223], v[36:39]
  ds_read_b64_tr_b16 v[134:135], v11 offset:21536
  v_mfma_f32_16x16x32_bf16 v[40:43], v[140:143], v[216:219], v[40:43]
  ds_read_b64_tr_b16 v[136:137], v10 offset:14400
  v_mfma_f32_16x16x32_bf16 v[44:47], v[140:143], v[220:223], v[44:47]
  ds_read_b64_tr_b16 v[138:139], v10 offset:21568
  v_mfma_f32_16x16x32_bf16 v[48:51], v[144:147], v[216:219], v[48:51]
  ds_read_b64_tr_b16 v[140:141], v11 offset:14432
  v_mfma_f32_16x16x32_bf16 v[52:55], v[144:147], v[220:223], v[52:55]
  ds_read_b64_tr_b16 v[142:143], v11 offset:21600
  buffer_load_dwordx4 v[204:207], v14, s[4:7], s46 offen offset:0 sc1
  v_mfma_f32_16x16x32_bf16 v[56:59], v[148:151], v[216:219], v[56:59]
  ds_read_b64_tr_b16 v[144:145], v10 offset:14464
  v_mfma_f32_16x16x32_bf16 v[60:63], v[148:151], v[220:223], v[60:63]
  ds_read_b64_tr_b16 v[146:147], v10 offset:21632
  s_waitcnt lgkmcnt(15)
  v_mfma_f32_16x16x32_bf16 v[64:67], v[152:155], v[216:219], v[64:67]
  ds_read_b64_tr_b16 v[148:149], v11 offset:14496
  v_mfma_f32_16x16x32_bf16 v[68:71], v[152:155], v[220:223], v[68:71]
  ds_read_b64_tr_b16 v[150:151], v11 offset:21664
  v_mfma_f32_16x16x32_bf16 v[72:75], v[156:159], v[216:219], v[72:75]
  ds_read_b64_tr_b16 v[152:153], v10 offset:14528
  v_mfma_f32_16x16x32_bf16 v[76:79], v[156:159], v[220:223], v[76:79]
  ds_read_b64_tr_b16 v[154:155], v10 offset:21696
  buffer_load_dwordx4 v[208:211], v1, s[4:7], s46 offen offset:1024 sc1
  v_mfma_f32_16x16x32_bf16 v[80:83], v[160:163], v[216:219], v[80:83]
  ds_read_b64_tr_b16 v[156:157], v11 offset:14560
  v_mfma_f32_16x16x32_bf16 v[84:87], v[160:163], v[220:223], v[84:87]
  ds_read_b64_tr_b16 v[158:159], v11 offset:21728
  v_mfma_f32_16x16x32_bf16 v[88:91], v[164:167], v[216:219], v[88:91]
  ds_read_b64_tr_b16 v[160:161], v10 offset:14592
  v_mfma_f32_16x16x32_bf16 v[92:95], v[164:167], v[220:223], v[92:95]
  ds_read_b64_tr_b16 v[162:163], v10 offset:21760
  v_mfma_f32_16x16x32_bf16 v[96:99], v[168:171], v[216:219], v[96:99]
  ds_read_b64_tr_b16 v[164:165], v11 offset:14624
  v_mfma_f32_16x16x32_bf16 v[100:103], v[168:171], v[220:223], v[100:103]
  ds_read_b64_tr_b16 v[166:167], v11 offset:21792
  buffer_load_dwordx4 v[212:215], v14, s[4:7], s46 offen offset:1024 sc1
  s_add_u32 s46, s46, 2048
  s_waitcnt lgkmcnt(15)
  v_mfma_f32_16x16x32_bf16 v[104:107], v[172:175], v[216:219], v[104:107]
  ds_read_b64_tr_b16 v[168:169], v10 offset:14656
  v_mfma_f32_16x16x32_bf16 v[108:111], v[172:175], v[220:223], v[108:111]
  ds_read_b64_tr_b16 v[170:171], v10 offset:21824
  v_mfma_f32_16x16x32_bf16 v[112:115], v[176:179], v[216:219], v[112:115]
  ds_read_b64_tr_b16 v[172:173], v11 offset:14688
  v_mfma_f32_16x16x32_bf16 v[116:119], v[176:179], v[220:223], v[116:119]
  ds_read_b64_tr_b16 v[174:175], v11 offset:21856
  v_mfma_f32_16x16x32_bf16 v[120:123], v[180:183], v[216:219], v[120:123]
  ds_read_b64_tr_b16 v[176:177], v10 offset:14720
  v_mfma_f32_16x16x32_bf16 v[124:127], v[180:183], v[220:223], v[124:127]
  ds_read_b64_tr_b16 v[178:179], v10 offset:21888
  ds_read_b64_tr_b16 v[180:181], v11 offset:14752
  ds_read_b64_tr_b16 v[182:183], v11 offset:21920
  s_waitcnt vmcnt(20)
  s_barrier
  v_mfma_f32_16x16x32_bf16 v[16:19], v[128:131], v[224:227], v[16:19]
  v_mfma_f32_16x16x32_bf16 v[20:23], v[128:131], v[228:231], v[20:23]
  v_mfma_f32_16x16x32_bf16 v[24:27], v[132:135], v[224:227], v[24:27]
  ds_read_b64_tr_b16 v[128:129], v10 offset:28672
  v_mfma_f32_16x16x32_bf16 v[28:31], v[132:135], v[228:231], v[28:31]
  ds_read_b64_tr_b16 v[130:131], v10 offset:35840
  buffer_load_dwordx4 v[216:219], v1, s[4:7], s46 offen offset:0 sc1
  s_waitcnt lgkmcnt(15)
  v_mfma_f32_16x16x32_bf16 v[32:35], v[136:139], v[224:227], v[32:35]
  ds_read_b64_tr_b16 v[132:133], v11 offset:28704
  v_mfma_f32_16x16x32_bf16 v[36:39], v[136:139], v[228:231], v[36:39]
  ds_read_b64_tr_b16 v[134:135], v11 offset:35872
  v_mfma_f32_16x16x32_bf16 v[40:43], v[140:143], v[224:227], v[40:43]
  ds_read_b64_tr_b16 v[136:137], v10 offset:28736
  v_mfma_f32_16x16x32_bf16 v[44:47], v[140:143], v[228:231], v[44:47]
  ds_read_b64_tr_b16 v[138:139], v10 offset:35904
  v_mfma_f32_16x16x32_bf16 v[48:51], v[144:147], v[224:227], v[48:51]
  ds_read_b64_tr_b16 v[140:141], v11 offset:28768
  v_mfma_f32_16x16x32_bf16 v[52:55], v[144:147], v[228:231], v[52:55]
  ds_read_b64_tr_b16 v[142:143], v11 offset:35936
  buffer_load_dwordx4 v[220:223], v14, s[4:7], s46 offen offset:0 sc1
  v_mfma_f32_16x16x32_bf16 v[56:59], v[148:151], v[224:227], v[56:59]
  ds_read_b64_tr_b16 v[144:145], v10 offset:28800
  v_mfma_f32_16x16x32_bf16 v[60:63], v[148:151], v[228:231], v[60:63]
  ds_read_b64_tr_b16 v[146:147], v10 offset:35968
  v_mfma_f32_16x16x32_bf16 v[64:67], v[152:155], v[224:227], v[64:67]
  ds_read_b64_tr_b16 v[148:149], v11 offset:28832
  v_mfma_f32_16x16x32_bf16 v[68:71], v[152:155], v[228:231], v[68:71]
  ds_read_b64_tr_b16 v[150:151], v11 offset:36000
  s_waitcnt lgkmcnt(15)
  v_mfma_f32_16x16x32_bf16 v[72:75], v[156:159], v[224:227], v[72:75]
  ds_read_b64_tr_b16 v[152:153], v10 offset:28864
  v_mfma_f32_16x16x32_bf16 v[76:79], v[156:159], v[228:231], v[76:79]
  ds_read_b64_tr_b16 v[154:155], v10 offset:36032
  v_mfma_f32_16x16x32_bf16 v[80:83], v[160:163], v[224:227], v[80:83]
  ds_read_b64_tr_b16 v[156:157], v11 offset:28896
  v_mfma_f32_16x16x32_bf16 v[84:87], v[160:163], v[228:231], v[84:87]
  ds_read_b64_tr_b16 v[158:159], v11 offset:36064
  v_mfma_f32_16x16x32_bf16 v[88:91], v[164:167], v[224:227], v[88:91]
  ds_read_b64_tr_b16 v[160:161], v10 offset:28928
  v_mfma_f32_16x16x32_bf16 v[92:95], v[164:167], v[228:231], v[92:95]
  ds_read_b64_tr_b16 v[162:163], v10 offset:36096
  v_mfma_f32_16x16x32_bf16 v[96:99], v[168:171], v[224:227], v[96:99]
  ds_read_b64_tr_b16 v[164:165], v11 offset:28960
  v_mfma_f32_16x16x32_bf16 v[100:103], v[168:171], v[228:231], v[100:103]
  ds_read_b64_tr_b16 v[166:167], v11 offset:36128
  v_mfma_f32_16x16x32_bf16 v[104:107], v[172:175], v[224:227], v[104:107]
  ds_read_b64_tr_b16 v[168:169], v10 offset:28992
  v_mfma_f32_16x16x32_bf16 v[108:111], v[172:175], v[228:231], v[108:111]
  ds_read_b64_tr_b16 v[170:171], v10 offset:36160
  s_waitcnt lgkmcnt(15)
  v_mfma_f32_16x16x32_bf16 v[112:115], v[176:179], v[224:227], v[112:115]
  ds_read_b64_tr_b16 v[172:173], v11 offset:29024
  v_mfma_f32_16x16x32_bf16 v[116:119], v[176:179], v[228:231], v[116:119]
  ds_read_b64_tr_b16 v[174:175], v11 offset:36192
  v_mfma_f32_16x16x32_bf16 v[120:123], v[180:183], v[224:227], v[120:123]
  ds_read_b64_tr_b16 v[176:177], v10 offset:29056
  v_mfma_f32_16x16x32_bf16 v[124:127], v[180:183], v[228:231], v[124:127]
  ds_read_b64_tr_b16 v[178:179], v10 offset:36224
  ds_read_b64_tr_b16 v[180:181], v11 offset:29088
  ds_read_b64_tr_b16 v[182:183], v11 offset:36256
  s_waitcnt vmcnt(20)
  v_mfma_f32_16x16x32_bf16 v[16:19], v[128:131], v[232:235], v[16:19]
  v_mfma_f32_16x16x32_bf16 v[20:23], v[128:131], v[236:239], v[20:23]
  v_mfma_f32_16x16x32_bf16 v[24:27], v[132:135], v[232:235], v[24:27]
  ds_read_b64_tr_b16 v[128:129], v10 offset:43008
  v_mfma_f32_16x16x32_bf16 v[28:31], v[132:135], v[236:239], v[28:31]
  ds_read_b64_tr_b16 v[130:131], v10 offset:50176
  buffer_load_dwordx4 v[224:227], v1, s[4:7], s46 offen offset:1024 sc1
  v_mfma_f32_16x16x32_bf16 v[32:35], v[136:139], v[232:235], v[32:35]
  ds_read_b64_tr_b16 v[132:133], v11 offset:43040
  v_mfma_f32_16x16x32_bf16 v[36:39], v[136:139], v[236:239], v[36:39]
  ds_read_b64_tr_b16 v[134:135], v11 offset:50208
  s_waitcnt lgkmcnt(15)
  v_mfma_f32_16x16x32_bf16 v[40:43], v[140:143], v[232:235], v[40:43]
  ds_read_b64_tr_b16 v[136:137], v10 offset:43072
  v_mfma_f32_16x16x32_bf16 v[44:47], v[140:143], v[236:239], v[44:47]
  ds_read_b64_tr_b16 v[138:139], v10 offset:50240
  v_mfma_f32_16x16x32_bf16 v[48:51], v[144:147], v[232:235], v[48:51]
  ds_read_b64_tr_b16 v[140:141], v11 offset:43104
  v_mfma_f32_16x16x32_bf16 v[52:55], v[144:147], v[236:239], v[52:55]
  ds_read_b64_tr_b16 v[142:143], v11 offset:50272
  buffer_load_dwordx4 v[228:231], v14, s[4:7], s46 offen offset:1024 sc1
  s_add_u32 s46, s46, 2048
  v_mfma_f32_16x16x32_bf16 v[56:59], v[148:151], v[232:235], v[56:59]
  ds_read_b64_tr_b16 v[144:145], v10 offset:43136
  v_mfma_f32_16x16x32_bf16 v[60:63], v[148:151], v[236:239], v[60:63]
  ds_read_b64_tr_b16 v[146:147], v10 offset:50304
  v_mfma_f32_16x16x32_bf16 v[64:67], v[152:155], v[232:235], v[64:67]
  ds_read_b64_tr_b16 v[148:149], v11 offset:43168
  v_mfma_f32_16x16x32_bf16 v[68:71], v[152:155], v[236:239], v[68:71]
  ds_read_b64_tr_b16 v[150:151], v11 offset:50336
  v_mfma_f32_16x16x32_bf16 v[72:75], v[156:159], v[232:235], v[72:75]
  ds_read_b64_tr_b16 v[152:153], v10 offset:43200
  v_mfma_f32_16x16x32_bf16 v[76:79], v[156:159], v[236:239], v[76:79]
  ds_read_b64_tr_b16 v[154:155], v10 offset:50368
  s_waitcnt lgkmcnt(15)
  v_mfma_f32_16x16x32_bf16 v[80:83], v[160:163], v[232:235], v[80:83]
  ds_read_b64_tr_b16 v[156:157], v11 offset:43232
  v_mfma_f32_16x16x32_bf16 v[84:87], v[160:163], v[236:239], v[84:87]
  ds_read_b64_tr_b16 v[158:159], v11 offset:50400
  v_mfma_f32_16x16x32_bf16 v[88:91], v[164:167], v[232:235], v[88:91]
  ds_read_b64_tr_b16 v[160:161], v10 offset:43264
  v_mfma_f32_16x16x32_bf16 v[92:95], v[164:167], v[236:239], v[92:95]
  ds_read_b64_tr_b16 v[162:163], v10 offset:50432
  v_mfma_f32_16x16x32_bf16 v[96:99], v[168:171], v[232:235], v[96:99]
  ds_read_b64_tr_b16 v[164:165], v11 offset:43296
  v_mfma_f32_16x16x32_bf16 v[100:103], v[168:171], v[236:239], v[100:103]
  ds_read_b64_tr_b16 v[166:167], v11 offset:50464
  v_mfma_f32_16x16x32_bf16 v[104:107], v[172:175], v[232:235], v[104:107]
  ds_read_b64_tr_b16 v[168:169], v10 offset:43328
  v_mfma_f32_16x16x32_bf16 v[108:111], v[172:175], v[236:239], v[108:111]
  ds_read_b64_tr_b16 v[170:171], v10 offset:50496
  v_mfma_f32_16x16x32_bf16 v[112:115], v[176:179], v[232:235], v[112:115]
  ds_read_b64_tr_b16 v[172:173], v11 offset:43360
  v_mfma_f32_16x16x32_bf16 v[116:119], v[176:179], v[236:239], v[116:119]
  ds_read_b64_tr_b16 v[174:175], v11 offset:50528
  s_waitcnt lgkmcnt(15)
  v_mfma_f32_16x16x32_bf16 v[120:123], v[180:183], v[232:235], v[120:123]
  ds_read_b64_tr_b16 v[176:177], v10 offset:43392
  v_mfma_f32_16x16x32_bf16 v[124:127], v[180:183], v[236:239], v[124:127]
  ds_read_b64_tr_b16 v[178:179], v10 offset:50560
  ds_read_b64_tr_b16 v[180:181], v11 offset:43424
  ds_read_b64_tr_b16 v[182:183], v11 offset:50592
  s_waitcnt vmcnt(20)
  s_barrier
  v_mfma_f32_16x16x32_bf16 v[16:19], v[128:131], v[240:243], v[16:19]
  v_mfma_f32_16x16x32_bf16 v[20:23], v[128:131], v[244:247], v[20:23]
  v_mfma_f32_16x16x32_bf16 v[24:27], v[132:135], v[240:243], v[24:27]
  ds_read_b64_tr_b16 v[128:129], v12 offset:0
  v_mfma_f32_16x16x32_bf16 v[28:31], v[132:135], v[244:247], v[28:31]
  ds_read_b64_tr_b16 v[130:131], v12 offset:7168
  buffer_load_dwordx4 v[232:235], v1, s[4:7], s46 offen offset:0 sc1
  v_mfma_f32_16x16x32_bf16 v[32:35], v[136:139], v[240:243], v[32:35]
  ds_read_b64_tr_b16 v[132:133], v13 offset:32
  v_mfma_f32_16x16x32_bf16 v[36:39], v[136:139], v[244:247], v[36:39]
  ds_read_b64_tr_b16 v[134:135], v13 offset:7200
  v_mfma_f32_16x16x32_bf16 v[40:43], v[140:143], v[240:243], v[40:43]
  ds_read_b64_tr_b16 v[136:137], v12 offset:64
  v_mfma_f32_16x16x32_bf16 v[44:47], v[140:143], v[244:247], v[44:47]
  ds_read_b64_tr_b16 v[138:139], v12 offset:7232
  s_waitcnt lgkmcnt(15)
  v_mfma_f32_16x16x32_bf16 v[48:51], v[144:147], v[240:243], v[48:51]
  ds_read_b64_tr_b16 v[140:141], v13 offset:96
  v_mfma_f32_16x16x32_bf16 v[52:55], v[144:147], v[244:247], v[52:55]
  ds_read_b64_tr_b16 v[142:143], v13 offset:7264
  buffer_load_dwordx4 v[236:239], v14, s[4:7], s46 offen offset:0 sc1
  v_mfma_f32_16x16x32_bf16 v[56:59], v[148:151], v[240:243], v[56:59]
  ds_read_b64_tr_b16 v[144:145], v12 offset:128
  v_mfma_f32_16x16x32_bf16 v[60:63], v[148:151], v[244:247], v[60:63]
  ds_read_b64_tr_b16 v[146:147], v12 offset:7296
  v_mfma_f32_16x16x32_bf16 v[64:67], v[152:155], v[240:243], v[64:67]
  ds_read_b64_tr_b16 v[148:149], v13 offset:160
  v_mfma_f32_16x16x32_bf16 v[68:71], v[152:155], v[244:247], v[68:71]
  ds_read_b64_tr_b16 v[150:151], v13 offset:7328
  v_mfma_f32_16x16x32_bf16 v[72:75], v[156:159], v[240:243], v[72:75]
  ds_read_b64_tr_b16 v[152:153], v12 offset:192
  v_mfma_f32_16x16x32_bf16 v[76:79], v[156:159], v[244:247], v[76:79]
  ds_read_b64_tr_b16 v[154:155], v12 offset:7360
  v_mfma_f32_16x16x32_bf16 v[80:83], v[160:163], v[240:243], v[80:83]
  ds_read_b64_tr_b16 v[156:157], v13 offset:224
  v_mfma_f32_16x16x32_bf16 v[84:87], v[160:163], v[244:247], v[84:87]
  ds_read_b64_tr_b16 v[158:159], v13 offset:7392
  s_waitcnt lgkmcnt(15)
  v_mfma_f32_16x16x32_bf16 v[88:91], v[164:167], v[240:243], v[88:91]
  ds_read_b64_tr_b16 v[160:161], v12 offset:256
  v_mfma_f32_16x16x32_bf16 v[92:95], v[164:167], v[244:247], v[92:95]
  ds_read_b64_tr_b16 v[162:163], v12 offset:7424
  v_mfma_f32_16x16x32_bf16 v[96:99], v[168:171], v[240:243], v[96:99]
  ds_read_b64_tr_b16 v[164:165], v13 offset:288
  v_mfma_f32_16x16x32_bf16 v[100:103], v[168:171], v[244:247], v[100:103]
  ds_read_b64_tr_b16 v[166:167], v13 offset:7456
  v_mfma_f32_16x16x32_bf16 v[104:107], v[172:175], v[240:243], v[104:107]
  ds_read_b64_tr_b16 v[168:169], v12 offset:320
  v_mfma_f32_16x16x32_bf16 v[108:111], v[172:175], v[244:247], v[108:111]
  ds_read_b64_tr_b16 v[170:171], v12 offset:7488
  v_mfma_f32_16x16x32_bf16 v[112:115], v[176:179], v[240:243], v[112:115]
  ds_read_b64_tr_b16 v[172:173], v13 offset:352
  v_mfma_f32_16x16x32_bf16 v[116:119], v[176:179], v[244:247], v[116:119]
  ds_read_b64_tr_b16 v[174:175], v13 offset:7520
  v_mfma_f32_16x16x32_bf16 v[120:123], v[180:183], v[240:243], v[120:123]
  ds_read_b64_tr_b16 v[176:177], v12 offset:384
  v_mfma_f32_16x16x32_bf16 v[124:127], v[180:183], v[244:247], v[124:127]
  ds_read_b64_tr_b16 v[178:179], v12 offset:7552
  ds_read_b64_tr_b16 v[180:181], v13 offset:416
  ds_read_b64_tr_b16 v[182:183], v13 offset:7584
  s_waitcnt vmcnt(12)
  s_waitcnt lgkmcnt(15)
  v_mfma_f32_16x16x32_bf16 v[16:19], v[128:131], v[184:187], v[16:19]
  v_mfma_f32_16x16x32_bf16 v[20:23], v[128:131], v[188:191], v[20:23]
  v_mfma_f32_16x16x32_bf16 v[24:27], v[132:135], v[184:187], v[24:27]
  ds_read_b64_tr_b16 v[128:129], v12 offset:14336
  v_mfma_f32_16x16x32_bf16 v[28:31], v[132:135], v[188:191], v[28:31]
  ds_read_b64_tr_b16 v[130:131], v12 offset:21504
  buffer_load_dwordx4 v[240:243], v1, s[4:7], s46 offen offset:1024 sc1
  v_mfma_f32_16x16x32_bf16 v[32:35], v[136:139], v[184:187], v[32:35]
  ds_read_b64_tr_b16 v[132:133], v13 offset:14368
  v_mfma_f32_16x16x32_bf16 v[36:39], v[136:139], v[188:191], v[36:39]
  ds_read_b64_tr_b16 v[134:135], v13 offset:21536
  v_mfma_f32_16x16x32_bf16 v[40:43], v[140:143], v[184:187], v[40:43]
  ds_read_b64_tr_b16 v[136:137], v12 offset:14400
  v_mfma_f32_16x16x32_bf16 v[44:47], v[140:143], v[188:191], v[44:47]
  ds_read_b64_tr_b16 v[138:139], v12 offset:21568
  v_mfma_f32_16x16x32_bf16 v[48:51], v[144:147], v[184:187], v[48:51]
  ds_read_b64_tr_b16 v[140:141], v13 offset:14432
  v_mfma_f32_16x16x32_bf16 v[52:55], v[144:147], v[188:191], v[52:55]
  ds_read_b64_tr_b16 v[142:143], v13 offset:21600
  buffer_load_dwordx4 v[244:247], v14, s[4:7], s46 offen offset:1024 sc1
  s_add_u32 s46, s46, 2048
  v_mfma_f32_16x16x32_bf16 v[56:59], v[148:151], v[184:187], v[56:59]
  ds_read_b64_tr_b16 v[144:145], v12 offset:14464
  v_mfma_f32_16x16x32_bf16 v[60:63], v[148:151], v[188:191], v[60:63]
  ds_read_b64_tr_b16 v[146:147], v12 offset:21632
  s_waitcnt lgkmcnt(15)
  v_mfma_f32_16x16x32_bf16 v[64:67], v[152:155], v[184:187], v[64:67]
  ds_read_b64_tr_b16 v[148:149], v13 offset:14496
  v_mfma_f32_16x16x32_bf16 v[68:71], v[152:155], v[188:191], v[68:71]
  ds_read_b64_tr_b16 v[150:151], v13 offset:21664
  v_mfma_f32_16x16x32_bf16 v[72:75], v[156:159], v[184:187], v[72:75]
  ds_read_b64_tr_b16 v[152:153], v12 offset:14528
  v_mfma_f32_16x16x32_bf16 v[76:79], v[156:159], v[188:191], v[76:79]
  ds_read_b64_tr_b16 v[154:155], v12 offset:21696
  v_mfma_f32_16x16x32_bf16 v[80:83], v[160:163], v[184:187], v[80:83]
  ds_read_b64_tr_b16 v[156:157], v13 offset:14560
  v_mfma_f32_16x16x32_bf16 v[84:87], v[160:163], v[188:191], v[84:87]
  ds_read_b64_tr_b16 v[158:159], v13 offset:21728
  v_mfma_f32_16x16x32_bf16 v[88:91], v[164:167], v[184:187], v[88:91]
  ds_read_b64_tr_b16 v[160:161], v12 offset:14592
  v_mfma_f32_16x16x32_bf16 v[92:95], v[164:167], v[188:191], v[92:95]
  ds_read_b64_tr_b16 v[162:163], v12 offset:21760
  v_mfma_f32_16x16x32_bf16 v[96:99], v[168:171], v[184:187], v[96:99]
  ds_read_b64_tr_b16 v[164:165], v13 offset:14624
  v_mfma_f32_16x16x32_bf16 v[100:103], v[168:171], v[188:191], v[100:103]
  ds_read_b64_tr_b16 v[166:167], v13 offset:21792
  s_waitcnt lgkmcnt(15)
  v_mfma_f32_16x16x32_bf16 v[104:107], v[172:175], v[184:187], v[104:107]
  ds_read_b64_tr_b16 v[168:169], v12 offset:14656
  v_mfma_f32_16x16x32_bf16 v[108:111], v[172:175], v[188:191], v[108:111]
  ds_read_b64_tr_b16 v[170:171], v12 offset:21824
  v_mfma_f32_16x16x32_bf16 v[112:115], v[176:179], v[184:187], v[112:115]
  ds_read_b64_tr_b16 v[172:173], v13 offset:14688
  v_mfma_f32_16x16x32_bf16 v[116:119], v[176:179], v[188:191], v[116:119]
  ds_read_b64_tr_b16 v[174:175], v13 offset:21856
  v_mfma_f32_16x16x32_bf16 v[120:123], v[180:183], v[184:187], v[120:123]
  ds_read_b64_tr_b16 v[176:177], v12 offset:14720
  v_mfma_f32_16x16x32_bf16 v[124:127], v[180:183], v[188:191], v[124:127]
  ds_read_b64_tr_b16 v[178:179], v12 offset:21888
  ds_read_b64_tr_b16 v[180:181], v13 offset:14752
  ds_read_b64_tr_b16 v[182:183], v13 offset:21920
  s_waitcnt vmcnt(12)
  s_barrier
  v_mfma_f32_16x16x32_bf16 v[16:19], v[128:131], v[192:195], v[16:19]
  v_mfma_f32_16x16x32_bf16 v[20:23], v[128:131], v[196:199], v[20:23]
  v_mfma_f32_16x16x32_bf16 v[24:27], v[132:135], v[192:195], v[24:27]
  ds_read_b64_tr_b16 v[128:129], v8 offset:0
  v_mfma_f32_16x16x32_bf16 v[28:31], v[132:135], v[196:199], v[28:31]
  ds_read_b64_tr_b16 v[130:131], v8 offset:7168
  buffer_load_dwordx4 v[184:187], v1, s[4:7], s46 offen offset:0 sc1
  s_waitcnt lgkmcnt(15)
  v_mfma_f32_16x16x32_bf16 v[32:35], v[136:139], v[192:195], v[32:35]
  ds_read_b64_tr_b16 v[132:133], v9 offset:32
  v_mfma_f32_16x16x32_bf16 v[36:39], v[136:139], v[196:199], v[36:39]
  ds_read_b64_tr_b16 v[134:135], v9 offset:7200
  v_mfma_f32_16x16x32_bf16 v[40:43], v[140:143], v[192:195], v[40:43]
  ds_read_b64_tr_b16 v[136:137], v8 offset:64
  v_mfma_f32_16x16x32_bf16 v[44:47], v[140:143], v[196:199], v[44:47]
  ds_read_b64_tr_b16 v[138:139], v8 offset:7232
  v_mfma_f32_16x16x32_bf16 v[48:51], v[144:147], v[192:195], v[48:51]
  ds_read_b64_tr_b16 v[140:141], v9 offset:96
  v_mfma_f32_16x16x32_bf16 v[52:55], v[144:147], v[196:199], v[52:55]
  ds_read_b64_tr_b16 v[142:143], v9 offset:7264
  buffer_load_dwordx4 v[188:191], v14, s[4:7], s46 offen offset:0 sc1
  v_mfma_f32_16x16x32_bf16 v[56:59], v[148:151], v[192:195], v[56:59]
  ds_read_b64_tr_b16 v[144:145], v8 offset:128
  v_mfma_f32_16x16x32_bf16 v[60:63], v[148:151], v[196:199], v[60:63]
  ds_read_b64_tr_b16 v[146:147], v8 offset:7296
  v_mfma_f32_16x16x32_bf16 v[64:67], v[152:155], v[192:195], v[64:67]
  ds_read_b64_tr_b16 v[148:149], v9 offset:160
  v_mfma_f32_16x16x32_bf16 v[68:71], v[152:155], v[196:199], v[68:71]
  ds_read_b64_tr_b16 v[150:151], v9 offset:7328
  s_waitcnt lgkmcnt(15)
  v_mfma_f32_16x16x32_bf16 v[72:75], v[156:159], v[192:195], v[72:75]
  ds_read_b64_tr_b16 v[152:153], v8 offset:192
  v_mfma_f32_16x16x32_bf16 v[76:79], v[156:159], v[196:199], v[76:79]
  ds_read_b64_tr_b16 v[154:155], v8 offset:7360
  v_mfma_f32_16x16x32_bf16 v[80:83], v[160:163], v[192:195], v[80:83]
  ds_read_b64_tr_b16 v[156:157], v9 offset:224
  v_mfma_f32_16x16x32_bf16 v[84:87], v[160:163], v[196:199], v[84:87]
  ds_read_b64_tr_b16 v[158:159], v9 offset:7392
  v_mfma_f32_16x16x32_bf16 v[88:91], v[164:167], v[192:195], v[88:91]
  ds_read_b64_tr_b16 v[160:161], v8 offset:256
  v_mfma_f32_16x16x32_bf16 v[92:95], v[164:167], v[196:199], v[92:95]
  ds_read_b64_tr_b16 v[162:163], v8 offset:7424
  v_mfma_f32_16x16x32_bf16 v[96:99], v[168:171], v[192:195], v[96:99]
  ds_read_b64_tr_b16 v[164:165], v9 offset:288
  v_mfma_f32_16x16x32_bf16 v[100:103], v[168:171], v[196:199], v[100:103]
  ds_read_b64_tr_b16 v[166:167], v9 offset:7456
  v_mfma_f32_16x16x32_bf16 v[104:107], v[172:175], v[192:195], v[104:107]
  ds_read_b64_tr_b16 v[168:169], v8 offset:320
  v_mfma_f32_16x16x32_bf16 v[108:111], v[172:175], v[196:199], v[108:111]
  ds_read_b64_tr_b16 v[170:171], v8 offset:7488
  s_waitcnt lgkmcnt(15)
  v_mfma_f32_16x16x32_bf16 v[112:115], v[176:179], v[192:195], v[112:115]
  ds_read_b64_tr_b16 v[172:173], v9 offset:352
  v_mfma_f32_16x16x32_bf16 v[116:119], v[176:179], v[196:199], v[116:119]
  ds_read_b64_tr_b16 v[174:175], v9 offset:7520
  v_mfma_f32_16x16x32_bf16 v[120:123], v[180:183], v[192:195], v[120:123]
  ds_read_b64_tr_b16 v[176:177], v8 offset:384
  v_mfma_f32_16x16x32_bf16 v[124:127], v[180:183], v[196:199], v[124:127]
  ds_read_b64_tr_b16 v[178:179], v8 offset:7552
  ds_read_b64_tr_b16 v[180:181], v9 offset:416
  ds_read_b64_tr_b16 v[182:183], v9 offset:7584
  s_waitcnt vmcnt(12)
  v_mfma_f32_16x16x32_bf16 v[16:19], v[128:131], v[200:203], v[16:19]
  v_mfma_f32_16x16x32_bf16 v[20:23], v[128:131], v[204:207], v[20:23]
  v_mfma_f32_16x16x32_bf16 v[24:27], v[132:135], v[200:203], v[24:27]
  ds_read_b64_tr_b16 v[128:129], v8 offset:14336
  v_mfma_f32_16x16x32_bf16 v[28:31], v[132:135], v[204:207], v[28:31]
  ds_read_b64_tr_b16 v[130:131], v8 offset:21504
  buffer_load_dwordx4 v[192:195], v1, s[4:7], s46 offen offset:1024 sc1
  v_mfma_f32_16x16x32_bf16 v[32:35], v[136:139], v[200:203], v[32:35]
  ds_read_b64_tr_b16 v[132:133], v9 offset:14368
  v_mfma_f32_16x16x32_bf16 v[36:39], v[136:139], v[204:207], v[36:39]
  ds_read_b64_tr_b16 v[134:135], v9 offset:21536
  s_waitcnt lgkmcnt(15)
  v_mfma_f32_16x16x32_bf16 v[40:43], v[140:143], v[200:203], v[40:43]
  ds_read_b64_tr_b16 v[136:137], v8 offset:14400
  v_mfma_f32_16x16x32_bf16 v[44:47], v[140:143], v[204:207], v[44:47]
  ds_read_b64_tr_b16 v[138:139], v8 offset:21568
  v_mfma_f32_16x16x32_bf16 v[48:51], v[144:147], v[200:203], v[48:51]
  ds_read_b64_tr_b16 v[140:141], v9 offset:14432
  v_mfma_f32_16x16x32_bf16 v[52:55], v[144:147], v[204:207], v[52:55]
  ds_read_b64_tr_b16 v[142:143], v9 offset:21600
  buffer_load_dwordx4 v[196:199], v14, s[4:7], s46 offen offset:1024 sc1
  s_add_u32 s46, s46, 2048
  v_mfma_f32_16x16x32_bf16 v[56:59], v[148:151], v[200:203], v[56:59]
  ds_read_b64_tr_b16 v[144:145], v8 offset:14464
  v_mfma_f32_16x16x32_bf16 v[60:63], v[148:151], v[204:207], v[60:63]
  ds_read_b64_tr_b16 v[146:147], v8 offset:21632
  v_mfma_f32_16x16x32_bf16 v[64:67], v[152:155], v[200:203], v[64:67]
  ds_read_b64_tr_b16 v[148:149], v9 offset:14496
  v_mfma_f32_16x16x32_bf16 v[68:71], v[152:155], v[204:207], v[68:71]
  ds_read_b64_tr_b16 v[150:151], v9 offset:21664
  v_mfma_f32_16x16x32_bf16 v[72:75], v[156:159], v[200:203], v[72:75]
  ds_read_b64_tr_b16 v[152:153], v8 offset:14528
  v_mfma_f32_16x16x32_bf16 v[76:79], v[156:159], v[204:207], v[76:79]
  ds_read_b64_tr_b16 v[154:155], v8 offset:21696
  s_waitcnt lgkmcnt(15)
  v_mfma_f32_16x16x32_bf16 v[80:83], v[160:163], v[200:203], v[80:83]
  ds_read_b64_tr_b16 v[156:157], v9 offset:14560
  v_mfma_f32_16x16x32_bf16 v[84:87], v[160:163], v[204:207], v[84:87]
  ds_read_b64_tr_b16 v[158:159], v9 offset:21728
  v_mfma_f32_16x16x32_bf16 v[88:91], v[164:167], v[200:203], v[88:91]
  ds_read_b64_tr_b16 v[160:161], v8 offset:14592
  v_mfma_f32_16x16x32_bf16 v[92:95], v[164:167], v[204:207], v[92:95]
  ds_read_b64_tr_b16 v[162:163], v8 offset:21760
  v_mfma_f32_16x16x32_bf16 v[96:99], v[168:171], v[200:203], v[96:99]
  ds_read_b64_tr_b16 v[164:165], v9 offset:14624
  v_mfma_f32_16x16x32_bf16 v[100:103], v[168:171], v[204:207], v[100:103]
  ds_read_b64_tr_b16 v[166:167], v9 offset:21792
  v_mfma_f32_16x16x32_bf16 v[104:107], v[172:175], v[200:203], v[104:107]
  ds_read_b64_tr_b16 v[168:169], v8 offset:14656
  v_mfma_f32_16x16x32_bf16 v[108:111], v[172:175], v[204:207], v[108:111]
  ds_read_b64_tr_b16 v[170:171], v8 offset:21824
  v_mfma_f32_16x16x32_bf16 v[112:115], v[176:179], v[200:203], v[112:115]
  ds_read_b64_tr_b16 v[172:173], v9 offset:14688
  v_mfma_f32_16x16x32_bf16 v[116:119], v[176:179], v[204:207], v[116:119]
  ds_read_b64_tr_b16 v[174:175], v9 offset:21856
  s_waitcnt lgkmcnt(15)
  v_mfma_f32_16x16x32_bf16 v[120:123], v[180:183], v[200:203], v[120:123]
  ds_read_b64_tr_b16 v[176:177], v8 offset:14720
  v_mfma_f32_16x16x32_bf16 v[124:127], v[180:183], v[204:207], v[124:127]
  ds_read_b64_tr_b16 v[178:179], v8 offset:21888
  ds_read_b64_tr_b16 v[180:181], v9 offset:14752
  ds_read_b64_tr_b16 v[182:183], v9 offset:21920
  s_waitcnt vmcnt(12)
  s_barrier
  v_mfma_f32_16x16x32_bf16 v[16:19], v[128:131], v[208:211], v[16:19]
  v_mfma_f32_16x16x32_bf16 v[20:23], v[128:131], v[212:215], v[20:23]
  v_mfma_f32_16x16x32_bf16 v[24:27], v[132:135], v[208:211], v[24:27]
  ds_read_b64_tr_b16 v[128:129], v8 offset:28672
  v_mfma_f32_16x16x32_bf16 v[28:31], v[132:135], v[212:215], v[28:31]
  ds_read_b64_tr_b16 v[130:131], v8 offset:35840
  buffer_load_dwordx4 v[200:203], v1, s[4:7], s46 offen offset:0 sc1
  v_mfma_f32_16x16x32_bf16 v[32:35], v[136:139], v[208:211], v[32:35]
  ds_read_b64_tr_b16 v[132:133], v9 offset:28704
  v_mfma_f32_16x16x32_bf16 v[36:39], v[136:139], v[212:215], v[36:39]
  ds_read_b64_tr_b16 v[134:135], v9 offset:35872
  v_mfma_f32_16x16x32_bf16 v[40:43], v[140:143], v[208:211], v[40:43]
  ds_read_b64_tr_b16 v[136:137], v8 offset:28736
  v_mfma_f32_16x16x32_bf16 v[44:47], v[140:143], v[212:215], v[44:47]
  ds_read_b64_tr_b16 v[138:139], v8 offset:35904
  s_waitcnt lgkmcnt(15)
  v_mfma_f32_16x16x32_bf16 v[48:51], v[144:147], v[208:211], v[48:51]
  ds_read_b64_tr_b16 v[140:141], v9 offset:28768
  v_mfma_f32_16x16x32_bf16 v[52:55], v[144:147], v[212:215], v[52:55]
  ds_read_b64_tr_b16 v[142:143], v9 offset:35936
  buffer_load_dwordx4 v[204:207], v14, s[4:7], s46 offen offset:0 sc1
  v_mfma_f32_16x16x32_bf16 v[56:59], v[148:151], v[208:211], v[56:59]
  ds_read_b64_tr_b16 v[144:145], v8 offset:28800
  v_mfma_f32_16x16x32_bf16 v[60:63], v[148:151], v[212:215], v[60:63]
  ds_read_b64_tr_b16 v[146:147], v8 offset:35968
  v_mfma_f32_16x16x32_bf16 v[64:67], v[152:155], v[208:211], v[64:67]
  ds_read_b64_tr_b16 v[148:149], v9 offset:28832
  v_mfma_f32_16x16x32_bf16 v[68:71], v[152:155], v[212:215], v[68:71]
  ds_read_b64_tr_b16 v[150:151], v9 offset:36000
  v_mfma_f32_16x16x32_bf16 v[72:75], v[156:159], v[208:211], v[72:75]
  ds_read_b64_tr_b16 v[152:153], v8 offset:28864
  v_mfma_f32_16x16x32_bf16 v[76:79], v[156:159], v[212:215], v[76:79]
  ds_read_b64_tr_b16 v[154:155], v8 offset:36032
  v_mfma_f32_16x16x32_bf16 v[80:83], v[160:163], v[208:211], v[80:83]
  ds_read_b64_tr_b16 v[156:157], v9 offset:28896
  v_mfma_f32_16x16x32_bf16 v[84:87], v[160:163], v[212:215], v[84:87]
  ds_read_b64_tr_b16 v[158:159], v9 offset:36064
  s_waitcnt lgkmcnt(15)
  v_mfma_f32_16x16x32_bf16 v[88:91], v[164:167], v[208:211], v[88:91]
  ds_read_b64_tr_b16 v[160:161], v8 offset:28928
  v_mfma_f32_16x16x32_bf16 v[92:95], v[164:167], v[212:215], v[92:95]
  ds_read_b64_tr_b16 v[162:163], v8 offset:36096
  v_mfma_f32_16x16x32_bf16 v[96:99], v[168:171], v[208:211], v[96:99]
  ds_read_b64_tr_b16 v[164:165], v9 offset:28960
  v_mfma_f32_16x16x32_bf16 v[100:103], v[168:171], v[212:215], v[100:103]
  ds_read_b64_tr_b16 v[166:167], v9 offset:36128
  v_mfma_f32_16x16x32_bf16 v[104:107], v[172:175], v[208:211], v[104:107]
  ds_read_b64_tr_b16 v[168:169], v8 offset:28992
  v_mfma_f32_16x16x32_bf16 v[108:111], v[172:175], v[212:215], v[108:111]
  ds_read_b64_tr_b16 v[170:171], v8 offset:36160
  v_mfma_f32_16x16x32_bf16 v[112:115], v[176:179], v[208:211], v[112:115]
  ds_read_b64_tr_b16 v[172:173], v9 offset:29024
  v_mfma_f32_16x16x32_bf16 v[116:119], v[176:179], v[212:215], v[116:119]
  ds_read_b64_tr_b16 v[174:175], v9 offset:36192
  v_mfma_f32_16x16x32_bf16 v[120:123], v[180:183], v[208:211], v[120:123]
  ds_read_b64_tr_b16 v[176:177], v8 offset:29056
  v_mfma_f32_16x16x32_bf16 v[124:127], v[180:183], v[212:215], v[124:127]
  ds_read_b64_tr_b16 v[178:179], v8 offset:36224
  ds_read_b64_tr_b16 v[180:181], v9 offset:29088
  ds_read_b64_tr_b16 v[182:183], v9 offset:36256
  s_waitcnt vmcnt(12)
  s_waitcnt lgkmcnt(15)
  v_mfma_f32_16x16x32_bf16 v[16:19], v[128:131], v[216:219], v[16:19]
  v_mfma_f32_16x16x32_bf16 v[20:23], v[128:131], v[220:223], v[20:23]
  v_mfma_f32_16x16x32_bf16 v[24:27], v[132:135], v[216:219], v[24:27]
  ds_read_b64_tr_b16 v[128:129], v8 offset:43008
  v_mfma_f32_16x16x32_bf16 v[28:31], v[132:135], v[220:223], v[28:31]
  ds_read_b64_tr_b16 v[130:131], v8 offset:50176
  buffer_load_dwordx4 v[208:211], v1, s[4:7], s46 offen offset:1024 sc1
  v_mfma_f32_16x16x32_bf16 v[32:35], v[136:139], v[216:219], v[32:35]
  ds_read_b64_tr_b16 v[132:133], v9 offset:43040
  v_mfma_f32_16x16x32_bf16 v[36:39], v[136:139], v[220:223], v[36:39]
  ds_read_b64_tr_b16 v[134:135], v9 offset:50208
  v_mfma_f32_16x16x32_bf16 v[40:43], v[140:143], v[216:219], v[40:43]
  ds_read_b64_tr_b16 v[136:137], v8 offset:43072
  v_mfma_f32_16x16x32_bf16 v[44:47], v[140:143], v[220:223], v[44:47]
  ds_read_b64_tr_b16 v[138:139], v8 offset:50240
  v_mfma_f32_16x16x32_bf16 v[48:51], v[144:147], v[216:219], v[48:51]
  ds_read_b64_tr_b16 v[140:141], v9 offset:43104
  v_mfma_f32_16x16x32_bf16 v[52:55], v[144:147], v[220:223], v[52:55]
  ds_read_b64_tr_b16 v[142:143], v9 offset:50272
  buffer_load_dwordx4 v[212:215], v14, s[4:7], s46 offen offset:1024 sc1
  s_add_u32 s46, s46, 2048
  v_mfma_f32_16x16x32_bf16 v[56:59], v[148:151], v[216:219], v[56:59]
  ds_read_b64_tr_b16 v[144:145], v8 offset:43136
  v_mfma_f32_16x16x32_bf16 v[60:63], v[148:151], v[220:223], v[60:63]
  ds_read_b64_tr_b16 v[146:147], v8 offset:50304
  s_waitcnt lgkmcnt(15)
  v_mfma_f32_16x16x32_bf16 v[64:67], v[152:155], v[216:219], v[64:67]
  ds_read_b64_tr_b16 v[148:149], v9 offset:43168
  v_mfma_f32_16x16x32_bf16 v[68:71], v[152:155], v[220:223], v[68:71]
  ds_read_b64_tr_b16 v[150:151], v9 offset:50336
  v_mfma_f32_16x16x32_bf16 v[72:75], v[156:159], v[216:219], v[72:75]
  ds_read_b64_tr_b16 v[152:153], v8 offset:43200
  v_mfma_f32_16x16x32_bf16 v[76:79], v[156:159], v[220:223], v[76:79]
  ds_read_b64_tr_b16 v[154:155], v8 offset:50368
  v_mfma_f32_16x16x32_bf16 v[80:83], v[160:163], v[216:219], v[80:83]
  ds_read_b64_tr_b16 v[156:157], v9 offset:43232
  v_mfma_f32_16x16x32_bf16 v[84:87], v[160:163], v[220:223], v[84:87]
  ds_read_b64_tr_b16 v[158:159], v9 offset:50400
  v_mfma_f32_16x16x32_bf16 v[88:91], v[164:167], v[216:219], v[88:91]
  ds_read_b64_tr_b16 v[160:161], v8 offset:43264
  v_mfma_f32_16x16x32_bf16 v[92:95], v[164:167], v[220:223], v[92:95]
  ds_read_b64_tr_b16 v[162:163], v8 offset:50432
  v_mfma_f32_16x16x32_bf16 v[96:99], v[168:171], v[216:219], v[96:99]
  ds_read_b64_tr_b16 v[164:165], v9 offset:43296
  v_mfma_f32_16x16x32_bf16 v[100:103], v[168:171], v[220:223], v[100:103]
  ds_read_b64_tr_b16 v[166:167], v9 offset:50464
  s_waitcnt lgkmcnt(15)
  v_mfma_f32_16x16x32_bf16 v[104:107], v[172:175], v[216:219], v[104:107]
  ds_read_b64_tr_b16 v[168:169], v8 offset:43328
  v_mfma_f32_16x16x32_bf16 v[108:111], v[172:175], v[220:223], v[108:111]
  ds_read_b64_tr_b16 v[170:171], v8 offset:50496
  v_mfma_f32_16x16x32_bf16 v[112:115], v[176:179], v[216:219], v[112:115]
  ds_read_b64_tr_b16 v[172:173], v9 offset:43360
  v_mfma_f32_16x16x32_bf16 v[116:119], v[176:179], v[220:223], v[116:119]
  ds_read_b64_tr_b16 v[174:175], v9 offset:50528
  v_mfma_f32_16x16x32_bf16 v[120:123], v[180:183], v[216:219], v[120:123]
  ds_read_b64_tr_b16 v[176:177], v8 offset:43392
  v_mfma_f32_16x16x32_bf16 v[124:127], v[180:183], v[220:223], v[124:127]
  ds_read_b64_tr_b16 v[178:179], v8 offset:50560
  ds_read_b64_tr_b16 v[180:181], v9 offset:43424
  ds_read_b64_tr_b16 v[182:183], v9 offset:50592
  s_waitcnt vmcnt(12)
  s_barrier
  v_mfma_f32_16x16x32_bf16 v[16:19], v[128:131], v[224:227], v[16:19]
  v_mfma_f32_16x16x32_bf16 v[20:23], v[128:131], v[228:231], v[20:23]
  v_mfma_f32_16x16x32_bf16 v[24:27], v[132:135], v[224:227], v[24:27]
  ds_read_b64_tr_b16 v[128:129], v10 offset:0
  v_mfma_f32_16x16x32_bf16 v[28:31], v[132:135], v[228:231], v[28:31]
  ds_read_b64_tr_b16 v[130:131], v10 offset:7168
  buffer_load_dwordx4 v[216:219], v1, s[4:7], s46 offen offset:0 sc1
  s_waitcnt lgkmcnt(15)
  v_mfma_f32_16x16x32_bf16 v[32:35], v[136:139], v[224:227], v[32:35]
  ds_read_b64_tr_b16 v[132:133], v11 offset:32
  v_mfma_f32_16x16x32_bf16 v[36:39], v[136:139], v[228:231], v[36:39]
  ds_read_b64_tr_b16 v[134:135], v11 offset:7200
  v_mfma_f32_16x16x32_bf16 v[40:43], v[140:143], v[224:227], v[40:43]
  ds_read_b64_tr_b16 v[136:137], v10 offset:64
  v_mfma_f32_16x16x32_bf16 v[44:47], v[140:143], v[228:231], v[44:47]
  ds_read_b64_tr_b16 v[138:139], v10 offset:7232
  v_mfma_f32_16x16x32_bf16 v[48:51], v[144:147], v[224:227], v[48:51]
  ds_read_b64_tr_b16 v[140:141], v11 offset:96
  v_mfma_f32_16x16x32_bf16 v[52:55], v[144:147], v[228:231], v[52:55]
  ds_read_b64_tr_b16 v[142:143], v11 offset:7264
  buffer_load_dwordx4 v[220:223], v14, s[4:7], s46 offen offset:0 sc1
  v_mfma_f32_16x16x32_bf16 v[56:59], v[148:151], v[224:227], v[56:59]
  ds_read_b64_tr_b16 v[144:145], v10 offset:128
  v_mfma_f32_16x16x32_bf16 v[60:63], v[148:151], v[228:231], v[60:63]
  ds_read_b64_tr_b16 v[146:147], v10 offset:7296
  v_mfma_f32_16x16x32_bf16 v[64:67], v[152:155], v[224:227], v[64:67]
  ds_read_b64_tr_b16 v[148:149], v11 offset:160
  v_mfma_f32_16x16x32_bf16 v[68:71], v[152:155], v[228:231], v[68:71]
  ds_read_b64_tr_b16 v[150:151], v11 offset:7328
  s_waitcnt lgkmcnt(15)
  v_mfma_f32_16x16x32_bf16 v[72:75], v[156:159], v[224:227], v[72:75]
  ds_read_b64_tr_b16 v[152:153], v10 offset:192
  v_mfma_f32_16x16x32_bf16 v[76:79], v[156:159], v[228:231], v[76:79]
  ds_read_b64_tr_b16 v[154:155], v10 offset:7360
  v_mfma_f32_16x16x32_bf16 v[80:83], v[160:163], v[224:227], v[80:83]
  ds_read_b64_tr_b16 v[156:157], v11 offset:224
  v_mfma_f32_16x16x32_bf16 v[84:87], v[160:163], v[228:231], v[84:87]
  ds_read_b64_tr_b16 v[158:159], v11 offset:7392
  v_mfma_f32_16x16x32_bf16 v[88:91], v[164:167], v[224:227], v[88:91]
  ds_read_b64_tr_b16 v[160:161], v10 offset:256
  v_mfma_f32_16x16x32_bf16 v[92:95], v[164:167], v[228:231], v[92:95]
  ds_read_b64_tr_b16 v[162:163], v10 offset:7424
  v_mfma_f32_16x16x32_bf16 v[96:99], v[168:171], v[224:227], v[96:99]
  ds_read_b64_tr_b16 v[164:165], v11 offset:288
  v_mfma_f32_16x16x32_bf16 v[100:103], v[168:171], v[228:231], v[100:103]
  ds_read_b64_tr_b16 v[166:167], v11 offset:7456
  v_mfma_f32_16x16x32_bf16 v[104:107], v[172:175], v[224:227], v[104:107]
  ds_read_b64_tr_b16 v[168:169], v10 offset:320
  v_mfma_f32_16x16x32_bf16 v[108:111], v[172:175], v[228:231], v[108:111]
  ds_read_b64_tr_b16 v[170:171], v10 offset:7488
  s_waitcnt lgkmcnt(15)
  v_mfma_f32_16x16x32_bf16 v[112:115], v[176:179], v[224:227], v[112:115]
  ds_read_b64_tr_b16 v[172:173], v11 offset:352
  v_mfma_f32_16x16x32_bf16 v[116:119], v[176:179], v[228:231], v[116:119]
  ds_read_b64_tr_b16 v[174:175], v11 offset:7520
  v_mfma_f32_16x16x32_bf16 v[120:123], v[180:183], v[224:227], v[120:123]
  ds_read_b64_tr_b16 v[176:177], v10 offset:384
  v_mfma_f32_16x16x32_bf16 v[124:127], v[180:183], v[228:231], v[124:127]
  ds_read_b64_tr_b16 v[178:179], v10 offset:7552
  ds_read_b64_tr_b16 v[180:181], v11 offset:416
  ds_read_b64_tr_b16 v[182:183], v11 offset:7584
  s_waitcnt vmcnt(12)
  v_mfma_f32_16x16x32_bf16 v[16:19], v[128:131], v[232:235], v[16:19]
  v_mfma_f32_16x16x32_bf16 v[20:23], v[128:131], v[236:239], v[20:23]
  v_mfma_f32_16x16x32_bf16 v[24:27], v[132:135], v[232:235], v[24:27]
  ds_read_b64_tr_b16 v[128:129], v10 offset:14336
  v_mfma_f32_16x16x32_bf16 v[28:31], v[132:135], v[236:239], v[28:31]
  ds_read_b64_tr_b16 v[130:131], v10 offset:21504
  buffer_load_dwordx4 v[224:227], v1, s[4:7], s46 offen offset:1024 sc1
  v_mfma_f32_16x16x32_bf16 v[32:35], v[136:139], v[232:235], v[32:35]
  ds_read_b64_tr_b16 v[132:133], v11 offset:14368
  v_mfma_f32_16x16x32_bf16 v[36:39], v[136:139], v[236:239], v[36:39]
  ds_read_b64_tr_b16 v[134:135], v11 offset:21536
  s_waitcnt lgkmcnt(15)
  v_mfma_f32_16x16x32_bf16 v[40:43], v[140:143], v[232:235], v[40:43]
  ds_read_b64_tr_b16 v[136:137], v10 offset:14400
  v_mfma_f32_16x16x32_bf16 v[44:47], v[140:143], v[236:239], v[44:47]
  ds_read_b64_tr_b16 v[138:139], v10 offset:21568
  v_mfma_f32_16x16x32_bf16 v[48:51], v[144:147], v[232:235], v[48:51]
  ds_read_b64_tr_b16 v[140:141], v11 offset:14432
  v_mfma_f32_16x16x32_bf16 v[52:55], v[144:147], v[236:239], v[52:55]
  ds_read_b64_tr_b16 v[142:143], v11 offset:21600
  buffer_load_dwordx4 v[228:231], v14, s[4:7], s46 offen offset:1024 sc1
  s_add_u32 s46, s46, 2048
  v_mfma_f32_16x16x32_bf16 v[56:59], v[148:151], v[232:235], v[56:59]
  ds_read_b64_tr_b16 v[144:145], v10 offset:14464
  v_mfma_f32_16x16x32_bf16 v[60:63], v[148:151], v[236:239], v[60:63]
  ds_read_b64_tr_b16 v[146:147], v10 offset:21632
  v_mfma_f32_16x16x32_bf16 v[64:67], v[152:155], v[232:235], v[64:67]
  ds_read_b64_tr_b16 v[148:149], v11 offset:14496
  v_mfma_f32_16x16x32_bf16 v[68:71], v[152:155], v[236:239], v[68:71]
  ds_read_b64_tr_b16 v[150:151], v11 offset:21664
  v_mfma_f32_16x16x32_bf16 v[72:75], v[156:159], v[232:235], v[72:75]
  ds_read_b64_tr_b16 v[152:153], v10 offset:14528
  v_mfma_f32_16x16x32_bf16 v[76:79], v[156:159], v[236:239], v[76:79]
  ds_read_b64_tr_b16 v[154:155], v10 offset:21696
  s_waitcnt lgkmcnt(15)
  v_mfma_f32_16x16x32_bf16 v[80:83], v[160:163], v[232:235], v[80:83]
  ds_read_b64_tr_b16 v[156:157], v11 offset:14560
  v_mfma_f32_16x16x32_bf16 v[84:87], v[160:163], v[236:239], v[84:87]
  ds_read_b64_tr_b16 v[158:159], v11 offset:21728
  v_mfma_f32_16x16x32_bf16 v[88:91], v[164:167], v[232:235], v[88:91]
  ds_read_b64_tr_b16 v[160:161], v10 offset:14592
  v_mfma_f32_16x16x32_bf16 v[92:95], v[164:167], v[236:239], v[92:95]
  ds_read_b64_tr_b16 v[162:163], v10 offset:21760
  v_mfma_f32_16x16x32_bf16 v[96:99], v[168:171], v[232:235], v[96:99]
  ds_read_b64_tr_b16 v[164:165], v11 offset:14624
  v_mfma_f32_16x16x32_bf16 v[100:103], v[168:171], v[236:239], v[100:103]
  ds_read_b64_tr_b16 v[166:167], v11 offset:21792
  v_mfma_f32_16x16x32_bf16 v[104:107], v[172:175], v[232:235], v[104:107]
  ds_read_b64_tr_b16 v[168:169], v10 offset:14656
  v_mfma_f32_16x16x32_bf16 v[108:111], v[172:175], v[236:239], v[108:111]
  ds_read_b64_tr_b16 v[170:171], v10 offset:21824
  v_mfma_f32_16x16x32_bf16 v[112:115], v[176:179], v[232:235], v[112:115]
  ds_read_b64_tr_b16 v[172:173], v11 offset:14688
  v_mfma_f32_16x16x32_bf16 v[116:119], v[176:179], v[236:239], v[116:119]
  ds_read_b64_tr_b16 v[174:175], v11 offset:21856
  s_waitcnt lgkmcnt(15)
  v_mfma_f32_16x16x32_bf16 v[120:123], v[180:183], v[232:235], v[120:123]
  ds_read_b64_tr_b16 v[176:177], v10 offset:14720
  v_mfma_f32_16x16x32_bf16 v[124:127], v[180:183], v[236:239], v[124:127]
  ds_read_b64_tr_b16 v[178:179], v10 offset:21888
  ds_read_b64_tr_b16 v[180:181], v11 offset:14752
  ds_read_b64_tr_b16 v[182:183], v11 offset:21920
  s_waitcnt vmcnt(12)
  s_barrier
  v_mfma_f32_16x16x32_bf16 v[16:19], v[128:131], v[240:243], v[16:19]
  v_mfma_f32_16x16x32_bf16 v[20:23], v[128:131], v[244:247], v[20:23]
  v_mfma_f32_16x16x32_bf16 v[24:27], v[132:135], v[240:243], v[24:27]
  ds_read_b64_tr_b16 v[128:129], v10 offset:28672
  v_mfma_f32_16x16x32_bf16 v[28:31], v[132:135], v[244:247], v[28:31]
  ds_read_b64_tr_b16 v[130:131], v10 offset:35840
  buffer_load_dwordx4 v[232:235], v1, s[4:7], s46 offen offset:0 sc1
  v_mfma_f32_16x16x32_bf16 v[32:35], v[136:139], v[240:243], v[32:35]
  ds_read_b64_tr_b16 v[132:133], v11 offset:28704
  v_mfma_f32_16x16x32_bf16 v[36:39], v[136:139], v[244:247], v[36:39]
  ds_read_b64_tr_b16 v[134:135], v11 offset:35872
  v_mfma_f32_16x16x32_bf16 v[40:43], v[140:143], v[240:243], v[40:43]
  ds_read_b64_tr_b16 v[136:137], v10 offset:28736
  v_mfma_f32_16x16x32_bf16 v[44:47], v[140:143], v[244:247], v[44:47]
  ds_read_b64_tr_b16 v[138:139], v10 offset:35904
  s_waitcnt lgkmcnt(15)
  v_mfma_f32_16x16x32_bf16 v[48:51], v[144:147], v[240:243], v[48:51]
  ds_read_b64_tr_b16 v[140:141], v11 offset:28768
  v_mfma_f32_16x16x32_bf16 v[52:55], v[144:147], v[244:247], v[52:55]
  ds_read_b64_tr_b16 v[142:143], v11 offset:35936
  buffer_load_dwordx4 v[236:239], v14, s[4:7], s46 offen offset:0 sc1
  v_mfma_f32_16x16x32_bf16 v[56:59], v[148:151], v[240:243], v[56:59]
  ds_read_b64_tr_b16 v[144:145], v10 offset:28800
  v_mfma_f32_16x16x32_bf16 v[60:63], v[148:151], v[244:247], v[60:63]
  ds_read_b64_tr_b16 v[146:147], v10 offset:35968
  v_mfma_f32_16x16x32_bf16 v[64:67], v[152:155], v[240:243], v[64:67]
  ds_read_b64_tr_b16 v[148:149], v11 offset:28832
  v_mfma_f32_16x16x32_bf16 v[68:71], v[152:155], v[244:247], v[68:71]
  ds_read_b64_tr_b16 v[150:151], v11 offset:36000
  v_mfma_f32_16x16x32_bf16 v[72:75], v[156:159], v[240:243], v[72:75]
  ds_read_b64_tr_b16 v[152:153], v10 offset:28864
  v_mfma_f32_16x16x32_bf16 v[76:79], v[156:159], v[244:247], v[76:79]
  ds_read_b64_tr_b16 v[154:155], v10 offset:36032
  v_mfma_f32_16x16x32_bf16 v[80:83], v[160:163], v[240:243], v[80:83]
  ds_read_b64_tr_b16 v[156:157], v11 offset:28896
  v_mfma_f32_16x16x32_bf16 v[84:87], v[160:163], v[244:247], v[84:87]
  ds_read_b64_tr_b16 v[158:159], v11 offset:36064
  s_waitcnt lgkmcnt(15)
  v_mfma_f32_16x16x32_bf16 v[88:91], v[164:167], v[240:243], v[88:91]
  ds_read_b64_tr_b16 v[160:161], v10 offset:28928
  v_mfma_f32_16x16x32_bf16 v[92:95], v[164:167], v[244:247], v[92:95]
  ds_read_b64_tr_b16 v[162:163], v10 offset:36096
  v_mfma_f32_16x16x32_bf16 v[96:99], v[168:171], v[240:243], v[96:99]
  ds_read_b64_tr_b16 v[164:165], v11 offset:28960
  v_mfma_f32_16x16x32_bf16 v[100:103], v[168:171], v[244:247], v[100:103]
  ds_read_b64_tr_b16 v[166:167], v11 offset:36128
  v_mfma_f32_16x16x32_bf16 v[104:107], v[172:175], v[240:243], v[104:107]
  ds_read_b64_tr_b16 v[168:169], v10 offset:28992
  v_mfma_f32_16x16x32_bf16 v[108:111], v[172:175], v[244:247], v[108:111]
  ds_read_b64_tr_b16 v[170:171], v10 offset:36160
  v_mfma_f32_16x16x32_bf16 v[112:115], v[176:179], v[240:243], v[112:115]
  ds_read_b64_tr_b16 v[172:173], v11 offset:29024
  v_mfma_f32_16x16x32_bf16 v[116:119], v[176:179], v[244:247], v[116:119]
  ds_read_b64_tr_b16 v[174:175], v11 offset:36192
  v_mfma_f32_16x16x32_bf16 v[120:123], v[180:183], v[240:243], v[120:123]
  ds_read_b64_tr_b16 v[176:177], v10 offset:29056
  v_mfma_f32_16x16x32_bf16 v[124:127], v[180:183], v[244:247], v[124:127]
  ds_read_b64_tr_b16 v[178:179], v10 offset:36224
  ds_read_b64_tr_b16 v[180:181], v11 offset:29088
  ds_read_b64_tr_b16 v[182:183], v11 offset:36256
  s_waitcnt vmcnt(12)
  s_waitcnt lgkmcnt(15)
  v_mfma_f32_16x16x32_bf16 v[16:19], v[128:131], v[184:187], v[16:19]
  v_mfma_f32_16x16x32_bf16 v[20:23], v[128:131], v[188:191], v[20:23]
  v_mfma_f32_16x16x32_bf16 v[24:27], v[132:135], v[184:187], v[24:27]
  ds_read_b64_tr_b16 v[128:129], v10 offset:43008
  v_mfma_f32_16x16x32_bf16 v[28:31], v[132:135], v[188:191], v[28:31]
  ds_read_b64_tr_b16 v[130:131], v10 offset:50176
  buffer_load_dwordx4 v[240:243], v1, s[4:7], s46 offen offset:1024 sc1
  v_mfma_f32_16x16x32_bf16 v[32:35], v[136:139], v[184:187], v[32:35]
  ds_read_b64_tr_b16 v[132:133], v11 offset:43040
  v_mfma_f32_16x16x32_bf16 v[36:39], v[136:139], v[188:191], v[36:39]
  ds_read_b64_tr_b16 v[134:135], v11 offset:50208
  v_mfma_f32_16x16x32_bf16 v[40:43], v[140:143], v[184:187], v[40:43]
  ds_read_b64_tr_b16 v[136:137], v10 offset:43072
  v_mfma_f32_16x16x32_bf16 v[44:47], v[140:143], v[188:191], v[44:47]
  ds_read_b64_tr_b16 v[138:139], v10 offset:50240
  v_mfma_f32_16x16x32_bf16 v[48:51], v[144:147], v[184:187], v[48:51]
  ds_read_b64_tr_b16 v[140:141], v11 offset:43104
  v_mfma_f32_16x16x32_bf16 v[52:55], v[144:147], v[188:191], v[52:55]
  ds_read_b64_tr_b16 v[142:143], v11 offset:50272
  buffer_load_dwordx4 v[244:247], v14, s[4:7], s46 offen offset:1024 sc1
  s_add_u32 s46, s46, 2048
  v_mfma_f32_16x16x32_bf16 v[56:59], v[148:151], v[184:187], v[56:59]
  ds_read_b64_tr_b16 v[144:145], v10 offset:43136
  v_mfma_f32_16x16x32_bf16 v[60:63], v[148:151], v[188:191], v[60:63]
  ds_read_b64_tr_b16 v[146:147], v10 offset:50304
  s_waitcnt lgkmcnt(15)
  v_mfma_f32_16x16x32_bf16 v[64:67], v[152:155], v[184:187], v[64:67]
  ds_read_b64_tr_b16 v[148:149], v11 offset:43168
  v_mfma_f32_16x16x32_bf16 v[68:71], v[152:155], v[188:191], v[68:71]
  ds_read_b64_tr_b16 v[150:151], v11 offset:50336
  v_mfma_f32_16x16x32_bf16 v[72:75], v[156:159], v[184:187], v[72:75]
  ds_read_b64_tr_b16 v[152:153], v10 offset:43200
  v_mfma_f32_16x16x32_bf16 v[76:79], v[156:159], v[188:191], v[76:79]
  ds_read_b64_tr_b16 v[154:155], v10 offset:50368
  v_mfma_f32_16x16x32_bf16 v[80:83], v[160:163], v[184:187], v[80:83]
  ds_read_b64_tr_b16 v[156:157], v11 offset:43232
  v_mfma_f32_16x16x32_bf16 v[84:87], v[160:163], v[188:191], v[84:87]
  ds_read_b64_tr_b16 v[158:159], v11 offset:50400
  v_mfma_f32_16x16x32_bf16 v[88:91], v[164:167], v[184:187], v[88:91]
  ds_read_b64_tr_b16 v[160:161], v10 offset:43264
  v_mfma_f32_16x16x32_bf16 v[92:95], v[164:167], v[188:191], v[92:95]
  ds_read_b64_tr_b16 v[162:163], v10 offset:50432
  v_mfma_f32_16x16x32_bf16 v[96:99], v[168:171], v[184:187], v[96:99]
  ds_read_b64_tr_b16 v[164:165], v11 offset:43296
  v_mfma_f32_16x16x32_bf16 v[100:103], v[168:171], v[188:191], v[100:103]
  ds_read_b64_tr_b16 v[166:167], v11 offset:50464
  s_waitcnt lgkmcnt(15)
  v_mfma_f32_16x16x32_bf16 v[104:107], v[172:175], v[184:187], v[104:107]
  ds_read_b64_tr_b16 v[168:169], v10 offset:43328
  v_mfma_f32_16x16x32_bf16 v[108:111], v[172:175], v[188:191], v[108:111]
  ds_read_b64_tr_b16 v[170:171], v10 offset:50496
  v_mfma_f32_16x16x32_bf16 v[112:115], v[176:179], v[184:187], v[112:115]
  ds_read_b64_tr_b16 v[172:173], v11 offset:43360
  v_mfma_f32_16x16x32_bf16 v[116:119], v[176:179], v[188:191], v[116:119]
  ds_read_b64_tr_b16 v[174:175], v11 offset:50528
  v_mfma_f32_16x16x32_bf16 v[120:123], v[180:183], v[184:187], v[120:123]
  ds_read_b64_tr_b16 v[176:177], v10 offset:43392
  v_mfma_f32_16x16x32_bf16 v[124:127], v[180:183], v[188:191], v[124:127]
  ds_read_b64_tr_b16 v[178:179], v10 offset:50560
  ds_read_b64_tr_b16 v[180:181], v11 offset:43424
  ds_read_b64_tr_b16 v[182:183], v11 offset:50592
  s_waitcnt vmcnt(12)
  s_barrier
  v_mfma_f32_16x16x32_bf16 v[16:19], v[128:131], v[192:195], v[16:19]
  v_mfma_f32_16x16x32_bf16 v[20:23], v[128:131], v[196:199], v[20:23]
  v_mfma_f32_16x16x32_bf16 v[24:27], v[132:135], v[192:195], v[24:27]
  ds_read_b64_tr_b16 v[128:129], v12 offset:0
  v_mfma_f32_16x16x32_bf16 v[28:31], v[132:135], v[196:199], v[28:31]
  ds_read_b64_tr_b16 v[130:131], v12 offset:7168
  buffer_load_dwordx4 v[184:187], v1, s[4:7], s46 offen offset:0 sc1
  s_waitcnt lgkmcnt(15)
  v_mfma_f32_16x16x32_bf16 v[32:35], v[136:139], v[192:195], v[32:35]
  ds_read_b64_tr_b16 v[132:133], v13 offset:32
  v_mfma_f32_16x16x32_bf16 v[36:39], v[136:139], v[196:199], v[36:39]
  ds_read_b64_tr_b16 v[134:135], v13 offset:7200
  v_mfma_f32_16x16x32_bf16 v[40:43], v[140:143], v[192:195], v[40:43]
  ds_read_b64_tr_b16 v[136:137], v12 offset:64
  v_mfma_f32_16x16x32_bf16 v[44:47], v[140:143], v[196:199], v[44:47]
  ds_read_b64_tr_b16 v[138:139], v12 offset:7232
  v_mfma_f32_16x16x32_bf16 v[48:51], v[144:147], v[192:195], v[48:51]
  ds_read_b64_tr_b16 v[140:141], v13 offset:96
  v_mfma_f32_16x16x32_bf16 v[52:55], v[144:147], v[196:199], v[52:55]
  ds_read_b64_tr_b16 v[142:143], v13 offset:7264
  buffer_load_dwordx4 v[188:191], v14, s[4:7], s46 offen offset:0 sc1
  v_mfma_f32_16x16x32_bf16 v[56:59], v[148:151], v[192:195], v[56:59]
  ds_read_b64_tr_b16 v[144:145], v12 offset:128
  v_mfma_f32_16x16x32_bf16 v[60:63], v[148:151], v[196:199], v[60:63]
  ds_read_b64_tr_b16 v[146:147], v12 offset:7296
  v_mfma_f32_16x16x32_bf16 v[64:67], v[152:155], v[192:195], v[64:67]
  ds_read_b64_tr_b16 v[148:149], v13 offset:160
  v_mfma_f32_16x16x32_bf16 v[68:71], v[152:155], v[196:199], v[68:71]
  ds_read_b64_tr_b16 v[150:151], v13 offset:7328
  s_waitcnt lgkmcnt(15)
  v_mfma_f32_16x16x32_bf16 v[72:75], v[156:159], v[192:195], v[72:75]
  ds_read_b64_tr_b16 v[152:153], v12 offset:192
  v_mfma_f32_16x16x32_bf16 v[76:79], v[156:159], v[196:199], v[76:79]
  ds_read_b64_tr_b16 v[154:155], v12 offset:7360
  v_mfma_f32_16x16x32_bf16 v[80:83], v[160:163], v[192:195], v[80:83]
  ds_read_b64_tr_b16 v[156:157], v13 offset:224
  v_mfma_f32_16x16x32_bf16 v[84:87], v[160:163], v[196:199], v[84:87]
  ds_read_b64_tr_b16 v[158:159], v13 offset:7392
  v_mfma_f32_16x16x32_bf16 v[88:91], v[164:167], v[192:195], v[88:91]
  ds_read_b64_tr_b16 v[160:161], v12 offset:256
  v_mfma_f32_16x16x32_bf16 v[92:95], v[164:167], v[196:199], v[92:95]
  ds_read_b64_tr_b16 v[162:163], v12 offset:7424
  v_mfma_f32_16x16x32_bf16 v[96:99], v[168:171], v[192:195], v[96:99]
  ds_read_b64_tr_b16 v[164:165], v13 offset:288
  v_mfma_f32_16x16x32_bf16 v[100:103], v[168:171], v[196:199], v[100:103]
  ds_read_b64_tr_b16 v[166:167], v13 offset:7456
  v_mfma_f32_16x16x32_bf16 v[104:107], v[172:175], v[192:195], v[104:107]
  ds_read_b64_tr_b16 v[168:169], v12 offset:320
  v_mfma_f32_16x16x32_bf16 v[108:111], v[172:175], v[196:199], v[108:111]
  ds_read_b64_tr_b16 v[170:171], v12 offset:7488
  s_waitcnt lgkmcnt(15)
  v_mfma_f32_16x16x32_bf16 v[112:115], v[176:179], v[192:195], v[112:115]
  ds_read_b64_tr_b16 v[172:173], v13 offset:352
  v_mfma_f32_16x16x32_bf16 v[116:119], v[176:179], v[196:199], v[116:119]
  ds_read_b64_tr_b16 v[174:175], v13 offset:7520
  v_mfma_f32_16x16x32_bf16 v[120:123], v[180:183], v[192:195], v[120:123]
  ds_read_b64_tr_b16 v[176:177], v12 offset:384
  v_mfma_f32_16x16x32_bf16 v[124:127], v[180:183], v[196:199], v[124:127]
  ds_read_b64_tr_b16 v[178:179], v12 offset:7552
  ds_read_b64_tr_b16 v[180:181], v13 offset:416
  ds_read_b64_tr_b16 v[182:183], v13 offset:7584
  s_waitcnt vmcnt(12)
  v_mfma_f32_16x16x32_bf16 v[16:19], v[128:131], v[200:203], v[16:19]
  v_mfma_f32_16x16x32_bf16 v[20:23], v[128:131], v[204:207], v[20:23]
  v_mfma_f32_16x16x32_bf16 v[24:27], v[132:135], v[200:203], v[24:27]
  ds_read_b64_tr_b16 v[128:129], v12 offset:14336
  v_mfma_f32_16x16x32_bf16 v[28:31], v[132:135], v[204:207], v[28:31]
  ds_read_b64_tr_b16 v[130:131], v12 offset:21504
  buffer_load_dwordx4 v[192:195], v1, s[4:7], s46 offen offset:1024 sc1
  v_mfma_f32_16x16x32_bf16 v[32:35], v[136:139], v[200:203], v[32:35]
  ds_read_b64_tr_b16 v[132:133], v13 offset:14368
  v_mfma_f32_16x16x32_bf16 v[36:39], v[136:139], v[204:207], v[36:39]
  ds_read_b64_tr_b16 v[134:135], v13 offset:21536
  s_waitcnt lgkmcnt(15)
  v_mfma_f32_16x16x32_bf16 v[40:43], v[140:143], v[200:203], v[40:43]
  ds_read_b64_tr_b16 v[136:137], v12 offset:14400
  v_mfma_f32_16x16x32_bf16 v[44:47], v[140:143], v[204:207], v[44:47]
  ds_read_b64_tr_b16 v[138:139], v12 offset:21568
  v_mfma_f32_16x16x32_bf16 v[48:51], v[144:147], v[200:203], v[48:51]
  ds_read_b64_tr_b16 v[140:141], v13 offset:14432
  v_mfma_f32_16x16x32_bf16 v[52:55], v[144:147], v[204:207], v[52:55]
  ds_read_b64_tr_b16 v[142:143], v13 offset:21600
  buffer_load_dwordx4 v[196:199], v14, s[4:7], s46 offen offset:1024 sc1
  s_add_u32 s46, s46, 2048
  v_mfma_f32_16x16x32_bf16 v[56:59], v[148:151], v[200:203], v[56:59]
  ds_read_b64_tr_b16 v[144:145], v12 offset:14464
  v_mfma_f32_16x16x32_bf16 v[60:63], v[148:151], v[204:207], v[60:63]
  ds_read_b64_tr_b16 v[146:147], v12 offset:21632
  v_mfma_f32_16x16x32_bf16 v[64:67], v[152:155], v[200:203], v[64:67]
  ds_read_b64_tr_b16 v[148:149], v13 offset:14496
  v_mfma_f32_16x16x32_bf16 v[68:71], v[152:155], v[204:207], v[68:71]
  ds_read_b64_tr_b16 v[150:151], v13 offset:21664
  v_mfma_f32_16x16x32_bf16 v[72:75], v[156:159], v[200:203], v[72:75]
  ds_read_b64_tr_b16 v[152:153], v12 offset:14528
  v_mfma_f32_16x16x32_bf16 v[76:79], v[156:159], v[204:207], v[76:79]
  ds_read_b64_tr_b16 v[154:155], v12 offset:21696
  s_waitcnt lgkmcnt(15)
  v_mfma_f32_16x16x32_bf16 v[80:83], v[160:163], v[200:203], v[80:83]
  ds_read_b64_tr_b16 v[156:157], v13 offset:14560
  v_mfma_f32_16x16x32_bf16 v[84:87], v[160:163], v[204:207], v[84:87]
  ds_read_b64_tr_b16 v[158:159], v13 offset:21728
  v_mfma_f32_16x16x32_bf16 v[88:91], v[164:167], v[200:203], v[88:91]
  ds_read_b64_tr_b16 v[160:161], v12 offset:14592
  v_mfma_f32_16x16x32_bf16 v[92:95], v[164:167], v[204:207], v[92:95]
  ds_read_b64_tr_b16 v[162:163], v12 offset:21760
  v_mfma_f32_16x16x32_bf16 v[96:99], v[168:171], v[200:203], v[96:99]
  ds_read_b64_tr_b16 v[164:165], v13 offset:14624
  v_mfma_f32_16x16x32_bf16 v[100:103], v[168:171], v[204:207], v[100:103]
  ds_read_b64_tr_b16 v[166:167], v13 offset:21792
  v_mfma_f32_16x16x32_bf16 v[104:107], v[172:175], v[200:203], v[104:107]
  ds_read_b64_tr_b16 v[168:169], v12 offset:14656
  v_mfma_f32_16x16x32_bf16 v[108:111], v[172:175], v[204:207], v[108:111]
  ds_read_b64_tr_b16 v[170:171], v12 offset:21824
  v_mfma_f32_16x16x32_bf16 v[112:115], v[176:179], v[200:203], v[112:115]
  ds_read_b64_tr_b16 v[172:173], v13 offset:14688
  v_mfma_f32_16x16x32_bf16 v[116:119], v[176:179], v[204:207], v[116:119]
  ds_read_b64_tr_b16 v[174:175], v13 offset:21856
  s_waitcnt lgkmcnt(15)
  v_mfma_f32_16x16x32_bf16 v[120:123], v[180:183], v[200:203], v[120:123]
  ds_read_b64_tr_b16 v[176:177], v12 offset:14720
  v_mfma_f32_16x16x32_bf16 v[124:127], v[180:183], v[204:207], v[124:127]
  ds_read_b64_tr_b16 v[178:179], v12 offset:21888
  ds_read_b64_tr_b16 v[180:181], v13 offset:14752
  ds_read_b64_tr_b16 v[182:183], v13 offset:21920
  s_waitcnt vmcnt(12)
  s_barrier
  v_mfma_f32_16x16x32_bf16 v[16:19], v[128:131], v[208:211], v[16:19]
  v_mfma_f32_16x16x32_bf16 v[20:23], v[128:131], v[212:215], v[20:23]
  v_mfma_f32_16x16x32_bf16 v[24:27], v[132:135], v[208:211], v[24:27]
  ds_read_b64_tr_b16 v[128:129], v8 offset:0
  v_mfma_f32_16x16x32_bf16 v[28:31], v[132:135], v[212:215], v[28:31]
  ds_read_b64_tr_b16 v[130:131], v8 offset:7168
  buffer_load_dwordx4 v[200:203], v1, s[4:7], s46 offen offset:0 sc1
  v_mfma_f32_16x16x32_bf16 v[32:35], v[136:139], v[208:211], v[32:35]
  ds_read_b64_tr_b16 v[132:133], v9 offset:32
  v_mfma_f32_16x16x32_bf16 v[36:39], v[136:139], v[212:215], v[36:39]
  ds_read_b64_tr_b16 v[134:135], v9 offset:7200
  v_mfma_f32_16x16x32_bf16 v[40:43], v[140:143], v[208:211], v[40:43]
  ds_read_b64_tr_b16 v[136:137], v8 offset:64
  v_mfma_f32_16x16x32_bf16 v[44:47], v[140:143], v[212:215], v[44:47]
  ds_read_b64_tr_b16 v[138:139], v8 offset:7232
  s_waitcnt lgkmcnt(15)
  v_mfma_f32_16x16x32_bf16 v[48:51], v[144:147], v[208:211], v[48:51]
  ds_read_b64_tr_b16 v[140:141], v9 offset:96
  v_mfma_f32_16x16x32_bf16 v[52:55], v[144:147], v[212:215], v[52:55]
  ds_read_b64_tr_b16 v[142:143], v9 offset:7264
  buffer_load_dwordx4 v[204:207], v14, s[4:7], s46 offen offset:0 sc1
  v_mfma_f32_16x16x32_bf16 v[56:59], v[148:151], v[208:211], v[56:59]
  ds_read_b64_tr_b16 v[144:145], v8 offset:128
  v_mfma_f32_16x16x32_bf16 v[60:63], v[148:151], v[212:215], v[60:63]
  ds_read_b64_tr_b16 v[146:147], v8 offset:7296
  v_mfma_f32_16x16x32_bf16 v[64:67], v[152:155], v[208:211], v[64:67]
  ds_read_b64_tr_b16 v[148:149], v9 offset:160
  v_mfma_f32_16x16x32_bf16 v[68:71], v[152:155], v[212:215], v[68:71]
  ds_read_b64_tr_b16 v[150:151], v9 offset:7328
  v_mfma_f32_16x16x32_bf16 v[72:75], v[156:159], v[208:211], v[72:75]
  ds_read_b64_tr_b16 v[152:153], v8 offset:192
  v_mfma_f32_16x16x32_bf16 v[76:79], v[156:159], v[212:215], v[76:79]
  ds_read_b64_tr_b16 v[154:155], v8 offset:7360
  v_mfma_f32_16x16x32_bf16 v[80:83], v[160:163], v[208:211], v[80:83]
  ds_read_b64_tr_b16 v[156:157], v9 offset:224
  v_mfma_f32_16x16x32_bf16 v[84:87], v[160:163], v[212:215], v[84:87]
  ds_read_b64_tr_b16 v[158:159], v9 offset:7392
  s_waitcnt lgkmcnt(15)
  v_mfma_f32_16x16x32_bf16 v[88:91], v[164:167], v[208:211], v[88:91]
  ds_read_b64_tr_b16 v[160:161], v8 offset:256
  v_mfma_f32_16x16x32_bf16 v[92:95], v[164:167], v[212:215], v[92:95]
  ds_read_b64_tr_b16 v[162:163], v8 offset:7424
  v_mfma_f32_16x16x32_bf16 v[96:99], v[168:171], v[208:211], v[96:99]
  ds_read_b64_tr_b16 v[164:165], v9 offset:288
  v_mfma_f32_16x16x32_bf16 v[100:103], v[168:171], v[212:215], v[100:103]
  ds_read_b64_tr_b16 v[166:167], v9 offset:7456
  v_mfma_f32_16x16x32_bf16 v[104:107], v[172:175], v[208:211], v[104:107]
  ds_read_b64_tr_b16 v[168:169], v8 offset:320
  v_mfma_f32_16x16x32_bf16 v[108:111], v[172:175], v[212:215], v[108:111]
  ds_read_b64_tr_b16 v[170:171], v8 offset:7488
  v_mfma_f32_16x16x32_bf16 v[112:115], v[176:179], v[208:211], v[112:115]
  ds_read_b64_tr_b16 v[172:173], v9 offset:352
  v_mfma_f32_16x16x32_bf16 v[116:119], v[176:179], v[212:215], v[116:119]
  ds_read_b64_tr_b16 v[174:175], v9 offset:7520
  v_mfma_f32_16x16x32_bf16 v[120:123], v[180:183], v[208:211], v[120:123]
  ds_read_b64_tr_b16 v[176:177], v8 offset:384
  v_mfma_f32_16x16x32_bf16 v[124:127], v[180:183], v[212:215], v[124:127]
  ds_read_b64_tr_b16 v[178:179], v8 offset:7552
  ds_read_b64_tr_b16 v[180:181], v9 offset:416
  ds_read_b64_tr_b16 v[182:183], v9 offset:7584
  s_waitcnt vmcnt(12)
  s_waitcnt lgkmcnt(15)
  v_mfma_f32_16x16x32_bf16 v[16:19], v[128:131], v[216:219], v[16:19]
  v_mfma_f32_16x16x32_bf16 v[20:23], v[128:131], v[220:223], v[20:23]
  v_mfma_f32_16x16x32_bf16 v[24:27], v[132:135], v[216:219], v[24:27]
  ds_read_b64_tr_b16 v[128:129], v8 offset:14336
  v_mfma_f32_16x16x32_bf16 v[28:31], v[132:135], v[220:223], v[28:31]
  ds_read_b64_tr_b16 v[130:131], v8 offset:21504
  buffer_load_dwordx4 v[208:211], v1, s[4:7], s46 offen offset:1024 sc1
  v_mfma_f32_16x16x32_bf16 v[32:35], v[136:139], v[216:219], v[32:35]
  ds_read_b64_tr_b16 v[132:133], v9 offset:14368
  v_mfma_f32_16x16x32_bf16 v[36:39], v[136:139], v[220:223], v[36:39]
  ds_read_b64_tr_b16 v[134:135], v9 offset:21536
  v_mfma_f32_16x16x32_bf16 v[40:43], v[140:143], v[216:219], v[40:43]
  ds_read_b64_tr_b16 v[136:137], v8 offset:14400
  v_mfma_f32_16x16x32_bf16 v[44:47], v[140:143], v[220:223], v[44:47]
  ds_read_b64_tr_b16 v[138:139], v8 offset:21568
  v_mfma_f32_16x16x32_bf16 v[48:51], v[144:147], v[216:219], v[48:51]
  ds_read_b64_tr_b16 v[140:141], v9 offset:14432
  v_mfma_f32_16x16x32_bf16 v[52:55], v[144:147], v[220:223], v[52:55]
  ds_read_b64_tr_b16 v[142:143], v9 offset:21600
  buffer_load_dwordx4 v[212:215], v14, s[4:7], s46 offen offset:1024 sc1
  s_add_u32 s46, s46, 2048
  v_mfma_f32_16x16x32_bf16 v[56:59], v[148:151], v[216:219], v[56:59]
  ds_read_b64_tr_b16 v[144:145], v8 offset:14464
  v_mfma_f32_16x16x32_bf16 v[60:63], v[148:151], v[220:223], v[60:63]
  ds_read_b64_tr_b16 v[146:147], v8 offset:21632
  s_waitcnt lgkmcnt(15)
  v_mfma_f32_16x16x32_bf16 v[64:67], v[152:155], v[216:219], v[64:67]
  ds_read_b64_tr_b16 v[148:149], v9 offset:14496
  v_mfma_f32_16x16x32_bf16 v[68:71], v[152:155], v[220:223], v[68:71]
  ds_read_b64_tr_b16 v[150:151], v9 offset:21664
  v_mfma_f32_16x16x32_bf16 v[72:75], v[156:159], v[216:219], v[72:75]
  ds_read_b64_tr_b16 v[152:153], v8 offset:14528
  v_mfma_f32_16x16x32_bf16 v[76:79], v[156:159], v[220:223], v[76:79]
  ds_read_b64_tr_b16 v[154:155], v8 offset:21696
  v_mfma_f32_16x16x32_bf16 v[80:83], v[160:163], v[216:219], v[80:83]
  ds_read_b64_tr_b16 v[156:157], v9 offset:14560
  v_mfma_f32_16x16x32_bf16 v[84:87], v[160:163], v[220:223], v[84:87]
  ds_read_b64_tr_b16 v[158:159], v9 offset:21728
  v_mfma_f32_16x16x32_bf16 v[88:91], v[164:167], v[216:219], v[88:91]
  ds_read_b64_tr_b16 v[160:161], v8 offset:14592
  v_mfma_f32_16x16x32_bf16 v[92:95], v[164:167], v[220:223], v[92:95]
  ds_read_b64_tr_b16 v[162:163], v8 offset:21760
  v_mfma_f32_16x16x32_bf16 v[96:99], v[168:171], v[216:219], v[96:99]
  ds_read_b64_tr_b16 v[164:165], v9 offset:14624
  v_mfma_f32_16x16x32_bf16 v[100:103], v[168:171], v[220:223], v[100:103]
  ds_read_b64_tr_b16 v[166:167], v9 offset:21792
  s_waitcnt lgkmcnt(15)
  v_mfma_f32_16x16x32_bf16 v[104:107], v[172:175], v[216:219], v[104:107]
  ds_read_b64_tr_b16 v[168:169], v8 offset:14656
  v_mfma_f32_16x16x32_bf16 v[108:111], v[172:175], v[220:223], v[108:111]
  ds_read_b64_tr_b16 v[170:171], v8 offset:21824
  v_mfma_f32_16x16x32_bf16 v[112:115], v[176:179], v[216:219], v[112:115]
  ds_read_b64_tr_b16 v[172:173], v9 offset:14688
  v_mfma_f32_16x16x32_bf16 v[116:119], v[176:179], v[220:223], v[116:119]
  ds_read_b64_tr_b16 v[174:175], v9 offset:21856
  v_mfma_f32_16x16x32_bf16 v[120:123], v[180:183], v[216:219], v[120:123]
  ds_read_b64_tr_b16 v[176:177], v8 offset:14720
  v_mfma_f32_16x16x32_bf16 v[124:127], v[180:183], v[220:223], v[124:127]
  ds_read_b64_tr_b16 v[178:179], v8 offset:21888
  ds_read_b64_tr_b16 v[180:181], v9 offset:14752
  ds_read_b64_tr_b16 v[182:183], v9 offset:21920
  s_waitcnt vmcnt(12)
  s_barrier
  v_mfma_f32_16x16x32_bf16 v[16:19], v[128:131], v[224:227], v[16:19]
  v_mfma_f32_16x16x32_bf16 v[20:23], v[128:131], v[228:231], v[20:23]
  v_mfma_f32_16x16x32_bf16 v[24:27], v[132:135], v[224:227], v[24:27]
  ds_read_b64_tr_b16 v[128:129], v8 offset:28672
  v_mfma_f32_16x16x32_bf16 v[28:31], v[132:135], v[228:231], v[28:31]
  ds_read_b64_tr_b16 v[130:131], v8 offset:35840
  buffer_load_dwordx4 v[216:219], v1, s[4:7], s46 offen offset:0 sc1
  s_waitcnt lgkmcnt(15)
  v_mfma_f32_16x16x32_bf16 v[32:35], v[136:139], v[224:227], v[32:35]
  ds_read_b64_tr_b16 v[132:133], v9 offset:28704
  v_mfma_f32_16x16x32_bf16 v[36:39], v[136:139], v[228:231], v[36:39]
  ds_read_b64_tr_b16 v[134:135], v9 offset:35872
  v_mfma_f32_16x16x32_bf16 v[40:43], v[140:143], v[224:227], v[40:43]
  ds_read_b64_tr_b16 v[136:137], v8 offset:28736
  v_mfma_f32_16x16x32_bf16 v[44:47], v[140:143], v[228:231], v[44:47]
  ds_read_b64_tr_b16 v[138:139], v8 offset:35904
  v_mfma_f32_16x16x32_bf16 v[48:51], v[144:147], v[224:227], v[48:51]
  ds_read_b64_tr_b16 v[140:141], v9 offset:28768
  v_mfma_f32_16x16x32_bf16 v[52:55], v[144:147], v[228:231], v[52:55]
  ds_read_b64_tr_b16 v[142:143], v9 offset:35936
  buffer_load_dwordx4 v[220:223], v14, s[4:7], s46 offen offset:0 sc1
  v_mfma_f32_16x16x32_bf16 v[56:59], v[148:151], v[224:227], v[56:59]
  ds_read_b64_tr_b16 v[144:145], v8 offset:28800
  v_mfma_f32_16x16x32_bf16 v[60:63], v[148:151], v[228:231], v[60:63]
  ds_read_b64_tr_b16 v[146:147], v8 offset:35968
  v_mfma_f32_16x16x32_bf16 v[64:67], v[152:155], v[224:227], v[64:67]
  ds_read_b64_tr_b16 v[148:149], v9 offset:28832
  v_mfma_f32_16x16x32_bf16 v[68:71], v[152:155], v[228:231], v[68:71]
  ds_read_b64_tr_b16 v[150:151], v9 offset:36000
  s_waitcnt lgkmcnt(15)
  v_mfma_f32_16x16x32_bf16 v[72:75], v[156:159], v[224:227], v[72:75]
  ds_read_b64_tr_b16 v[152:153], v8 offset:28864
  v_mfma_f32_16x16x32_bf16 v[76:79], v[156:159], v[228:231], v[76:79]
  ds_read_b64_tr_b16 v[154:155], v8 offset:36032
  v_mfma_f32_16x16x32_bf16 v[80:83], v[160:163], v[224:227], v[80:83]
  ds_read_b64_tr_b16 v[156:157], v9 offset:28896
  v_mfma_f32_16x16x32_bf16 v[84:87], v[160:163], v[228:231], v[84:87]
  ds_read_b64_tr_b16 v[158:159], v9 offset:36064
  v_mfma_f32_16x16x32_bf16 v[88:91], v[164:167], v[224:227], v[88:91]
  ds_read_b64_tr_b16 v[160:161], v8 offset:28928
  v_mfma_f32_16x16x32_bf16 v[92:95], v[164:167], v[228:231], v[92:95]
  ds_read_b64_tr_b16 v[162:163], v8 offset:36096
  v_mfma_f32_16x16x32_bf16 v[96:99], v[168:171], v[224:227], v[96:99]
  ds_read_b64_tr_b16 v[164:165], v9 offset:28960
  v_mfma_f32_16x16x32_bf16 v[100:103], v[168:171], v[228:231], v[100:103]
  ds_read_b64_tr_b16 v[166:167], v9 offset:36128
  v_mfma_f32_16x16x32_bf16 v[104:107], v[172:175], v[224:227], v[104:107]
  ds_read_b64_tr_b16 v[168:169], v8 offset:28992
  v_mfma_f32_16x16x32_bf16 v[108:111], v[172:175], v[228:231], v[108:111]
  ds_read_b64_tr_b16 v[170:171], v8 offset:36160
  s_waitcnt lgkmcnt(15)
  v_mfma_f32_16x16x32_bf16 v[112:115], v[176:179], v[224:227], v[112:115]
  ds_read_b64_tr_b16 v[172:173], v9 offset:29024
  v_mfma_f32_16x16x32_bf16 v[116:119], v[176:179], v[228:231], v[116:119]
  ds_read_b64_tr_b16 v[174:175], v9 offset:36192
  v_mfma_f32_16x16x32_bf16 v[120:123], v[180:183], v[224:227], v[120:123]
  ds_read_b64_tr_b16 v[176:177], v8 offset:29056
  v_mfma_f32_16x16x32_bf16 v[124:127], v[180:183], v[228:231], v[124:127]
  ds_read_b64_tr_b16 v[178:179], v8 offset:36224
  ds_read_b64_tr_b16 v[180:181], v9 offset:29088
  ds_read_b64_tr_b16 v[182:183], v9 offset:36256
  s_waitcnt vmcnt(12)
  v_mfma_f32_16x16x32_bf16 v[16:19], v[128:131], v[232:235], v[16:19]
  v_mfma_f32_16x16x32_bf16 v[20:23], v[128:131], v[236:239], v[20:23]
  v_mfma_f32_16x16x32_bf16 v[24:27], v[132:135], v[232:235], v[24:27]
  ds_read_b64_tr_b16 v[128:129], v8 offset:43008
  v_mfma_f32_16x16x32_bf16 v[28:31], v[132:135], v[236:239], v[28:31]
  ds_read_b64_tr_b16 v[130:131], v8 offset:50176
  buffer_load_dwordx4 v[224:227], v1, s[4:7], s46 offen offset:1024 sc1
  v_mfma_f32_16x16x32_bf16 v[32:35], v[136:139], v[232:235], v[32:35]
  ds_read_b64_tr_b16 v[132:133], v9 offset:43040
  v_mfma_f32_16x16x32_bf16 v[36:39], v[136:139], v[236:239], v[36:39]
  ds_read_b64_tr_b16 v[134:135], v9 offset:50208
  s_waitcnt lgkmcnt(15)
  v_mfma_f32_16x16x32_bf16 v[40:43], v[140:143], v[232:235], v[40:43]
  ds_read_b64_tr_b16 v[136:137], v8 offset:43072
  v_mfma_f32_16x16x32_bf16 v[44:47], v[140:143], v[236:239], v[44:47]
  ds_read_b64_tr_b16 v[138:139], v8 offset:50240
  v_mfma_f32_16x16x32_bf16 v[48:51], v[144:147], v[232:235], v[48:51]
  ds_read_b64_tr_b16 v[140:141], v9 offset:43104
  v_mfma_f32_16x16x32_bf16 v[52:55], v[144:147], v[236:239], v[52:55]
  ds_read_b64_tr_b16 v[142:143], v9 offset:50272
  buffer_load_dwordx4 v[228:231], v14, s[4:7], s46 offen offset:1024 sc1
  s_add_u32 s46, s46, 2048
  v_mfma_f32_16x16x32_bf16 v[56:59], v[148:151], v[232:235], v[56:59]
  ds_read_b64_tr_b16 v[144:145], v8 offset:43136
  v_mfma_f32_16x16x32_bf16 v[60:63], v[148:151], v[236:239], v[60:63]
  ds_read_b64_tr_b16 v[146:147], v8 offset:50304
  v_mfma_f32_16x16x32_bf16 v[64:67], v[152:155], v[232:235], v[64:67]
  ds_read_b64_tr_b16 v[148:149], v9 offset:43168
  v_mfma_f32_16x16x32_bf16 v[68:71], v[152:155], v[236:239], v[68:71]
  ds_read_b64_tr_b16 v[150:151], v9 offset:50336
  v_mfma_f32_16x16x32_bf16 v[72:75], v[156:159], v[232:235], v[72:75]
  ds_read_b64_tr_b16 v[152:153], v8 offset:43200
  v_mfma_f32_16x16x32_bf16 v[76:79], v[156:159], v[236:239], v[76:79]
  ds_read_b64_tr_b16 v[154:155], v8 offset:50368
  s_waitcnt lgkmcnt(15)
  v_mfma_f32_16x16x32_bf16 v[80:83], v[160:163], v[232:235], v[80:83]
  ds_read_b64_tr_b16 v[156:157], v9 offset:43232
  v_mfma_f32_16x16x32_bf16 v[84:87], v[160:163], v[236:239], v[84:87]
  ds_read_b64_tr_b16 v[158:159], v9 offset:50400
  v_mfma_f32_16x16x32_bf16 v[88:91], v[164:167], v[232:235], v[88:91]
  ds_read_b64_tr_b16 v[160:161], v8 offset:43264
  v_mfma_f32_16x16x32_bf16 v[92:95], v[164:167], v[236:239], v[92:95]
  ds_read_b64_tr_b16 v[162:163], v8 offset:50432
  v_mfma_f32_16x16x32_bf16 v[96:99], v[168:171], v[232:235], v[96:99]
  ds_read_b64_tr_b16 v[164:165], v9 offset:43296
  v_mfma_f32_16x16x32_bf16 v[100:103], v[168:171], v[236:239], v[100:103]
  ds_read_b64_tr_b16 v[166:167], v9 offset:50464
  v_mfma_f32_16x16x32_bf16 v[104:107], v[172:175], v[232:235], v[104:107]
  ds_read_b64_tr_b16 v[168:169], v8 offset:43328
  v_mfma_f32_16x16x32_bf16 v[108:111], v[172:175], v[236:239], v[108:111]
  ds_read_b64_tr_b16 v[170:171], v8 offset:50496
  v_mfma_f32_16x16x32_bf16 v[112:115], v[176:179], v[232:235], v[112:115]
  ds_read_b64_tr_b16 v[172:173], v9 offset:43360
  v_mfma_f32_16x16x32_bf16 v[116:119], v[176:179], v[236:239], v[116:119]
  ds_read_b64_tr_b16 v[174:175], v9 offset:50528
  s_waitcnt lgkmcnt(15)
  v_mfma_f32_16x16x32_bf16 v[120:123], v[180:183], v[232:235], v[120:123]
  ds_read_b64_tr_b16 v[176:177], v8 offset:43392
  v_mfma_f32_16x16x32_bf16 v[124:127], v[180:183], v[236:239], v[124:127]
  ds_read_b64_tr_b16 v[178:179], v8 offset:50560
  ds_read_b64_tr_b16 v[180:181], v9 offset:43424
  ds_read_b64_tr_b16 v[182:183], v9 offset:50592
  s_waitcnt vmcnt(12)
  s_barrier
  v_mfma_f32_16x16x32_bf16 v[16:19], v[128:131], v[240:243], v[16:19]
  v_mfma_f32_16x16x32_bf16 v[20:23], v[128:131], v[244:247], v[20:23]
  v_mfma_f32_16x16x32_bf16 v[24:27], v[132:135], v[240:243], v[24:27]
  ds_read_b64_tr_b16 v[128:129], v10 offset:0
  v_mfma_f32_16x16x32_bf16 v[28:31], v[132:135], v[244:247], v[28:31]
  ds_read_b64_tr_b16 v[130:131], v10 offset:7168
  buffer_load_dwordx4 v[232:235], v1, s[4:7], s46 offen offset:0 sc1
  v_mfma_f32_16x16x32_bf16 v[32:35], v[136:139], v[240:243], v[32:35]
  ds_read_b64_tr_b16 v[132:133], v11 offset:32
  v_mfma_f32_16x16x32_bf16 v[36:39], v[136:139], v[244:247], v[36:39]
  ds_read_b64_tr_b16 v[134:135], v11 offset:7200
  v_mfma_f32_16x16x32_bf16 v[40:43], v[140:143], v[240:243], v[40:43]
  ds_read_b64_tr_b16 v[136:137], v10 offset:64
  v_mfma_f32_16x16x32_bf16 v[44:47], v[140:143], v[244:247], v[44:47]
  ds_read_b64_tr_b16 v[138:139], v10 offset:7232
  s_waitcnt lgkmcnt(15)
  v_mfma_f32_16x16x32_bf16 v[48:51], v[144:147], v[240:243], v[48:51]
  ds_read_b64_tr_b16 v[140:141], v11 offset:96
  v_mfma_f32_16x16x32_bf16 v[52:55], v[144:147], v[244:247], v[52:55]
  ds_read_b64_tr_b16 v[142:143], v11 offset:7264
  buffer_load_dwordx4 v[236:239], v14, s[4:7], s46 offen offset:0 sc1
  v_mfma_f32_16x16x32_bf16 v[56:59], v[148:151], v[240:243], v[56:59]
  ds_read_b64_tr_b16 v[144:145], v10 offset:128
  v_mfma_f32_16x16x32_bf16 v[60:63], v[148:151], v[244:247], v[60:63]
  ds_read_b64_tr_b16 v[146:147], v10 offset:7296
  v_mfma_f32_16x16x32_bf16 v[64:67], v[152:155], v[240:243], v[64:67]
  ds_read_b64_tr_b16 v[148:149], v11 offset:160
  v_mfma_f32_16x16x32_bf16 v[68:71], v[152:155], v[244:247], v[68:71]
  ds_read_b64_tr_b16 v[150:151], v11 offset:7328
  v_mfma_f32_16x16x32_bf16 v[72:75], v[156:159], v[240:243], v[72:75]
  ds_read_b64_tr_b16 v[152:153], v10 offset:192
  v_mfma_f32_16x16x32_bf16 v[76:79], v[156:159], v[244:247], v[76:79]
  ds_read_b64_tr_b16 v[154:155], v10 offset:7360
  v_mfma_f32_16x16x32_bf16 v[80:83], v[160:163], v[240:243], v[80:83]
  ds_read_b64_tr_b16 v[156:157], v11 offset:224
  v_mfma_f32_16x16x32_bf16 v[84:87], v[160:163], v[244:247], v[84:87]
  ds_read_b64_tr_b16 v[158:159], v11 offset:7392
  s_waitcnt lgkmcnt(15)
  v_mfma_f32_16x16x32_bf16 v[88:91], v[164:167], v[240:243], v[88:91]
  ds_read_b64_tr_b16 v[160:161], v10 offset:256
  v_mfma_f32_16x16x32_bf16 v[92:95], v[164:167], v[244:247], v[92:95]
  ds_read_b64_tr_b16 v[162:163], v10 offset:7424
  v_mfma_f32_16x16x32_bf16 v[96:99], v[168:171], v[240:243], v[96:99]
  ds_read_b64_tr_b16 v[164:165], v11 offset:288
  v_mfma_f32_16x16x32_bf16 v[100:103], v[168:171], v[244:247], v[100:103]
  ds_read_b64_tr_b16 v[166:167], v11 offset:7456
  v_mfma_f32_16x16x32_bf16 v[104:107], v[172:175], v[240:243], v[104:107]
  ds_read_b64_tr_b16 v[168:169], v10 offset:320
  v_mfma_f32_16x16x32_bf16 v[108:111], v[172:175], v[244:247], v[108:111]
  ds_read_b64_tr_b16 v[170:171], v10 offset:7488
  v_mfma_f32_16x16x32_bf16 v[112:115], v[176:179], v[240:243], v[112:115]
  ds_read_b64_tr_b16 v[172:173], v11 offset:352
  v_mfma_f32_16x16x32_bf16 v[116:119], v[176:179], v[244:247], v[116:119]
  ds_read_b64_tr_b16 v[174:175], v11 offset:7520
  v_mfma_f32_16x16x32_bf16 v[120:123], v[180:183], v[240:243], v[120:123]
  ds_read_b64_tr_b16 v[176:177], v10 offset:384
  v_mfma_f32_16x16x32_bf16 v[124:127], v[180:183], v[244:247], v[124:127]
  ds_read_b64_tr_b16 v[178:179], v10 offset:7552
  ds_read_b64_tr_b16 v[180:181], v11 offset:416
  ds_read_b64_tr_b16 v[182:183], v11 offset:7584
  s_waitcnt vmcnt(12)
  s_waitcnt lgkmcnt(15)
  v_mfma_f32_16x16x32_bf16 v[16:19], v[128:131], v[184:187], v[16:19]
  v_mfma_f32_16x16x32_bf16 v[20:23], v[128:131], v[188:191], v[20:23]
  v_mfma_f32_16x16x32_bf16 v[24:27], v[132:135], v[184:187], v[24:27]
  ds_read_b64_tr_b16 v[128:129], v10 offset:14336
  v_mfma_f32_16x16x32_bf16 v[28:31], v[132:135], v[188:191], v[28:31]
  ds_read_b64_tr_b16 v[130:131], v10 offset:21504
  buffer_load_dwordx4 v[240:243], v1, s[4:7], s46 offen offset:1024 sc1
  v_mfma_f32_16x16x32_bf16 v[32:35], v[136:139], v[184:187], v[32:35]
  ds_read_b64_tr_b16 v[132:133], v11 offset:14368
  v_mfma_f32_16x16x32_bf16 v[36:39], v[136:139], v[188:191], v[36:39]
  ds_read_b64_tr_b16 v[134:135], v11 offset:21536
  v_mfma_f32_16x16x32_bf16 v[40:43], v[140:143], v[184:187], v[40:43]
  ds_read_b64_tr_b16 v[136:137], v10 offset:14400
  v_mfma_f32_16x16x32_bf16 v[44:47], v[140:143], v[188:191], v[44:47]
  ds_read_b64_tr_b16 v[138:139], v10 offset:21568
  v_mfma_f32_16x16x32_bf16 v[48:51], v[144:147], v[184:187], v[48:51]
  ds_read_b64_tr_b16 v[140:141], v11 offset:14432
  v_mfma_f32_16x16x32_bf16 v[52:55], v[144:147], v[188:191], v[52:55]
  ds_read_b64_tr_b16 v[142:143], v11 offset:21600
  buffer_load_dwordx4 v[244:247], v14, s[4:7], s46 offen offset:1024 sc1
  s_add_u32 s46, s46, 2048
  v_mfma_f32_16x16x32_bf16 v[56:59], v[148:151], v[184:187], v[56:59]
  ds_read_b64_tr_b16 v[144:145], v10 offset:14464
  v_mfma_f32_16x16x32_bf16 v[60:63], v[148:151], v[188:191], v[60:63]
  ds_read_b64_tr_b16 v[146:147], v10 offset:21632
  s_waitcnt lgkmcnt(15)
  v_mfma_f32_16x16x32_bf16 v[64:67], v[152:155], v[184:187], v[64:67]
  ds_read_b64_tr_b16 v[148:149], v11 offset:14496
  v_mfma_f32_16x16x32_bf16 v[68:71], v[152:155], v[188:191], v[68:71]
  ds_read_b64_tr_b16 v[150:151], v11 offset:21664
  v_mfma_f32_16x16x32_bf16 v[72:75], v[156:159], v[184:187], v[72:75]
  ds_read_b64_tr_b16 v[152:153], v10 offset:14528
  v_mfma_f32_16x16x32_bf16 v[76:79], v[156:159], v[188:191], v[76:79]
  ds_read_b64_tr_b16 v[154:155], v10 offset:21696
  v_mfma_f32_16x16x32_bf16 v[80:83], v[160:163], v[184:187], v[80:83]
  ds_read_b64_tr_b16 v[156:157], v11 offset:14560
  v_mfma_f32_16x16x32_bf16 v[84:87], v[160:163], v[188:191], v[84:87]
  ds_read_b64_tr_b16 v[158:159], v11 offset:21728
  v_mfma_f32_16x16x32_bf16 v[88:91], v[164:167], v[184:187], v[88:91]
  ds_read_b64_tr_b16 v[160:161], v10 offset:14592
  v_mfma_f32_16x16x32_bf16 v[92:95], v[164:167], v[188:191], v[92:95]
  ds_read_b64_tr_b16 v[162:163], v10 offset:21760
  v_mfma_f32_16x16x32_bf16 v[96:99], v[168:171], v[184:187], v[96:99]
  ds_read_b64_tr_b16 v[164:165], v11 offset:14624
  v_mfma_f32_16x16x32_bf16 v[100:103], v[168:171], v[188:191], v[100:103]
  ds_read_b64_tr_b16 v[166:167], v11 offset:21792
  s_waitcnt lgkmcnt(15)
  v_mfma_f32_16x16x32_bf16 v[104:107], v[172:175], v[184:187], v[104:107]
  ds_read_b64_tr_b16 v[168:169], v10 offset:14656
  v_mfma_f32_16x16x32_bf16 v[108:111], v[172:175], v[188:191], v[108:111]
  ds_read_b64_tr_b16 v[170:171], v10 offset:21824
  v_mfma_f32_16x16x32_bf16 v[112:115], v[176:179], v[184:187], v[112:115]
  ds_read_b64_tr_b16 v[172:173], v11 offset:14688
  v_mfma_f32_16x16x32_bf16 v[116:119], v[176:179], v[188:191], v[116:119]
  ds_read_b64_tr_b16 v[174:175], v11 offset:21856
  v_mfma_f32_16x16x32_bf16 v[120:123], v[180:183], v[184:187], v[120:123]
  ds_read_b64_tr_b16 v[176:177], v10 offset:14720
  v_mfma_f32_16x16x32_bf16 v[124:127], v[180:183], v[188:191], v[124:127]
  ds_read_b64_tr_b16 v[178:179], v10 offset:21888
  ds_read_b64_tr_b16 v[180:181], v11 offset:14752
  ds_read_b64_tr_b16 v[182:183], v11 offset:21920
  s_waitcnt vmcnt(12)
  s_barrier
  v_mfma_f32_16x16x32_bf16 v[16:19], v[128:131], v[192:195], v[16:19]
  v_mfma_f32_16x16x32_bf16 v[20:23], v[128:131], v[196:199], v[20:23]
  v_mfma_f32_16x16x32_bf16 v[24:27], v[132:135], v[192:195], v[24:27]
  ds_read_b64_tr_b16 v[128:129], v10 offset:28672
  v_mfma_f32_16x16x32_bf16 v[28:31], v[132:135], v[196:199], v[28:31]
  ds_read_b64_tr_b16 v[130:131], v10 offset:35840
  s_waitcnt lgkmcnt(15)
  v_mfma_f32_16x16x32_bf16 v[32:35], v[136:139], v[192:195], v[32:35]
  ds_read_b64_tr_b16 v[132:133], v11 offset:28704
  v_mfma_f32_16x16x32_bf16 v[36:39], v[136:139], v[196:199], v[36:39]
  ds_read_b64_tr_b16 v[134:135], v11 offset:35872
  v_mfma_f32_16x16x32_bf16 v[40:43], v[140:143], v[192:195], v[40:43]
  ds_read_b64_tr_b16 v[136:137], v10 offset:28736
  v_mfma_f32_16x16x32_bf16 v[44:47], v[140:143], v[196:199], v[44:47]
  ds_read_b64_tr_b16 v[138:139], v10 offset:35904
  v_mfma_f32_16x16x32_bf16 v[48:51], v[144:147], v[192:195], v[48:51]
  ds_read_b64_tr_b16 v[140:141], v11 offset:28768
  v_mfma_f32_16x16x32_bf16 v[52:55], v[144:147], v[196:199], v[52:55]
  ds_read_b64_tr_b16 v[142:143], v11 offset:35936
  v_mfma_f32_16x16x32_bf16 v[56:59], v[148:151], v[192:195], v[56:59]
  ds_read_b64_tr_b16 v[144:145], v10 offset:28800
  v_mfma_f32_16x16x32_bf16 v[60:63], v[148:151], v[196:199], v[60:63]
  ds_read_b64_tr_b16 v[146:147], v10 offset:35968
  v_mfma_f32_16x16x32_bf16 v[64:67], v[152:155], v[192:195], v[64:67]
  ds_read_b64_tr_b16 v[148:149], v11 offset:28832
  v_mfma_f32_16x16x32_bf16 v[68:71], v[152:155], v[196:199], v[68:71]
  ds_read_b64_tr_b16 v[150:151], v11 offset:36000
  s_waitcnt lgkmcnt(15)
  v_mfma_f32_16x16x32_bf16 v[72:75], v[156:159], v[192:195], v[72:75]
  ds_read_b64_tr_b16 v[152:153], v10 offset:28864
  v_mfma_f32_16x16x32_bf16 v[76:79], v[156:159], v[196:199], v[76:79]
  ds_read_b64_tr_b16 v[154:155], v10 offset:36032
  v_mfma_f32_16x16x32_bf16 v[80:83], v[160:163], v[192:195], v[80:83]
  ds_read_b64_tr_b16 v[156:157], v11 offset:28896
  v_mfma_f32_16x16x32_bf16 v[84:87], v[160:163], v[196:199], v[84:87]
  ds_read_b64_tr_b16 v[158:159], v11 offset:36064
  v_mfma_f32_16x16x32_bf16 v[88:91], v[164:167], v[192:195], v[88:91]
  ds_read_b64_tr_b16 v[160:161], v10 offset:28928
  v_mfma_f32_16x16x32_bf16 v[92:95], v[164:167], v[196:199], v[92:95]
  ds_read_b64_tr_b16 v[162:163], v10 offset:36096
  v_mfma_f32_16x16x32_bf16 v[96:99], v[168:171], v[192:195], v[96:99]
  ds_read_b64_tr_b16 v[164:165], v11 offset:28960
  v_mfma_f32_16x16x32_bf16 v[100:103], v[168:171], v[196:199], v[100:103]
  ds_read_b64_tr_b16 v[166:167], v11 offset:36128
  v_mfma_f32_16x16x32_bf16 v[104:107], v[172:175], v[192:195], v[104:107]
  ds_read_b64_tr_b16 v[168:169], v10 offset:28992
  v_mfma_f32_16x16x32_bf16 v[108:111], v[172:175], v[196:199], v[108:111]
  ds_read_b64_tr_b16 v[170:171], v10 offset:36160
  s_waitcnt lgkmcnt(15)
  v_mfma_f32_16x16x32_bf16 v[112:115], v[176:179], v[192:195], v[112:115]
  ds_read_b64_tr_b16 v[172:173], v11 offset:29024
  v_mfma_f32_16x16x32_bf16 v[116:119], v[176:179], v[196:199], v[116:119]
  ds_read_b64_tr_b16 v[174:175], v11 offset:36192
  v_mfma_f32_16x16x32_bf16 v[120:123], v[180:183], v[192:195], v[120:123]
  ds_read_b64_tr_b16 v[176:177], v10 offset:29056
  v_mfma_f32_16x16x32_bf16 v[124:127], v[180:183], v[196:199], v[124:127]
  ds_read_b64_tr_b16 v[178:179], v10 offset:36224
  ds_read_b64_tr_b16 v[180:181], v11 offset:29088
  ds_read_b64_tr_b16 v[182:183], v11 offset:36256
  s_waitcnt vmcnt(10)
  v_mfma_f32_16x16x32_bf16 v[16:19], v[128:131], v[200:203], v[16:19]
  v_mfma_f32_16x16x32_bf16 v[20:23], v[128:131], v[204:207], v[20:23]
  v_mfma_f32_16x16x32_bf16 v[24:27], v[132:135], v[200:203], v[24:27]
  ds_read_b64_tr_b16 v[128:129], v10 offset:43008
  v_mfma_f32_16x16x32_bf16 v[28:31], v[132:135], v[204:207], v[28:31]
  ds_read_b64_tr_b16 v[130:131], v10 offset:50176
  v_mfma_f32_16x16x32_bf16 v[32:35], v[136:139], v[200:203], v[32:35]
  ds_read_b64_tr_b16 v[132:133], v11 offset:43040
  v_mfma_f32_16x16x32_bf16 v[36:39], v[136:139], v[204:207], v[36:39]
  ds_read_b64_tr_b16 v[134:135], v11 offset:50208
  s_waitcnt lgkmcnt(15)
  v_mfma_f32_16x16x32_bf16 v[40:43], v[140:143], v[200:203], v[40:43]
  ds_read_b64_tr_b16 v[136:137], v10 offset:43072
  v_mfma_f32_16x16x32_bf16 v[44:47], v[140:143], v[204:207], v[44:47]
  ds_read_b64_tr_b16 v[138:139], v10 offset:50240
  v_mfma_f32_16x16x32_bf16 v[48:51], v[144:147], v[200:203], v[48:51]
  ds_read_b64_tr_b16 v[140:141], v11 offset:43104
  v_mfma_f32_16x16x32_bf16 v[52:55], v[144:147], v[204:207], v[52:55]
  ds_read_b64_tr_b16 v[142:143], v11 offset:50272
  v_mfma_f32_16x16x32_bf16 v[56:59], v[148:151], v[200:203], v[56:59]
  ds_read_b64_tr_b16 v[144:145], v10 offset:43136
  v_mfma_f32_16x16x32_bf16 v[60:63], v[148:151], v[204:207], v[60:63]
  ds_read_b64_tr_b16 v[146:147], v10 offset:50304
  v_mfma_f32_16x16x32_bf16 v[64:67], v[152:155], v[200:203], v[64:67]
  ds_read_b64_tr_b16 v[148:149], v11 offset:43168
  v_mfma_f32_16x16x32_bf16 v[68:71], v[152:155], v[204:207], v[68:71]
  ds_read_b64_tr_b16 v[150:151], v11 offset:50336
  v_mfma_f32_16x16x32_bf16 v[72:75], v[156:159], v[200:203], v[72:75]
  ds_read_b64_tr_b16 v[152:153], v10 offset:43200
  v_mfma_f32_16x16x32_bf16 v[76:79], v[156:159], v[204:207], v[76:79]
  ds_read_b64_tr_b16 v[154:155], v10 offset:50368
  s_waitcnt lgkmcnt(15)
  v_mfma_f32_16x16x32_bf16 v[80:83], v[160:163], v[200:203], v[80:83]
  ds_read_b64_tr_b16 v[156:157], v11 offset:43232
  v_mfma_f32_16x16x32_bf16 v[84:87], v[160:163], v[204:207], v[84:87]
  ds_read_b64_tr_b16 v[158:159], v11 offset:50400
  v_mfma_f32_16x16x32_bf16 v[88:91], v[164:167], v[200:203], v[88:91]
  ds_read_b64_tr_b16 v[160:161], v10 offset:43264
  v_mfma_f32_16x16x32_bf16 v[92:95], v[164:167], v[204:207], v[92:95]
  ds_read_b64_tr_b16 v[162:163], v10 offset:50432
  v_mfma_f32_16x16x32_bf16 v[96:99], v[168:171], v[200:203], v[96:99]
  ds_read_b64_tr_b16 v[164:165], v11 offset:43296
  v_mfma_f32_16x16x32_bf16 v[100:103], v[168:171], v[204:207], v[100:103]
  ds_read_b64_tr_b16 v[166:167], v11 offset:50464
  v_mfma_f32_16x16x32_bf16 v[104:107], v[172:175], v[200:203], v[104:107]
  ds_read_b64_tr_b16 v[168:169], v10 offset:43328
  v_mfma_f32_16x16x32_bf16 v[108:111], v[172:175], v[204:207], v[108:111]
  ds_read_b64_tr_b16 v[170:171], v10 offset:50496
  v_mfma_f32_16x16x32_bf16 v[112:115], v[176:179], v[200:203], v[112:115]
  ds_read_b64_tr_b16 v[172:173], v11 offset:43360
  v_mfma_f32_16x16x32_bf16 v[116:119], v[176:179], v[204:207], v[116:119]
  ds_read_b64_tr_b16 v[174:175], v11 offset:50528
  s_waitcnt lgkmcnt(15)
  v_mfma_f32_16x16x32_bf16 v[120:123], v[180:183], v[200:203], v[120:123]
  ds_read_b64_tr_b16 v[176:177], v10 offset:43392
  v_mfma_f32_16x16x32_bf16 v[124:127], v[180:183], v[204:207], v[124:127]
  ds_read_b64_tr_b16 v[178:179], v10 offset:50560
  ds_read_b64_tr_b16 v[180:181], v11 offset:43424
  ds_read_b64_tr_b16 v[182:183], v11 offset:50592
  s_waitcnt vmcnt(8)
  s_barrier
  v_mfma_f32_16x16x32_bf16 v[16:19], v[128:131], v[208:211], v[16:19]
  v_mfma_f32_16x16x32_bf16 v[20:23], v[128:131], v[212:215], v[20:23]
  v_mfma_f32_16x16x32_bf16 v[24:27], v[132:135], v[208:211], v[24:27]
  ds_read_b64_tr_b16 v[128:129], v12 offset:0
  v_mfma_f32_16x16x32_bf16 v[28:31], v[132:135], v[212:215], v[28:31]
  ds_read_b64_tr_b16 v[130:131], v12 offset:7168
  v_mfma_f32_16x16x32_bf16 v[32:35], v[136:139], v[208:211], v[32:35]
  ds_read_b64_tr_b16 v[132:133], v13 offset:32
  v_mfma_f32_16x16x32_bf16 v[36:39], v[136:139], v[212:215], v[36:39]
  ds_read_b64_tr_b16 v[134:135], v13 offset:7200
  v_mfma_f32_16x16x32_bf16 v[40:43], v[140:143], v[208:211], v[40:43]
  ds_read_b64_tr_b16 v[136:137], v12 offset:64
  v_mfma_f32_16x16x32_bf16 v[44:47], v[140:143], v[212:215], v[44:47]
  ds_read_b64_tr_b16 v[138:139], v12 offset:7232
  s_waitcnt lgkmcnt(15)
  v_mfma_f32_16x16x32_bf16 v[48:51], v[144:147], v[208:211], v[48:51]
  ds_read_b64_tr_b16 v[140:141], v13 offset:96
  v_mfma_f32_16x16x32_bf16 v[52:55], v[144:147], v[212:215], v[52:55]
  ds_read_b64_tr_b16 v[142:143], v13 offset:7264
  v_mfma_f32_16x16x32_bf16 v[56:59], v[148:151], v[208:211], v[56:59]
  ds_read_b64_tr_b16 v[144:145], v12 offset:128
  v_mfma_f32_16x16x32_bf16 v[60:63], v[148:151], v[212:215], v[60:63]
  ds_read_b64_tr_b16 v[146:147], v12 offset:7296
  v_mfma_f32_16x16x32_bf16 v[64:67], v[152:155], v[208:211], v[64:67]
  ds_read_b64_tr_b16 v[148:149], v13 offset:160
  v_mfma_f32_16x16x32_bf16 v[68:71], v[152:155], v[212:215], v[68:71]
  ds_read_b64_tr_b16 v[150:151], v13 offset:7328
  v_mfma_f32_16x16x32_bf16 v[72:75], v[156:159], v[208:211], v[72:75]
  ds_read_b64_tr_b16 v[152:153], v12 offset:192
  v_mfma_f32_16x16x32_bf16 v[76:79], v[156:159], v[212:215], v[76:79]
  ds_read_b64_tr_b16 v[154:155], v12 offset:7360
  v_mfma_f32_16x16x32_bf16 v[80:83], v[160:163], v[208:211], v[80:83]
  ds_read_b64_tr_b16 v[156:157], v13 offset:224
  v_mfma_f32_16x16x32_bf16 v[84:87], v[160:163], v[212:215], v[84:87]
  ds_read_b64_tr_b16 v[158:159], v13 offset:7392
  s_waitcnt lgkmcnt(15)
  v_mfma_f32_16x16x32_bf16 v[88:91], v[164:167], v[208:211], v[88:91]
  ds_read_b64_tr_b16 v[160:161], v12 offset:256
  v_mfma_f32_16x16x32_bf16 v[92:95], v[164:167], v[212:215], v[92:95]
  ds_read_b64_tr_b16 v[162:163], v12 offset:7424
  v_mfma_f32_16x16x32_bf16 v[96:99], v[168:171], v[208:211], v[96:99]
  ds_read_b64_tr_b16 v[164:165], v13 offset:288
  v_mfma_f32_16x16x32_bf16 v[100:103], v[168:171], v[212:215], v[100:103]
  ds_read_b64_tr_b16 v[166:167], v13 offset:7456
  v_mfma_f32_16x16x32_bf16 v[104:107], v[172:175], v[208:211], v[104:107]
  ds_read_b64_tr_b16 v[168:169], v12 offset:320
  v_mfma_f32_16x16x32_bf16 v[108:111], v[172:175], v[212:215], v[108:111]
  ds_read_b64_tr_b16 v[170:171], v12 offset:7488
  v_mfma_f32_16x16x32_bf16 v[112:115], v[176:179], v[208:211], v[112:115]
  ds_read_b64_tr_b16 v[172:173], v13 offset:352
  v_mfma_f32_16x16x32_bf16 v[116:119], v[176:179], v[212:215], v[116:119]
  ds_read_b64_tr_b16 v[174:175], v13 offset:7520
  v_mfma_f32_16x16x32_bf16 v[120:123], v[180:183], v[208:211], v[120:123]
  ds_read_b64_tr_b16 v[176:177], v12 offset:384
  v_mfma_f32_16x16x32_bf16 v[124:127], v[180:183], v[212:215], v[124:127]
  ds_read_b64_tr_b16 v[178:179], v12 offset:7552
  ds_read_b64_tr_b16 v[180:181], v13 offset:416
  ds_read_b64_tr_b16 v[182:183], v13 offset:7584
  s_waitcnt vmcnt(6)
  s_waitcnt lgkmcnt(15)
  v_mfma_f32_16x16x32_bf16 v[16:19], v[128:131], v[216:219], v[16:19]
  v_mfma_f32_16x16x32_bf16 v[20:23], v[128:131], v[220:223], v[20:23]
  v_mfma_f32_16x16x32_bf16 v[24:27], v[132:135], v[216:219], v[24:27]
  ds_read_b64_tr_b16 v[128:129], v12 offset:14336
  v_mfma_f32_16x16x32_bf16 v[28:31], v[132:135], v[220:223], v[28:31]
  ds_read_b64_tr_b16 v[130:131], v12 offset:21504
  v_mfma_f32_16x16x32_bf16 v[32:35], v[136:139], v[216:219], v[32:35]
  ds_read_b64_tr_b16 v[132:133], v13 offset:14368
  v_mfma_f32_16x16x32_bf16 v[36:39], v[136:139], v[220:223], v[36:39]
  ds_read_b64_tr_b16 v[134:135], v13 offset:21536
  v_mfma_f32_16x16x32_bf16 v[40:43], v[140:143], v[216:219], v[40:43]
  ds_read_b64_tr_b16 v[136:137], v12 offset:14400
  v_mfma_f32_16x16x32_bf16 v[44:47], v[140:143], v[220:223], v[44:47]
  ds_read_b64_tr_b16 v[138:139], v12 offset:21568
  v_mfma_f32_16x16x32_bf16 v[48:51], v[144:147], v[216:219], v[48:51]
  ds_read_b64_tr_b16 v[140:141], v13 offset:14432
  v_mfma_f32_16x16x32_bf16 v[52:55], v[144:147], v[220:223], v[52:55]
  ds_read_b64_tr_b16 v[142:143], v13 offset:21600
  v_mfma_f32_16x16x32_bf16 v[56:59], v[148:151], v[216:219], v[56:59]
  ds_read_b64_tr_b16 v[144:145], v12 offset:14464
  v_mfma_f32_16x16x32_bf16 v[60:63], v[148:151], v[220:223], v[60:63]
  ds_read_b64_tr_b16 v[146:147], v12 offset:21632
  s_waitcnt lgkmcnt(15)
  v_mfma_f32_16x16x32_bf16 v[64:67], v[152:155], v[216:219], v[64:67]
  ds_read_b64_tr_b16 v[148:149], v13 offset:14496
  v_mfma_f32_16x16x32_bf16 v[68:71], v[152:155], v[220:223], v[68:71]
  ds_read_b64_tr_b16 v[150:151], v13 offset:21664
  v_mfma_f32_16x16x32_bf16 v[72:75], v[156:159], v[216:219], v[72:75]
  ds_read_b64_tr_b16 v[152:153], v12 offset:14528
  v_mfma_f32_16x16x32_bf16 v[76:79], v[156:159], v[220:223], v[76:79]
  ds_read_b64_tr_b16 v[154:155], v12 offset:21696
  v_mfma_f32_16x16x32_bf16 v[80:83], v[160:163], v[216:219], v[80:83]
  ds_read_b64_tr_b16 v[156:157], v13 offset:14560
  v_mfma_f32_16x16x32_bf16 v[84:87], v[160:163], v[220:223], v[84:87]
  ds_read_b64_tr_b16 v[158:159], v13 offset:21728
  v_mfma_f32_16x16x32_bf16 v[88:91], v[164:167], v[216:219], v[88:91]
  ds_read_b64_tr_b16 v[160:161], v12 offset:14592
  v_mfma_f32_16x16x32_bf16 v[92:95], v[164:167], v[220:223], v[92:95]
  ds_read_b64_tr_b16 v[162:163], v12 offset:21760
  v_mfma_f32_16x16x32_bf16 v[96:99], v[168:171], v[216:219], v[96:99]
  ds_read_b64_tr_b16 v[164:165], v13 offset:14624
  v_mfma_f32_16x16x32_bf16 v[100:103], v[168:171], v[220:223], v[100:103]
  ds_read_b64_tr_b16 v[166:167], v13 offset:21792
  s_waitcnt lgkmcnt(15)
  v_mfma_f32_16x16x32_bf16 v[104:107], v[172:175], v[216:219], v[104:107]
  ds_read_b64_tr_b16 v[168:169], v12 offset:14656
  v_mfma_f32_16x16x32_bf16 v[108:111], v[172:175], v[220:223], v[108:111]
  ds_read_b64_tr_b16 v[170:171], v12 offset:21824
  v_mfma_f32_16x16x32_bf16 v[112:115], v[176:179], v[216:219], v[112:115]
  ds_read_b64_tr_b16 v[172:173], v13 offset:14688
  v_mfma_f32_16x16x32_bf16 v[116:119], v[176:179], v[220:223], v[116:119]
  ds_read_b64_tr_b16 v[174:175], v13 offset:21856
  v_mfma_f32_16x16x32_bf16 v[120:123], v[180:183], v[216:219], v[120:123]
  ds_read_b64_tr_b16 v[176:177], v12 offset:14720
  v_mfma_f32_16x16x32_bf16 v[124:127], v[180:183], v[220:223], v[124:127]
  ds_read_b64_tr_b16 v[178:179], v12 offset:21888
  ds_read_b64_tr_b16 v[180:181], v13 offset:14752
  ds_read_b64_tr_b16 v[182:183], v13 offset:21920
  s_waitcnt vmcnt(4)
  s_barrier
  v_mfma_f32_16x16x32_bf16 v[16:19], v[128:131], v[224:227], v[16:19]
  v_mfma_f32_16x16x32_bf16 v[20:23], v[128:131], v[228:231], v[20:23]
  v_mfma_f32_16x16x32_bf16 v[24:27], v[132:135], v[224:227], v[24:27]
  ds_read_b64_tr_b16 v[128:129], v8 offset:0
  v_mfma_f32_16x16x32_bf16 v[28:31], v[132:135], v[228:231], v[28:31]
  ds_read_b64_tr_b16 v[130:131], v8 offset:7168
  s_waitcnt lgkmcnt(15)
  v_mfma_f32_16x16x32_bf16 v[32:35], v[136:139], v[224:227], v[32:35]
  ds_read_b64_tr_b16 v[132:133], v9 offset:32
  v_mfma_f32_16x16x32_bf16 v[36:39], v[136:139], v[228:231], v[36:39]
  ds_read_b64_tr_b16 v[134:135], v9 offset:7200
  v_mfma_f32_16x16x32_bf16 v[40:43], v[140:143], v[224:227], v[40:43]
  ds_read_b64_tr_b16 v[136:137], v8 offset:64
  v_mfma_f32_16x16x32_bf16 v[44:47], v[140:143], v[228:231], v[44:47]
  ds_read_b64_tr_b16 v[138:139], v8 offset:7232
  v_mfma_f32_16x16x32_bf16 v[48:51], v[144:147], v[224:227], v[48:51]
  ds_read_b64_tr_b16 v[140:141], v9 offset:96
  v_mfma_f32_16x16x32_bf16 v[52:55], v[144:147], v[228:231], v[52:55]
  ds_read_b64_tr_b16 v[142:143], v9 offset:7264
  v_mfma_f32_16x16x32_bf16 v[56:59], v[148:151], v[224:227], v[56:59]
  ds_read_b64_tr_b16 v[144:145], v8 offset:128
  v_mfma_f32_16x16x32_bf16 v[60:63], v[148:151], v[228:231], v[60:63]
  ds_read_b64_tr_b16 v[146:147], v8 offset:7296
  v_mfma_f32_16x16x32_bf16 v[64:67], v[152:155], v[224:227], v[64:67]
  ds_read_b64_tr_b16 v[148:149], v9 offset:160
  v_mfma_f32_16x16x32_bf16 v[68:71], v[152:155], v[228:231], v[68:71]
  ds_read_b64_tr_b16 v[150:151], v9 offset:7328
  s_waitcnt lgkmcnt(15)
  v_mfma_f32_16x16x32_bf16 v[72:75], v[156:159], v[224:227], v[72:75]
  ds_read_b64_tr_b16 v[152:153], v8 offset:192
  v_mfma_f32_16x16x32_bf16 v[76:79], v[156:159], v[228:231], v[76:79]
  ds_read_b64_tr_b16 v[154:155], v8 offset:7360
  v_mfma_f32_16x16x32_bf16 v[80:83], v[160:163], v[224:227], v[80:83]
  ds_read_b64_tr_b16 v[156:157], v9 offset:224
  v_mfma_f32_16x16x32_bf16 v[84:87], v[160:163], v[228:231], v[84:87]
  ds_read_b64_tr_b16 v[158:159], v9 offset:7392
  v_mfma_f32_16x16x32_bf16 v[88:91], v[164:167], v[224:227], v[88:91]
  ds_read_b64_tr_b16 v[160:161], v8 offset:256
  v_mfma_f32_16x16x32_bf16 v[92:95], v[164:167], v[228:231], v[92:95]
  ds_read_b64_tr_b16 v[162:163], v8 offset:7424
  v_mfma_f32_16x16x32_bf16 v[96:99], v[168:171], v[224:227], v[96:99]
  ds_read_b64_tr_b16 v[164:165], v9 offset:288
  v_mfma_f32_16x16x32_bf16 v[100:103], v[168:171], v[228:231], v[100:103]
  ds_read_b64_tr_b16 v[166:167], v9 offset:7456
  v_mfma_f32_16x16x32_bf16 v[104:107], v[172:175], v[224:227], v[104:107]
  ds_read_b64_tr_b16 v[168:169], v8 offset:320
  v_mfma_f32_16x16x32_bf16 v[108:111], v[172:175], v[228:231], v[108:111]
  ds_read_b64_tr_b16 v[170:171], v8 offset:7488
  s_waitcnt lgkmcnt(15)
  v_mfma_f32_16x16x32_bf16 v[112:115], v[176:179], v[224:227], v[112:115]
  ds_read_b64_tr_b16 v[172:173], v9 offset:352
  v_mfma_f32_16x16x32_bf16 v[116:119], v[176:179], v[228:231], v[116:119]
  ds_read_b64_tr_b16 v[174:175], v9 offset:7520
  v_mfma_f32_16x16x32_bf16 v[120:123], v[180:183], v[224:227], v[120:123]
  ds_read_b64_tr_b16 v[176:177], v8 offset:384
  v_mfma_f32_16x16x32_bf16 v[124:127], v[180:183], v[228:231], v[124:127]
  ds_read_b64_tr_b16 v[178:179], v8 offset:7552
  ds_read_b64_tr_b16 v[180:181], v9 offset:416
  ds_read_b64_tr_b16 v[182:183], v9 offset:7584
  s_waitcnt vmcnt(2)
  v_mfma_f32_16x16x32_bf16 v[16:19], v[128:131], v[232:235], v[16:19]
  v_mfma_f32_16x16x32_bf16 v[20:23], v[128:131], v[236:239], v[20:23]
  v_mfma_f32_16x16x32_bf16 v[24:27], v[132:135], v[232:235], v[24:27]
  ds_read_b64_tr_b16 v[128:129], v8 offset:14336
  v_mfma_f32_16x16x32_bf16 v[28:31], v[132:135], v[236:239], v[28:31]
  ds_read_b64_tr_b16 v[130:131], v8 offset:21504
  v_mfma_f32_16x16x32_bf16 v[32:35], v[136:139], v[232:235], v[32:35]
  ds_read_b64_tr_b16 v[132:133], v9 offset:14368
  v_mfma_f32_16x16x32_bf16 v[36:39], v[136:139], v[236:239], v[36:39]
  ds_read_b64_tr_b16 v[134:135], v9 offset:21536
  s_waitcnt lgkmcnt(15)
  v_mfma_f32_16x16x32_bf16 v[40:43], v[140:143], v[232:235], v[40:43]
  ds_read_b64_tr_b16 v[136:137], v8 offset:14400
  v_mfma_f32_16x16x32_bf16 v[44:47], v[140:143], v[236:239], v[44:47]
  ds_read_b64_tr_b16 v[138:139], v8 offset:21568
  v_mfma_f32_16x16x32_bf16 v[48:51], v[144:147], v[232:235], v[48:51]
  ds_read_b64_tr_b16 v[140:141], v9 offset:14432
  v_mfma_f32_16x16x32_bf16 v[52:55], v[144:147], v[236:239], v[52:55]
  ds_read_b64_tr_b16 v[142:143], v9 offset:21600
  v_mfma_f32_16x16x32_bf16 v[56:59], v[148:151], v[232:235], v[56:59]
  ds_read_b64_tr_b16 v[144:145], v8 offset:14464
  v_mfma_f32_16x16x32_bf16 v[60:63], v[148:151], v[236:239], v[60:63]
  ds_read_b64_tr_b16 v[146:147], v8 offset:21632
  v_mfma_f32_16x16x32_bf16 v[64:67], v[152:155], v[232:235], v[64:67]
  ds_read_b64_tr_b16 v[148:149], v9 offset:14496
  v_mfma_f32_16x16x32_bf16 v[68:71], v[152:155], v[236:239], v[68:71]
  ds_read_b64_tr_b16 v[150:151], v9 offset:21664
  v_mfma_f32_16x16x32_bf16 v[72:75], v[156:159], v[232:235], v[72:75]
  ds_read_b64_tr_b16 v[152:153], v8 offset:14528
  v_mfma_f32_16x16x32_bf16 v[76:79], v[156:159], v[236:239], v[76:79]
  ds_read_b64_tr_b16 v[154:155], v8 offset:21696
  s_waitcnt lgkmcnt(15)
  v_mfma_f32_16x16x32_bf16 v[80:83], v[160:163], v[232:235], v[80:83]
  ds_read_b64_tr_b16 v[156:157], v9 offset:14560
  v_mfma_f32_16x16x32_bf16 v[84:87], v[160:163], v[236:239], v[84:87]
  ds_read_b64_tr_b16 v[158:159], v9 offset:21728
  v_mfma_f32_16x16x32_bf16 v[88:91], v[164:167], v[232:235], v[88:91]
  ds_read_b64_tr_b16 v[160:161], v8 offset:14592
  v_mfma_f32_16x16x32_bf16 v[92:95], v[164:167], v[236:239], v[92:95]
  ds_read_b64_tr_b16 v[162:163], v8 offset:21760
  v_mfma_f32_16x16x32_bf16 v[96:99], v[168:171], v[232:235], v[96:99]
  ds_read_b64_tr_b16 v[164:165], v9 offset:14624
  v_mfma_f32_16x16x32_bf16 v[100:103], v[168:171], v[236:239], v[100:103]
  ds_read_b64_tr_b16 v[166:167], v9 offset:21792
  v_mfma_f32_16x16x32_bf16 v[104:107], v[172:175], v[232:235], v[104:107]
  ds_read_b64_tr_b16 v[168:169], v8 offset:14656
  v_mfma_f32_16x16x32_bf16 v[108:111], v[172:175], v[236:239], v[108:111]
  ds_read_b64_tr_b16 v[170:171], v8 offset:21824
  v_mfma_f32_16x16x32_bf16 v[112:115], v[176:179], v[232:235], v[112:115]
  ds_read_b64_tr_b16 v[172:173], v9 offset:14688
  v_mfma_f32_16x16x32_bf16 v[116:119], v[176:179], v[236:239], v[116:119]
  ds_read_b64_tr_b16 v[174:175], v9 offset:21856
  s_waitcnt lgkmcnt(15)
  v_mfma_f32_16x16x32_bf16 v[120:123], v[180:183], v[232:235], v[120:123]
  ds_read_b64_tr_b16 v[176:177], v8 offset:14720
  v_mfma_f32_16x16x32_bf16 v[124:127], v[180:183], v[236:239], v[124:127]
  ds_read_b64_tr_b16 v[178:179], v8 offset:21888
  ds_read_b64_tr_b16 v[180:181], v9 offset:14752
  ds_read_b64_tr_b16 v[182:183], v9 offset:21920
  s_waitcnt vmcnt(0)
  v_mfma_f32_16x16x32_bf16 v[16:19], v[128:131], v[240:243], v[16:19]
  v_mfma_f32_16x16x32_bf16 v[20:23], v[128:131], v[244:247], v[20:23]
  v_mfma_f32_16x16x32_bf16 v[24:27], v[132:135], v[240:243], v[24:27]
  v_mfma_f32_16x16x32_bf16 v[28:31], v[132:135], v[244:247], v[28:31]
  v_mfma_f32_16x16x32_bf16 v[32:35], v[136:139], v[240:243], v[32:35]
  v_mfma_f32_16x16x32_bf16 v[36:39], v[136:139], v[244:247], v[36:39]
  v_mfma_f32_16x16x32_bf16 v[40:43], v[140:143], v[240:243], v[40:43]
  v_mfma_f32_16x16x32_bf16 v[44:47], v[140:143], v[244:247], v[44:47]
  s_waitcnt lgkmcnt(15)
  v_mfma_f32_16x16x32_bf16 v[48:51], v[144:147], v[240:243], v[48:51]
  v_mfma_f32_16x16x32_bf16 v[52:55], v[144:147], v[244:247], v[52:55]
  v_mfma_f32_16x16x32_bf16 v[56:59], v[148:151], v[240:243], v[56:59]
  v_mfma_f32_16x16x32_bf16 v[60:63], v[148:151], v[244:247], v[60:63]
  s_waitcnt lgkmcnt(14)
  v_mfma_f32_16x16x32_bf16 v[64:67], v[152:155], v[240:243], v[64:67]
  v_mfma_f32_16x16x32_bf16 v[68:71], v[152:155], v[244:247], v[68:71]
  s_waitcnt lgkmcnt(12)
  v_mfma_f32_16x16x32_bf16 v[72:75], v[156:159], v[240:243], v[72:75]
  v_mfma_f32_16x16x32_bf16 v[76:79], v[156:159], v[244:247], v[76:79]
  s_waitcnt lgkmcnt(10)
  v_mfma_f32_16x16x32_bf16 v[80:83], v[160:163], v[240:243], v[80:83]
  v_mfma_f32_16x16x32_bf16 v[84:87], v[160:163], v[244:247], v[84:87]
  s_waitcnt lgkmcnt(8)
  v_mfma_f32_16x16x32_bf16 v[88:91], v[164:167], v[240:243], v[88:91]
  v_mfma_f32_16x16x32_bf16 v[92:95], v[164:167], v[244:247], v[92:95]
  s_waitcnt lgkmcnt(6)
  v_mfma_f32_16x16x32_bf16 v[96:99], v[168:171], v[240:243], v[96:99]
  v_mfma_f32_16x16x32_bf16 v[100:103], v[168:171], v[244:247], v[100:103]
  s_waitcnt lgkmcnt(4)
  v_mfma_f32_16x16x32_bf16 v[104:107], v[172:175], v[240:243], v[104:107]
  v_mfma_f32_16x16x32_bf16 v[108:111], v[172:175], v[244:247], v[108:111]
  s_waitcnt lgkmcnt(2)
  v_mfma_f32_16x16x32_bf16 v[112:115], v[176:179], v[240:243], v[112:115]
  v_mfma_f32_16x16x32_bf16 v[116:119], v[176:179], v[244:247], v[116:119]
  s_waitcnt lgkmcnt(0)
  v_mfma_f32_16x16x32_bf16 v[120:123], v[180:183], v[240:243], v[120:123]
  v_mfma_f32_16x16x32_bf16 v[124:127], v[180:183], v[244:247], v[124:127]
g2_cwend:
g3_epi:
  ds_read_b128 v[128:131], v15 offset:0
  ds_read_b128 v[132:135], v15 offset:64
  v_add_f32 v248, v248, v249
  v_add_f32 v248, v248, v250
  v_add_f32 v248, v248, v251
  v_add_f32 v248, v248, v252
  v_add_f32 v248, v248, v253
  v_add_f32 v248, v248, v254
  v_add_f32 v248, v248, v255
  v_mov_b32 v252, v248
  s_nop 1
  v_permlane32_swap_b32 v248, v252
  s_nop 1
  v_mov_b32 v249, v248
  s_nop 1
  v_permlane16_swap_b32 v248, v249
  s_nop 1
  v_mul_f32 v248, 0x3a800000, v248
  v_mul_f32 v249, 0x3a800000, v249
  v_fma_f32 v249, -v248, v248, v249
  v_max_f32 v249, 0, v249
  v_add_f32 v249, 0x3727c5ac, v249
  v_rsq_f32 v249, v249
  s_nop 0
  v_sub_f32 v216, 0, v248
  v_rcp_f32 v217, v249
  v_mul_f32 v4, v249, v249
  v_mul_f32 v219, 0xc0135761, v249
  v_mul_f32 v4, 0x3d372713, v4
  v_mul_f32 v218, v4, v219
  v_mov_b32 v253, v252
  s_nop 1
  v_permlane16_swap_b32 v252, v253
  s_nop 1
  v_mul_f32 v252, 0x3a800000, v252
  v_mul_f32 v253, 0x3a800000, v253
  v_fma_f32 v253, -v252, v252, v253
  v_max_f32 v253, 0, v253
  v_add_f32 v253, 0x3727c5ac, v253
  v_rsq_f32 v253, v253
  s_nop 0
  v_sub_f32 v220, 0, v252
  v_rcp_f32 v221, v253
  v_mul_f32 v4, v253, v253
  v_mul_f32 v223, 0xc0135761, v253
  v_mul_f32 v4, 0x3d372713, v4
  v_mul_f32 v222, v4, v223
  ds_read_b128 v[136:139], v15 offset:128
  ds_read_b128 v[140:143], v15 offset:192
  s_waitcnt lgkmcnt(2)
  v_pk_fma_f32 v[16:17], v[128:129], v[216:217], v[16:17] op_sel_hi:[1,0,1]
  v_pk_fma_f32 v[18:19], v[130:131], v[216:217], v[18:19] op_sel_hi:[1,0,1]
  v_pk_fma_f32 v[24:25], v[132:133], v[216:217], v[24:25] op_sel_hi:[1,0,1]
  v_pk_fma_f32 v[26:27], v[134:135], v[216:217], v[26:27] op_sel_hi:[1,0,1]
  v_pk_fma_f32 v[20:21], v[128:129], v[220:221], v[20:21] op_sel_hi:[1,0,1]
  v_pk_fma_f32 v[22:23], v[130:131], v[220:221], v[22:23] op_sel_hi:[1,0,1]
  v_pk_fma_f32 v[28:29], v[132:133], v[220:221], v[28:29] op_sel_hi:[1,0,1]
  v_pk_fma_f32 v[30:31], v[134:135], v[220:221], v[30:31] op_sel_hi:[1,0,1]
  v_pk_mul_f32 v[144:145], v[16:17], v[16:17]
  v_pk_mul_f32 v[146:147], v[18:19], v[18:19]
  v_pk_mul_f32 v[148:149], v[24:25], v[24:25]
  v_pk_mul_f32 v[150:151], v[26:27], v[26:27]
  v_pk_mul_f32 v[152:153], v[20:21], v[20:21]
  v_pk_mul_f32 v[154:155], v[22:23], v[22:23]
  v_pk_mul_f32 v[156:157], v[28:29], v[28:29]
  v_pk_mul_f32 v[158:159], v[30:31], v[30:31]
  v_pk_fma_f32 v[144:145], v[144:145], v[218:219], v[218:219] op_sel:[0,0,1] op_sel_hi:[1,0,1]
  v_pk_fma_f32 v[146:147], v[146:147], v[218:219], v[218:219] op_sel:[0,0,1] op_sel_hi:[1,0,1]
  v_pk_fma_f32 v[148:149], v[148:149], v[218:219], v[218:219] op_sel:[0,0,1] op_sel_hi:[1,0,1]
  v_pk_fma_f32 v[150:151], v[150:151], v[218:219], v[218:219] op_sel:[0,0,1] op_sel_hi:[1,0,1]
  v_pk_fma_f32 v[152:153], v[152:153], v[222:223], v[222:223] op_sel:[0,0,1] op_sel_hi:[1,0,1]
  v_pk_fma_f32 v[154:155], v[154:155], v[222:223], v[222:223] op_sel:[0,0,1] op_sel_hi:[1,0,1]
  v_pk_fma_f32 v[156:157], v[156:157], v[222:223], v[222:223] op_sel:[0,0,1] op_sel_hi:[1,0,1]
  v_pk_fma_f32 v[158:159], v[158:159], v[222:223], v[222:223] op_sel:[0,0,1] op_sel_hi:[1,0,1]
  v_pk_mul_f32 v[144:145], v[144:145], v[16:17]
  v_pk_mul_f32 v[146:147], v[146:147], v[18:19]
  v_pk_mul_f32 v[148:149], v[148:149], v[24:25]
  v_pk_mul_f32 v[150:151], v[150:151], v[26:27]
  v_pk_mul_f32 v[152:153], v[152:153], v[20:21]
  v_pk_mul_f32 v[154:155], v[154:155], v[22:23]
  v_pk_mul_f32 v[156:157], v[156:157], v[28:29]
  v_pk_mul_f32 v[158:159], v[158:159], v[30:31]
  v_exp_f32 v144, v144
  v_exp_f32 v145, v145
  v_exp_f32 v146, v146
  v_exp_f32 v147, v147
  v_exp_f32 v148, v148
  v_exp_f32 v149, v149
  v_exp_f32 v150, v150
  v_exp_f32 v151, v151
  v_exp_f32 v152, v152
  v_exp_f32 v153, v153
  v_exp_f32 v154, v154
  v_exp_f32 v155, v155
  v_exp_f32 v156, v156
  v_exp_f32 v157, v157
  v_exp_f32 v158, v158
  v_exp_f32 v159, v159
  v_pk_fma_f32 v[144:145], v[144:145], v[216:217], v[216:217] op_sel:[0,1,1] op_sel_hi:[1,1,1]
  v_pk_fma_f32 v[146:147], v[146:147], v[216:217], v[216:217] op_sel:[0,1,1] op_sel_hi:[1,1,1]
  v_pk_fma_f32 v[148:149], v[148:149], v[216:217], v[216:217] op_sel:[0,1,1] op_sel_hi:[1,1,1]
  v_pk_fma_f32 v[150:151], v[150:151], v[216:217], v[216:217] op_sel:[0,1,1] op_sel_hi:[1,1,1]
  v_pk_fma_f32 v[152:153], v[152:153], v[220:221], v[220:221] op_sel:[0,1,1] op_sel_hi:[1,1,1]
  v_pk_fma_f32 v[154:155], v[154:155], v[220:221], v[220:221] op_sel:[0,1,1] op_sel_hi:[1,1,1]
  v_pk_fma_f32 v[156:157], v[156:157], v[220:221], v[220:221] op_sel:[0,1,1] op_sel_hi:[1,1,1]
  v_pk_fma_f32 v[158:159], v[158:159], v[220:221], v[220:221] op_sel:[0,1,1] op_sel_hi:[1,1,1]
  v_rcp_f32 v144, v144
  v_rcp_f32 v145, v145
  v_rcp_f32 v146, v146
  v_rcp_f32 v147, v147
  v_rcp_f32 v148, v148
  v_rcp_f32 v149, v149
  v_rcp_f32 v150, v150
  v_rcp_f32 v151, v151
  v_rcp_f32 v152, v152
  v_rcp_f32 v153, v153
  v_rcp_f32 v154, v154
  v_rcp_f32 v155, v155
  v_rcp_f32 v156, v156
  v_rcp_f32 v157, v157
  v_rcp_f32 v158, v158
  v_rcp_f32 v159, v159
  v_pk_mul_f32 v[16:17], v[16:17], v[144:145]
  v_pk_mul_f32 v[18:19], v[18:19], v[146:147]
  v_pk_mul_f32 v[24:25], v[24:25], v[148:149]
  v_pk_mul_f32 v[26:27], v[26:27], v[150:151]
  v_pk_mul_f32 v[20:21], v[20:21], v[152:153]
  v_pk_mul_f32 v[22:23], v[22:23], v[154:155]
  v_pk_mul_f32 v[28:29], v[28:29], v[156:157]
  v_pk_mul_f32 v[30:31], v[30:31], v[158:159]
  v_cvt_pk_bf16_f32 v184, v16, v17
  v_cvt_pk_bf16_f32 v185, v18, v19
  v_cvt_pk_bf16_f32 v186, v24, v25
  v_cvt_pk_bf16_f32 v187, v26, v27
  v_cvt_pk_bf16_f32 v188, v20, v21
  v_cvt_pk_bf16_f32 v189, v22, v23
  v_cvt_pk_bf16_f32 v190, v28, v29
  v_cvt_pk_bf16_f32 v191, v30, v31
  s_mov_b32 s26, 0
  buffer_store_dwordx4 v[184:187], v6, s[12:15], s26 offen sc1
  buffer_store_dwordx4 v[188:191], v7, s[12:15], s26 offen sc1
  ds_read_b128 v[128:131], v15 offset:256
  ds_read_b128 v[132:135], v15 offset:320
  s_waitcnt lgkmcnt(2)
  v_pk_fma_f32 v[32:33], v[136:137], v[216:217], v[32:33] op_sel_hi:[1,0,1]
  v_pk_fma_f32 v[34:35], v[138:139], v[216:217], v[34:35] op_sel_hi:[1,0,1]
  v_pk_fma_f32 v[40:41], v[140:141], v[216:217], v[40:41] op_sel_hi:[1,0,1]
  v_pk_fma_f32 v[42:43], v[142:143], v[216:217], v[42:43] op_sel_hi:[1,0,1]
  v_pk_fma_f32 v[36:37], v[136:137], v[220:221], v[36:37] op_sel_hi:[1,0,1]
  v_pk_fma_f32 v[38:39], v[138:139], v[220:221], v[38:39] op_sel_hi:[1,0,1]
  v_pk_fma_f32 v[44:45], v[140:141], v[220:221], v[44:45] op_sel_hi:[1,0,1]
  v_pk_fma_f32 v[46:47], v[142:143], v[220:221], v[46:47] op_sel_hi:[1,0,1]
  v_pk_mul_f32 v[144:145], v[32:33], v[32:33]
  v_pk_mul_f32 v[146:147], v[34:35], v[34:35]
  v_pk_mul_f32 v[148:149], v[40:41], v[40:41]
  v_pk_mul_f32 v[150:151], v[42:43], v[42:43]
  v_pk_mul_f32 v[152:153], v[36:37], v[36:37]
  v_pk_mul_f32 v[154:155], v[38:39], v[38:39]
  v_pk_mul_f32 v[156:157], v[44:45], v[44:45]
  v_pk_mul_f32 v[158:159], v[46:47], v[46:47]
  v_pk_fma_f32 v[144:145], v[144:145], v[218:219], v[218:219] op_sel:[0,0,1] op_sel_hi:[1,0,1]
  v_pk_fma_f32 v[146:147], v[146:147], v[218:219], v[218:219] op_sel:[0,0,1] op_sel_hi:[1,0,1]
  v_pk_fma_f32 v[148:149], v[148:149], v[218:219], v[218:219] op_sel:[0,0,1] op_sel_hi:[1,0,1]
  v_pk_fma_f32 v[150:151], v[150:151], v[218:219], v[218:219] op_sel:[0,0,1] op_sel_hi:[1,0,1]
  v_pk_fma_f32 v[152:153], v[152:153], v[222:223], v[222:223] op_sel:[0,0,1] op_sel_hi:[1,0,1]
  v_pk_fma_f32 v[154:155], v[154:155], v[222:223], v[222:223] op_sel:[0,0,1] op_sel_hi:[1,0,1]
  v_pk_fma_f32 v[156:157], v[156:157], v[222:223], v[222:223] op_sel:[0,0,1] op_sel_hi:[1,0,1]
  v_pk_fma_f32 v[158:159], v[158:159], v[222:223], v[222:223] op_sel:[0,0,1] op_sel_hi:[1,0,1]
  v_pk_mul_f32 v[144:145], v[144:145], v[32:33]
  v_pk_mul_f32 v[146:147], v[146:147], v[34:35]
  v_pk_mul_f32 v[148:149], v[148:149], v[40:41]
  v_pk_mul_f32 v[150:151], v[150:151], v[42:43]
  v_pk_mul_f32 v[152:153], v[152:153], v[36:37]
  v_pk_mul_f32 v[154:155], v[154:155], v[38:39]
  v_pk_mul_f32 v[156:157], v[156:157], v[44:45]
  v_pk_mul_f32 v[158:159], v[158:159], v[46:47]
  v_exp_f32 v144, v144
  v_exp_f32 v145, v145
  v_exp_f32 v146, v146
  v_exp_f32 v147, v147
  v_exp_f32 v148, v148
  v_exp_f32 v149, v149
  v_exp_f32 v150, v150
  v_exp_f32 v151, v151
  v_exp_f32 v152, v152
  v_exp_f32 v153, v153
  v_exp_f32 v154, v154
  v_exp_f32 v155, v155
  v_exp_f32 v156, v156
  v_exp_f32 v157, v157
  v_exp_f32 v158, v158
  v_exp_f32 v159, v159
  v_pk_fma_f32 v[144:145], v[144:145], v[216:217], v[216:217] op_sel:[0,1,1] op_sel_hi:[1,1,1]
  v_pk_fma_f32 v[146:147], v[146:147], v[216:217], v[216:217] op_sel:[0,1,1] op_sel_hi:[1,1,1]
  v_pk_fma_f32 v[148:149], v[148:149], v[216:217], v[216:217] op_sel:[0,1,1] op_sel_hi:[1,1,1]
  v_pk_fma_f32 v[150:151], v[150:151], v[216:217], v[216:217] op_sel:[0,1,1] op_sel_hi:[1,1,1]
  v_pk_fma_f32 v[152:153], v[152:153], v[220:221], v[220:221] op_sel:[0,1,1] op_sel_hi:[1,1,1]
  v_pk_fma_f32 v[154:155], v[154:155], v[220:221], v[220:221] op_sel:[0,1,1] op_sel_hi:[1,1,1]
  v_pk_fma_f32 v[156:157], v[156:157], v[220:221], v[220:221] op_sel:[0,1,1] op_sel_hi:[1,1,1]
  v_pk_fma_f32 v[158:159], v[158:159], v[220:221], v[220:221] op_sel:[0,1,1] op_sel_hi:[1,1,1]
  v_rcp_f32 v144, v144
  v_rcp_f32 v145, v145
  v_rcp_f32 v146, v146
  v_rcp_f32 v147, v147
  v_rcp_f32 v148, v148
  v_rcp_f32 v149, v149
  v_rcp_f32 v150, v150
  v_rcp_f32 v151, v151
  v_rcp_f32 v152, v152
  v_rcp_f32 v153, v153
  v_rcp_f32 v154, v154
  v_rcp_f32 v155, v155
  v_rcp_f32 v156, v156
  v_rcp_f32 v157, v157
  v_rcp_f32 v158, v158
  v_rcp_f32 v159, v159
  v_pk_mul_f32 v[32:33], v[32:33], v[144:145]
  v_pk_mul_f32 v[34:35], v[34:35], v[146:147]
  v_pk_mul_f32 v[40:41], v[40:41], v[148:149]
  v_pk_mul_f32 v[42:43], v[42:43], v[150:151]
  v_pk_mul_f32 v[36:37], v[36:37], v[152:153]
  v_pk_mul_f32 v[38:39], v[38:39], v[154:155]
  v_pk_mul_f32 v[44:45], v[44:45], v[156:157]
  v_pk_mul_f32 v[46:47], v[46:47], v[158:159]
  v_cvt_pk_bf16_f32 v192, v32, v33
  v_cvt_pk_bf16_f32 v193, v34, v35
  v_cvt_pk_bf16_f32 v194, v40, v41
  v_cvt_pk_bf16_f32 v195, v42, v43
  v_cvt_pk_bf16_f32 v196, v36, v37
  v_cvt_pk_bf16_f32 v197, v38, v39
  v_cvt_pk_bf16_f32 v198, v44, v45
  v_cvt_pk_bf16_f32 v199, v46, v47
  s_mov_b32 s26, 1024
  buffer_store_dwordx4 v[192:195], v6, s[12:15], s26 offen sc1
  buffer_store_dwordx4 v[196:199], v7, s[12:15], s26 offen sc1
  ds_read_b128 v[136:139], v15 offset:384
  ds_read_b128 v[140:143], v15 offset:448
  s_waitcnt lgkmcnt(2)
  v_pk_fma_f32 v[48:49], v[128:129], v[216:217], v[48:49] op_sel_hi:[1,0,1]
  v_pk_fma_f32 v[50:51], v[130:131], v[216:217], v[50:51] op_sel_hi:[1,0,1]
  v_pk_fma_f32 v[56:57], v[132:133], v[216:217], v[56:57] op_sel_hi:[1,0,1]
  v_pk_fma_f32 v[58:59], v[134:135], v[216:217], v[58:59] op_sel_hi:[1,0,1]
  v_pk_fma_f32 v[52:53], v[128:129], v[220:221], v[52:53] op_sel_hi:[1,0,1]
  v_pk_fma_f32 v[54:55], v[130:131], v[220:221], v[54:55] op_sel_hi:[1,0,1]
  v_pk_fma_f32 v[60:61], v[132:133], v[220:221], v[60:61] op_sel_hi:[1,0,1]
  v_pk_fma_f32 v[62:63], v[134:135], v[220:221], v[62:63] op_sel_hi:[1,0,1]
  v_pk_mul_f32 v[144:145], v[48:49], v[48:49]
  v_pk_mul_f32 v[146:147], v[50:51], v[50:51]
  v_pk_mul_f32 v[148:149], v[56:57], v[56:57]
  v_pk_mul_f32 v[150:151], v[58:59], v[58:59]
  v_pk_mul_f32 v[152:153], v[52:53], v[52:53]
  v_pk_mul_f32 v[154:155], v[54:55], v[54:55]
  v_pk_mul_f32 v[156:157], v[60:61], v[60:61]
  v_pk_mul_f32 v[158:159], v[62:63], v[62:63]
  v_pk_fma_f32 v[144:145], v[144:145], v[218:219], v[218:219] op_sel:[0,0,1] op_sel_hi:[1,0,1]
  v_pk_fma_f32 v[146:147], v[146:147], v[218:219], v[218:219] op_sel:[0,0,1] op_sel_hi:[1,0,1]
  v_pk_fma_f32 v[148:149], v[148:149], v[218:219], v[218:219] op_sel:[0,0,1] op_sel_hi:[1,0,1]
  v_pk_fma_f32 v[150:151], v[150:151], v[218:219], v[218:219] op_sel:[0,0,1] op_sel_hi:[1,0,1]
  v_pk_fma_f32 v[152:153], v[152:153], v[222:223], v[222:223] op_sel:[0,0,1] op_sel_hi:[1,0,1]
  v_pk_fma_f32 v[154:155], v[154:155], v[222:223], v[222:223] op_sel:[0,0,1] op_sel_hi:[1,0,1]
  v_pk_fma_f32 v[156:157], v[156:157], v[222:223], v[222:223] op_sel:[0,0,1] op_sel_hi:[1,0,1]
  v_pk_fma_f32 v[158:159], v[158:159], v[222:223], v[222:223] op_sel:[0,0,1] op_sel_hi:[1,0,1]
  v_pk_mul_f32 v[144:145], v[144:145], v[48:49]
  v_pk_mul_f32 v[146:147], v[146:147], v[50:51]
  v_pk_mul_f32 v[148:149], v[148:149], v[56:57]
  v_pk_mul_f32 v[150:151], v[150:151], v[58:59]
  v_pk_mul_f32 v[152:153], v[152:153], v[52:53]
  v_pk_mul_f32 v[154:155], v[154:155], v[54:55]
  v_pk_mul_f32 v[156:157], v[156:157], v[60:61]
  v_pk_mul_f32 v[158:159], v[158:159], v[62:63]
  v_exp_f32 v144, v144
  v_exp_f32 v145, v145
  v_exp_f32 v146, v146
  v_exp_f32 v147, v147
  v_exp_f32 v148, v148
  v_exp_f32 v149, v149
  v_exp_f32 v150, v150
  v_exp_f32 v151, v151
  v_exp_f32 v152, v152
  v_exp_f32 v153, v153
  v_exp_f32 v154, v154
  v_exp_f32 v155, v155
  v_exp_f32 v156, v156
  v_exp_f32 v157, v157
  v_exp_f32 v158, v158
  v_exp_f32 v159, v159
  v_pk_fma_f32 v[144:145], v[144:145], v[216:217], v[216:217] op_sel:[0,1,1] op_sel_hi:[1,1,1]
  v_pk_fma_f32 v[146:147], v[146:147], v[216:217], v[216:217] op_sel:[0,1,1] op_sel_hi:[1,1,1]
  v_pk_fma_f32 v[148:149], v[148:149], v[216:217], v[216:217] op_sel:[0,1,1] op_sel_hi:[1,1,1]
  v_pk_fma_f32 v[150:151], v[150:151], v[216:217], v[216:217] op_sel:[0,1,1] op_sel_hi:[1,1,1]
  v_pk_fma_f32 v[152:153], v[152:153], v[220:221], v[220:221] op_sel:[0,1,1] op_sel_hi:[1,1,1]
  v_pk_fma_f32 v[154:155], v[154:155], v[220:221], v[220:221] op_sel:[0,1,1] op_sel_hi:[1,1,1]
  v_pk_fma_f32 v[156:157], v[156:157], v[220:221], v[220:221] op_sel:[0,1,1] op_sel_hi:[1,1,1]
  v_pk_fma_f32 v[158:159], v[158:159], v[220:221], v[220:221] op_sel:[0,1,1] op_sel_hi:[1,1,1]
  v_rcp_f32 v144, v144
  v_rcp_f32 v145, v145
  v_rcp_f32 v146, v146
  v_rcp_f32 v147, v147
  v_rcp_f32 v148, v148
  v_rcp_f32 v149, v149
  v_rcp_f32 v150, v150
  v_rcp_f32 v151, v151
  v_rcp_f32 v152, v152
  v_rcp_f32 v153, v153
  v_rcp_f32 v154, v154
  v_rcp_f32 v155, v155
  v_rcp_f32 v156, v156
  v_rcp_f32 v157, v157
  v_rcp_f32 v158, v158
  v_rcp_f32 v159, v159
  v_pk_mul_f32 v[48:49], v[48:49], v[144:145]
  v_pk_mul_f32 v[50:51], v[50:51], v[146:147]
  v_pk_mul_f32 v[56:57], v[56:57], v[148:149]
  v_pk_mul_f32 v[58:59], v[58:59], v[150:151]
  v_pk_mul_f32 v[52:53], v[52:53], v[152:153]
  v_pk_mul_f32 v[54:55], v[54:55], v[154:155]
  v_pk_mul_f32 v[60:61], v[60:61], v[156:157]
  v_pk_mul_f32 v[62:63], v[62:63], v[158:159]
  v_cvt_pk_bf16_f32 v184, v48, v49
  v_cvt_pk_bf16_f32 v185, v50, v51
  v_cvt_pk_bf16_f32 v186, v56, v57
  v_cvt_pk_bf16_f32 v187, v58, v59
  v_cvt_pk_bf16_f32 v188, v52, v53
  v_cvt_pk_bf16_f32 v189, v54, v55
  v_cvt_pk_bf16_f32 v190, v60, v61
  v_cvt_pk_bf16_f32 v191, v62, v63
  s_mov_b32 s26, 2048
  buffer_store_dwordx4 v[184:187], v6, s[12:15], s26 offen sc1
  buffer_store_dwordx4 v[188:191], v7, s[12:15], s26 offen sc1
  ds_read_b128 v[128:131], v15 offset:512
  ds_read_b128 v[132:135], v15 offset:576
  s_waitcnt lgkmcnt(2)
  v_pk_fma_f32 v[64:65], v[136:137], v[216:217], v[64:65] op_sel_hi:[1,0,1]
  v_pk_fma_f32 v[66:67], v[138:139], v[216:217], v[66:67] op_sel_hi:[1,0,1]
  v_pk_fma_f32 v[72:73], v[140:141], v[216:217], v[72:73] op_sel_hi:[1,0,1]
  v_pk_fma_f32 v[74:75], v[142:143], v[216:217], v[74:75] op_sel_hi:[1,0,1]
  v_pk_fma_f32 v[68:69], v[136:137], v[220:221], v[68:69] op_sel_hi:[1,0,1]
  v_pk_fma_f32 v[70:71], v[138:139], v[220:221], v[70:71] op_sel_hi:[1,0,1]
  v_pk_fma_f32 v[76:77], v[140:141], v[220:221], v[76:77] op_sel_hi:[1,0,1]
  v_pk_fma_f32 v[78:79], v[142:143], v[220:221], v[78:79] op_sel_hi:[1,0,1]
  v_pk_mul_f32 v[144:145], v[64:65], v[64:65]
  v_pk_mul_f32 v[146:147], v[66:67], v[66:67]
  v_pk_mul_f32 v[148:149], v[72:73], v[72:73]
  v_pk_mul_f32 v[150:151], v[74:75], v[74:75]
  v_pk_mul_f32 v[152:153], v[68:69], v[68:69]
  v_pk_mul_f32 v[154:155], v[70:71], v[70:71]
  v_pk_mul_f32 v[156:157], v[76:77], v[76:77]
  v_pk_mul_f32 v[158:159], v[78:79], v[78:79]
  v_pk_fma_f32 v[144:145], v[144:145], v[218:219], v[218:219] op_sel:[0,0,1] op_sel_hi:[1,0,1]
  v_pk_fma_f32 v[146:147], v[146:147], v[218:219], v[218:219] op_sel:[0,0,1] op_sel_hi:[1,0,1]
  v_pk_fma_f32 v[148:149], v[148:149], v[218:219], v[218:219] op_sel:[0,0,1] op_sel_hi:[1,0,1]
  v_pk_fma_f32 v[150:151], v[150:151], v[218:219], v[218:219] op_sel:[0,0,1] op_sel_hi:[1,0,1]
  v_pk_fma_f32 v[152:153], v[152:153], v[222:223], v[222:223] op_sel:[0,0,1] op_sel_hi:[1,0,1]
  v_pk_fma_f32 v[154:155], v[154:155], v[222:223], v[222:223] op_sel:[0,0,1] op_sel_hi:[1,0,1]
  v_pk_fma_f32 v[156:157], v[156:157], v[222:223], v[222:223] op_sel:[0,0,1] op_sel_hi:[1,0,1]
  v_pk_fma_f32 v[158:159], v[158:159], v[222:223], v[222:223] op_sel:[0,0,1] op_sel_hi:[1,0,1]
  v_pk_mul_f32 v[144:145], v[144:145], v[64:65]
  v_pk_mul_f32 v[146:147], v[146:147], v[66:67]
  v_pk_mul_f32 v[148:149], v[148:149], v[72:73]
  v_pk_mul_f32 v[150:151], v[150:151], v[74:75]
  v_pk_mul_f32 v[152:153], v[152:153], v[68:69]
  v_pk_mul_f32 v[154:155], v[154:155], v[70:71]
  v_pk_mul_f32 v[156:157], v[156:157], v[76:77]
  v_pk_mul_f32 v[158:159], v[158:159], v[78:79]
  v_exp_f32 v144, v144
  v_exp_f32 v145, v145
  v_exp_f32 v146, v146
  v_exp_f32 v147, v147
  v_exp_f32 v148, v148
  v_exp_f32 v149, v149
  v_exp_f32 v150, v150
  v_exp_f32 v151, v151
  v_exp_f32 v152, v152
  v_exp_f32 v153, v153
  v_exp_f32 v154, v154
  v_exp_f32 v155, v155
  v_exp_f32 v156, v156
  v_exp_f32 v157, v157
  v_exp_f32 v158, v158
  v_exp_f32 v159, v159
  v_pk_fma_f32 v[144:145], v[144:145], v[216:217], v[216:217] op_sel:[0,1,1] op_sel_hi:[1,1,1]
  v_pk_fma_f32 v[146:147], v[146:147], v[216:217], v[216:217] op_sel:[0,1,1] op_sel_hi:[1,1,1]
  v_pk_fma_f32 v[148:149], v[148:149], v[216:217], v[216:217] op_sel:[0,1,1] op_sel_hi:[1,1,1]
  v_pk_fma_f32 v[150:151], v[150:151], v[216:217], v[216:217] op_sel:[0,1,1] op_sel_hi:[1,1,1]
  v_pk_fma_f32 v[152:153], v[152:153], v[220:221], v[220:221] op_sel:[0,1,1] op_sel_hi:[1,1,1]
  v_pk_fma_f32 v[154:155], v[154:155], v[220:221], v[220:221] op_sel:[0,1,1] op_sel_hi:[1,1,1]
  v_pk_fma_f32 v[156:157], v[156:157], v[220:221], v[220:221] op_sel:[0,1,1] op_sel_hi:[1,1,1]
  v_pk_fma_f32 v[158:159], v[158:159], v[220:221], v[220:221] op_sel:[0,1,1] op_sel_hi:[1,1,1]
  v_rcp_f32 v144, v144
  v_rcp_f32 v145, v145
  v_rcp_f32 v146, v146
  v_rcp_f32 v147, v147
  v_rcp_f32 v148, v148
  v_rcp_f32 v149, v149
  v_rcp_f32 v150, v150
  v_rcp_f32 v151, v151
  v_rcp_f32 v152, v152
  v_rcp_f32 v153, v153
  v_rcp_f32 v154, v154
  v_rcp_f32 v155, v155
  v_rcp_f32 v156, v156
  v_rcp_f32 v157, v157
  v_rcp_f32 v158, v158
  v_rcp_f32 v159, v159
  v_pk_mul_f32 v[64:65], v[64:65], v[144:145]
  v_pk_mul_f32 v[66:67], v[66:67], v[146:147]
  v_pk_mul_f32 v[72:73], v[72:73], v[148:149]
  v_pk_mul_f32 v[74:75], v[74:75], v[150:151]
  v_pk_mul_f32 v[68:69], v[68:69], v[152:153]
  v_pk_mul_f32 v[70:71], v[70:71], v[154:155]
  v_pk_mul_f32 v[76:77], v[76:77], v[156:157]
  v_pk_mul_f32 v[78:79], v[78:79], v[158:159]
  v_cvt_pk_bf16_f32 v192, v64, v65
  v_cvt_pk_bf16_f32 v193, v66, v67
  v_cvt_pk_bf16_f32 v194, v72, v73
  v_cvt_pk_bf16_f32 v195, v74, v75
  v_cvt_pk_bf16_f32 v196, v68, v69
  v_cvt_pk_bf16_f32 v197, v70, v71
  v_cvt_pk_bf16_f32 v198, v76, v77
  v_cvt_pk_bf16_f32 v199, v78, v79
  s_mov_b32 s26, 3072
  buffer_store_dwordx4 v[192:195], v6, s[12:15], s26 offen sc1
  buffer_store_dwordx4 v[196:199], v7, s[12:15], s26 offen sc1
  ds_read_b128 v[136:139], v15 offset:640
  ds_read_b128 v[140:143], v15 offset:704
  s_waitcnt lgkmcnt(2)
  v_pk_fma_f32 v[80:81], v[128:129], v[216:217], v[80:81] op_sel_hi:[1,0,1]
  v_pk_fma_f32 v[82:83], v[130:131], v[216:217], v[82:83] op_sel_hi:[1,0,1]
  v_pk_fma_f32 v[88:89], v[132:133], v[216:217], v[88:89] op_sel_hi:[1,0,1]
  v_pk_fma_f32 v[90:91], v[134:135], v[216:217], v[90:91] op_sel_hi:[1,0,1]
  v_pk_fma_f32 v[84:85], v[128:129], v[220:221], v[84:85] op_sel_hi:[1,0,1]
  v_pk_fma_f32 v[86:87], v[130:131], v[220:221], v[86:87] op_sel_hi:[1,0,1]
  v_pk_fma_f32 v[92:93], v[132:133], v[220:221], v[92:93] op_sel_hi:[1,0,1]
  v_pk_fma_f32 v[94:95], v[134:135], v[220:221], v[94:95] op_sel_hi:[1,0,1]
  v_pk_mul_f32 v[144:145], v[80:81], v[80:81]
  v_pk_mul_f32 v[146:147], v[82:83], v[82:83]
  v_pk_mul_f32 v[148:149], v[88:89], v[88:89]
  v_pk_mul_f32 v[150:151], v[90:91], v[90:91]
  v_pk_mul_f32 v[152:153], v[84:85], v[84:85]
  v_pk_mul_f32 v[154:155], v[86:87], v[86:87]
  v_pk_mul_f32 v[156:157], v[92:93], v[92:93]
  v_pk_mul_f32 v[158:159], v[94:95], v[94:95]
  v_pk_fma_f32 v[144:145], v[144:145], v[218:219], v[218:219] op_sel:[0,0,1] op_sel_hi:[1,0,1]
  v_pk_fma_f32 v[146:147], v[146:147], v[218:219], v[218:219] op_sel:[0,0,1] op_sel_hi:[1,0,1]
  v_pk_fma_f32 v[148:149], v[148:149], v[218:219], v[218:219] op_sel:[0,0,1] op_sel_hi:[1,0,1]
  v_pk_fma_f32 v[150:151], v[150:151], v[218:219], v[218:219] op_sel:[0,0,1] op_sel_hi:[1,0,1]
  v_pk_fma_f32 v[152:153], v[152:153], v[222:223], v[222:223] op_sel:[0,0,1] op_sel_hi:[1,0,1]
  v_pk_fma_f32 v[154:155], v[154:155], v[222:223], v[222:223] op_sel:[0,0,1] op_sel_hi:[1,0,1]
  v_pk_fma_f32 v[156:157], v[156:157], v[222:223], v[222:223] op_sel:[0,0,1] op_sel_hi:[1,0,1]
  v_pk_fma_f32 v[158:159], v[158:159], v[222:223], v[222:223] op_sel:[0,0,1] op_sel_hi:[1,0,1]
  v_pk_mul_f32 v[144:145], v[144:145], v[80:81]
  v_pk_mul_f32 v[146:147], v[146:147], v[82:83]
  v_pk_mul_f32 v[148:149], v[148:149], v[88:89]
  v_pk_mul_f32 v[150:151], v[150:151], v[90:91]
  v_pk_mul_f32 v[152:153], v[152:153], v[84:85]
  v_pk_mul_f32 v[154:155], v[154:155], v[86:87]
  v_pk_mul_f32 v[156:157], v[156:157], v[92:93]
  v_pk_mul_f32 v[158:159], v[158:159], v[94:95]
  v_exp_f32 v144, v144
  v_exp_f32 v145, v145
  v_exp_f32 v146, v146
  v_exp_f32 v147, v147
  v_exp_f32 v148, v148
  v_exp_f32 v149, v149
  v_exp_f32 v150, v150
  v_exp_f32 v151, v151
  v_exp_f32 v152, v152
  v_exp_f32 v153, v153
  v_exp_f32 v154, v154
  v_exp_f32 v155, v155
  v_exp_f32 v156, v156
  v_exp_f32 v157, v157
  v_exp_f32 v158, v158
  v_exp_f32 v159, v159
  v_pk_fma_f32 v[144:145], v[144:145], v[216:217], v[216:217] op_sel:[0,1,1] op_sel_hi:[1,1,1]
  v_pk_fma_f32 v[146:147], v[146:147], v[216:217], v[216:217] op_sel:[0,1,1] op_sel_hi:[1,1,1]
  v_pk_fma_f32 v[148:149], v[148:149], v[216:217], v[216:217] op_sel:[0,1,1] op_sel_hi:[1,1,1]
  v_pk_fma_f32 v[150:151], v[150:151], v[216:217], v[216:217] op_sel:[0,1,1] op_sel_hi:[1,1,1]
  v_pk_fma_f32 v[152:153], v[152:153], v[220:221], v[220:221] op_sel:[0,1,1] op_sel_hi:[1,1,1]
  v_pk_fma_f32 v[154:155], v[154:155], v[220:221], v[220:221] op_sel:[0,1,1] op_sel_hi:[1,1,1]
  v_pk_fma_f32 v[156:157], v[156:157], v[220:221], v[220:221] op_sel:[0,1,1] op_sel_hi:[1,1,1]
  v_pk_fma_f32 v[158:159], v[158:159], v[220:221], v[220:221] op_sel:[0,1,1] op_sel_hi:[1,1,1]
  v_rcp_f32 v144, v144
  v_rcp_f32 v145, v145
  v_rcp_f32 v146, v146
  v_rcp_f32 v147, v147
  v_rcp_f32 v148, v148
  v_rcp_f32 v149, v149
  v_rcp_f32 v150, v150
  v_rcp_f32 v151, v151
  v_rcp_f32 v152, v152
  v_rcp_f32 v153, v153
  v_rcp_f32 v154, v154
  v_rcp_f32 v155, v155
  v_rcp_f32 v156, v156
  v_rcp_f32 v157, v157
  v_rcp_f32 v158, v158
  v_rcp_f32 v159, v159
  v_pk_mul_f32 v[80:81], v[80:81], v[144:145]
  v_pk_mul_f32 v[82:83], v[82:83], v[146:147]
  v_pk_mul_f32 v[88:89], v[88:89], v[148:149]
  v_pk_mul_f32 v[90:91], v[90:91], v[150:151]
  v_pk_mul_f32 v[84:85], v[84:85], v[152:153]
  v_pk_mul_f32 v[86:87], v[86:87], v[154:155]
  v_pk_mul_f32 v[92:93], v[92:93], v[156:157]
  v_pk_mul_f32 v[94:95], v[94:95], v[158:159]
  v_cvt_pk_bf16_f32 v184, v80, v81
  v_cvt_pk_bf16_f32 v185, v82, v83
  v_cvt_pk_bf16_f32 v186, v88, v89
  v_cvt_pk_bf16_f32 v187, v90, v91
  v_cvt_pk_bf16_f32 v188, v84, v85
  v_cvt_pk_bf16_f32 v189, v86, v87
  v_cvt_pk_bf16_f32 v190, v92, v93
  v_cvt_pk_bf16_f32 v191, v94, v95
  s_mov_b32 s26, 4096
  buffer_store_dwordx4 v[184:187], v6, s[12:15], s26 offen sc1
  buffer_store_dwordx4 v[188:191], v7, s[12:15], s26 offen sc1
  ds_read_b128 v[128:131], v15 offset:768
  ds_read_b128 v[132:135], v15 offset:832
  s_waitcnt lgkmcnt(2)
  v_pk_fma_f32 v[96:97], v[136:137], v[216:217], v[96:97] op_sel_hi:[1,0,1]
  v_pk_fma_f32 v[98:99], v[138:139], v[216:217], v[98:99] op_sel_hi:[1,0,1]
  v_pk_fma_f32 v[104:105], v[140:141], v[216:217], v[104:105] op_sel_hi:[1,0,1]
  v_pk_fma_f32 v[106:107], v[142:143], v[216:217], v[106:107] op_sel_hi:[1,0,1]
  v_pk_fma_f32 v[100:101], v[136:137], v[220:221], v[100:101] op_sel_hi:[1,0,1]
  v_pk_fma_f32 v[102:103], v[138:139], v[220:221], v[102:103] op_sel_hi:[1,0,1]
  v_pk_fma_f32 v[108:109], v[140:141], v[220:221], v[108:109] op_sel_hi:[1,0,1]
  v_pk_fma_f32 v[110:111], v[142:143], v[220:221], v[110:111] op_sel_hi:[1,0,1]
  v_pk_mul_f32 v[144:145], v[96:97], v[96:97]
  v_pk_mul_f32 v[146:147], v[98:99], v[98:99]
  v_pk_mul_f32 v[148:149], v[104:105], v[104:105]
  v_pk_mul_f32 v[150:151], v[106:107], v[106:107]
  v_pk_mul_f32 v[152:153], v[100:101], v[100:101]
  v_pk_mul_f32 v[154:155], v[102:103], v[102:103]
  v_pk_mul_f32 v[156:157], v[108:109], v[108:109]
  v_pk_mul_f32 v[158:159], v[110:111], v[110:111]
  v_pk_fma_f32 v[144:145], v[144:145], v[218:219], v[218:219] op_sel:[0,0,1] op_sel_hi:[1,0,1]
  v_pk_fma_f32 v[146:147], v[146:147], v[218:219], v[218:219] op_sel:[0,0,1] op_sel_hi:[1,0,1]
  v_pk_fma_f32 v[148:149], v[148:149], v[218:219], v[218:219] op_sel:[0,0,1] op_sel_hi:[1,0,1]
  v_pk_fma_f32 v[150:151], v[150:151], v[218:219], v[218:219] op_sel:[0,0,1] op_sel_hi:[1,0,1]
  v_pk_fma_f32 v[152:153], v[152:153], v[222:223], v[222:223] op_sel:[0,0,1] op_sel_hi:[1,0,1]
  v_pk_fma_f32 v[154:155], v[154:155], v[222:223], v[222:223] op_sel:[0,0,1] op_sel_hi:[1,0,1]
  v_pk_fma_f32 v[156:157], v[156:157], v[222:223], v[222:223] op_sel:[0,0,1] op_sel_hi:[1,0,1]
  v_pk_fma_f32 v[158:159], v[158:159], v[222:223], v[222:223] op_sel:[0,0,1] op_sel_hi:[1,0,1]
  v_pk_mul_f32 v[144:145], v[144:145], v[96:97]
  v_pk_mul_f32 v[146:147], v[146:147], v[98:99]
  v_pk_mul_f32 v[148:149], v[148:149], v[104:105]
  v_pk_mul_f32 v[150:151], v[150:151], v[106:107]
  v_pk_mul_f32 v[152:153], v[152:153], v[100:101]
  v_pk_mul_f32 v[154:155], v[154:155], v[102:103]
  v_pk_mul_f32 v[156:157], v[156:157], v[108:109]
  v_pk_mul_f32 v[158:159], v[158:159], v[110:111]
  v_exp_f32 v144, v144
  v_exp_f32 v145, v145
  v_exp_f32 v146, v146
  v_exp_f32 v147, v147
  v_exp_f32 v148, v148
  v_exp_f32 v149, v149
  v_exp_f32 v150, v150
  v_exp_f32 v151, v151
  v_exp_f32 v152, v152
  v_exp_f32 v153, v153
  v_exp_f32 v154, v154
  v_exp_f32 v155, v155
  v_exp_f32 v156, v156
  v_exp_f32 v157, v157
  v_exp_f32 v158, v158
  v_exp_f32 v159, v159
  v_pk_fma_f32 v[144:145], v[144:145], v[216:217], v[216:217] op_sel:[0,1,1] op_sel_hi:[1,1,1]
  v_pk_fma_f32 v[146:147], v[146:147], v[216:217], v[216:217] op_sel:[0,1,1] op_sel_hi:[1,1,1]
  v_pk_fma_f32 v[148:149], v[148:149], v[216:217], v[216:217] op_sel:[0,1,1] op_sel_hi:[1,1,1]
  v_pk_fma_f32 v[150:151], v[150:151], v[216:217], v[216:217] op_sel:[0,1,1] op_sel_hi:[1,1,1]
  v_pk_fma_f32 v[152:153], v[152:153], v[220:221], v[220:221] op_sel:[0,1,1] op_sel_hi:[1,1,1]
  v_pk_fma_f32 v[154:155], v[154:155], v[220:221], v[220:221] op_sel:[0,1,1] op_sel_hi:[1,1,1]
  v_pk_fma_f32 v[156:157], v[156:157], v[220:221], v[220:221] op_sel:[0,1,1] op_sel_hi:[1,1,1]
  v_pk_fma_f32 v[158:159], v[158:159], v[220:221], v[220:221] op_sel:[0,1,1] op_sel_hi:[1,1,1]
  v_rcp_f32 v144, v144
  v_rcp_f32 v145, v145
  v_rcp_f32 v146, v146
  v_rcp_f32 v147, v147
  v_rcp_f32 v148, v148
  v_rcp_f32 v149, v149
  v_rcp_f32 v150, v150
  v_rcp_f32 v151, v151
  v_rcp_f32 v152, v152
  v_rcp_f32 v153, v153
  v_rcp_f32 v154, v154
  v_rcp_f32 v155, v155
  v_rcp_f32 v156, v156
  v_rcp_f32 v157, v157
  v_rcp_f32 v158, v158
  v_rcp_f32 v159, v159
  v_pk_mul_f32 v[96:97], v[96:97], v[144:145]
  v_pk_mul_f32 v[98:99], v[98:99], v[146:147]
  v_pk_mul_f32 v[104:105], v[104:105], v[148:149]
  v_pk_mul_f32 v[106:107], v[106:107], v[150:151]
  v_pk_mul_f32 v[100:101], v[100:101], v[152:153]
  v_pk_mul_f32 v[102:103], v[102:103], v[154:155]
  v_pk_mul_f32 v[108:109], v[108:109], v[156:157]
  v_pk_mul_f32 v[110:111], v[110:111], v[158:159]
  v_cvt_pk_bf16_f32 v192, v96, v97
  v_cvt_pk_bf16_f32 v193, v98, v99
  v_cvt_pk_bf16_f32 v194, v104, v105
  v_cvt_pk_bf16_f32 v195, v106, v107
  v_cvt_pk_bf16_f32 v196, v100, v101
  v_cvt_pk_bf16_f32 v197, v102, v103
  v_cvt_pk_bf16_f32 v198, v108, v109
  v_cvt_pk_bf16_f32 v199, v110, v111
  s_mov_b32 s26, 5120
  buffer_store_dwordx4 v[192:195], v6, s[12:15], s26 offen sc1
  buffer_store_dwordx4 v[196:199], v7, s[12:15], s26 offen sc1
  s_waitcnt lgkmcnt(0)
  v_pk_fma_f32 v[112:113], v[128:129], v[216:217], v[112:113] op_sel_hi:[1,0,1]
  v_pk_fma_f32 v[114:115], v[130:131], v[216:217], v[114:115] op_sel_hi:[1,0,1]
  v_pk_fma_f32 v[120:121], v[132:133], v[216:217], v[120:121] op_sel_hi:[1,0,1]
  v_pk_fma_f32 v[122:123], v[134:135], v[216:217], v[122:123] op_sel_hi:[1,0,1]
  v_pk_fma_f32 v[116:117], v[128:129], v[220:221], v[116:117] op_sel_hi:[1,0,1]
  v_pk_fma_f32 v[118:119], v[130:131], v[220:221], v[118:119] op_sel_hi:[1,0,1]
  v_pk_fma_f32 v[124:125], v[132:133], v[220:221], v[124:125] op_sel_hi:[1,0,1]
  v_pk_fma_f32 v[126:127], v[134:135], v[220:221], v[126:127] op_sel_hi:[1,0,1]
  v_pk_mul_f32 v[144:145], v[112:113], v[112:113]
  v_pk_mul_f32 v[146:147], v[114:115], v[114:115]
  v_pk_mul_f32 v[148:149], v[120:121], v[120:121]
  v_pk_mul_f32 v[150:151], v[122:123], v[122:123]
  v_pk_mul_f32 v[152:153], v[116:117], v[116:117]
  v_pk_mul_f32 v[154:155], v[118:119], v[118:119]
  v_pk_mul_f32 v[156:157], v[124:125], v[124:125]
  v_pk_mul_f32 v[158:159], v[126:127], v[126:127]
  v_pk_fma_f32 v[144:145], v[144:145], v[218:219], v[218:219] op_sel:[0,0,1] op_sel_hi:[1,0,1]
  v_pk_fma_f32 v[146:147], v[146:147], v[218:219], v[218:219] op_sel:[0,0,1] op_sel_hi:[1,0,1]
  v_pk_fma_f32 v[148:149], v[148:149], v[218:219], v[218:219] op_sel:[0,0,1] op_sel_hi:[1,0,1]
  v_pk_fma_f32 v[150:151], v[150:151], v[218:219], v[218:219] op_sel:[0,0,1] op_sel_hi:[1,0,1]
  v_pk_fma_f32 v[152:153], v[152:153], v[222:223], v[222:223] op_sel:[0,0,1] op_sel_hi:[1,0,1]
  v_pk_fma_f32 v[154:155], v[154:155], v[222:223], v[222:223] op_sel:[0,0,1] op_sel_hi:[1,0,1]
  v_pk_fma_f32 v[156:157], v[156:157], v[222:223], v[222:223] op_sel:[0,0,1] op_sel_hi:[1,0,1]
  v_pk_fma_f32 v[158:159], v[158:159], v[222:223], v[222:223] op_sel:[0,0,1] op_sel_hi:[1,0,1]
  v_pk_mul_f32 v[144:145], v[144:145], v[112:113]
  v_pk_mul_f32 v[146:147], v[146:147], v[114:115]
  v_pk_mul_f32 v[148:149], v[148:149], v[120:121]
  v_pk_mul_f32 v[150:151], v[150:151], v[122:123]
  v_pk_mul_f32 v[152:153], v[152:153], v[116:117]
  v_pk_mul_f32 v[154:155], v[154:155], v[118:119]
  v_pk_mul_f32 v[156:157], v[156:157], v[124:125]
  v_pk_mul_f32 v[158:159], v[158:159], v[126:127]
  v_exp_f32 v144, v144
  v_exp_f32 v145, v145
  v_exp_f32 v146, v146
  v_exp_f32 v147, v147
  v_exp_f32 v148, v148
  v_exp_f32 v149, v149
  v_exp_f32 v150, v150
  v_exp_f32 v151, v151
  v_exp_f32 v152, v152
  v_exp_f32 v153, v153
  v_exp_f32 v154, v154
  v_exp_f32 v155, v155
  v_exp_f32 v156, v156
  v_exp_f32 v157, v157
  v_exp_f32 v158, v158
  v_exp_f32 v159, v159
  v_pk_fma_f32 v[144:145], v[144:145], v[216:217], v[216:217] op_sel:[0,1,1] op_sel_hi:[1,1,1]
  v_pk_fma_f32 v[146:147], v[146:147], v[216:217], v[216:217] op_sel:[0,1,1] op_sel_hi:[1,1,1]
  v_pk_fma_f32 v[148:149], v[148:149], v[216:217], v[216:217] op_sel:[0,1,1] op_sel_hi:[1,1,1]
  v_pk_fma_f32 v[150:151], v[150:151], v[216:217], v[216:217] op_sel:[0,1,1] op_sel_hi:[1,1,1]
  v_pk_fma_f32 v[152:153], v[152:153], v[220:221], v[220:221] op_sel:[0,1,1] op_sel_hi:[1,1,1]
  v_pk_fma_f32 v[154:155], v[154:155], v[220:221], v[220:221] op_sel:[0,1,1] op_sel_hi:[1,1,1]
  v_pk_fma_f32 v[156:157], v[156:157], v[220:221], v[220:221] op_sel:[0,1,1] op_sel_hi:[1,1,1]
  v_pk_fma_f32 v[158:159], v[158:159], v[220:221], v[220:221] op_sel:[0,1,1] op_sel_hi:[1,1,1]
  v_rcp_f32 v144, v144
  v_rcp_f32 v145, v145
  v_rcp_f32 v146, v146
  v_rcp_f32 v147, v147
  v_rcp_f32 v148, v148
  v_rcp_f32 v149, v149
  v_rcp_f32 v150, v150
  v_rcp_f32 v151, v151
  v_rcp_f32 v152, v152
  v_rcp_f32 v153, v153
  v_rcp_f32 v154, v154
  v_rcp_f32 v155, v155
  v_rcp_f32 v156, v156
  v_rcp_f32 v157, v157
  v_rcp_f32 v158, v158
  v_rcp_f32 v159, v159
  v_pk_mul_f32 v[112:113], v[112:113], v[144:145]
  v_pk_mul_f32 v[114:115], v[114:115], v[146:147]
  v_pk_mul_f32 v[120:121], v[120:121], v[148:149]
  v_pk_mul_f32 v[122:123], v[122:123], v[150:151]
  v_pk_mul_f32 v[116:117], v[116:117], v[152:153]
  v_pk_mul_f32 v[118:119], v[118:119], v[154:155]
  v_pk_mul_f32 v[124:125], v[124:125], v[156:157]
  v_pk_mul_f32 v[126:127], v[126:127], v[158:159]
  v_cvt_pk_bf16_f32 v184, v112, v113
  v_cvt_pk_bf16_f32 v185, v114, v115
  v_cvt_pk_bf16_f32 v186, v120, v121
  v_cvt_pk_bf16_f32 v187, v122, v123
  v_cvt_pk_bf16_f32 v188, v116, v117
  v_cvt_pk_bf16_f32 v189, v118, v119
  v_cvt_pk_bf16_f32 v190, v124, v125
  v_cvt_pk_bf16_f32 v191, v126, v127
  s_mov_b32 s26, 6144
  buffer_store_dwordx4 v[184:187], v6, s[12:15], s26 offen sc1
  buffer_store_dwordx4 v[188:191], v7, s[12:15], s26 offen sc1
  s_lshr_b32 s24, s23, 1
  s_lshl_b32 s24, s24, 1
  s_lshr_b32 s25, s22, 3
  s_add_u32 s24, s24, s25
  s_lshl_b32 s24, s24, 7
  s_add_u32 s24, s24, 802816
  s_waitcnt vmcnt(0)
  v_lshlrev_b32 v4, 22, v3
  v_mov_b32 v5, 1
  buffer_atomic_add v5, v4, s[16:19], s24 offen sc1
  s_barrier
g4_c:
  s_load_dwordx4 s[28:31], s[0:1], 80
  s_load_dwordx4 s[40:43], s[0:1], 96
  s_load_dwordx2 s[32:33], s[0:1], 0
  s_and_b32 s24, s2, 7
  s_lshr_b32 s25, s2, 3
  s_and_b32 s25, s25, 31
  s_lshr_b32 s21, s24, 1
  s_lshl_b32 s21, s21, 2
  s_lshr_b32 s22, s25, 3
  s_add_u32 s21, s21, s22
  s_and_b32 s22, s24, 1
  s_lshl_b32 s22, s22, 3
  s_and_b32 s25, s25, 7
  s_add_u32 s22, s22, s25
  s_lshr_b32 s58, s22, 3
  s_and_b32 s22, s22, 7
  s_lshl_b32 s59, s22, 1
  s_add_u32 s59, s59, s58
  v_lshrrev_b32 v2, 6, v0
  v_and_b32 v3, 63, v0
  v_readfirstlane_b32 s100, v2
  s_nop 0
  s_and_b32 s20, s100, 3
  s_lshr_b32 s3, s100, 2
  s_lshl_b32 s23, s21, 3
  s_lshl_b32 s24, s20, 1
  s_add_u32 s23, s23, s24
  s_lshl_b32 s26, s20, 13
  s_add_u32 s26, s26, 131072
  s_mov_b32 s46, 0
  s_mov_b32 s47, 0
  s_mul_i32 s24, s23, 114688
  s_mul_i32 s25, s58, 57344
  s_add_u32 s24, s24, s25
  v_lshl_add_u32 v4, v3, 4, s24
  v_add_u32 v5, 114688, v4
  s_waitcnt lgkmcnt(0)
  s_add_u32 s12, s42, 4194304
  s_addc_u32 s13, s43, 0
  s_mov_b32 s14, 4194304
  s_mov_b32 s15, 0x20000
  s_add_u32 s16, s42, 33554432
  s_addc_u32 s17, s43, 0
  s_mov_b32 s18, 4194304
  s_mov_b32 s19, 0x20000
  v_lshrrev_b32 v29, 2, v3
  v_lshlrev_b32 v29, 8, v29
  v_and_b32 v30, 3, v3
  v_lshl_add_u32 v29, v30, 3, v29
  v_bfe_u32 v28, v3, 2, 3
  s_lshl_b32 s24, s58, 2
  v_xor_b32 v28, s24, v28
  v_xor_b32 v30, 0, v28
  v_lshl_add_u32 v8, v30, 5, v29
  v_add_u32 v16, 65536, v8
  v_xor_b32 v30, 1, v28
  v_lshl_add_u32 v9, v30, 5, v29
  v_add_u32 v17, 65536, v9
  v_xor_b32 v30, 2, v28
  v_lshl_add_u32 v10, v30, 5, v29
  v_add_u32 v18, 65536, v10
  v_xor_b32 v30, 3, v28
  v_lshl_add_u32 v11, v30, 5, v29
  v_add_u32 v19, 65536, v11
  v_xor_b32 v30, 4, v28
  v_lshl_add_u32 v12, v30, 5, v29
  v_add_u32 v20, 65536, v12
  v_xor_b32 v30, 5, v28
  v_lshl_add_u32 v13, v30, 5, v29
  v_add_u32 v21, 65536, v13
  v_xor_b32 v30, 6, v28
  v_lshl_add_u32 v14, v30, 5, v29
  v_add_u32 v22, 65536, v14
  v_xor_b32 v30, 7, v28
  v_lshl_add_u32 v15, v30, 5, v29
  v_add_u32 v23, 65536, v15
  s_lshl_b32 s24, s23, 15
  s_lshl_b32 s25, s59, 11
  s_add_u32 s24, s24, s25
  v_lshl_add_u32 v6, v3, 4, s24
  v_add_u32 v7, 32768, v6
  v_mov_b32 v1, 0
  v_and_b32 v28, 15, v3
  s_lshl_b32 s24, s23, 7
  v_lshl_add_u32 v24, v28, 3, s24
  s_mov_b32 s48, s30
  s_mov_b32 s49, s31
  s_mov_b32 s50, 4194304
  s_mov_b32 s51, 0x20000
  s_add_u32 s52, s42, 37748736
  s_addc_u32 s53, s43, 0
  s_mov_b32 s54, 8388608
  s_mov_b32 s55, 0x20000
  s_add_u32 s4, s42, 8388608
  s_addc_u32 s5, s43, 0
  s_mov_b32 s6, 14680064
  s_mov_b32 s7, 0x20000
  s_lshr_b32 s24, s23, 1
  s_lshl_b32 s24, s24, 1
  s_add_u32 s24, s24, s58
  s_lshl_b32 s24, s24, 7
  s_add_u32 s24, s24, 802816
  s_mov_b32 s57, 0
gc_psp6:
  buffer_load_dword v2, v1, s[16:19], s24 offen sc1
  s_waitcnt vmcnt(0)
  v_readfirstlane_b32 s56, v2
  s_add_u32 s57, s57, 1
  s_cmp_ge_u32 s56, 8
  s_cbranch_scc1 gc_pok5
  s_cmp_ge_u32 s57, 262144
  s_cbranch_scc1 gc_pok5
  s_sleep 1
  s_branch gc_psp6
gc_pok5:
  buffer_load_dwordx4 v[128:131], v4, s[4:7], s46 offen offset:0 sc1
  buffer_load_dwordx4 v[132:135], v5, s[4:7], s46 offen offset:0 sc1
  buffer_load_dwordx4 v[136:139], v4, s[4:7], s46 offen offset:1024 sc1
  buffer_load_dwordx4 v[140:143], v5, s[4:7], s46 offen offset:1024 sc1
  s_add_u32 s46, s46, 2048
  buffer_load_dwordx4 v[144:147], v4, s[4:7], s46 offen offset:0 sc1
  buffer_load_dwordx4 v[148:151], v5, s[4:7], s46 offen offset:0 sc1
  buffer_load_dwordx4 v[152:155], v4, s[4:7], s46 offen offset:1024 sc1
  buffer_load_dwordx4 v[156:159], v5, s[4:7], s46 offen offset:1024 sc1
  s_add_u32 s46, s46, 2048
  buffer_load_dwordx4 v[160:163], v4, s[4:7], s46 offen offset:0 sc1
  buffer_load_dwordx4 v[164:167], v5, s[4:7], s46 offen offset:0 sc1
  buffer_load_dwordx4 v[168:171], v4, s[4:7], s46 offen offset:1024 sc1
  buffer_load_dwordx4 v[172:175], v5, s[4:7], s46 offen offset:1024 sc1
  s_add_u32 s46, s46, 2048
  s_barrier
  ds_read_b64_tr_b16 v[96:97], v8 offset:0
  ds_read_b64_tr_b16 v[98:99], v8 offset:4096
  ds_read_b64_tr_b16 v[100:101], v9 offset:0
  ds_read_b64_tr_b16 v[102:103], v9 offset:4096
  ds_read_b64_tr_b16 v[104:105], v10 offset:0
  ds_read_b64_tr_b16 v[106:107], v10 offset:4096
  ds_read_b64_tr_b16 v[108:109], v11 offset:0
  ds_read_b64_tr_b16 v[110:111], v11 offset:4096
  ds_read_b64_tr_b16 v[112:113], v12 offset:0
  ds_read_b64_tr_b16 v[114:115], v12 offset:4096
  ds_read_b64_tr_b16 v[116:117], v13 offset:0
  ds_read_b64_tr_b16 v[118:119], v13 offset:4096
  ds_read_b64_tr_b16 v[120:121], v14 offset:0
  ds_read_b64_tr_b16 v[122:123], v14 offset:4096
  s_waitcnt lgkmcnt(12)
  s_waitcnt vmcnt(10)
  v_mfma_f32_16x16x32_bf16 v[32:35], v[96:99], v[128:131], 0
  ds_read_b64_tr_b16 v[124:125], v15 offset:0
  ds_read_b64_tr_b16 v[126:127], v15 offset:4096
  v_mfma_f32_16x16x32_bf16 v[36:39], v[96:99], v[132:135], 0
  s_waitcnt lgkmcnt(12)
  v_mfma_f32_16x16x32_bf16 v[40:43], v[100:103], v[128:131], 0
  ds_read_b64_tr_b16 v[96:97], v8 offset:8192
  ds_read_b64_tr_b16 v[98:99], v8 offset:12288
  v_mfma_f32_16x16x32_bf16 v[44:47], v[100:103], v[132:135], 0
  buffer_load_dwordx4 v[176:179], v4, s[4:7], s46 offen offset:0 sc1
  buffer_load_dwordx4 v[180:183], v5, s[4:7], s46 offen offset:0 sc1
  s_waitcnt lgkmcnt(12)
  v_mfma_f32_16x16x32_bf16 v[48:51], v[104:107], v[128:131], 0
  ds_read_b64_tr_b16 v[100:101], v9 offset:8192
  ds_read_b64_tr_b16 v[102:103], v9 offset:12288
  v_mfma_f32_16x16x32_bf16 v[52:55], v[104:107], v[132:135], 0
  s_waitcnt lgkmcnt(12)
  v_mfma_f32_16x16x32_bf16 v[56:59], v[108:111], v[128:131], 0
  ds_read_b64_tr_b16 v[104:105], v10 offset:8192
  ds_read_b64_tr_b16 v[106:107], v10 offset:12288
  v_mfma_f32_16x16x32_bf16 v[60:63], v[108:111], v[132:135], 0
  buffer_load_dwordx4 v[184:187], v4, s[4:7], s46 offen offset:1024 sc1
  buffer_load_dwordx4 v[188:191], v5, s[4:7], s46 offen offset:1024 sc1
  s_add_u32 s46, s46, 2048
  s_waitcnt lgkmcnt(12)
  v_mfma_f32_16x16x32_bf16 v[64:67], v[112:115], v[128:131], 0
  ds_read_b64_tr_b16 v[108:109], v11 offset:8192
  ds_read_b64_tr_b16 v[110:111], v11 offset:12288
  v_mfma_f32_16x16x32_bf16 v[68:71], v[112:115], v[132:135], 0
  s_waitcnt lgkmcnt(12)
  v_mfma_f32_16x16x32_bf16 v[72:75], v[116:119], v[128:131], 0
  ds_read_b64_tr_b16 v[112:113], v12 offset:8192
  ds_read_b64_tr_b16 v[114:115], v12 offset:12288
  v_mfma_f32_16x16x32_bf16 v[76:79], v[116:119], v[132:135], 0
  buffer_load_dwordx4 v[192:195], v4, s[4:7], s46 offen offset:0 sc1
  buffer_load_dwordx4 v[196:199], v5, s[4:7], s46 offen offset:0 sc1
  s_waitcnt lgkmcnt(12)
  v_mfma_f32_16x16x32_bf16 v[80:83], v[120:123], v[128:131], 0
  ds_read_b64_tr_b16 v[116:117], v13 offset:8192
  ds_read_b64_tr_b16 v[118:119], v13 offset:12288
  v_mfma_f32_16x16x32_bf16 v[84:87], v[120:123], v[132:135], 0
  s_waitcnt lgkmcnt(12)
  v_mfma_f32_16x16x32_bf16 v[88:91], v[124:127], v[128:131], 0
  ds_read_b64_tr_b16 v[120:121], v14 offset:8192
  ds_read_b64_tr_b16 v[122:123], v14 offset:12288
  v_mfma_f32_16x16x32_bf16 v[92:95], v[124:127], v[132:135], 0
  buffer_load_dwordx4 v[200:203], v4, s[4:7], s46 offen offset:1024 sc1
  buffer_load_dwordx4 v[204:207], v5, s[4:7], s46 offen offset:1024 sc1
  s_add_u32 s46, s46, 2048
  s_waitcnt lgkmcnt(12)
  s_waitcnt vmcnt(16)
  v_mfma_f32_16x16x32_bf16 v[32:35], v[96:99], v[136:139], v[32:35]
  ds_read_b64_tr_b16 v[124:125], v15 offset:8192
  ds_read_b64_tr_b16 v[126:127], v15 offset:12288
  v_mfma_f32_16x16x32_bf16 v[36:39], v[96:99], v[140:143], v[36:39]
  s_waitcnt lgkmcnt(12)
  v_mfma_f32_16x16x32_bf16 v[40:43], v[100:103], v[136:139], v[40:43]
  s_barrier
  ds_read_b64_tr_b16 v[96:97], v8 offset:16384
  ds_read_b64_tr_b16 v[98:99], v8 offset:20480
  v_mfma_f32_16x16x32_bf16 v[44:47], v[100:103], v[140:143], v[44:47]
  buffer_load_dwordx4 v[128:131], v4, s[4:7], s46 offen offset:0 sc1
  buffer_load_dwordx4 v[132:135], v5, s[4:7], s46 offen offset:0 sc1
  s_waitcnt lgkmcnt(12)
  v_mfma_f32_16x16x32_bf16 v[48:51], v[104:107], v[136:139], v[48:51]
  ds_read_b64_tr_b16 v[100:101], v9 offset:16384
  ds_read_b64_tr_b16 v[102:103], v9 offset:20480
  v_mfma_f32_16x16x32_bf16 v[52:55], v[104:107], v[140:143], v[52:55]
  s_waitcnt lgkmcnt(12)
  v_mfma_f32_16x16x32_bf16 v[56:59], v[108:111], v[136:139], v[56:59]
  ds_read_b64_tr_b16 v[104:105], v10 offset:16384
  ds_read_b64_tr_b16 v[106:107], v10 offset:20480
  v_mfma_f32_16x16x32_bf16 v[60:63], v[108:111], v[140:143], v[60:63]
  s_waitcnt lgkmcnt(12)
  v_mfma_f32_16x16x32_bf16 v[64:67], v[112:115], v[136:139], v[64:67]
  ds_read_b64_tr_b16 v[108:109], v11 offset:16384
  ds_read_b64_tr_b16 v[110:111], v11 offset:20480
  v_mfma_f32_16x16x32_bf16 v[68:71], v[112:115], v[140:143], v[68:71]
  s_waitcnt lgkmcnt(12)
  v_mfma_f32_16x16x32_bf16 v[72:75], v[116:119], v[136:139], v[72:75]
  ds_read_b64_tr_b16 v[112:113], v12 offset:16384
  ds_read_b64_tr_b16 v[114:115], v12 offset:20480
  v_mfma_f32_16x16x32_bf16 v[76:79], v[116:119], v[140:143], v[76:79]
  s_waitcnt lgkmcnt(12)
  v_mfma_f32_16x16x32_bf16 v[80:83], v[120:123], v[136:139], v[80:83]
  ds_read_b64_tr_b16 v[116:117], v13 offset:16384
  ds_read_b64_tr_b16 v[118:119], v13 offset:20480
  v_mfma_f32_16x16x32_bf16 v[84:87], v[120:123], v[140:143], v[84:87]
  s_waitcnt lgkmcnt(12)
  v_mfma_f32_16x16x32_bf16 v[88:91], v[124:127], v[136:139], v[88:91]
  ds_read_b64_tr_b16 v[120:121], v14 offset:16384
  ds_read_b64_tr_b16 v[122:123], v14 offset:20480
  v_mfma_f32_16x16x32_bf16 v[92:95], v[124:127], v[140:143], v[92:95]
  s_waitcnt lgkmcnt(12)
  s_waitcnt vmcnt(16)
  v_mfma_f32_16x16x32_bf16 v[32:35], v[96:99], v[144:147], v[32:35]
  ds_read_b64_tr_b16 v[124:125], v15 offset:16384
  ds_read_b64_tr_b16 v[126:127], v15 offset:20480
  v_mfma_f32_16x16x32_bf16 v[36:39], v[96:99], v[148:151], v[36:39]
  s_waitcnt lgkmcnt(12)
  v_mfma_f32_16x16x32_bf16 v[40:43], v[100:103], v[144:147], v[40:43]
  ds_read_b64_tr_b16 v[96:97], v8 offset:24576
  ds_read_b64_tr_b16 v[98:99], v8 offset:28672
  v_mfma_f32_16x16x32_bf16 v[44:47], v[100:103], v[148:151], v[44:47]
  buffer_load_dwordx4 v[136:139], v4, s[4:7], s46 offen offset:1024 sc1
  buffer_load_dwordx4 v[140:143], v5, s[4:7], s46 offen offset:1024 sc1
  s_add_u32 s46, s46, 2048
  s_waitcnt lgkmcnt(12)
  v_mfma_f32_16x16x32_bf16 v[48:51], v[104:107], v[144:147], v[48:51]
  ds_read_b64_tr_b16 v[100:101], v9 offset:24576
  ds_read_b64_tr_b16 v[102:103], v9 offset:28672
  v_mfma_f32_16x16x32_bf16 v[52:55], v[104:107], v[148:151], v[52:55]
  s_waitcnt lgkmcnt(12)
  v_mfma_f32_16x16x32_bf16 v[56:59], v[108:111], v[144:147], v[56:59]
  ds_read_b64_tr_b16 v[104:105], v10 offset:24576
  ds_read_b64_tr_b16 v[106:107], v10 offset:28672
  v_mfma_f32_16x16x32_bf16 v[60:63], v[108:111], v[148:151], v[60:63]
  s_waitcnt lgkmcnt(12)
  v_mfma_f32_16x16x32_bf16 v[64:67], v[112:115], v[144:147], v[64:67]
  ds_read_b64_tr_b16 v[108:109], v11 offset:24576
  ds_read_b64_tr_b16 v[110:111], v11 offset:28672
  v_mfma_f32_16x16x32_bf16 v[68:71], v[112:115], v[148:151], v[68:71]
  s_waitcnt lgkmcnt(12)
  v_mfma_f32_16x16x32_bf16 v[72:75], v[116:119], v[144:147], v[72:75]
  ds_read_b64_tr_b16 v[112:113], v12 offset:24576
  ds_read_b64_tr_b16 v[114:115], v12 offset:28672
  v_mfma_f32_16x16x32_bf16 v[76:79], v[116:119], v[148:151], v[76:79]
  s_waitcnt lgkmcnt(12)
  v_mfma_f32_16x16x32_bf16 v[80:83], v[120:123], v[144:147], v[80:83]
  ds_read_b64_tr_b16 v[116:117], v13 offset:24576
  ds_read_b64_tr_b16 v[118:119], v13 offset:28672
  v_mfma_f32_16x16x32_bf16 v[84:87], v[120:123], v[148:151], v[84:87]
  s_waitcnt lgkmcnt(12)
  v_mfma_f32_16x16x32_bf16 v[88:91], v[124:127], v[144:147], v[88:91]
  ds_read_b64_tr_b16 v[120:121], v14 offset:24576
  ds_read_b64_tr_b16 v[122:123], v14 offset:28672
  v_mfma_f32_16x16x32_bf16 v[92:95], v[124:127], v[148:151], v[92:95]
  s_waitcnt lgkmcnt(12)
  s_waitcnt vmcnt(16)
  v_mfma_f32_16x16x32_bf16 v[32:35], v[96:99], v[152:155], v[32:35]
  ds_read_b64_tr_b16 v[124:125], v15 offset:24576
  ds_read_b64_tr_b16 v[126:127], v15 offset:28672
  v_mfma_f32_16x16x32_bf16 v[36:39], v[96:99], v[156:159], v[36:39]
  s_waitcnt lgkmcnt(12)
  v_mfma_f32_16x16x32_bf16 v[40:43], v[100:103], v[152:155], v[40:43]
  s_barrier
  ds_read_b64_tr_b16 v[96:97], v8 offset:32768
  ds_read_b64_tr_b16 v[98:99], v8 offset:36864
  v_mfma_f32_16x16x32_bf16 v[44:47], v[100:103], v[156:159], v[44:47]
  buffer_load_dwordx4 v[144:147], v4, s[4:7], s46 offen offset:0 sc1
  buffer_load_dwordx4 v[148:151], v5, s[4:7], s46 offen offset:0 sc1
  s_waitcnt lgkmcnt(12)
  v_mfma_f32_16x16x32_bf16 v[48:51], v[104:107], v[152:155], v[48:51]
  ds_read_b64_tr_b16 v[100:101], v9 offset:32768
  ds_read_b64_tr_b16 v[102:103], v9 offset:36864
  v_mfma_f32_16x16x32_bf16 v[52:55], v[104:107], v[156:159], v[52:55]
  s_waitcnt lgkmcnt(12)
  v_mfma_f32_16x16x32_bf16 v[56:59], v[108:111], v[152:155], v[56:59]
  ds_read_b64_tr_b16 v[104:105], v10 offset:32768
  ds_read_b64_tr_b16 v[106:107], v10 offset:36864
  v_mfma_f32_16x16x32_bf16 v[60:63], v[108:111], v[156:159], v[60:63]
  s_waitcnt lgkmcnt(12)
  v_mfma_f32_16x16x32_bf16 v[64:67], v[112:115], v[152:155], v[64:67]
  ds_read_b64_tr_b16 v[108:109], v11 offset:32768
  ds_read_b64_tr_b16 v[110:111], v11 offset:36864
  v_mfma_f32_16x16x32_bf16 v[68:71], v[112:115], v[156:159], v[68:71]
  s_waitcnt lgkmcnt(12)
  v_mfma_f32_16x16x32_bf16 v[72:75], v[116:119], v[152:155], v[72:75]
  ds_read_b64_tr_b16 v[112:113], v12 offset:32768
  ds_read_b64_tr_b16 v[114:115], v12 offset:36864
  v_mfma_f32_16x16x32_bf16 v[76:79], v[116:119], v[156:159], v[76:79]
  s_waitcnt lgkmcnt(12)
  v_mfma_f32_16x16x32_bf16 v[80:83], v[120:123], v[152:155], v[80:83]
  ds_read_b64_tr_b16 v[116:117], v13 offset:32768
  ds_read_b64_tr_b16 v[118:119], v13 offset:36864
  v_mfma_f32_16x16x32_bf16 v[84:87], v[120:123], v[156:159], v[84:87]
  s_waitcnt lgkmcnt(12)
  v_mfma_f32_16x16x32_bf16 v[88:91], v[124:127], v[152:155], v[88:91]
  ds_read_b64_tr_b16 v[120:121], v14 offset:32768
  ds_read_b64_tr_b16 v[122:123], v14 offset:36864
  v_mfma_f32_16x16x32_bf16 v[92:95], v[124:127], v[156:159], v[92:95]
  s_waitcnt lgkmcnt(12)
  s_waitcnt vmcnt(16)
  v_mfma_f32_16x16x32_bf16 v[32:35], v[96:99], v[160:163], v[32:35]
  ds_read_b64_tr_b16 v[124:125], v15 offset:32768
  ds_read_b64_tr_b16 v[126:127], v15 offset:36864
  v_mfma_f32_16x16x32_bf16 v[36:39], v[96:99], v[164:167], v[36:39]
  s_waitcnt lgkmcnt(12)
  v_mfma_f32_16x16x32_bf16 v[40:43], v[100:103], v[160:163], v[40:43]
  ds_read_b64_tr_b16 v[96:97], v8 offset:40960
  ds_read_b64_tr_b16 v[98:99], v8 offset:45056
  v_mfma_f32_16x16x32_bf16 v[44:47], v[100:103], v[164:167], v[44:47]
  buffer_load_dwordx4 v[152:155], v4, s[4:7], s46 offen offset:1024 sc1
  buffer_load_dwordx4 v[156:159], v5, s[4:7], s46 offen offset:1024 sc1
  s_add_u32 s46, s46, 2048
  s_waitcnt lgkmcnt(12)
  v_mfma_f32_16x16x32_bf16 v[48:51], v[104:107], v[160:163], v[48:51]
  ds_read_b64_tr_b16 v[100:101], v9 offset:40960
  ds_read_b64_tr_b16 v[102:103], v9 offset:45056
  v_mfma_f32_16x16x32_bf16 v[52:55], v[104:107], v[164:167], v[52:55]
  s_waitcnt lgkmcnt(12)
  v_mfma_f32_16x16x32_bf16 v[56:59], v[108:111], v[160:163], v[56:59]
  ds_read_b64_tr_b16 v[104:105], v10 offset:40960
  ds_read_b64_tr_b16 v[106:107], v10 offset:45056
  v_mfma_f32_16x16x32_bf16 v[60:63], v[108:111], v[164:167], v[60:63]
  s_waitcnt lgkmcnt(12)
  v_mfma_f32_16x16x32_bf16 v[64:67], v[112:115], v[160:163], v[64:67]
  ds_read_b64_tr_b16 v[108:109], v11 offset:40960
  ds_read_b64_tr_b16 v[110:111], v11 offset:45056
  v_mfma_f32_16x16x32_bf16 v[68:71], v[112:115], v[164:167], v[68:71]
  s_waitcnt lgkmcnt(12)
  v_mfma_f32_16x16x32_bf16 v[72:75], v[116:119], v[160:163], v[72:75]
  ds_read_b64_tr_b16 v[112:113], v12 offset:40960
  ds_read_b64_tr_b16 v[114:115], v12 offset:45056
  v_mfma_f32_16x16x32_bf16 v[76:79], v[116:119], v[164:167], v[76:79]
  s_waitcnt lgkmcnt(12)
  v_mfma_f32_16x16x32_bf16 v[80:83], v[120:123], v[160:163], v[80:83]
  ds_read_b64_tr_b16 v[116:117], v13 offset:40960
  ds_read_b64_tr_b16 v[118:119], v13 offset:45056
  v_mfma_f32_16x16x32_bf16 v[84:87], v[120:123], v[164:167], v[84:87]
  s_waitcnt lgkmcnt(12)
  v_mfma_f32_16x16x32_bf16 v[88:91], v[124:127], v[160:163], v[88:91]
  ds_read_b64_tr_b16 v[120:121], v14 offset:40960
  ds_read_b64_tr_b16 v[122:123], v14 offset:45056
  v_mfma_f32_16x16x32_bf16 v[92:95], v[124:127], v[164:167], v[92:95]
  s_waitcnt lgkmcnt(12)
  s_waitcnt vmcnt(16)
  v_mfma_f32_16x16x32_bf16 v[32:35], v[96:99], v[168:171], v[32:35]
  ds_read_b64_tr_b16 v[124:125], v15 offset:40960
  ds_read_b64_tr_b16 v[126:127], v15 offset:45056
  v_mfma_f32_16x16x32_bf16 v[36:39], v[96:99], v[172:175], v[36:39]
  s_waitcnt lgkmcnt(12)
  v_mfma_f32_16x16x32_bf16 v[40:43], v[100:103], v[168:171], v[40:43]
  s_barrier
  ds_read_b64_tr_b16 v[96:97], v8 offset:49152
  ds_read_b64_tr_b16 v[98:99], v8 offset:53248
  v_mfma_f32_16x16x32_bf16 v[44:47], v[100:103], v[172:175], v[44:47]
  buffer_load_dwordx4 v[160:163], v4, s[4:7], s46 offen offset:0 sc1
  buffer_load_dwordx4 v[164:167], v5, s[4:7], s46 offen offset:0 sc1
  s_waitcnt lgkmcnt(12)
  v_mfma_f32_16x16x32_bf16 v[48:51], v[104:107], v[168:171], v[48:51]
  ds_read_b64_tr_b16 v[100:101], v9 offset:49152
  ds_read_b64_tr_b16 v[102:103], v9 offset:53248
  v_mfma_f32_16x16x32_bf16 v[52:55], v[104:107], v[172:175], v[52:55]
  s_waitcnt lgkmcnt(12)
  v_mfma_f32_16x16x32_bf16 v[56:59], v[108:111], v[168:171], v[56:59]
  ds_read_b64_tr_b16 v[104:105], v10 offset:49152
  ds_read_b64_tr_b16 v[106:107], v10 offset:53248
  v_mfma_f32_16x16x32_bf16 v[60:63], v[108:111], v[172:175], v[60:63]
  s_waitcnt lgkmcnt(12)
  v_mfma_f32_16x16x32_bf16 v[64:67], v[112:115], v[168:171], v[64:67]
  ds_read_b64_tr_b16 v[108:109], v11 offset:49152
  ds_read_b64_tr_b16 v[110:111], v11 offset:53248
  v_mfma_f32_16x16x32_bf16 v[68:71], v[112:115], v[172:175], v[68:71]
  s_waitcnt lgkmcnt(12)
  v_mfma_f32_16x16x32_bf16 v[72:75], v[116:119], v[168:171], v[72:75]
  ds_read_b64_tr_b16 v[112:113], v12 offset:49152
  ds_read_b64_tr_b16 v[114:115], v12 offset:53248
  v_mfma_f32_16x16x32_bf16 v[76:79], v[116:119], v[172:175], v[76:79]
  s_waitcnt lgkmcnt(12)
  v_mfma_f32_16x16x32_bf16 v[80:83], v[120:123], v[168:171], v[80:83]
  ds_read_b64_tr_b16 v[116:117], v13 offset:49152
  ds_read_b64_tr_b16 v[118:119], v13 offset:53248
  v_mfma_f32_16x16x32_bf16 v[84:87], v[120:123], v[172:175], v[84:87]
  s_waitcnt lgkmcnt(12)
  v_mfma_f32_16x16x32_bf16 v[88:91], v[124:127], v[168:171], v[88:91]
  ds_read_b64_tr_b16 v[120:121], v14 offset:49152
  ds_read_b64_tr_b16 v[122:123], v14 offset:53248
  v_mfma_f32_16x16x32_bf16 v[92:95], v[124:127], v[172:175], v[92:95]
  s_waitcnt lgkmcnt(12)
  s_waitcnt vmcnt(16)
  v_mfma_f32_16x16x32_bf16 v[32:35], v[96:99], v[176:179], v[32:35]
  ds_read_b64_tr_b16 v[124:125], v15 offset:49152
  ds_read_b64_tr_b16 v[126:127], v15 offset:53248
  v_mfma_f32_16x16x32_bf16 v[36:39], v[96:99], v[180:183], v[36:39]
  s_waitcnt lgkmcnt(12)
  v_mfma_f32_16x16x32_bf16 v[40:43], v[100:103], v[176:179], v[40:43]
  ds_read_b64_tr_b16 v[96:97], v8 offset:57344
  ds_read_b64_tr_b16 v[98:99], v8 offset:61440
  v_mfma_f32_16x16x32_bf16 v[44:47], v[100:103], v[180:183], v[44:47]
  buffer_load_dwordx4 v[168:171], v4, s[4:7], s46 offen offset:1024 sc1
  buffer_load_dwordx4 v[172:175], v5, s[4:7], s46 offen offset:1024 sc1
  s_add_u32 s46, s46, 2048
  s_waitcnt lgkmcnt(12)
  v_mfma_f32_16x16x32_bf16 v[48:51], v[104:107], v[176:179], v[48:51]
  ds_read_b64_tr_b16 v[100:101], v9 offset:57344
  ds_read_b64_tr_b16 v[102:103], v9 offset:61440
  v_mfma_f32_16x16x32_bf16 v[52:55], v[104:107], v[180:183], v[52:55]
  s_waitcnt lgkmcnt(12)
  v_mfma_f32_16x16x32_bf16 v[56:59], v[108:111], v[176:179], v[56:59]
  ds_read_b64_tr_b16 v[104:105], v10 offset:57344
  ds_read_b64_tr_b16 v[106:107], v10 offset:61440
  v_mfma_f32_16x16x32_bf16 v[60:63], v[108:111], v[180:183], v[60:63]
  s_waitcnt lgkmcnt(12)
  v_mfma_f32_16x16x32_bf16 v[64:67], v[112:115], v[176:179], v[64:67]
  ds_read_b64_tr_b16 v[108:109], v11 offset:57344
  ds_read_b64_tr_b16 v[110:111], v11 offset:61440
  v_mfma_f32_16x16x32_bf16 v[68:71], v[112:115], v[180:183], v[68:71]
  s_waitcnt lgkmcnt(12)
  v_mfma_f32_16x16x32_bf16 v[72:75], v[116:119], v[176:179], v[72:75]
  ds_read_b64_tr_b16 v[112:113], v12 offset:57344
  ds_read_b64_tr_b16 v[114:115], v12 offset:61440
  v_mfma_f32_16x16x32_bf16 v[76:79], v[116:119], v[180:183], v[76:79]
  s_waitcnt lgkmcnt(12)
  v_mfma_f32_16x16x32_bf16 v[80:83], v[120:123], v[176:179], v[80:83]
  ds_read_b64_tr_b16 v[116:117], v13 offset:57344
  ds_read_b64_tr_b16 v[118:119], v13 offset:61440
  v_mfma_f32_16x16x32_bf16 v[84:87], v[120:123], v[180:183], v[84:87]
  s_waitcnt lgkmcnt(12)
  v_mfma_f32_16x16x32_bf16 v[88:91], v[124:127], v[176:179], v[88:91]
  ds_read_b64_tr_b16 v[120:121], v14 offset:57344
  ds_read_b64_tr_b16 v[122:123], v14 offset:61440
  v_mfma_f32_16x16x32_bf16 v[92:95], v[124:127], v[180:183], v[92:95]
  s_waitcnt lgkmcnt(12)
  s_waitcnt vmcnt(16)
  v_mfma_f32_16x16x32_bf16 v[32:35], v[96:99], v[184:187], v[32:35]
  ds_read_b64_tr_b16 v[124:125], v15 offset:57344
  ds_read_b64_tr_b16 v[126:127], v15 offset:61440
  v_mfma_f32_16x16x32_bf16 v[36:39], v[96:99], v[188:191], v[36:39]
  s_waitcnt lgkmcnt(12)
  v_mfma_f32_16x16x32_bf16 v[40:43], v[100:103], v[184:187], v[40:43]
  s_barrier
  ds_read_b64_tr_b16 v[96:97], v16 offset:0
  ds_read_b64_tr_b16 v[98:99], v16 offset:4096
  v_mfma_f32_16x16x32_bf16 v[44:47], v[100:103], v[188:191], v[44:47]
  buffer_load_dwordx4 v[176:179], v4, s[4:7], s46 offen offset:0 sc1
  buffer_load_dwordx4 v[180:183], v5, s[4:7], s46 offen offset:0 sc1
  s_waitcnt lgkmcnt(12)
  v_mfma_f32_16x16x32_bf16 v[48:51], v[104:107], v[184:187], v[48:51]
  ds_read_b64_tr_b16 v[100:101], v17 offset:0
  ds_read_b64_tr_b16 v[102:103], v17 offset:4096
  v_mfma_f32_16x16x32_bf16 v[52:55], v[104:107], v[188:191], v[52:55]
  s_waitcnt lgkmcnt(12)
  v_mfma_f32_16x16x32_bf16 v[56:59], v[108:111], v[184:187], v[56:59]
  ds_read_b64_tr_b16 v[104:105], v18 offset:0
  ds_read_b64_tr_b16 v[106:107], v18 offset:4096
  v_mfma_f32_16x16x32_bf16 v[60:63], v[108:111], v[188:191], v[60:63]
  s_waitcnt lgkmcnt(12)
  v_mfma_f32_16x16x32_bf16 v[64:67], v[112:115], v[184:187], v[64:67]
  ds_read_b64_tr_b16 v[108:109], v19 offset:0
  ds_read_b64_tr_b16 v[110:111], v19 offset:4096
  v_mfma_f32_16x16x32_bf16 v[68:71], v[112:115], v[188:191], v[68:71]
  s_waitcnt lgkmcnt(12)
  v_mfma_f32_16x16x32_bf16 v[72:75], v[116:119], v[184:187], v[72:75]
  ds_read_b64_tr_b16 v[112:113], v20 offset:0
  ds_read_b64_tr_b16 v[114:115], v20 offset:4096
  v_mfma_f32_16x16x32_bf16 v[76:79], v[116:119], v[188:191], v[76:79]
  s_waitcnt lgkmcnt(12)
  v_mfma_f32_16x16x32_bf16 v[80:83], v[120:123], v[184:187], v[80:83]
  ds_read_b64_tr_b16 v[116:117], v21 offset:0
  ds_read_b64_tr_b16 v[118:119], v21 offset:4096
  v_mfma_f32_16x16x32_bf16 v[84:87], v[120:123], v[188:191], v[84:87]
  s_waitcnt lgkmcnt(12)
  v_mfma_f32_16x16x32_bf16 v[88:91], v[124:127], v[184:187], v[88:91]
  ds_read_b64_tr_b16 v[120:121], v22 offset:0
  ds_read_b64_tr_b16 v[122:123], v22 offset:4096
  v_mfma_f32_16x16x32_bf16 v[92:95], v[124:127], v[188:191], v[92:95]
  s_waitcnt lgkmcnt(12)
  s_waitcnt vmcnt(16)
  v_mfma_f32_16x16x32_bf16 v[32:35], v[96:99], v[192:195], v[32:35]
  ds_read_b64_tr_b16 v[124:125], v23 offset:0
  ds_read_b64_tr_b16 v[126:127], v23 offset:4096
  v_mfma_f32_16x16x32_bf16 v[36:39], v[96:99], v[196:199], v[36:39]
  s_waitcnt lgkmcnt(12)
  v_mfma_f32_16x16x32_bf16 v[40:43], v[100:103], v[192:195], v[40:43]
  ds_read_b64_tr_b16 v[96:97], v16 offset:8192
  ds_read_b64_tr_b16 v[98:99], v16 offset:12288
  v_mfma_f32_16x16x32_bf16 v[44:47], v[100:103], v[196:199], v[44:47]
  buffer_load_dwordx4 v[184:187], v4, s[4:7], s46 offen offset:1024 sc1
  buffer_load_dwordx4 v[188:191], v5, s[4:7], s46 offen offset:1024 sc1
  s_add_u32 s46, s46, 2048
  s_waitcnt lgkmcnt(12)
  v_mfma_f32_16x16x32_bf16 v[48:51], v[104:107], v[192:195], v[48:51]
  ds_read_b64_tr_b16 v[100:101], v17 offset:8192
  ds_read_b64_tr_b16 v[102:103], v17 offset:12288
  v_mfma_f32_16x16x32_bf16 v[52:55], v[104:107], v[196:199], v[52:55]
  s_waitcnt lgkmcnt(12)
  v_mfma_f32_16x16x32_bf16 v[56:59], v[108:111], v[192:195], v[56:59]
  ds_read_b64_tr_b16 v[104:105], v18 offset:8192
  ds_read_b64_tr_b16 v[106:107], v18 offset:12288
  v_mfma_f32_16x16x32_bf16 v[60:63], v[108:111], v[196:199], v[60:63]
  s_waitcnt lgkmcnt(12)
  v_mfma_f32_16x16x32_bf16 v[64:67], v[112:115], v[192:195], v[64:67]
  ds_read_b64_tr_b16 v[108:109], v19 offset:8192
  ds_read_b64_tr_b16 v[110:111], v19 offset:12288
  v_mfma_f32_16x16x32_bf16 v[68:71], v[112:115], v[196:199], v[68:71]
  s_waitcnt lgkmcnt(12)
  v_mfma_f32_16x16x32_bf16 v[72:75], v[116:119], v[192:195], v[72:75]
  ds_read_b64_tr_b16 v[112:113], v20 offset:8192
  ds_read_b64_tr_b16 v[114:115], v20 offset:12288
  v_mfma_f32_16x16x32_bf16 v[76:79], v[116:119], v[196:199], v[76:79]
  s_waitcnt lgkmcnt(12)
  v_mfma_f32_16x16x32_bf16 v[80:83], v[120:123], v[192:195], v[80:83]
  ds_read_b64_tr_b16 v[116:117], v21 offset:8192
  ds_read_b64_tr_b16 v[118:119], v21 offset:12288
  v_mfma_f32_16x16x32_bf16 v[84:87], v[120:123], v[196:199], v[84:87]
  s_waitcnt lgkmcnt(12)
  v_mfma_f32_16x16x32_bf16 v[88:91], v[124:127], v[192:195], v[88:91]
  ds_read_b64_tr_b16 v[120:121], v22 offset:8192
  ds_read_b64_tr_b16 v[122:123], v22 offset:12288
  v_mfma_f32_16x16x32_bf16 v[92:95], v[124:127], v[196:199], v[92:95]
  s_waitcnt lgkmcnt(12)
  s_waitcnt vmcnt(16)
  v_mfma_f32_16x16x32_bf16 v[32:35], v[96:99], v[200:203], v[32:35]
  ds_read_b64_tr_b16 v[124:125], v23 offset:8192
  ds_read_b64_tr_b16 v[126:127], v23 offset:12288
  v_mfma_f32_16x16x32_bf16 v[36:39], v[96:99], v[204:207], v[36:39]
  s_waitcnt lgkmcnt(12)
  v_mfma_f32_16x16x32_bf16 v[40:43], v[100:103], v[200:203], v[40:43]
  s_barrier
  ds_read_b64_tr_b16 v[96:97], v16 offset:16384
  ds_read_b64_tr_b16 v[98:99], v16 offset:20480
  v_mfma_f32_16x16x32_bf16 v[44:47], v[100:103], v[204:207], v[44:47]
  buffer_load_dwordx4 v[192:195], v4, s[4:7], s46 offen offset:0 sc1
  buffer_load_dwordx4 v[196:199], v5, s[4:7], s46 offen offset:0 sc1
  s_waitcnt lgkmcnt(12)
  v_mfma_f32_16x16x32_bf16 v[48:51], v[104:107], v[200:203], v[48:51]
  ds_read_b64_tr_b16 v[100:101], v17 offset:16384
  ds_read_b64_tr_b16 v[102:103], v17 offset:20480
  v_mfma_f32_16x16x32_bf16 v[52:55], v[104:107], v[204:207], v[52:55]
  s_waitcnt lgkmcnt(12)
  v_mfma_f32_16x16x32_bf16 v[56:59], v[108:111], v[200:203], v[56:59]
  ds_read_b64_tr_b16 v[104:105], v18 offset:16384
  ds_read_b64_tr_b16 v[106:107], v18 offset:20480
  v_mfma_f32_16x16x32_bf16 v[60:63], v[108:111], v[204:207], v[60:63]
  s_waitcnt lgkmcnt(12)
  v_mfma_f32_16x16x32_bf16 v[64:67], v[112:115], v[200:203], v[64:67]
  ds_read_b64_tr_b16 v[108:109], v19 offset:16384
  ds_read_b64_tr_b16 v[110:111], v19 offset:20480
  v_mfma_f32_16x16x32_bf16 v[68:71], v[112:115], v[204:207], v[68:71]
  s_waitcnt lgkmcnt(12)
  v_mfma_f32_16x16x32_bf16 v[72:75], v[116:119], v[200:203], v[72:75]
  ds_read_b64_tr_b16 v[112:113], v20 offset:16384
  ds_read_b64_tr_b16 v[114:115], v20 offset:20480
  v_mfma_f32_16x16x32_bf16 v[76:79], v[116:119], v[204:207], v[76:79]
  s_waitcnt lgkmcnt(12)
  v_mfma_f32_16x16x32_bf16 v[80:83], v[120:123], v[200:203], v[80:83]
  ds_read_b64_tr_b16 v[116:117], v21 offset:16384
  ds_read_b64_tr_b16 v[118:119], v21 offset:20480
  v_mfma_f32_16x16x32_bf16 v[84:87], v[120:123], v[204:207], v[84:87]
  s_waitcnt lgkmcnt(12)
  v_mfma_f32_16x16x32_bf16 v[88:91], v[124:127], v[200:203], v[88:91]
  ds_read_b64_tr_b16 v[120:121], v22 offset:16384
  ds_read_b64_tr_b16 v[122:123], v22 offset:20480
  v_mfma_f32_16x16x32_bf16 v[92:95], v[124:127], v[204:207], v[92:95]
  s_waitcnt lgkmcnt(12)
  s_waitcnt vmcnt(16)
  v_mfma_f32_16x16x32_bf16 v[32:35], v[96:99], v[128:131], v[32:35]
  ds_read_b64_tr_b16 v[124:125], v23 offset:16384
  ds_read_b64_tr_b16 v[126:127], v23 offset:20480
  v_mfma_f32_16x16x32_bf16 v[36:39], v[96:99], v[132:135], v[36:39]
  s_waitcnt lgkmcnt(12)
  v_mfma_f32_16x16x32_bf16 v[40:43], v[100:103], v[128:131], v[40:43]
  ds_read_b64_tr_b16 v[96:97], v16 offset:24576
  ds_read_b64_tr_b16 v[98:99], v16 offset:28672
  v_mfma_f32_16x16x32_bf16 v[44:47], v[100:103], v[132:135], v[44:47]
  buffer_load_dwordx4 v[200:203], v4, s[4:7], s46 offen offset:1024 sc1
  buffer_load_dwordx4 v[204:207], v5, s[4:7], s46 offen offset:1024 sc1
  s_add_u32 s46, s46, 2048
  s_waitcnt lgkmcnt(12)
  v_mfma_f32_16x16x32_bf16 v[48:51], v[104:107], v[128:131], v[48:51]
  ds_read_b64_tr_b16 v[100:101], v17 offset:24576
  ds_read_b64_tr_b16 v[102:103], v17 offset:28672
  v_mfma_f32_16x16x32_bf16 v[52:55], v[104:107], v[132:135], v[52:55]
  s_waitcnt lgkmcnt(12)
  v_mfma_f32_16x16x32_bf16 v[56:59], v[108:111], v[128:131], v[56:59]
  ds_read_b64_tr_b16 v[104:105], v18 offset:24576
  ds_read_b64_tr_b16 v[106:107], v18 offset:28672
  v_mfma_f32_16x16x32_bf16 v[60:63], v[108:111], v[132:135], v[60:63]
  s_waitcnt lgkmcnt(12)
  v_mfma_f32_16x16x32_bf16 v[64:67], v[112:115], v[128:131], v[64:67]
  ds_read_b64_tr_b16 v[108:109], v19 offset:24576
  ds_read_b64_tr_b16 v[110:111], v19 offset:28672
  v_mfma_f32_16x16x32_bf16 v[68:71], v[112:115], v[132:135], v[68:71]
  s_waitcnt lgkmcnt(12)
  v_mfma_f32_16x16x32_bf16 v[72:75], v[116:119], v[128:131], v[72:75]
  ds_read_b64_tr_b16 v[112:113], v20 offset:24576
  ds_read_b64_tr_b16 v[114:115], v20 offset:28672
  v_mfma_f32_16x16x32_bf16 v[76:79], v[116:119], v[132:135], v[76:79]
  s_waitcnt lgkmcnt(12)
  v_mfma_f32_16x16x32_bf16 v[80:83], v[120:123], v[128:131], v[80:83]
  ds_read_b64_tr_b16 v[116:117], v21 offset:24576
  ds_read_b64_tr_b16 v[118:119], v21 offset:28672
  v_mfma_f32_16x16x32_bf16 v[84:87], v[120:123], v[132:135], v[84:87]
  s_waitcnt lgkmcnt(12)
  v_mfma_f32_16x16x32_bf16 v[88:91], v[124:127], v[128:131], v[88:91]
  ds_read_b64_tr_b16 v[120:121], v22 offset:24576
  ds_read_b64_tr_b16 v[122:123], v22 offset:28672
  v_mfma_f32_16x16x32_bf16 v[92:95], v[124:127], v[132:135], v[92:95]
  s_waitcnt lgkmcnt(12)
  s_waitcnt vmcnt(16)
  v_mfma_f32_16x16x32_bf16 v[32:35], v[96:99], v[136:139], v[32:35]
  ds_read_b64_tr_b16 v[124:125], v23 offset:24576
  ds_read_b64_tr_b16 v[126:127], v23 offset:28672
  v_mfma_f32_16x16x32_bf16 v[36:39], v[96:99], v[140:143], v[36:39]
  s_waitcnt lgkmcnt(12)
  v_mfma_f32_16x16x32_bf16 v[40:43], v[100:103], v[136:139], v[40:43]
  s_barrier
  ds_read_b64_tr_b16 v[96:97], v8 offset:0
  ds_read_b64_tr_b16 v[98:99], v8 offset:4096
  v_mfma_f32_16x16x32_bf16 v[44:47], v[100:103], v[140:143], v[44:47]
  buffer_load_dwordx4 v[128:131], v4, s[4:7], s46 offen offset:0 sc1
  buffer_load_dwordx4 v[132:135], v5, s[4:7], s46 offen offset:0 sc1
  s_waitcnt lgkmcnt(12)
  v_mfma_f32_16x16x32_bf16 v[48:51], v[104:107], v[136:139], v[48:51]
  ds_read_b64_tr_b16 v[100:101], v9 offset:0
  ds_read_b64_tr_b16 v[102:103], v9 offset:4096
  v_mfma_f32_16x16x32_bf16 v[52:55], v[104:107], v[140:143], v[52:55]
  s_waitcnt lgkmcnt(12)
  v_mfma_f32_16x16x32_bf16 v[56:59], v[108:111], v[136:139], v[56:59]
  ds_read_b64_tr_b16 v[104:105], v10 offset:0
  ds_read_b64_tr_b16 v[106:107], v10 offset:4096
  v_mfma_f32_16x16x32_bf16 v[60:63], v[108:111], v[140:143], v[60:63]
  s_waitcnt lgkmcnt(12)
  v_mfma_f32_16x16x32_bf16 v[64:67], v[112:115], v[136:139], v[64:67]
  ds_read_b64_tr_b16 v[108:109], v11 offset:0
  ds_read_b64_tr_b16 v[110:111], v11 offset:4096
  v_mfma_f32_16x16x32_bf16 v[68:71], v[112:115], v[140:143], v[68:71]
  s_waitcnt lgkmcnt(12)
  v_mfma_f32_16x16x32_bf16 v[72:75], v[116:119], v[136:139], v[72:75]
  ds_read_b64_tr_b16 v[112:113], v12 offset:0
  ds_read_b64_tr_b16 v[114:115], v12 offset:4096
  v_mfma_f32_16x16x32_bf16 v[76:79], v[116:119], v[140:143], v[76:79]
  s_waitcnt lgkmcnt(12)
  v_mfma_f32_16x16x32_bf16 v[80:83], v[120:123], v[136:139], v[80:83]
  ds_read_b64_tr_b16 v[116:117], v13 offset:0
  ds_read_b64_tr_b16 v[118:119], v13 offset:4096
  v_mfma_f32_16x16x32_bf16 v[84:87], v[120:123], v[140:143], v[84:87]
  s_waitcnt lgkmcnt(12)
  v_mfma_f32_16x16x32_bf16 v[88:91], v[124:127], v[136:139], v[88:91]
  ds_read_b64_tr_b16 v[120:121], v14 offset:0
  ds_read_b64_tr_b16 v[122:123], v14 offset:4096
  v_mfma_f32_16x16x32_bf16 v[92:95], v[124:127], v[140:143], v[92:95]
  s_waitcnt lgkmcnt(12)
  s_waitcnt vmcnt(16)
  v_mfma_f32_16x16x32_bf16 v[32:35], v[96:99], v[144:147], v[32:35]
  ds_read_b64_tr_b16 v[124:125], v15 offset:0
  ds_read_b64_tr_b16 v[126:127], v15 offset:4096
  v_mfma_f32_16x16x32_bf16 v[36:39], v[96:99], v[148:151], v[36:39]
  s_waitcnt lgkmcnt(12)
  v_mfma_f32_16x16x32_bf16 v[40:43], v[100:103], v[144:147], v[40:43]
  ds_read_b64_tr_b16 v[96:97], v8 offset:8192
  ds_read_b64_tr_b16 v[98:99], v8 offset:12288
  v_mfma_f32_16x16x32_bf16 v[44:47], v[100:103], v[148:151], v[44:47]
  buffer_load_dwordx4 v[136:139], v4, s[4:7], s46 offen offset:1024 sc1
  buffer_load_dwordx4 v[140:143], v5, s[4:7], s46 offen offset:1024 sc1
  s_add_u32 s46, s46, 2048
  s_waitcnt lgkmcnt(12)
  v_mfma_f32_16x16x32_bf16 v[48:51], v[104:107], v[144:147], v[48:51]
  ds_read_b64_tr_b16 v[100:101], v9 offset:8192
  ds_read_b64_tr_b16 v[102:103], v9 offset:12288
  v_mfma_f32_16x16x32_bf16 v[52:55], v[104:107], v[148:151], v[52:55]
  s_waitcnt lgkmcnt(12)
  v_mfma_f32_16x16x32_bf16 v[56:59], v[108:111], v[144:147], v[56:59]
  ds_read_b64_tr_b16 v[104:105], v10 offset:8192
  ds_read_b64_tr_b16 v[106:107], v10 offset:12288
  v_mfma_f32_16x16x32_bf16 v[60:63], v[108:111], v[148:151], v[60:63]
  s_waitcnt lgkmcnt(12)
  v_mfma_f32_16x16x32_bf16 v[64:67], v[112:115], v[144:147], v[64:67]
  ds_read_b64_tr_b16 v[108:109], v11 offset:8192
  ds_read_b64_tr_b16 v[110:111], v11 offset:12288
  v_mfma_f32_16x16x32_bf16 v[68:71], v[112:115], v[148:151], v[68:71]
  s_waitcnt lgkmcnt(12)
  v_mfma_f32_16x16x32_bf16 v[72:75], v[116:119], v[144:147], v[72:75]
  ds_read_b64_tr_b16 v[112:113], v12 offset:8192
  ds_read_b64_tr_b16 v[114:115], v12 offset:12288
  v_mfma_f32_16x16x32_bf16 v[76:79], v[116:119], v[148:151], v[76:79]
  s_waitcnt lgkmcnt(12)
  v_mfma_f32_16x16x32_bf16 v[80:83], v[120:123], v[144:147], v[80:83]
  ds_read_b64_tr_b16 v[116:117], v13 offset:8192
  ds_read_b64_tr_b16 v[118:119], v13 offset:12288
  v_mfma_f32_16x16x32_bf16 v[84:87], v[120:123], v[148:151], v[84:87]
  s_waitcnt lgkmcnt(12)
  v_mfma_f32_16x16x32_bf16 v[88:91], v[124:127], v[144:147], v[88:91]
  ds_read_b64_tr_b16 v[120:121], v14 offset:8192
  ds_read_b64_tr_b16 v[122:123], v14 offset:12288
  v_mfma_f32_16x16x32_bf16 v[92:95], v[124:127], v[148:151], v[92:95]
  s_waitcnt lgkmcnt(12)
  s_waitcnt vmcnt(16)
  v_mfma_f32_16x16x32_bf16 v[32:35], v[96:99], v[152:155], v[32:35]
  ds_read_b64_tr_b16 v[124:125], v15 offset:8192
  ds_read_b64_tr_b16 v[126:127], v15 offset:12288
  v_mfma_f32_16x16x32_bf16 v[36:39], v[96:99], v[156:159], v[36:39]
  s_waitcnt lgkmcnt(12)
  v_mfma_f32_16x16x32_bf16 v[40:43], v[100:103], v[152:155], v[40:43]
  s_barrier
  ds_read_b64_tr_b16 v[96:97], v8 offset:16384
  ds_read_b64_tr_b16 v[98:99], v8 offset:20480
  v_mfma_f32_16x16x32_bf16 v[44:47], v[100:103], v[156:159], v[44:47]
  buffer_load_dwordx4 v[144:147], v4, s[4:7], s46 offen offset:0 sc1
  buffer_load_dwordx4 v[148:151], v5, s[4:7], s46 offen offset:0 sc1
  s_waitcnt lgkmcnt(12)
  v_mfma_f32_16x16x32_bf16 v[48:51], v[104:107], v[152:155], v[48:51]
  ds_read_b64_tr_b16 v[100:101], v9 offset:16384
  ds_read_b64_tr_b16 v[102:103], v9 offset:20480
  v_mfma_f32_16x16x32_bf16 v[52:55], v[104:107], v[156:159], v[52:55]
  s_waitcnt lgkmcnt(12)
  v_mfma_f32_16x16x32_bf16 v[56:59], v[108:111], v[152:155], v[56:59]
  ds_read_b64_tr_b16 v[104:105], v10 offset:16384
  ds_read_b64_tr_b16 v[106:107], v10 offset:20480
  v_mfma_f32_16x16x32_bf16 v[60:63], v[108:111], v[156:159], v[60:63]
  s_waitcnt lgkmcnt(12)
  v_mfma_f32_16x16x32_bf16 v[64:67], v[112:115], v[152:155], v[64:67]
  ds_read_b64_tr_b16 v[108:109], v11 offset:16384
  ds_read_b64_tr_b16 v[110:111], v11 offset:20480
  v_mfma_f32_16x16x32_bf16 v[68:71], v[112:115], v[156:159], v[68:71]
  s_waitcnt lgkmcnt(12)
  v_mfma_f32_16x16x32_bf16 v[72:75], v[116:119], v[152:155], v[72:75]
  ds_read_b64_tr_b16 v[112:113], v12 offset:16384
  ds_read_b64_tr_b16 v[114:115], v12 offset:20480
  v_mfma_f32_16x16x32_bf16 v[76:79], v[116:119], v[156:159], v[76:79]
  s_waitcnt lgkmcnt(12)
  v_mfma_f32_16x16x32_bf16 v[80:83], v[120:123], v[152:155], v[80:83]
  ds_read_b64_tr_b16 v[116:117], v13 offset:16384
  ds_read_b64_tr_b16 v[118:119], v13 offset:20480
  v_mfma_f32_16x16x32_bf16 v[84:87], v[120:123], v[156:159], v[84:87]
  s_waitcnt lgkmcnt(12)
  v_mfma_f32_16x16x32_bf16 v[88:91], v[124:127], v[152:155], v[88:91]
  ds_read_b64_tr_b16 v[120:121], v14 offset:16384
  ds_read_b64_tr_b16 v[122:123], v14 offset:20480
  v_mfma_f32_16x16x32_bf16 v[92:95], v[124:127], v[156:159], v[92:95]
  s_waitcnt lgkmcnt(12)
  s_waitcnt vmcnt(16)
  v_mfma_f32_16x16x32_bf16 v[32:35], v[96:99], v[160:163], v[32:35]
  ds_read_b64_tr_b16 v[124:125], v15 offset:16384
  ds_read_b64_tr_b16 v[126:127], v15 offset:20480
  v_mfma_f32_16x16x32_bf16 v[36:39], v[96:99], v[164:167], v[36:39]
  s_waitcnt lgkmcnt(12)
  v_mfma_f32_16x16x32_bf16 v[40:43], v[100:103], v[160:163], v[40:43]
  ds_read_b64_tr_b16 v[96:97], v8 offset:24576
  ds_read_b64_tr_b16 v[98:99], v8 offset:28672
  v_mfma_f32_16x16x32_bf16 v[44:47], v[100:103], v[164:167], v[44:47]
  buffer_load_dwordx4 v[152:155], v4, s[4:7], s46 offen offset:1024 sc1
  buffer_load_dwordx4 v[156:159], v5, s[4:7], s46 offen offset:1024 sc1
  s_add_u32 s46, s46, 2048
  s_waitcnt lgkmcnt(12)
  v_mfma_f32_16x16x32_bf16 v[48:51], v[104:107], v[160:163], v[48:51]
  ds_read_b64_tr_b16 v[100:101], v9 offset:24576
  ds_read_b64_tr_b16 v[102:103], v9 offset:28672
  v_mfma_f32_16x16x32_bf16 v[52:55], v[104:107], v[164:167], v[52:55]
  s_waitcnt lgkmcnt(12)
  v_mfma_f32_16x16x32_bf16 v[56:59], v[108:111], v[160:163], v[56:59]
  ds_read_b64_tr_b16 v[104:105], v10 offset:24576
  ds_read_b64_tr_b16 v[106:107], v10 offset:28672
  v_mfma_f32_16x16x32_bf16 v[60:63], v[108:111], v[164:167], v[60:63]
  s_waitcnt lgkmcnt(12)
  v_mfma_f32_16x16x32_bf16 v[64:67], v[112:115], v[160:163], v[64:67]
  ds_read_b64_tr_b16 v[108:109], v11 offset:24576
  ds_read_b64_tr_b16 v[110:111], v11 offset:28672
  v_mfma_f32_16x16x32_bf16 v[68:71], v[112:115], v[164:167], v[68:71]
  s_waitcnt lgkmcnt(12)
  v_mfma_f32_16x16x32_bf16 v[72:75], v[116:119], v[160:163], v[72:75]
  ds_read_b64_tr_b16 v[112:113], v12 offset:24576
  ds_read_b64_tr_b16 v[114:115], v12 offset:28672
  v_mfma_f32_16x16x32_bf16 v[76:79], v[116:119], v[164:167], v[76:79]
  s_waitcnt lgkmcnt(12)
  v_mfma_f32_16x16x32_bf16 v[80:83], v[120:123], v[160:163], v[80:83]
  ds_read_b64_tr_b16 v[116:117], v13 offset:24576
  ds_read_b64_tr_b16 v[118:119], v13 offset:28672
  v_mfma_f32_16x16x32_bf16 v[84:87], v[120:123], v[164:167], v[84:87]
  s_waitcnt lgkmcnt(12)
  v_mfma_f32_16x16x32_bf16 v[88:91], v[124:127], v[160:163], v[88:91]
  ds_read_b64_tr_b16 v[120:121], v14 offset:24576
  ds_read_b64_tr_b16 v[122:123], v14 offset:28672
  v_mfma_f32_16x16x32_bf16 v[92:95], v[124:127], v[164:167], v[92:95]
  s_waitcnt lgkmcnt(12)
  s_waitcnt vmcnt(16)
  v_mfma_f32_16x16x32_bf16 v[32:35], v[96:99], v[168:171], v[32:35]
  ds_read_b64_tr_b16 v[124:125], v15 offset:24576
  ds_read_b64_tr_b16 v[126:127], v15 offset:28672
  v_mfma_f32_16x16x32_bf16 v[36:39], v[96:99], v[172:175], v[36:39]
  s_waitcnt lgkmcnt(12)
  v_mfma_f32_16x16x32_bf16 v[40:43], v[100:103], v[168:171], v[40:43]
  s_barrier
  ds_read_b64_tr_b16 v[96:97], v8 offset:32768
  ds_read_b64_tr_b16 v[98:99], v8 offset:36864
  v_mfma_f32_16x16x32_bf16 v[44:47], v[100:103], v[172:175], v[44:47]
  buffer_load_dwordx4 v[160:163], v4, s[4:7], s46 offen offset:0 sc1
  buffer_load_dwordx4 v[164:167], v5, s[4:7], s46 offen offset:0 sc1
  s_waitcnt lgkmcnt(12)
  v_mfma_f32_16x16x32_bf16 v[48:51], v[104:107], v[168:171], v[48:51]
  ds_read_b64_tr_b16 v[100:101], v9 offset:32768
  ds_read_b64_tr_b16 v[102:103], v9 offset:36864
  v_mfma_f32_16x16x32_bf16 v[52:55], v[104:107], v[172:175], v[52:55]
  s_waitcnt lgkmcnt(12)
  v_mfma_f32_16x16x32_bf16 v[56:59], v[108:111], v[168:171], v[56:59]
  ds_read_b64_tr_b16 v[104:105], v10 offset:32768
  ds_read_b64_tr_b16 v[106:107], v10 offset:36864
  v_mfma_f32_16x16x32_bf16 v[60:63], v[108:111], v[172:175], v[60:63]
  s_waitcnt lgkmcnt(12)
  v_mfma_f32_16x16x32_bf16 v[64:67], v[112:115], v[168:171], v[64:67]
  ds_read_b64_tr_b16 v[108:109], v11 offset:32768
  ds_read_b64_tr_b16 v[110:111], v11 offset:36864
  v_mfma_f32_16x16x32_bf16 v[68:71], v[112:115], v[172:175], v[68:71]
  s_waitcnt lgkmcnt(12)
  v_mfma_f32_16x16x32_bf16 v[72:75], v[116:119], v[168:171], v[72:75]
  ds_read_b64_tr_b16 v[112:113], v12 offset:32768
  ds_read_b64_tr_b16 v[114:115], v12 offset:36864
  v_mfma_f32_16x16x32_bf16 v[76:79], v[116:119], v[172:175], v[76:79]
  s_waitcnt lgkmcnt(12)
  v_mfma_f32_16x16x32_bf16 v[80:83], v[120:123], v[168:171], v[80:83]
  ds_read_b64_tr_b16 v[116:117], v13 offset:32768
  ds_read_b64_tr_b16 v[118:119], v13 offset:36864
  v_mfma_f32_16x16x32_bf16 v[84:87], v[120:123], v[172:175], v[84:87]
  s_waitcnt lgkmcnt(12)
  v_mfma_f32_16x16x32_bf16 v[88:91], v[124:127], v[168:171], v[88:91]
  ds_read_b64_tr_b16 v[120:121], v14 offset:32768
  ds_read_b64_tr_b16 v[122:123], v14 offset:36864
  v_mfma_f32_16x16x32_bf16 v[92:95], v[124:127], v[172:175], v[92:95]
  s_waitcnt lgkmcnt(12)
  s_waitcnt vmcnt(16)
  v_mfma_f32_16x16x32_bf16 v[32:35], v[96:99], v[176:179], v[32:35]
  ds_read_b64_tr_b16 v[124:125], v15 offset:32768
  ds_read_b64_tr_b16 v[126:127], v15 offset:36864
  v_mfma_f32_16x16x32_bf16 v[36:39], v[96:99], v[180:183], v[36:39]
  s_waitcnt lgkmcnt(12)
  v_mfma_f32_16x16x32_bf16 v[40:43], v[100:103], v[176:179], v[40:43]
  ds_read_b64_tr_b16 v[96:97], v8 offset:40960
  ds_read_b64_tr_b16 v[98:99], v8 offset:45056
  v_mfma_f32_16x16x32_bf16 v[44:47], v[100:103], v[180:183], v[44:47]
  buffer_load_dwordx4 v[168:171], v4, s[4:7], s46 offen offset:1024 sc1
  buffer_load_dwordx4 v[172:175], v5, s[4:7], s46 offen offset:1024 sc1
  s_add_u32 s46, s46, 2048
  s_waitcnt lgkmcnt(12)
  v_mfma_f32_16x16x32_bf16 v[48:51], v[104:107], v[176:179], v[48:51]
  ds_read_b64_tr_b16 v[100:101], v9 offset:40960
  ds_read_b64_tr_b16 v[102:103], v9 offset:45056
  v_mfma_f32_16x16x32_bf16 v[52:55], v[104:107], v[180:183], v[52:55]
  s_waitcnt lgkmcnt(12)
  v_mfma_f32_16x16x32_bf16 v[56:59], v[108:111], v[176:179], v[56:59]
  ds_read_b64_tr_b16 v[104:105], v10 offset:40960
  ds_read_b64_tr_b16 v[106:107], v10 offset:45056
  v_mfma_f32_16x16x32_bf16 v[60:63], v[108:111], v[180:183], v[60:63]
  s_waitcnt lgkmcnt(12)
  v_mfma_f32_16x16x32_bf16 v[64:67], v[112:115], v[176:179], v[64:67]
  ds_read_b64_tr_b16 v[108:109], v11 offset:40960
  ds_read_b64_tr_b16 v[110:111], v11 offset:45056
  v_mfma_f32_16x16x32_bf16 v[68:71], v[112:115], v[180:183], v[68:71]
  s_waitcnt lgkmcnt(12)
  v_mfma_f32_16x16x32_bf16 v[72:75], v[116:119], v[176:179], v[72:75]
  ds_read_b64_tr_b16 v[112:113], v12 offset:40960
  ds_read_b64_tr_b16 v[114:115], v12 offset:45056
  v_mfma_f32_16x16x32_bf16 v[76:79], v[116:119], v[180:183], v[76:79]
  s_waitcnt lgkmcnt(12)
  v_mfma_f32_16x16x32_bf16 v[80:83], v[120:123], v[176:179], v[80:83]
  ds_read_b64_tr_b16 v[116:117], v13 offset:40960
  ds_read_b64_tr_b16 v[118:119], v13 offset:45056
  v_mfma_f32_16x16x32_bf16 v[84:87], v[120:123], v[180:183], v[84:87]
  s_waitcnt lgkmcnt(12)
  v_mfma_f32_16x16x32_bf16 v[88:91], v[124:127], v[176:179], v[88:91]
  ds_read_b64_tr_b16 v[120:121], v14 offset:40960
  ds_read_b64_tr_b16 v[122:123], v14 offset:45056
  v_mfma_f32_16x16x32_bf16 v[92:95], v[124:127], v[180:183], v[92:95]
  s_waitcnt lgkmcnt(12)
  s_waitcnt vmcnt(16)
  v_mfma_f32_16x16x32_bf16 v[32:35], v[96:99], v[184:187], v[32:35]
  ds_read_b64_tr_b16 v[124:125], v15 offset:40960
  ds_read_b64_tr_b16 v[126:127], v15 offset:45056
  v_mfma_f32_16x16x32_bf16 v[36:39], v[96:99], v[188:191], v[36:39]
  s_waitcnt lgkmcnt(12)
  v_mfma_f32_16x16x32_bf16 v[40:43], v[100:103], v[184:187], v[40:43]
  s_barrier
  ds_read_b64_tr_b16 v[96:97], v8 offset:49152
  ds_read_b64_tr_b16 v[98:99], v8 offset:53248
  v_mfma_f32_16x16x32_bf16 v[44:47], v[100:103], v[188:191], v[44:47]
  buffer_load_dwordx4 v[176:179], v4, s[4:7], s46 offen offset:0 sc1
  buffer_load_dwordx4 v[180:183], v5, s[4:7], s46 offen offset:0 sc1
  s_waitcnt lgkmcnt(12)
  v_mfma_f32_16x16x32_bf16 v[48:51], v[104:107], v[184:187], v[48:51]
  ds_read_b64_tr_b16 v[100:101], v9 offset:49152
  ds_read_b64_tr_b16 v[102:103], v9 offset:53248
  v_mfma_f32_16x16x32_bf16 v[52:55], v[104:107], v[188:191], v[52:55]
  s_waitcnt lgkmcnt(12)
  v_mfma_f32_16x16x32_bf16 v[56:59], v[108:111], v[184:187], v[56:59]
  ds_read_b64_tr_b16 v[104:105], v10 offset:49152
  ds_read_b64_tr_b16 v[106:107], v10 offset:53248
  v_mfma_f32_16x16x32_bf16 v[60:63], v[108:111], v[188:191], v[60:63]
  s_waitcnt lgkmcnt(12)
  v_mfma_f32_16x16x32_bf16 v[64:67], v[112:115], v[184:187], v[64:67]
  ds_read_b64_tr_b16 v[108:109], v11 offset:49152
  ds_read_b64_tr_b16 v[110:111], v11 offset:53248
  v_mfma_f32_16x16x32_bf16 v[68:71], v[112:115], v[188:191], v[68:71]
  s_waitcnt lgkmcnt(12)
  v_mfma_f32_16x16x32_bf16 v[72:75], v[116:119], v[184:187], v[72:75]
  ds_read_b64_tr_b16 v[112:113], v12 offset:49152
  ds_read_b64_tr_b16 v[114:115], v12 offset:53248
  v_mfma_f32_16x16x32_bf16 v[76:79], v[116:119], v[188:191], v[76:79]
  s_waitcnt lgkmcnt(12)
  v_mfma_f32_16x16x32_bf16 v[80:83], v[120:123], v[184:187], v[80:83]
  ds_read_b64_tr_b16 v[116:117], v13 offset:49152
  ds_read_b64_tr_b16 v[118:119], v13 offset:53248
  v_mfma_f32_16x16x32_bf16 v[84:87], v[120:123], v[188:191], v[84:87]
  s_waitcnt lgkmcnt(12)
  v_mfma_f32_16x16x32_bf16 v[88:91], v[124:127], v[184:187], v[88:91]
  ds_read_b64_tr_b16 v[120:121], v14 offset:49152
  ds_read_b64_tr_b16 v[122:123], v14 offset:53248
  v_mfma_f32_16x16x32_bf16 v[92:95], v[124:127], v[188:191], v[92:95]
  s_waitcnt lgkmcnt(12)
  s_waitcnt vmcnt(16)
  v_mfma_f32_16x16x32_bf16 v[32:35], v[96:99], v[192:195], v[32:35]
  ds_read_b64_tr_b16 v[124:125], v15 offset:49152
  ds_read_b64_tr_b16 v[126:127], v15 offset:53248
  v_mfma_f32_16x16x32_bf16 v[36:39], v[96:99], v[196:199], v[36:39]
  s_waitcnt lgkmcnt(12)
  v_mfma_f32_16x16x32_bf16 v[40:43], v[100:103], v[192:195], v[40:43]
  ds_read_b64_tr_b16 v[96:97], v8 offset:57344
  ds_read_b64_tr_b16 v[98:99], v8 offset:61440
  v_mfma_f32_16x16x32_bf16 v[44:47], v[100:103], v[196:199], v[44:47]
  buffer_load_dwordx4 v[184:187], v4, s[4:7], s46 offen offset:1024 sc1
  buffer_load_dwordx4 v[188:191], v5, s[4:7], s46 offen offset:1024 sc1
  s_add_u32 s46, s46, 2048
  s_waitcnt lgkmcnt(12)
  v_mfma_f32_16x16x32_bf16 v[48:51], v[104:107], v[192:195], v[48:51]
  ds_read_b64_tr_b16 v[100:101], v9 offset:57344
  ds_read_b64_tr_b16 v[102:103], v9 offset:61440
  v_mfma_f32_16x16x32_bf16 v[52:55], v[104:107], v[196:199], v[52:55]
  s_waitcnt lgkmcnt(12)
  v_mfma_f32_16x16x32_bf16 v[56:59], v[108:111], v[192:195], v[56:59]
  ds_read_b64_tr_b16 v[104:105], v10 offset:57344
  ds_read_b64_tr_b16 v[106:107], v10 offset:61440
  v_mfma_f32_16x16x32_bf16 v[60:63], v[108:111], v[196:199], v[60:63]
  s_waitcnt lgkmcnt(12)
  v_mfma_f32_16x16x32_bf16 v[64:67], v[112:115], v[192:195], v[64:67]
  ds_read_b64_tr_b16 v[108:109], v11 offset:57344
  ds_read_b64_tr_b16 v[110:111], v11 offset:61440
  v_mfma_f32_16x16x32_bf16 v[68:71], v[112:115], v[196:199], v[68:71]
  s_waitcnt lgkmcnt(12)
  v_mfma_f32_16x16x32_bf16 v[72:75], v[116:119], v[192:195], v[72:75]
  ds_read_b64_tr_b16 v[112:113], v12 offset:57344
  ds_read_b64_tr_b16 v[114:115], v12 offset:61440
  v_mfma_f32_16x16x32_bf16 v[76:79], v[116:119], v[196:199], v[76:79]
  s_waitcnt lgkmcnt(12)
  v_mfma_f32_16x16x32_bf16 v[80:83], v[120:123], v[192:195], v[80:83]
  ds_read_b64_tr_b16 v[116:117], v13 offset:57344
  ds_read_b64_tr_b16 v[118:119], v13 offset:61440
  v_mfma_f32_16x16x32_bf16 v[84:87], v[120:123], v[196:199], v[84:87]
  s_waitcnt lgkmcnt(12)
  v_mfma_f32_16x16x32_bf16 v[88:91], v[124:127], v[192:195], v[88:91]
  ds_read_b64_tr_b16 v[120:121], v14 offset:57344
  ds_read_b64_tr_b16 v[122:123], v14 offset:61440
  v_mfma_f32_16x16x32_bf16 v[92:95], v[124:127], v[196:199], v[92:95]
  s_waitcnt lgkmcnt(12)
  s_waitcnt vmcnt(16)
  v_mfma_f32_16x16x32_bf16 v[32:35], v[96:99], v[200:203], v[32:35]
  ds_read_b64_tr_b16 v[124:125], v15 offset:57344
  ds_read_b64_tr_b16 v[126:127], v15 offset:61440
  v_mfma_f32_16x16x32_bf16 v[36:39], v[96:99], v[204:207], v[36:39]
  s_waitcnt lgkmcnt(12)
  v_mfma_f32_16x16x32_bf16 v[40:43], v[100:103], v[200:203], v[40:43]
  s_barrier
  ds_read_b64_tr_b16 v[96:97], v16 offset:0
  ds_read_b64_tr_b16 v[98:99], v16 offset:4096
  v_mfma_f32_16x16x32_bf16 v[44:47], v[100:103], v[204:207], v[44:47]
  buffer_load_dwordx4 v[192:195], v4, s[4:7], s46 offen offset:0 sc1
  buffer_load_dwordx4 v[196:199], v5, s[4:7], s46 offen offset:0 sc1
  s_waitcnt lgkmcnt(12)
  v_mfma_f32_16x16x32_bf16 v[48:51], v[104:107], v[200:203], v[48:51]
  ds_read_b64_tr_b16 v[100:101], v17 offset:0
  ds_read_b64_tr_b16 v[102:103], v17 offset:4096
  v_mfma_f32_16x16x32_bf16 v[52:55], v[104:107], v[204:207], v[52:55]
  s_waitcnt lgkmcnt(12)
  v_mfma_f32_16x16x32_bf16 v[56:59], v[108:111], v[200:203], v[56:59]
  ds_read_b64_tr_b16 v[104:105], v18 offset:0
  ds_read_b64_tr_b16 v[106:107], v18 offset:4096
  v_mfma_f32_16x16x32_bf16 v[60:63], v[108:111], v[204:207], v[60:63]
  s_waitcnt lgkmcnt(12)
  v_mfma_f32_16x16x32_bf16 v[64:67], v[112:115], v[200:203], v[64:67]
  ds_read_b64_tr_b16 v[108:109], v19 offset:0
  ds_read_b64_tr_b16 v[110:111], v19 offset:4096
  v_mfma_f32_16x16x32_bf16 v[68:71], v[112:115], v[204:207], v[68:71]
  s_waitcnt lgkmcnt(12)
  v_mfma_f32_16x16x32_bf16 v[72:75], v[116:119], v[200:203], v[72:75]
  ds_read_b64_tr_b16 v[112:113], v20 offset:0
  ds_read_b64_tr_b16 v[114:115], v20 offset:4096
  v_mfma_f32_16x16x32_bf16 v[76:79], v[116:119], v[204:207], v[76:79]
  s_waitcnt lgkmcnt(12)
  v_mfma_f32_16x16x32_bf16 v[80:83], v[120:123], v[200:203], v[80:83]
  ds_read_b64_tr_b16 v[116:117], v21 offset:0
  ds_read_b64_tr_b16 v[118:119], v21 offset:4096
  v_mfma_f32_16x16x32_bf16 v[84:87], v[120:123], v[204:207], v[84:87]
  s_waitcnt lgkmcnt(12)
  v_mfma_f32_16x16x32_bf16 v[88:91], v[124:127], v[200:203], v[88:91]
  ds_read_b64_tr_b16 v[120:121], v22 offset:0
  ds_read_b64_tr_b16 v[122:123], v22 offset:4096
  v_mfma_f32_16x16x32_bf16 v[92:95], v[124:127], v[204:207], v[92:95]
  s_waitcnt lgkmcnt(12)
  s_waitcnt vmcnt(16)
  v_mfma_f32_16x16x32_bf16 v[32:35], v[96:99], v[128:131], v[32:35]
  ds_read_b64_tr_b16 v[124:125], v23 offset:0
  ds_read_b64_tr_b16 v[126:127], v23 offset:4096
  v_mfma_f32_16x16x32_bf16 v[36:39], v[96:99], v[132:135], v[36:39]
  s_waitcnt lgkmcnt(12)
  v_mfma_f32_16x16x32_bf16 v[40:43], v[100:103], v[128:131], v[40:43]
  ds_read_b64_tr_b16 v[96:97], v16 offset:8192
  ds_read_b64_tr_b16 v[98:99], v16 offset:12288
  v_mfma_f32_16x16x32_bf16 v[44:47], v[100:103], v[132:135], v[44:47]
  buffer_load_dwordx4 v[200:203], v4, s[4:7], s46 offen offset:1024 sc1
  buffer_load_dwordx4 v[204:207], v5, s[4:7], s46 offen offset:1024 sc1
  s_add_u32 s46, s46, 2048
  s_waitcnt lgkmcnt(12)
  v_mfma_f32_16x16x32_bf16 v[48:51], v[104:107], v[128:131], v[48:51]
  ds_read_b64_tr_b16 v[100:101], v17 offset:8192
  ds_read_b64_tr_b16 v[102:103], v17 offset:12288
  v_mfma_f32_16x16x32_bf16 v[52:55], v[104:107], v[132:135], v[52:55]
  s_waitcnt lgkmcnt(12)
  v_mfma_f32_16x16x32_bf16 v[56:59], v[108:111], v[128:131], v[56:59]
  ds_read_b64_tr_b16 v[104:105], v18 offset:8192
  ds_read_b64_tr_b16 v[106:107], v18 offset:12288
  v_mfma_f32_16x16x32_bf16 v[60:63], v[108:111], v[132:135], v[60:63]
  s_waitcnt lgkmcnt(12)
  v_mfma_f32_16x16x32_bf16 v[64:67], v[112:115], v[128:131], v[64:67]
  ds_read_b64_tr_b16 v[108:109], v19 offset:8192
  ds_read_b64_tr_b16 v[110:111], v19 offset:12288
  v_mfma_f32_16x16x32_bf16 v[68:71], v[112:115], v[132:135], v[68:71]
  s_waitcnt lgkmcnt(12)
  v_mfma_f32_16x16x32_bf16 v[72:75], v[116:119], v[128:131], v[72:75]
  ds_read_b64_tr_b16 v[112:113], v20 offset:8192
  ds_read_b64_tr_b16 v[114:115], v20 offset:12288
  v_mfma_f32_16x16x32_bf16 v[76:79], v[116:119], v[132:135], v[76:79]
  s_waitcnt lgkmcnt(12)
  v_mfma_f32_16x16x32_bf16 v[80:83], v[120:123], v[128:131], v[80:83]
  ds_read_b64_tr_b16 v[116:117], v21 offset:8192
  ds_read_b64_tr_b16 v[118:119], v21 offset:12288
  v_mfma_f32_16x16x32_bf16 v[84:87], v[120:123], v[132:135], v[84:87]
  s_waitcnt lgkmcnt(12)
  v_mfma_f32_16x16x32_bf16 v[88:91], v[124:127], v[128:131], v[88:91]
  ds_read_b64_tr_b16 v[120:121], v22 offset:8192
  ds_read_b64_tr_b16 v[122:123], v22 offset:12288
  v_mfma_f32_16x16x32_bf16 v[92:95], v[124:127], v[132:135], v[92:95]
  s_waitcnt lgkmcnt(12)
  s_waitcnt vmcnt(16)
  v_mfma_f32_16x16x32_bf16 v[32:35], v[96:99], v[136:139], v[32:35]
  ds_read_b64_tr_b16 v[124:125], v23 offset:8192
  ds_read_b64_tr_b16 v[126:127], v23 offset:12288
  v_mfma_f32_16x16x32_bf16 v[36:39], v[96:99], v[140:143], v[36:39]
  s_waitcnt lgkmcnt(12)
  v_mfma_f32_16x16x32_bf16 v[40:43], v[100:103], v[136:139], v[40:43]
  s_barrier
  ds_read_b64_tr_b16 v[96:97], v16 offset:16384
  ds_read_b64_tr_b16 v[98:99], v16 offset:20480
  v_mfma_f32_16x16x32_bf16 v[44:47], v[100:103], v[140:143], v[44:47]
  buffer_load_dwordx4 v[128:131], v4, s[4:7], s46 offen offset:0 sc1
  buffer_load_dwordx4 v[132:135], v5, s[4:7], s46 offen offset:0 sc1
  s_waitcnt lgkmcnt(12)
  v_mfma_f32_16x16x32_bf16 v[48:51], v[104:107], v[136:139], v[48:51]
  ds_read_b64_tr_b16 v[100:101], v17 offset:16384
  ds_read_b64_tr_b16 v[102:103], v17 offset:20480
  v_mfma_f32_16x16x32_bf16 v[52:55], v[104:107], v[140:143], v[52:55]
  s_waitcnt lgkmcnt(12)
  v_mfma_f32_16x16x32_bf16 v[56:59], v[108:111], v[136:139], v[56:59]
  ds_read_b64_tr_b16 v[104:105], v18 offset:16384
  ds_read_b64_tr_b16 v[106:107], v18 offset:20480
  v_mfma_f32_16x16x32_bf16 v[60:63], v[108:111], v[140:143], v[60:63]
  s_waitcnt lgkmcnt(12)
  v_mfma_f32_16x16x32_bf16 v[64:67], v[112:115], v[136:139], v[64:67]
  ds_read_b64_tr_b16 v[108:109], v19 offset:16384
  ds_read_b64_tr_b16 v[110:111], v19 offset:20480
  v_mfma_f32_16x16x32_bf16 v[68:71], v[112:115], v[140:143], v[68:71]
  s_waitcnt lgkmcnt(12)
  v_mfma_f32_16x16x32_bf16 v[72:75], v[116:119], v[136:139], v[72:75]
  ds_read_b64_tr_b16 v[112:113], v20 offset:16384
  ds_read_b64_tr_b16 v[114:115], v20 offset:20480
  v_mfma_f32_16x16x32_bf16 v[76:79], v[116:119], v[140:143], v[76:79]
  s_waitcnt lgkmcnt(12)
  v_mfma_f32_16x16x32_bf16 v[80:83], v[120:123], v[136:139], v[80:83]
  ds_read_b64_tr_b16 v[116:117], v21 offset:16384
  ds_read_b64_tr_b16 v[118:119], v21 offset:20480
  v_mfma_f32_16x16x32_bf16 v[84:87], v[120:123], v[140:143], v[84:87]
  s_waitcnt lgkmcnt(12)
  v_mfma_f32_16x16x32_bf16 v[88:91], v[124:127], v[136:139], v[88:91]
  ds_read_b64_tr_b16 v[120:121], v22 offset:16384
  ds_read_b64_tr_b16 v[122:123], v22 offset:20480
  v_mfma_f32_16x16x32_bf16 v[92:95], v[124:127], v[140:143], v[92:95]
  s_waitcnt lgkmcnt(12)
  s_waitcnt vmcnt(16)
  v_mfma_f32_16x16x32_bf16 v[32:35], v[96:99], v[144:147], v[32:35]
  ds_read_b64_tr_b16 v[124:125], v23 offset:16384
  ds_read_b64_tr_b16 v[126:127], v23 offset:20480
  v_mfma_f32_16x16x32_bf16 v[36:39], v[96:99], v[148:151], v[36:39]
  s_waitcnt lgkmcnt(12)
  v_mfma_f32_16x16x32_bf16 v[40:43], v[100:103], v[144:147], v[40:43]
  ds_read_b64_tr_b16 v[96:97], v16 offset:24576
  ds_read_b64_tr_b16 v[98:99], v16 offset:28672
  v_mfma_f32_16x16x32_bf16 v[44:47], v[100:103], v[148:151], v[44:47]
  buffer_load_dwordx4 v[136:139], v4, s[4:7], s46 offen offset:1024 sc1
  buffer_load_dwordx4 v[140:143], v5, s[4:7], s46 offen offset:1024 sc1
  s_add_u32 s46, s46, 2048
  s_waitcnt lgkmcnt(12)
  v_mfma_f32_16x16x32_bf16 v[48:51], v[104:107], v[144:147], v[48:51]
  ds_read_b64_tr_b16 v[100:101], v17 offset:24576
  ds_read_b64_tr_b16 v[102:103], v17 offset:28672
  v_mfma_f32_16x16x32_bf16 v[52:55], v[104:107], v[148:151], v[52:55]
  s_waitcnt lgkmcnt(12)
  v_mfma_f32_16x16x32_bf16 v[56:59], v[108:111], v[144:147], v[56:59]
  ds_read_b64_tr_b16 v[104:105], v18 offset:24576
  ds_read_b64_tr_b16 v[106:107], v18 offset:28672
  v_mfma_f32_16x16x32_bf16 v[60:63], v[108:111], v[148:151], v[60:63]
  s_waitcnt lgkmcnt(12)
  v_mfma_f32_16x16x32_bf16 v[64:67], v[112:115], v[144:147], v[64:67]
  ds_read_b64_tr_b16 v[108:109], v19 offset:24576
  ds_read_b64_tr_b16 v[110:111], v19 offset:28672
  v_mfma_f32_16x16x32_bf16 v[68:71], v[112:115], v[148:151], v[68:71]
  s_waitcnt lgkmcnt(12)
  v_mfma_f32_16x16x32_bf16 v[72:75], v[116:119], v[144:147], v[72:75]
  ds_read_b64_tr_b16 v[112:113], v20 offset:24576
  ds_read_b64_tr_b16 v[114:115], v20 offset:28672
  v_mfma_f32_16x16x32_bf16 v[76:79], v[116:119], v[148:151], v[76:79]
  s_waitcnt lgkmcnt(12)
  v_mfma_f32_16x16x32_bf16 v[80:83], v[120:123], v[144:147], v[80:83]
  ds_read_b64_tr_b16 v[116:117], v21 offset:24576
  ds_read_b64_tr_b16 v[118:119], v21 offset:28672
  v_mfma_f32_16x16x32_bf16 v[84:87], v[120:123], v[148:151], v[84:87]
  s_waitcnt lgkmcnt(12)
  v_mfma_f32_16x16x32_bf16 v[88:91], v[124:127], v[144:147], v[88:91]
  ds_read_b64_tr_b16 v[120:121], v22 offset:24576
  ds_read_b64_tr_b16 v[122:123], v22 offset:28672
  v_mfma_f32_16x16x32_bf16 v[92:95], v[124:127], v[148:151], v[92:95]
  s_waitcnt lgkmcnt(12)
  s_waitcnt vmcnt(16)
  v_mfma_f32_16x16x32_bf16 v[32:35], v[96:99], v[152:155], v[32:35]
  ds_read_b64_tr_b16 v[124:125], v23 offset:24576
  ds_read_b64_tr_b16 v[126:127], v23 offset:28672
  v_mfma_f32_16x16x32_bf16 v[36:39], v[96:99], v[156:159], v[36:39]
  s_waitcnt lgkmcnt(12)
  v_mfma_f32_16x16x32_bf16 v[40:43], v[100:103], v[152:155], v[40:43]
  s_barrier
  ds_read_b64_tr_b16 v[96:97], v8 offset:0
  ds_read_b64_tr_b16 v[98:99], v8 offset:4096
  v_mfma_f32_16x16x32_bf16 v[44:47], v[100:103], v[156:159], v[44:47]
  buffer_load_dwordx4 v[144:147], v4, s[4:7], s46 offen offset:0 sc1
  buffer_load_dwordx4 v[148:151], v5, s[4:7], s46 offen offset:0 sc1
  s_waitcnt lgkmcnt(12)
  v_mfma_f32_16x16x32_bf16 v[48:51], v[104:107], v[152:155], v[48:51]
  ds_read_b64_tr_b16 v[100:101], v9 offset:0
  ds_read_b64_tr_b16 v[102:103], v9 offset:4096
  v_mfma_f32_16x16x32_bf16 v[52:55], v[104:107], v[156:159], v[52:55]
  s_waitcnt lgkmcnt(12)
  v_mfma_f32_16x16x32_bf16 v[56:59], v[108:111], v[152:155], v[56:59]
  ds_read_b64_tr_b16 v[104:105], v10 offset:0
  ds_read_b64_tr_b16 v[106:107], v10 offset:4096
  v_mfma_f32_16x16x32_bf16 v[60:63], v[108:111], v[156:159], v[60:63]
  s_waitcnt lgkmcnt(12)
  v_mfma_f32_16x16x32_bf16 v[64:67], v[112:115], v[152:155], v[64:67]
  ds_read_b64_tr_b16 v[108:109], v11 offset:0
  ds_read_b64_tr_b16 v[110:111], v11 offset:4096
  v_mfma_f32_16x16x32_bf16 v[68:71], v[112:115], v[156:159], v[68:71]
  s_waitcnt lgkmcnt(12)
  v_mfma_f32_16x16x32_bf16 v[72:75], v[116:119], v[152:155], v[72:75]
  ds_read_b64_tr_b16 v[112:113], v12 offset:0
  ds_read_b64_tr_b16 v[114:115], v12 offset:4096
  v_mfma_f32_16x16x32_bf16 v[76:79], v[116:119], v[156:159], v[76:79]
  s_waitcnt lgkmcnt(12)
  v_mfma_f32_16x16x32_bf16 v[80:83], v[120:123], v[152:155], v[80:83]
  ds_read_b64_tr_b16 v[116:117], v13 offset:0
  ds_read_b64_tr_b16 v[118:119], v13 offset:4096
  v_mfma_f32_16x16x32_bf16 v[84:87], v[120:123], v[156:159], v[84:87]
  s_waitcnt lgkmcnt(12)
  v_mfma_f32_16x16x32_bf16 v[88:91], v[124:127], v[152:155], v[88:91]
  ds_read_b64_tr_b16 v[120:121], v14 offset:0
  ds_read_b64_tr_b16 v[122:123], v14 offset:4096
  v_mfma_f32_16x16x32_bf16 v[92:95], v[124:127], v[156:159], v[92:95]
  s_waitcnt lgkmcnt(12)
  s_waitcnt vmcnt(16)
  v_mfma_f32_16x16x32_bf16 v[32:35], v[96:99], v[160:163], v[32:35]
  ds_read_b64_tr_b16 v[124:125], v15 offset:0
  ds_read_b64_tr_b16 v[126:127], v15 offset:4096
  v_mfma_f32_16x16x32_bf16 v[36:39], v[96:99], v[164:167], v[36:39]
  s_waitcnt lgkmcnt(12)
  v_mfma_f32_16x16x32_bf16 v[40:43], v[100:103], v[160:163], v[40:43]
  ds_read_b64_tr_b16 v[96:97], v8 offset:8192
  ds_read_b64_tr_b16 v[98:99], v8 offset:12288
  v_mfma_f32_16x16x32_bf16 v[44:47], v[100:103], v[164:167], v[44:47]
  buffer_load_dwordx4 v[152:155], v4, s[4:7], s46 offen offset:1024 sc1
  buffer_load_dwordx4 v[156:159], v5, s[4:7], s46 offen offset:1024 sc1
  s_add_u32 s46, s46, 2048
  s_waitcnt lgkmcnt(12)
  v_mfma_f32_16x16x32_bf16 v[48:51], v[104:107], v[160:163], v[48:51]
  ds_read_b64_tr_b16 v[100:101], v9 offset:8192
  ds_read_b64_tr_b16 v[102:103], v9 offset:12288
  v_mfma_f32_16x16x32_bf16 v[52:55], v[104:107], v[164:167], v[52:55]
  s_waitcnt lgkmcnt(12)
  v_mfma_f32_16x16x32_bf16 v[56:59], v[108:111], v[160:163], v[56:59]
  ds_read_b64_tr_b16 v[104:105], v10 offset:8192
  ds_read_b64_tr_b16 v[106:107], v10 offset:12288
  v_mfma_f32_16x16x32_bf16 v[60:63], v[108:111], v[164:167], v[60:63]
  s_waitcnt lgkmcnt(12)
  v_mfma_f32_16x16x32_bf16 v[64:67], v[112:115], v[160:163], v[64:67]
  ds_read_b64_tr_b16 v[108:109], v11 offset:8192
  ds_read_b64_tr_b16 v[110:111], v11 offset:12288
  v_mfma_f32_16x16x32_bf16 v[68:71], v[112:115], v[164:167], v[68:71]
  s_waitcnt lgkmcnt(12)
  v_mfma_f32_16x16x32_bf16 v[72:75], v[116:119], v[160:163], v[72:75]
  ds_read_b64_tr_b16 v[112:113], v12 offset:8192
  ds_read_b64_tr_b16 v[114:115], v12 offset:12288
  v_mfma_f32_16x16x32_bf16 v[76:79], v[116:119], v[164:167], v[76:79]
  s_waitcnt lgkmcnt(12)
  v_mfma_f32_16x16x32_bf16 v[80:83], v[120:123], v[160:163], v[80:83]
  ds_read_b64_tr_b16 v[116:117], v13 offset:8192
  ds_read_b64_tr_b16 v[118:119], v13 offset:12288
  v_mfma_f32_16x16x32_bf16 v[84:87], v[120:123], v[164:167], v[84:87]
  s_waitcnt lgkmcnt(12)
  v_mfma_f32_16x16x32_bf16 v[88:91], v[124:127], v[160:163], v[88:91]
  ds_read_b64_tr_b16 v[120:121], v14 offset:8192
  ds_read_b64_tr_b16 v[122:123], v14 offset:12288
  v_mfma_f32_16x16x32_bf16 v[92:95], v[124:127], v[164:167], v[92:95]
  s_waitcnt lgkmcnt(12)
  s_waitcnt vmcnt(16)
  v_mfma_f32_16x16x32_bf16 v[32:35], v[96:99], v[168:171], v[32:35]
  ds_read_b64_tr_b16 v[124:125], v15 offset:8192
  ds_read_b64_tr_b16 v[126:127], v15 offset:12288
  v_mfma_f32_16x16x32_bf16 v[36:39], v[96:99], v[172:175], v[36:39]
  s_waitcnt lgkmcnt(12)
  v_mfma_f32_16x16x32_bf16 v[40:43], v[100:103], v[168:171], v[40:43]
  s_barrier
  ds_read_b64_tr_b16 v[96:97], v8 offset:16384
  ds_read_b64_tr_b16 v[98:99], v8 offset:20480
  v_mfma_f32_16x16x32_bf16 v[44:47], v[100:103], v[172:175], v[44:47]
  buffer_load_dwordx4 v[160:163], v4, s[4:7], s46 offen offset:0 sc1
  buffer_load_dwordx4 v[164:167], v5, s[4:7], s46 offen offset:0 sc1
  s_waitcnt lgkmcnt(12)
  v_mfma_f32_16x16x32_bf16 v[48:51], v[104:107], v[168:171], v[48:51]
  ds_read_b64_tr_b16 v[100:101], v9 offset:16384
  ds_read_b64_tr_b16 v[102:103], v9 offset:20480
  v_mfma_f32_16x16x32_bf16 v[52:55], v[104:107], v[172:175], v[52:55]
  s_waitcnt lgkmcnt(12)
  v_mfma_f32_16x16x32_bf16 v[56:59], v[108:111], v[168:171], v[56:59]
  ds_read_b64_tr_b16 v[104:105], v10 offset:16384
  ds_read_b64_tr_b16 v[106:107], v10 offset:20480
  v_mfma_f32_16x16x32_bf16 v[60:63], v[108:111], v[172:175], v[60:63]
  s_waitcnt lgkmcnt(12)
  v_mfma_f32_16x16x32_bf16 v[64:67], v[112:115], v[168:171], v[64:67]
  ds_read_b64_tr_b16 v[108:109], v11 offset:16384
  ds_read_b64_tr_b16 v[110:111], v11 offset:20480
  v_mfma_f32_16x16x32_bf16 v[68:71], v[112:115], v[172:175], v[68:71]
  s_waitcnt lgkmcnt(12)
  v_mfma_f32_16x16x32_bf16 v[72:75], v[116:119], v[168:171], v[72:75]
  ds_read_b64_tr_b16 v[112:113], v12 offset:16384
  ds_read_b64_tr_b16 v[114:115], v12 offset:20480
  v_mfma_f32_16x16x32_bf16 v[76:79], v[116:119], v[172:175], v[76:79]
  s_waitcnt lgkmcnt(12)
  v_mfma_f32_16x16x32_bf16 v[80:83], v[120:123], v[168:171], v[80:83]
  ds_read_b64_tr_b16 v[116:117], v13 offset:16384
  ds_read_b64_tr_b16 v[118:119], v13 offset:20480
  v_mfma_f32_16x16x32_bf16 v[84:87], v[120:123], v[172:175], v[84:87]
  s_waitcnt lgkmcnt(12)
  v_mfma_f32_16x16x32_bf16 v[88:91], v[124:127], v[168:171], v[88:91]
  ds_read_b64_tr_b16 v[120:121], v14 offset:16384
  ds_read_b64_tr_b16 v[122:123], v14 offset:20480
  v_mfma_f32_16x16x32_bf16 v[92:95], v[124:127], v[172:175], v[92:95]
  s_waitcnt lgkmcnt(12)
  s_waitcnt vmcnt(16)
  v_mfma_f32_16x16x32_bf16 v[32:35], v[96:99], v[176:179], v[32:35]
  ds_read_b64_tr_b16 v[124:125], v15 offset:16384
  ds_read_b64_tr_b16 v[126:127], v15 offset:20480
  v_mfma_f32_16x16x32_bf16 v[36:39], v[96:99], v[180:183], v[36:39]
  s_waitcnt lgkmcnt(12)
  v_mfma_f32_16x16x32_bf16 v[40:43], v[100:103], v[176:179], v[40:43]
  ds_read_b64_tr_b16 v[96:97], v8 offset:24576
  ds_read_b64_tr_b16 v[98:99], v8 offset:28672
  v_mfma_f32_16x16x32_bf16 v[44:47], v[100:103], v[180:183], v[44:47]
  buffer_load_dwordx4 v[168:171], v4, s[4:7], s46 offen offset:1024 sc1
  buffer_load_dwordx4 v[172:175], v5, s[4:7], s46 offen offset:1024 sc1
  s_add_u32 s46, s46, 2048
  s_waitcnt lgkmcnt(12)
  v_mfma_f32_16x16x32_bf16 v[48:51], v[104:107], v[176:179], v[48:51]
  ds_read_b64_tr_b16 v[100:101], v9 offset:24576
  ds_read_b64_tr_b16 v[102:103], v9 offset:28672
  v_mfma_f32_16x16x32_bf16 v[52:55], v[104:107], v[180:183], v[52:55]
  s_waitcnt lgkmcnt(12)
  v_mfma_f32_16x16x32_bf16 v[56:59], v[108:111], v[176:179], v[56:59]
  ds_read_b64_tr_b16 v[104:105], v10 offset:24576
  ds_read_b64_tr_b16 v[106:107], v10 offset:28672
  v_mfma_f32_16x16x32_bf16 v[60:63], v[108:111], v[180:183], v[60:63]
  s_waitcnt lgkmcnt(12)
  v_mfma_f32_16x16x32_bf16 v[64:67], v[112:115], v[176:179], v[64:67]
  ds_read_b64_tr_b16 v[108:109], v11 offset:24576
  ds_read_b64_tr_b16 v[110:111], v11 offset:28672
  v_mfma_f32_16x16x32_bf16 v[68:71], v[112:115], v[180:183], v[68:71]
  s_waitcnt lgkmcnt(12)
  v_mfma_f32_16x16x32_bf16 v[72:75], v[116:119], v[176:179], v[72:75]
  ds_read_b64_tr_b16 v[112:113], v12 offset:24576
  ds_read_b64_tr_b16 v[114:115], v12 offset:28672
  v_mfma_f32_16x16x32_bf16 v[76:79], v[116:119], v[180:183], v[76:79]
  s_waitcnt lgkmcnt(12)
  v_mfma_f32_16x16x32_bf16 v[80:83], v[120:123], v[176:179], v[80:83]
  ds_read_b64_tr_b16 v[116:117], v13 offset:24576
  ds_read_b64_tr_b16 v[118:119], v13 offset:28672
  v_mfma_f32_16x16x32_bf16 v[84:87], v[120:123], v[180:183], v[84:87]
  s_waitcnt lgkmcnt(12)
  v_mfma_f32_16x16x32_bf16 v[88:91], v[124:127], v[176:179], v[88:91]
  ds_read_b64_tr_b16 v[120:121], v14 offset:24576
  ds_read_b64_tr_b16 v[122:123], v14 offset:28672
  v_mfma_f32_16x16x32_bf16 v[92:95], v[124:127], v[180:183], v[92:95]
  s_waitcnt lgkmcnt(12)
  s_waitcnt vmcnt(16)
  v_mfma_f32_16x16x32_bf16 v[32:35], v[96:99], v[184:187], v[32:35]
  ds_read_b64_tr_b16 v[124:125], v15 offset:24576
  ds_read_b64_tr_b16 v[126:127], v15 offset:28672
  v_mfma_f32_16x16x32_bf16 v[36:39], v[96:99], v[188:191], v[36:39]
  s_waitcnt lgkmcnt(12)
  v_mfma_f32_16x16x32_bf16 v[40:43], v[100:103], v[184:187], v[40:43]
  s_barrier
  ds_read_b64_tr_b16 v[96:97], v8 offset:32768
  ds_read_b64_tr_b16 v[98:99], v8 offset:36864
  v_mfma_f32_16x16x32_bf16 v[44:47], v[100:103], v[188:191], v[44:47]
  buffer_load_dwordx4 v[176:179], v4, s[4:7], s46 offen offset:0 sc1
  buffer_load_dwordx4 v[180:183], v5, s[4:7], s46 offen offset:0 sc1
  s_waitcnt lgkmcnt(12)
  v_mfma_f32_16x16x32_bf16 v[48:51], v[104:107], v[184:187], v[48:51]
  ds_read_b64_tr_b16 v[100:101], v9 offset:32768
  ds_read_b64_tr_b16 v[102:103], v9 offset:36864
  v_mfma_f32_16x16x32_bf16 v[52:55], v[104:107], v[188:191], v[52:55]
  s_waitcnt lgkmcnt(12)
  v_mfma_f32_16x16x32_bf16 v[56:59], v[108:111], v[184:187], v[56:59]
  ds_read_b64_tr_b16 v[104:105], v10 offset:32768
  ds_read_b64_tr_b16 v[106:107], v10 offset:36864
  v_mfma_f32_16x16x32_bf16 v[60:63], v[108:111], v[188:191], v[60:63]
  s_waitcnt lgkmcnt(12)
  v_mfma_f32_16x16x32_bf16 v[64:67], v[112:115], v[184:187], v[64:67]
  ds_read_b64_tr_b16 v[108:109], v11 offset:32768
  ds_read_b64_tr_b16 v[110:111], v11 offset:36864
  v_mfma_f32_16x16x32_bf16 v[68:71], v[112:115], v[188:191], v[68:71]
  s_waitcnt lgkmcnt(12)
  v_mfma_f32_16x16x32_bf16 v[72:75], v[116:119], v[184:187], v[72:75]
  ds_read_b64_tr_b16 v[112:113], v12 offset:32768
  ds_read_b64_tr_b16 v[114:115], v12 offset:36864
  v_mfma_f32_16x16x32_bf16 v[76:79], v[116:119], v[188:191], v[76:79]
  s_waitcnt lgkmcnt(12)
  v_mfma_f32_16x16x32_bf16 v[80:83], v[120:123], v[184:187], v[80:83]
  ds_read_b64_tr_b16 v[116:117], v13 offset:32768
  ds_read_b64_tr_b16 v[118:119], v13 offset:36864
  v_mfma_f32_16x16x32_bf16 v[84:87], v[120:123], v[188:191], v[84:87]
  s_waitcnt lgkmcnt(12)
  v_mfma_f32_16x16x32_bf16 v[88:91], v[124:127], v[184:187], v[88:91]
  ds_read_b64_tr_b16 v[120:121], v14 offset:32768
  ds_read_b64_tr_b16 v[122:123], v14 offset:36864
  v_mfma_f32_16x16x32_bf16 v[92:95], v[124:127], v[188:191], v[92:95]
  s_waitcnt lgkmcnt(12)
  s_waitcnt vmcnt(16)
  v_mfma_f32_16x16x32_bf16 v[32:35], v[96:99], v[192:195], v[32:35]
  ds_read_b64_tr_b16 v[124:125], v15 offset:32768
  ds_read_b64_tr_b16 v[126:127], v15 offset:36864
  v_mfma_f32_16x16x32_bf16 v[36:39], v[96:99], v[196:199], v[36:39]
  s_waitcnt lgkmcnt(12)
  v_mfma_f32_16x16x32_bf16 v[40:43], v[100:103], v[192:195], v[40:43]
  ds_read_b64_tr_b16 v[96:97], v8 offset:40960
  ds_read_b64_tr_b16 v[98:99], v8 offset:45056
  v_mfma_f32_16x16x32_bf16 v[44:47], v[100:103], v[196:199], v[44:47]
  buffer_load_dwordx4 v[184:187], v4, s[4:7], s46 offen offset:1024 sc1
  buffer_load_dwordx4 v[188:191], v5, s[4:7], s46 offen offset:1024 sc1
  s_add_u32 s46, s46, 2048
  s_waitcnt lgkmcnt(12)
  v_mfma_f32_16x16x32_bf16 v[48:51], v[104:107], v[192:195], v[48:51]
  ds_read_b64_tr_b16 v[100:101], v9 offset:40960
  ds_read_b64_tr_b16 v[102:103], v9 offset:45056
  v_mfma_f32_16x16x32_bf16 v[52:55], v[104:107], v[196:199], v[52:55]
  s_waitcnt lgkmcnt(12)
  v_mfma_f32_16x16x32_bf16 v[56:59], v[108:111], v[192:195], v[56:59]
  ds_read_b64_tr_b16 v[104:105], v10 offset:40960
  ds_read_b64_tr_b16 v[106:107], v10 offset:45056
  v_mfma_f32_16x16x32_bf16 v[60:63], v[108:111], v[196:199], v[60:63]
  s_waitcnt lgkmcnt(12)
  v_mfma_f32_16x16x32_bf16 v[64:67], v[112:115], v[192:195], v[64:67]
  ds_read_b64_tr_b16 v[108:109], v11 offset:40960
  ds_read_b64_tr_b16 v[110:111], v11 offset:45056
  v_mfma_f32_16x16x32_bf16 v[68:71], v[112:115], v[196:199], v[68:71]
  s_waitcnt lgkmcnt(12)
  v_mfma_f32_16x16x32_bf16 v[72:75], v[116:119], v[192:195], v[72:75]
  ds_read_b64_tr_b16 v[112:113], v12 offset:40960
  ds_read_b64_tr_b16 v[114:115], v12 offset:45056
  v_mfma_f32_16x16x32_bf16 v[76:79], v[116:119], v[196:199], v[76:79]
  s_waitcnt lgkmcnt(12)
  v_mfma_f32_16x16x32_bf16 v[80:83], v[120:123], v[192:195], v[80:83]
  ds_read_b64_tr_b16 v[116:117], v13 offset:40960
  ds_read_b64_tr_b16 v[118:119], v13 offset:45056
  v_mfma_f32_16x16x32_bf16 v[84:87], v[120:123], v[196:199], v[84:87]
  s_waitcnt lgkmcnt(12)
  v_mfma_f32_16x16x32_bf16 v[88:91], v[124:127], v[192:195], v[88:91]
  ds_read_b64_tr_b16 v[120:121], v14 offset:40960
  ds_read_b64_tr_b16 v[122:123], v14 offset:45056
  v_mfma_f32_16x16x32_bf16 v[92:95], v[124:127], v[196:199], v[92:95]
  s_waitcnt lgkmcnt(12)
  s_waitcnt vmcnt(16)
  v_mfma_f32_16x16x32_bf16 v[32:35], v[96:99], v[200:203], v[32:35]
  ds_read_b64_tr_b16 v[124:125], v15 offset:40960
  ds_read_b64_tr_b16 v[126:127], v15 offset:45056
  v_mfma_f32_16x16x32_bf16 v[36:39], v[96:99], v[204:207], v[36:39]
  s_waitcnt lgkmcnt(12)
  v_mfma_f32_16x16x32_bf16 v[40:43], v[100:103], v[200:203], v[40:43]
  s_barrier
  ds_read_b64_tr_b16 v[96:97], v8 offset:49152
  ds_read_b64_tr_b16 v[98:99], v8 offset:53248
  v_mfma_f32_16x16x32_bf16 v[44:47], v[100:103], v[204:207], v[44:47]
  buffer_load_dwordx4 v[192:195], v4, s[4:7], s46 offen offset:0 sc1
  buffer_load_dwordx4 v[196:199], v5, s[4:7], s46 offen offset:0 sc1
  s_waitcnt lgkmcnt(12)
  v_mfma_f32_16x16x32_bf16 v[48:51], v[104:107], v[200:203], v[48:51]
  ds_read_b64_tr_b16 v[100:101], v9 offset:49152
  ds_read_b64_tr_b16 v[102:103], v9 offset:53248
  v_mfma_f32_16x16x32_bf16 v[52:55], v[104:107], v[204:207], v[52:55]
  s_waitcnt lgkmcnt(12)
  v_mfma_f32_16x16x32_bf16 v[56:59], v[108:111], v[200:203], v[56:59]
  ds_read_b64_tr_b16 v[104:105], v10 offset:49152
  ds_read_b64_tr_b16 v[106:107], v10 offset:53248
  v_mfma_f32_16x16x32_bf16 v[60:63], v[108:111], v[204:207], v[60:63]
  s_waitcnt lgkmcnt(12)
  v_mfma_f32_16x16x32_bf16 v[64:67], v[112:115], v[200:203], v[64:67]
  ds_read_b64_tr_b16 v[108:109], v11 offset:49152
  ds_read_b64_tr_b16 v[110:111], v11 offset:53248
  v_mfma_f32_16x16x32_bf16 v[68:71], v[112:115], v[204:207], v[68:71]
  s_waitcnt lgkmcnt(12)
  v_mfma_f32_16x16x32_bf16 v[72:75], v[116:119], v[200:203], v[72:75]
  ds_read_b64_tr_b16 v[112:113], v12 offset:49152
  ds_read_b64_tr_b16 v[114:115], v12 offset:53248
  v_mfma_f32_16x16x32_bf16 v[76:79], v[116:119], v[204:207], v[76:79]
  s_waitcnt lgkmcnt(12)
  v_mfma_f32_16x16x32_bf16 v[80:83], v[120:123], v[200:203], v[80:83]
  ds_read_b64_tr_b16 v[116:117], v13 offset:49152
  ds_read_b64_tr_b16 v[118:119], v13 offset:53248
  v_mfma_f32_16x16x32_bf16 v[84:87], v[120:123], v[204:207], v[84:87]
  s_waitcnt lgkmcnt(12)
  v_mfma_f32_16x16x32_bf16 v[88:91], v[124:127], v[200:203], v[88:91]
  ds_read_b64_tr_b16 v[120:121], v14 offset:49152
  ds_read_b64_tr_b16 v[122:123], v14 offset:53248
  v_mfma_f32_16x16x32_bf16 v[92:95], v[124:127], v[204:207], v[92:95]
  s_waitcnt lgkmcnt(12)
  s_waitcnt vmcnt(16)
  v_mfma_f32_16x16x32_bf16 v[32:35], v[96:99], v[128:131], v[32:35]
  ds_read_b64_tr_b16 v[124:125], v15 offset:49152
  ds_read_b64_tr_b16 v[126:127], v15 offset:53248
  v_mfma_f32_16x16x32_bf16 v[36:39], v[96:99], v[132:135], v[36:39]
  s_waitcnt lgkmcnt(12)
  v_mfma_f32_16x16x32_bf16 v[40:43], v[100:103], v[128:131], v[40:43]
  ds_read_b64_tr_b16 v[96:97], v8 offset:57344
  ds_read_b64_tr_b16 v[98:99], v8 offset:61440
  v_mfma_f32_16x16x32_bf16 v[44:47], v[100:103], v[132:135], v[44:47]
  buffer_load_dwordx4 v[200:203], v4, s[4:7], s46 offen offset:1024 sc1
  buffer_load_dwordx4 v[204:207], v5, s[4:7], s46 offen offset:1024 sc1
  s_add_u32 s46, s46, 2048
  s_waitcnt lgkmcnt(12)
  v_mfma_f32_16x16x32_bf16 v[48:51], v[104:107], v[128:131], v[48:51]
  ds_read_b64_tr_b16 v[100:101], v9 offset:57344
  ds_read_b64_tr_b16 v[102:103], v9 offset:61440
  v_mfma_f32_16x16x32_bf16 v[52:55], v[104:107], v[132:135], v[52:55]
  s_waitcnt lgkmcnt(12)
  v_mfma_f32_16x16x32_bf16 v[56:59], v[108:111], v[128:131], v[56:59]
  ds_read_b64_tr_b16 v[104:105], v10 offset:57344
  ds_read_b64_tr_b16 v[106:107], v10 offset:61440
  v_mfma_f32_16x16x32_bf16 v[60:63], v[108:111], v[132:135], v[60:63]
  s_waitcnt lgkmcnt(12)
  v_mfma_f32_16x16x32_bf16 v[64:67], v[112:115], v[128:131], v[64:67]
  ds_read_b64_tr_b16 v[108:109], v11 offset:57344
  ds_read_b64_tr_b16 v[110:111], v11 offset:61440
  v_mfma_f32_16x16x32_bf16 v[68:71], v[112:115], v[132:135], v[68:71]
  s_waitcnt lgkmcnt(12)
  v_mfma_f32_16x16x32_bf16 v[72:75], v[116:119], v[128:131], v[72:75]
  ds_read_b64_tr_b16 v[112:113], v12 offset:57344
  ds_read_b64_tr_b16 v[114:115], v12 offset:61440
  v_mfma_f32_16x16x32_bf16 v[76:79], v[116:119], v[132:135], v[76:79]
  s_waitcnt lgkmcnt(12)
  v_mfma_f32_16x16x32_bf16 v[80:83], v[120:123], v[128:131], v[80:83]
  ds_read_b64_tr_b16 v[116:117], v13 offset:57344
  ds_read_b64_tr_b16 v[118:119], v13 offset:61440
  v_mfma_f32_16x16x32_bf16 v[84:87], v[120:123], v[132:135], v[84:87]
  s_waitcnt lgkmcnt(12)
  v_mfma_f32_16x16x32_bf16 v[88:91], v[124:127], v[128:131], v[88:91]
  ds_read_b64_tr_b16 v[120:121], v14 offset:57344
  ds_read_b64_tr_b16 v[122:123], v14 offset:61440
  v_mfma_f32_16x16x32_bf16 v[92:95], v[124:127], v[132:135], v[92:95]
  s_waitcnt lgkmcnt(12)
  s_waitcnt vmcnt(16)
  v_mfma_f32_16x16x32_bf16 v[32:35], v[96:99], v[136:139], v[32:35]
  ds_read_b64_tr_b16 v[124:125], v15 offset:57344
  ds_read_b64_tr_b16 v[126:127], v15 offset:61440
  v_mfma_f32_16x16x32_bf16 v[36:39], v[96:99], v[140:143], v[36:39]
  s_waitcnt lgkmcnt(12)
  v_mfma_f32_16x16x32_bf16 v[40:43], v[100:103], v[136:139], v[40:43]
  s_barrier
  ds_read_b64_tr_b16 v[96:97], v16 offset:0
  ds_read_b64_tr_b16 v[98:99], v16 offset:4096
  v_mfma_f32_16x16x32_bf16 v[44:47], v[100:103], v[140:143], v[44:47]
  buffer_load_dwordx4 v[128:131], v4, s[4:7], s46 offen offset:0 sc1
  buffer_load_dwordx4 v[132:135], v5, s[4:7], s46 offen offset:0 sc1
  s_waitcnt lgkmcnt(12)
  v_mfma_f32_16x16x32_bf16 v[48:51], v[104:107], v[136:139], v[48:51]
  ds_read_b64_tr_b16 v[100:101], v17 offset:0
  ds_read_b64_tr_b16 v[102:103], v17 offset:4096
  v_mfma_f32_16x16x32_bf16 v[52:55], v[104:107], v[140:143], v[52:55]
  s_waitcnt lgkmcnt(12)
  v_mfma_f32_16x16x32_bf16 v[56:59], v[108:111], v[136:139], v[56:59]
  ds_read_b64_tr_b16 v[104:105], v18 offset:0
  ds_read_b64_tr_b16 v[106:107], v18 offset:4096
  v_mfma_f32_16x16x32_bf16 v[60:63], v[108:111], v[140:143], v[60:63]
  s_waitcnt lgkmcnt(12)
  v_mfma_f32_16x16x32_bf16 v[64:67], v[112:115], v[136:139], v[64:67]
  ds_read_b64_tr_b16 v[108:109], v19 offset:0
  ds_read_b64_tr_b16 v[110:111], v19 offset:4096
  v_mfma_f32_16x16x32_bf16 v[68:71], v[112:115], v[140:143], v[68:71]
  s_waitcnt lgkmcnt(12)
  v_mfma_f32_16x16x32_bf16 v[72:75], v[116:119], v[136:139], v[72:75]
  ds_read_b64_tr_b16 v[112:113], v20 offset:0
  ds_read_b64_tr_b16 v[114:115], v20 offset:4096
  v_mfma_f32_16x16x32_bf16 v[76:79], v[116:119], v[140:143], v[76:79]
  s_waitcnt lgkmcnt(12)
  v_mfma_f32_16x16x32_bf16 v[80:83], v[120:123], v[136:139], v[80:83]
  ds_read_b64_tr_b16 v[116:117], v21 offset:0
  ds_read_b64_tr_b16 v[118:119], v21 offset:4096
  v_mfma_f32_16x16x32_bf16 v[84:87], v[120:123], v[140:143], v[84:87]
  s_waitcnt lgkmcnt(12)
  v_mfma_f32_16x16x32_bf16 v[88:91], v[124:127], v[136:139], v[88:91]
  ds_read_b64_tr_b16 v[120:121], v22 offset:0
  ds_read_b64_tr_b16 v[122:123], v22 offset:4096
  v_mfma_f32_16x16x32_bf16 v[92:95], v[124:127], v[140:143], v[92:95]
  s_waitcnt lgkmcnt(12)
  s_waitcnt vmcnt(16)
  v_mfma_f32_16x16x32_bf16 v[32:35], v[96:99], v[144:147], v[32:35]
  ds_read_b64_tr_b16 v[124:125], v23 offset:0
  ds_read_b64_tr_b16 v[126:127], v23 offset:4096
  v_mfma_f32_16x16x32_bf16 v[36:39], v[96:99], v[148:151], v[36:39]
  s_waitcnt lgkmcnt(12)
  v_mfma_f32_16x16x32_bf16 v[40:43], v[100:103], v[144:147], v[40:43]
  ds_read_b64_tr_b16 v[96:97], v16 offset:8192
  ds_read_b64_tr_b16 v[98:99], v16 offset:12288
  v_mfma_f32_16x16x32_bf16 v[44:47], v[100:103], v[148:151], v[44:47]
  buffer_load_dwordx4 v[136:139], v4, s[4:7], s46 offen offset:1024 sc1
  buffer_load_dwordx4 v[140:143], v5, s[4:7], s46 offen offset:1024 sc1
  s_add_u32 s46, s46, 2048
  s_waitcnt lgkmcnt(12)
  v_mfma_f32_16x16x32_bf16 v[48:51], v[104:107], v[144:147], v[48:51]
  ds_read_b64_tr_b16 v[100:101], v17 offset:8192
  ds_read_b64_tr_b16 v[102:103], v17 offset:12288
  v_mfma_f32_16x16x32_bf16 v[52:55], v[104:107], v[148:151], v[52:55]
  s_waitcnt lgkmcnt(12)
  v_mfma_f32_16x16x32_bf16 v[56:59], v[108:111], v[144:147], v[56:59]
  ds_read_b64_tr_b16 v[104:105], v18 offset:8192
  ds_read_b64_tr_b16 v[106:107], v18 offset:12288
  v_mfma_f32_16x16x32_bf16 v[60:63], v[108:111], v[148:151], v[60:63]
  s_waitcnt lgkmcnt(12)
  v_mfma_f32_16x16x32_bf16 v[64:67], v[112:115], v[144:147], v[64:67]
  ds_read_b64_tr_b16 v[108:109], v19 offset:8192
  ds_read_b64_tr_b16 v[110:111], v19 offset:12288
  v_mfma_f32_16x16x32_bf16 v[68:71], v[112:115], v[148:151], v[68:71]
  s_waitcnt lgkmcnt(12)
  v_mfma_f32_16x16x32_bf16 v[72:75], v[116:119], v[144:147], v[72:75]
  ds_read_b64_tr_b16 v[112:113], v20 offset:8192
  ds_read_b64_tr_b16 v[114:115], v20 offset:12288
  v_mfma_f32_16x16x32_bf16 v[76:79], v[116:119], v[148:151], v[76:79]
  s_waitcnt lgkmcnt(12)
  v_mfma_f32_16x16x32_bf16 v[80:83], v[120:123], v[144:147], v[80:83]
  ds_read_b64_tr_b16 v[116:117], v21 offset:8192
  ds_read_b64_tr_b16 v[118:119], v21 offset:12288
  v_mfma_f32_16x16x32_bf16 v[84:87], v[120:123], v[148:151], v[84:87]
  s_waitcnt lgkmcnt(12)
  v_mfma_f32_16x16x32_bf16 v[88:91], v[124:127], v[144:147], v[88:91]
  ds_read_b64_tr_b16 v[120:121], v22 offset:8192
  ds_read_b64_tr_b16 v[122:123], v22 offset:12288
  v_mfma_f32_16x16x32_bf16 v[92:95], v[124:127], v[148:151], v[92:95]
  s_waitcnt lgkmcnt(12)
  s_waitcnt vmcnt(16)
  v_mfma_f32_16x16x32_bf16 v[32:35], v[96:99], v[152:155], v[32:35]
  ds_read_b64_tr_b16 v[124:125], v23 offset:8192
  ds_read_b64_tr_b16 v[126:127], v23 offset:12288
  v_mfma_f32_16x16x32_bf16 v[36:39], v[96:99], v[156:159], v[36:39]
  s_waitcnt lgkmcnt(12)
  v_mfma_f32_16x16x32_bf16 v[40:43], v[100:103], v[152:155], v[40:43]
  s_barrier
  ds_read_b64_tr_b16 v[96:97], v16 offset:16384
  ds_read_b64_tr_b16 v[98:99], v16 offset:20480
  v_mfma_f32_16x16x32_bf16 v[44:47], v[100:103], v[156:159], v[44:47]
  buffer_load_dwordx4 v[144:147], v4, s[4:7], s46 offen offset:0 sc1
  buffer_load_dwordx4 v[148:151], v5, s[4:7], s46 offen offset:0 sc1
  s_waitcnt lgkmcnt(12)
  v_mfma_f32_16x16x32_bf16 v[48:51], v[104:107], v[152:155], v[48:51]
  ds_read_b64_tr_b16 v[100:101], v17 offset:16384
  ds_read_b64_tr_b16 v[102:103], v17 offset:20480
  v_mfma_f32_16x16x32_bf16 v[52:55], v[104:107], v[156:159], v[52:55]
  s_waitcnt lgkmcnt(12)
  v_mfma_f32_16x16x32_bf16 v[56:59], v[108:111], v[152:155], v[56:59]
  ds_read_b64_tr_b16 v[104:105], v18 offset:16384
  ds_read_b64_tr_b16 v[106:107], v18 offset:20480
  v_mfma_f32_16x16x32_bf16 v[60:63], v[108:111], v[156:159], v[60:63]
  s_waitcnt lgkmcnt(12)
  v_mfma_f32_16x16x32_bf16 v[64:67], v[112:115], v[152:155], v[64:67]
  ds_read_b64_tr_b16 v[108:109], v19 offset:16384
  ds_read_b64_tr_b16 v[110:111], v19 offset:20480
  v_mfma_f32_16x16x32_bf16 v[68:71], v[112:115], v[156:159], v[68:71]
  s_waitcnt lgkmcnt(12)
  v_mfma_f32_16x16x32_bf16 v[72:75], v[116:119], v[152:155], v[72:75]
  ds_read_b64_tr_b16 v[112:113], v20 offset:16384
  ds_read_b64_tr_b16 v[114:115], v20 offset:20480
  v_mfma_f32_16x16x32_bf16 v[76:79], v[116:119], v[156:159], v[76:79]
  s_waitcnt lgkmcnt(12)
  v_mfma_f32_16x16x32_bf16 v[80:83], v[120:123], v[152:155], v[80:83]
  ds_read_b64_tr_b16 v[116:117], v21 offset:16384
  ds_read_b64_tr_b16 v[118:119], v21 offset:20480
  v_mfma_f32_16x16x32_bf16 v[84:87], v[120:123], v[156:159], v[84:87]
  s_waitcnt lgkmcnt(12)
  v_mfma_f32_16x16x32_bf16 v[88:91], v[124:127], v[152:155], v[88:91]
  ds_read_b64_tr_b16 v[120:121], v22 offset:16384
  ds_read_b64_tr_b16 v[122:123], v22 offset:20480
  v_mfma_f32_16x16x32_bf16 v[92:95], v[124:127], v[156:159], v[92:95]
  s_waitcnt lgkmcnt(12)
  s_waitcnt vmcnt(16)
  v_mfma_f32_16x16x32_bf16 v[32:35], v[96:99], v[160:163], v[32:35]
  ds_read_b64_tr_b16 v[124:125], v23 offset:16384
  ds_read_b64_tr_b16 v[126:127], v23 offset:20480
  v_mfma_f32_16x16x32_bf16 v[36:39], v[96:99], v[164:167], v[36:39]
  s_waitcnt lgkmcnt(12)
  v_mfma_f32_16x16x32_bf16 v[40:43], v[100:103], v[160:163], v[40:43]
  ds_read_b64_tr_b16 v[96:97], v16 offset:24576
  ds_read_b64_tr_b16 v[98:99], v16 offset:28672
  v_mfma_f32_16x16x32_bf16 v[44:47], v[100:103], v[164:167], v[44:47]
  buffer_load_dwordx4 v[152:155], v4, s[4:7], s46 offen offset:1024 sc1
  buffer_load_dwordx4 v[156:159], v5, s[4:7], s46 offen offset:1024 sc1
  s_add_u32 s46, s46, 2048
  s_waitcnt lgkmcnt(12)
  v_mfma_f32_16x16x32_bf16 v[48:51], v[104:107], v[160:163], v[48:51]
  ds_read_b64_tr_b16 v[100:101], v17 offset:24576
  ds_read_b64_tr_b16 v[102:103], v17 offset:28672
  v_mfma_f32_16x16x32_bf16 v[52:55], v[104:107], v[164:167], v[52:55]
  s_waitcnt lgkmcnt(12)
  v_mfma_f32_16x16x32_bf16 v[56:59], v[108:111], v[160:163], v[56:59]
  ds_read_b64_tr_b16 v[104:105], v18 offset:24576
  ds_read_b64_tr_b16 v[106:107], v18 offset:28672
  v_mfma_f32_16x16x32_bf16 v[60:63], v[108:111], v[164:167], v[60:63]
  s_waitcnt lgkmcnt(12)
  v_mfma_f32_16x16x32_bf16 v[64:67], v[112:115], v[160:163], v[64:67]
  ds_read_b64_tr_b16 v[108:109], v19 offset:24576
  ds_read_b64_tr_b16 v[110:111], v19 offset:28672
  v_mfma_f32_16x16x32_bf16 v[68:71], v[112:115], v[164:167], v[68:71]
  s_waitcnt lgkmcnt(12)
  v_mfma_f32_16x16x32_bf16 v[72:75], v[116:119], v[160:163], v[72:75]
  ds_read_b64_tr_b16 v[112:113], v20 offset:24576
  ds_read_b64_tr_b16 v[114:115], v20 offset:28672
  v_mfma_f32_16x16x32_bf16 v[76:79], v[116:119], v[164:167], v[76:79]
  s_waitcnt lgkmcnt(12)
  v_mfma_f32_16x16x32_bf16 v[80:83], v[120:123], v[160:163], v[80:83]
  ds_read_b64_tr_b16 v[116:117], v21 offset:24576
  ds_read_b64_tr_b16 v[118:119], v21 offset:28672
  v_mfma_f32_16x16x32_bf16 v[84:87], v[120:123], v[164:167], v[84:87]
  s_waitcnt lgkmcnt(12)
  v_mfma_f32_16x16x32_bf16 v[88:91], v[124:127], v[160:163], v[88:91]
  ds_read_b64_tr_b16 v[120:121], v22 offset:24576
  ds_read_b64_tr_b16 v[122:123], v22 offset:28672
  v_mfma_f32_16x16x32_bf16 v[92:95], v[124:127], v[164:167], v[92:95]
  s_waitcnt lgkmcnt(12)
  s_waitcnt vmcnt(16)
  v_mfma_f32_16x16x32_bf16 v[32:35], v[96:99], v[168:171], v[32:35]
  ds_read_b64_tr_b16 v[124:125], v23 offset:24576
  ds_read_b64_tr_b16 v[126:127], v23 offset:28672
  v_mfma_f32_16x16x32_bf16 v[36:39], v[96:99], v[172:175], v[36:39]
  s_waitcnt lgkmcnt(12)
  v_mfma_f32_16x16x32_bf16 v[40:43], v[100:103], v[168:171], v[40:43]
  s_barrier
  ds_read_b64_tr_b16 v[96:97], v8 offset:0
  ds_read_b64_tr_b16 v[98:99], v8 offset:4096
  v_mfma_f32_16x16x32_bf16 v[44:47], v[100:103], v[172:175], v[44:47]
  buffer_load_dwordx4 v[160:163], v4, s[4:7], s46 offen offset:0 sc1
  buffer_load_dwordx4 v[164:167], v5, s[4:7], s46 offen offset:0 sc1
  s_waitcnt lgkmcnt(12)
  v_mfma_f32_16x16x32_bf16 v[48:51], v[104:107], v[168:171], v[48:51]
  ds_read_b64_tr_b16 v[100:101], v9 offset:0
  ds_read_b64_tr_b16 v[102:103], v9 offset:4096
  v_mfma_f32_16x16x32_bf16 v[52:55], v[104:107], v[172:175], v[52:55]
  s_waitcnt lgkmcnt(12)
  v_mfma_f32_16x16x32_bf16 v[56:59], v[108:111], v[168:171], v[56:59]
  ds_read_b64_tr_b16 v[104:105], v10 offset:0
  ds_read_b64_tr_b16 v[106:107], v10 offset:4096
  v_mfma_f32_16x16x32_bf16 v[60:63], v[108:111], v[172:175], v[60:63]
  s_waitcnt lgkmcnt(12)
  v_mfma_f32_16x16x32_bf16 v[64:67], v[112:115], v[168:171], v[64:67]
  ds_read_b64_tr_b16 v[108:109], v11 offset:0
  ds_read_b64_tr_b16 v[110:111], v11 offset:4096
  v_mfma_f32_16x16x32_bf16 v[68:71], v[112:115], v[172:175], v[68:71]
  s_waitcnt lgkmcnt(12)
  v_mfma_f32_16x16x32_bf16 v[72:75], v[116:119], v[168:171], v[72:75]
  ds_read_b64_tr_b16 v[112:113], v12 offset:0
  ds_read_b64_tr_b16 v[114:115], v12 offset:4096
  v_mfma_f32_16x16x32_bf16 v[76:79], v[116:119], v[172:175], v[76:79]
  s_waitcnt lgkmcnt(12)
  v_mfma_f32_16x16x32_bf16 v[80:83], v[120:123], v[168:171], v[80:83]
  ds_read_b64_tr_b16 v[116:117], v13 offset:0
  ds_read_b64_tr_b16 v[118:119], v13 offset:4096
  v_mfma_f32_16x16x32_bf16 v[84:87], v[120:123], v[172:175], v[84:87]
  s_waitcnt lgkmcnt(12)
  v_mfma_f32_16x16x32_bf16 v[88:91], v[124:127], v[168:171], v[88:91]
  ds_read_b64_tr_b16 v[120:121], v14 offset:0
  ds_read_b64_tr_b16 v[122:123], v14 offset:4096
  v_mfma_f32_16x16x32_bf16 v[92:95], v[124:127], v[172:175], v[92:95]
  s_waitcnt lgkmcnt(12)
  s_waitcnt vmcnt(16)
  v_mfma_f32_16x16x32_bf16 v[32:35], v[96:99], v[176:179], v[32:35]
  ds_read_b64_tr_b16 v[124:125], v15 offset:0
  ds_read_b64_tr_b16 v[126:127], v15 offset:4096
  v_mfma_f32_16x16x32_bf16 v[36:39], v[96:99], v[180:183], v[36:39]
  s_waitcnt lgkmcnt(12)
  v_mfma_f32_16x16x32_bf16 v[40:43], v[100:103], v[176:179], v[40:43]
  ds_read_b64_tr_b16 v[96:97], v8 offset:8192
  ds_read_b64_tr_b16 v[98:99], v8 offset:12288
  v_mfma_f32_16x16x32_bf16 v[44:47], v[100:103], v[180:183], v[44:47]
  buffer_load_dwordx4 v[168:171], v4, s[4:7], s46 offen offset:1024 sc1
  buffer_load_dwordx4 v[172:175], v5, s[4:7], s46 offen offset:1024 sc1
  s_add_u32 s46, s46, 2048
  s_waitcnt lgkmcnt(12)
  v_mfma_f32_16x16x32_bf16 v[48:51], v[104:107], v[176:179], v[48:51]
  ds_read_b64_tr_b16 v[100:101], v9 offset:8192
  ds_read_b64_tr_b16 v[102:103], v9 offset:12288
  v_mfma_f32_16x16x32_bf16 v[52:55], v[104:107], v[180:183], v[52:55]
  s_waitcnt lgkmcnt(12)
  v_mfma_f32_16x16x32_bf16 v[56:59], v[108:111], v[176:179], v[56:59]
  ds_read_b64_tr_b16 v[104:105], v10 offset:8192
  ds_read_b64_tr_b16 v[106:107], v10 offset:12288
  v_mfma_f32_16x16x32_bf16 v[60:63], v[108:111], v[180:183], v[60:63]
  s_waitcnt lgkmcnt(12)
  v_mfma_f32_16x16x32_bf16 v[64:67], v[112:115], v[176:179], v[64:67]
  ds_read_b64_tr_b16 v[108:109], v11 offset:8192
  ds_read_b64_tr_b16 v[110:111], v11 offset:12288
  v_mfma_f32_16x16x32_bf16 v[68:71], v[112:115], v[180:183], v[68:71]
  s_waitcnt lgkmcnt(12)
  v_mfma_f32_16x16x32_bf16 v[72:75], v[116:119], v[176:179], v[72:75]
  ds_read_b64_tr_b16 v[112:113], v12 offset:8192
  ds_read_b64_tr_b16 v[114:115], v12 offset:12288
  v_mfma_f32_16x16x32_bf16 v[76:79], v[116:119], v[180:183], v[76:79]
  s_waitcnt lgkmcnt(12)
  v_mfma_f32_16x16x32_bf16 v[80:83], v[120:123], v[176:179], v[80:83]
  ds_read_b64_tr_b16 v[116:117], v13 offset:8192
  ds_read_b64_tr_b16 v[118:119], v13 offset:12288
  v_mfma_f32_16x16x32_bf16 v[84:87], v[120:123], v[180:183], v[84:87]
  s_waitcnt lgkmcnt(12)
  v_mfma_f32_16x16x32_bf16 v[88:91], v[124:127], v[176:179], v[88:91]
  ds_read_b64_tr_b16 v[120:121], v14 offset:8192
  ds_read_b64_tr_b16 v[122:123], v14 offset:12288
  v_mfma_f32_16x16x32_bf16 v[92:95], v[124:127], v[180:183], v[92:95]
  s_waitcnt lgkmcnt(12)
  s_waitcnt vmcnt(16)
  v_mfma_f32_16x16x32_bf16 v[32:35], v[96:99], v[184:187], v[32:35]
  ds_read_b64_tr_b16 v[124:125], v15 offset:8192
  ds_read_b64_tr_b16 v[126:127], v15 offset:12288
  v_mfma_f32_16x16x32_bf16 v[36:39], v[96:99], v[188:191], v[36:39]
  s_waitcnt lgkmcnt(12)
  v_mfma_f32_16x16x32_bf16 v[40:43], v[100:103], v[184:187], v[40:43]
  s_barrier
  ds_read_b64_tr_b16 v[96:97], v8 offset:16384
  ds_read_b64_tr_b16 v[98:99], v8 offset:20480
  v_mfma_f32_16x16x32_bf16 v[44:47], v[100:103], v[188:191], v[44:47]
  buffer_load_dwordx4 v[176:179], v4, s[4:7], s46 offen offset:0 sc1
  buffer_load_dwordx4 v[180:183], v5, s[4:7], s46 offen offset:0 sc1
  s_waitcnt lgkmcnt(12)
  v_mfma_f32_16x16x32_bf16 v[48:51], v[104:107], v[184:187], v[48:51]
  ds_read_b64_tr_b16 v[100:101], v9 offset:16384
  ds_read_b64_tr_b16 v[102:103], v9 offset:20480
  v_mfma_f32_16x16x32_bf16 v[52:55], v[104:107], v[188:191], v[52:55]
  s_waitcnt lgkmcnt(12)
  v_mfma_f32_16x16x32_bf16 v[56:59], v[108:111], v[184:187], v[56:59]
  ds_read_b64_tr_b16 v[104:105], v10 offset:16384
  ds_read_b64_tr_b16 v[106:107], v10 offset:20480
  v_mfma_f32_16x16x32_bf16 v[60:63], v[108:111], v[188:191], v[60:63]
  s_waitcnt lgkmcnt(12)
  v_mfma_f32_16x16x32_bf16 v[64:67], v[112:115], v[184:187], v[64:67]
  ds_read_b64_tr_b16 v[108:109], v11 offset:16384
  ds_read_b64_tr_b16 v[110:111], v11 offset:20480
  v_mfma_f32_16x16x32_bf16 v[68:71], v[112:115], v[188:191], v[68:71]
  s_waitcnt lgkmcnt(12)
  v_mfma_f32_16x16x32_bf16 v[72:75], v[116:119], v[184:187], v[72:75]
  ds_read_b64_tr_b16 v[112:113], v12 offset:16384
  ds_read_b64_tr_b16 v[114:115], v12 offset:20480
  v_mfma_f32_16x16x32_bf16 v[76:79], v[116:119], v[188:191], v[76:79]
  s_waitcnt lgkmcnt(12)
  v_mfma_f32_16x16x32_bf16 v[80:83], v[120:123], v[184:187], v[80:83]
  ds_read_b64_tr_b16 v[116:117], v13 offset:16384
  ds_read_b64_tr_b16 v[118:119], v13 offset:20480
  v_mfma_f32_16x16x32_bf16 v[84:87], v[120:123], v[188:191], v[84:87]
  s_waitcnt lgkmcnt(12)
  v_mfma_f32_16x16x32_bf16 v[88:91], v[124:127], v[184:187], v[88:91]
  ds_read_b64_tr_b16 v[120:121], v14 offset:16384
  ds_read_b64_tr_b16 v[122:123], v14 offset:20480
  v_mfma_f32_16x16x32_bf16 v[92:95], v[124:127], v[188:191], v[92:95]
  s_waitcnt lgkmcnt(12)
  s_waitcnt vmcnt(16)
  v_mfma_f32_16x16x32_bf16 v[32:35], v[96:99], v[192:195], v[32:35]
  ds_read_b64_tr_b16 v[124:125], v15 offset:16384
  ds_read_b64_tr_b16 v[126:127], v15 offset:20480
  v_mfma_f32_16x16x32_bf16 v[36:39], v[96:99], v[196:199], v[36:39]
  s_waitcnt lgkmcnt(12)
  v_mfma_f32_16x16x32_bf16 v[40:43], v[100:103], v[192:195], v[40:43]
  ds_read_b64_tr_b16 v[96:97], v8 offset:24576
  ds_read_b64_tr_b16 v[98:99], v8 offset:28672
  v_mfma_f32_16x16x32_bf16 v[44:47], v[100:103], v[196:199], v[44:47]
  buffer_load_dwordx4 v[184:187], v4, s[4:7], s46 offen offset:1024 sc1
  buffer_load_dwordx4 v[188:191], v5, s[4:7], s46 offen offset:1024 sc1
  s_add_u32 s46, s46, 2048
  s_waitcnt lgkmcnt(12)
  v_mfma_f32_16x16x32_bf16 v[48:51], v[104:107], v[192:195], v[48:51]
  ds_read_b64_tr_b16 v[100:101], v9 offset:24576
  ds_read_b64_tr_b16 v[102:103], v9 offset:28672
  v_mfma_f32_16x16x32_bf16 v[52:55], v[104:107], v[196:199], v[52:55]
  s_waitcnt lgkmcnt(12)
  v_mfma_f32_16x16x32_bf16 v[56:59], v[108:111], v[192:195], v[56:59]
  ds_read_b64_tr_b16 v[104:105], v10 offset:24576
  ds_read_b64_tr_b16 v[106:107], v10 offset:28672
  v_mfma_f32_16x16x32_bf16 v[60:63], v[108:111], v[196:199], v[60:63]
  s_waitcnt lgkmcnt(12)
  v_mfma_f32_16x16x32_bf16 v[64:67], v[112:115], v[192:195], v[64:67]
  ds_read_b64_tr_b16 v[108:109], v11 offset:24576
  ds_read_b64_tr_b16 v[110:111], v11 offset:28672
  v_mfma_f32_16x16x32_bf16 v[68:71], v[112:115], v[196:199], v[68:71]
  s_waitcnt lgkmcnt(12)
  v_mfma_f32_16x16x32_bf16 v[72:75], v[116:119], v[192:195], v[72:75]
  ds_read_b64_tr_b16 v[112:113], v12 offset:24576
  ds_read_b64_tr_b16 v[114:115], v12 offset:28672
  v_mfma_f32_16x16x32_bf16 v[76:79], v[116:119], v[196:199], v[76:79]
  s_waitcnt lgkmcnt(12)
  v_mfma_f32_16x16x32_bf16 v[80:83], v[120:123], v[192:195], v[80:83]
  ds_read_b64_tr_b16 v[116:117], v13 offset:24576
  ds_read_b64_tr_b16 v[118:119], v13 offset:28672
  v_mfma_f32_16x16x32_bf16 v[84:87], v[120:123], v[196:199], v[84:87]
  s_waitcnt lgkmcnt(12)
  v_mfma_f32_16x16x32_bf16 v[88:91], v[124:127], v[192:195], v[88:91]
  ds_read_b64_tr_b16 v[120:121], v14 offset:24576
  ds_read_b64_tr_b16 v[122:123], v14 offset:28672
  v_mfma_f32_16x16x32_bf16 v[92:95], v[124:127], v[196:199], v[92:95]
  s_waitcnt lgkmcnt(12)
  s_waitcnt vmcnt(16)
  v_mfma_f32_16x16x32_bf16 v[32:35], v[96:99], v[200:203], v[32:35]
  ds_read_b64_tr_b16 v[124:125], v15 offset:24576
  ds_read_b64_tr_b16 v[126:127], v15 offset:28672
  v_mfma_f32_16x16x32_bf16 v[36:39], v[96:99], v[204:207], v[36:39]
  s_waitcnt lgkmcnt(12)
  v_mfma_f32_16x16x32_bf16 v[40:43], v[100:103], v[200:203], v[40:43]
  s_barrier
  ds_read_b64_tr_b16 v[96:97], v8 offset:32768
  ds_read_b64_tr_b16 v[98:99], v8 offset:36864
  v_mfma_f32_16x16x32_bf16 v[44:47], v[100:103], v[204:207], v[44:47]
  buffer_load_dwordx4 v[192:195], v4, s[4:7], s46 offen offset:0 sc1
  buffer_load_dwordx4 v[196:199], v5, s[4:7], s46 offen offset:0 sc1
  s_waitcnt lgkmcnt(12)
  v_mfma_f32_16x16x32_bf16 v[48:51], v[104:107], v[200:203], v[48:51]
  ds_read_b64_tr_b16 v[100:101], v9 offset:32768
  ds_read_b64_tr_b16 v[102:103], v9 offset:36864
  v_mfma_f32_16x16x32_bf16 v[52:55], v[104:107], v[204:207], v[52:55]
  s_waitcnt lgkmcnt(12)
  v_mfma_f32_16x16x32_bf16 v[56:59], v[108:111], v[200:203], v[56:59]
  ds_read_b64_tr_b16 v[104:105], v10 offset:32768
  ds_read_b64_tr_b16 v[106:107], v10 offset:36864
  v_mfma_f32_16x16x32_bf16 v[60:63], v[108:111], v[204:207], v[60:63]
  s_waitcnt lgkmcnt(12)
  v_mfma_f32_16x16x32_bf16 v[64:67], v[112:115], v[200:203], v[64:67]
  ds_read_b64_tr_b16 v[108:109], v11 offset:32768
  ds_read_b64_tr_b16 v[110:111], v11 offset:36864
  v_mfma_f32_16x16x32_bf16 v[68:71], v[112:115], v[204:207], v[68:71]
  s_waitcnt lgkmcnt(12)
  v_mfma_f32_16x16x32_bf16 v[72:75], v[116:119], v[200:203], v[72:75]
  ds_read_b64_tr_b16 v[112:113], v12 offset:32768
  ds_read_b64_tr_b16 v[114:115], v12 offset:36864
  v_mfma_f32_16x16x32_bf16 v[76:79], v[116:119], v[204:207], v[76:79]
  s_waitcnt lgkmcnt(12)
  v_mfma_f32_16x16x32_bf16 v[80:83], v[120:123], v[200:203], v[80:83]
  ds_read_b64_tr_b16 v[116:117], v13 offset:32768
  ds_read_b64_tr_b16 v[118:119], v13 offset:36864
  v_mfma_f32_16x16x32_bf16 v[84:87], v[120:123], v[204:207], v[84:87]
  s_waitcnt lgkmcnt(12)
  v_mfma_f32_16x16x32_bf16 v[88:91], v[124:127], v[200:203], v[88:91]
  ds_read_b64_tr_b16 v[120:121], v14 offset:32768
  ds_read_b64_tr_b16 v[122:123], v14 offset:36864
  v_mfma_f32_16x16x32_bf16 v[92:95], v[124:127], v[204:207], v[92:95]
  s_waitcnt lgkmcnt(12)
  s_waitcnt vmcnt(16)
  v_mfma_f32_16x16x32_bf16 v[32:35], v[96:99], v[128:131], v[32:35]
  ds_read_b64_tr_b16 v[124:125], v15 offset:32768
  ds_read_b64_tr_b16 v[126:127], v15 offset:36864
  v_mfma_f32_16x16x32_bf16 v[36:39], v[96:99], v[132:135], v[36:39]
  s_waitcnt lgkmcnt(12)
  v_mfma_f32_16x16x32_bf16 v[40:43], v[100:103], v[128:131], v[40:43]
  ds_read_b64_tr_b16 v[96:97], v8 offset:40960
  ds_read_b64_tr_b16 v[98:99], v8 offset:45056
  v_mfma_f32_16x16x32_bf16 v[44:47], v[100:103], v[132:135], v[44:47]
  buffer_load_dwordx4 v[200:203], v4, s[4:7], s46 offen offset:1024 sc1
  buffer_load_dwordx4 v[204:207], v5, s[4:7], s46 offen offset:1024 sc1
  s_add_u32 s46, s46, 2048
  s_waitcnt lgkmcnt(12)
  v_mfma_f32_16x16x32_bf16 v[48:51], v[104:107], v[128:131], v[48:51]
  ds_read_b64_tr_b16 v[100:101], v9 offset:40960
  ds_read_b64_tr_b16 v[102:103], v9 offset:45056
  v_mfma_f32_16x16x32_bf16 v[52:55], v[104:107], v[132:135], v[52:55]
  s_waitcnt lgkmcnt(12)
  v_mfma_f32_16x16x32_bf16 v[56:59], v[108:111], v[128:131], v[56:59]
  ds_read_b64_tr_b16 v[104:105], v10 offset:40960
  ds_read_b64_tr_b16 v[106:107], v10 offset:45056
  v_mfma_f32_16x16x32_bf16 v[60:63], v[108:111], v[132:135], v[60:63]
  s_waitcnt lgkmcnt(12)
  v_mfma_f32_16x16x32_bf16 v[64:67], v[112:115], v[128:131], v[64:67]
  ds_read_b64_tr_b16 v[108:109], v11 offset:40960
  ds_read_b64_tr_b16 v[110:111], v11 offset:45056
  v_mfma_f32_16x16x32_bf16 v[68:71], v[112:115], v[132:135], v[68:71]
  s_waitcnt lgkmcnt(12)
  v_mfma_f32_16x16x32_bf16 v[72:75], v[116:119], v[128:131], v[72:75]
  ds_read_b64_tr_b16 v[112:113], v12 offset:40960
  ds_read_b64_tr_b16 v[114:115], v12 offset:45056
  v_mfma_f32_16x16x32_bf16 v[76:79], v[116:119], v[132:135], v[76:79]
  s_waitcnt lgkmcnt(12)
  v_mfma_f32_16x16x32_bf16 v[80:83], v[120:123], v[128:131], v[80:83]
  ds_read_b64_tr_b16 v[116:117], v13 offset:40960
  ds_read_b64_tr_b16 v[118:119], v13 offset:45056
  v_mfma_f32_16x16x32_bf16 v[84:87], v[120:123], v[132:135], v[84:87]
  s_waitcnt lgkmcnt(12)
  v_mfma_f32_16x16x32_bf16 v[88:91], v[124:127], v[128:131], v[88:91]
  ds_read_b64_tr_b16 v[120:121], v14 offset:40960
  ds_read_b64_tr_b16 v[122:123], v14 offset:45056
  v_mfma_f32_16x16x32_bf16 v[92:95], v[124:127], v[132:135], v[92:95]
  s_waitcnt lgkmcnt(12)
  s_waitcnt vmcnt(16)
  v_mfma_f32_16x16x32_bf16 v[32:35], v[96:99], v[136:139], v[32:35]
  ds_read_b64_tr_b16 v[124:125], v15 offset:40960
  ds_read_b64_tr_b16 v[126:127], v15 offset:45056
  v_mfma_f32_16x16x32_bf16 v[36:39], v[96:99], v[140:143], v[36:39]
  s_waitcnt lgkmcnt(12)
  v_mfma_f32_16x16x32_bf16 v[40:43], v[100:103], v[136:139], v[40:43]
  s_barrier
  ds_read_b64_tr_b16 v[96:97], v8 offset:49152
  ds_read_b64_tr_b16 v[98:99], v8 offset:53248
  v_mfma_f32_16x16x32_bf16 v[44:47], v[100:103], v[140:143], v[44:47]
  buffer_load_dwordx4 v[128:131], v4, s[4:7], s46 offen offset:0 sc1
  buffer_load_dwordx4 v[132:135], v5, s[4:7], s46 offen offset:0 sc1
  s_waitcnt lgkmcnt(12)
  v_mfma_f32_16x16x32_bf16 v[48:51], v[104:107], v[136:139], v[48:51]
  ds_read_b64_tr_b16 v[100:101], v9 offset:49152
  ds_read_b64_tr_b16 v[102:103], v9 offset:53248
  v_mfma_f32_16x16x32_bf16 v[52:55], v[104:107], v[140:143], v[52:55]
  s_waitcnt lgkmcnt(12)
  v_mfma_f32_16x16x32_bf16 v[56:59], v[108:111], v[136:139], v[56:59]
  ds_read_b64_tr_b16 v[104:105], v10 offset:49152
  ds_read_b64_tr_b16 v[106:107], v10 offset:53248
  v_mfma_f32_16x16x32_bf16 v[60:63], v[108:111], v[140:143], v[60:63]
  s_waitcnt lgkmcnt(12)
  v_mfma_f32_16x16x32_bf16 v[64:67], v[112:115], v[136:139], v[64:67]
  ds_read_b64_tr_b16 v[108:109], v11 offset:49152
  ds_read_b64_tr_b16 v[110:111], v11 offset:53248
  v_mfma_f32_16x16x32_bf16 v[68:71], v[112:115], v[140:143], v[68:71]
  s_waitcnt lgkmcnt(12)
  v_mfma_f32_16x16x32_bf16 v[72:75], v[116:119], v[136:139], v[72:75]
  ds_read_b64_tr_b16 v[112:113], v12 offset:49152
  ds_read_b64_tr_b16 v[114:115], v12 offset:53248
  v_mfma_f32_16x16x32_bf16 v[76:79], v[116:119], v[140:143], v[76:79]
  s_waitcnt lgkmcnt(12)
  v_mfma_f32_16x16x32_bf16 v[80:83], v[120:123], v[136:139], v[80:83]
  ds_read_b64_tr_b16 v[116:117], v13 offset:49152
  ds_read_b64_tr_b16 v[118:119], v13 offset:53248
  v_mfma_f32_16x16x32_bf16 v[84:87], v[120:123], v[140:143], v[84:87]
  s_waitcnt lgkmcnt(12)
  v_mfma_f32_16x16x32_bf16 v[88:91], v[124:127], v[136:139], v[88:91]
  ds_read_b64_tr_b16 v[120:121], v14 offset:49152
  ds_read_b64_tr_b16 v[122:123], v14 offset:53248
  v_mfma_f32_16x16x32_bf16 v[92:95], v[124:127], v[140:143], v[92:95]
  s_waitcnt lgkmcnt(12)
  s_waitcnt vmcnt(16)
  v_mfma_f32_16x16x32_bf16 v[32:35], v[96:99], v[144:147], v[32:35]
  ds_read_b64_tr_b16 v[124:125], v15 offset:49152
  ds_read_b64_tr_b16 v[126:127], v15 offset:53248
  v_mfma_f32_16x16x32_bf16 v[36:39], v[96:99], v[148:151], v[36:39]
  s_waitcnt lgkmcnt(12)
  v_mfma_f32_16x16x32_bf16 v[40:43], v[100:103], v[144:147], v[40:43]
  ds_read_b64_tr_b16 v[96:97], v8 offset:57344
  ds_read_b64_tr_b16 v[98:99], v8 offset:61440
  v_mfma_f32_16x16x32_bf16 v[44:47], v[100:103], v[148:151], v[44:47]
  buffer_load_dwordx4 v[136:139], v4, s[4:7], s46 offen offset:1024 sc1
  buffer_load_dwordx4 v[140:143], v5, s[4:7], s46 offen offset:1024 sc1
  s_add_u32 s46, s46, 2048
  s_waitcnt lgkmcnt(12)
  v_mfma_f32_16x16x32_bf16 v[48:51], v[104:107], v[144:147], v[48:51]
  ds_read_b64_tr_b16 v[100:101], v9 offset:57344
  ds_read_b64_tr_b16 v[102:103], v9 offset:61440
  v_mfma_f32_16x16x32_bf16 v[52:55], v[104:107], v[148:151], v[52:55]
  s_waitcnt lgkmcnt(12)
  v_mfma_f32_16x16x32_bf16 v[56:59], v[108:111], v[144:147], v[56:59]
  ds_read_b64_tr_b16 v[104:105], v10 offset:57344
  ds_read_b64_tr_b16 v[106:107], v10 offset:61440
  v_mfma_f32_16x16x32_bf16 v[60:63], v[108:111], v[148:151], v[60:63]
  s_waitcnt lgkmcnt(12)
  v_mfma_f32_16x16x32_bf16 v[64:67], v[112:115], v[144:147], v[64:67]
  ds_read_b64_tr_b16 v[108:109], v11 offset:57344
  ds_read_b64_tr_b16 v[110:111], v11 offset:61440
  v_mfma_f32_16x16x32_bf16 v[68:71], v[112:115], v[148:151], v[68:71]
  s_waitcnt lgkmcnt(12)
  v_mfma_f32_16x16x32_bf16 v[72:75], v[116:119], v[144:147], v[72:75]
  ds_read_b64_tr_b16 v[112:113], v12 offset:57344
  ds_read_b64_tr_b16 v[114:115], v12 offset:61440
  v_mfma_f32_16x16x32_bf16 v[76:79], v[116:119], v[148:151], v[76:79]
  s_waitcnt lgkmcnt(12)
  v_mfma_f32_16x16x32_bf16 v[80:83], v[120:123], v[144:147], v[80:83]
  ds_read_b64_tr_b16 v[116:117], v13 offset:57344
  ds_read_b64_tr_b16 v[118:119], v13 offset:61440
  v_mfma_f32_16x16x32_bf16 v[84:87], v[120:123], v[148:151], v[84:87]
  s_waitcnt lgkmcnt(12)
  v_mfma_f32_16x16x32_bf16 v[88:91], v[124:127], v[144:147], v[88:91]
  ds_read_b64_tr_b16 v[120:121], v14 offset:57344
  ds_read_b64_tr_b16 v[122:123], v14 offset:61440
  v_mfma_f32_16x16x32_bf16 v[92:95], v[124:127], v[148:151], v[92:95]
  s_waitcnt lgkmcnt(12)
  s_waitcnt vmcnt(16)
  v_mfma_f32_16x16x32_bf16 v[32:35], v[96:99], v[152:155], v[32:35]
  ds_read_b64_tr_b16 v[124:125], v15 offset:57344
  ds_read_b64_tr_b16 v[126:127], v15 offset:61440
  v_mfma_f32_16x16x32_bf16 v[36:39], v[96:99], v[156:159], v[36:39]
  s_waitcnt lgkmcnt(12)
  v_mfma_f32_16x16x32_bf16 v[40:43], v[100:103], v[152:155], v[40:43]
  s_barrier
  ds_read_b64_tr_b16 v[96:97], v16 offset:0
  ds_read_b64_tr_b16 v[98:99], v16 offset:4096
  v_mfma_f32_16x16x32_bf16 v[44:47], v[100:103], v[156:159], v[44:47]
  buffer_load_dwordx4 v[144:147], v4, s[4:7], s46 offen offset:0 sc1
  buffer_load_dwordx4 v[148:151], v5, s[4:7], s46 offen offset:0 sc1
  s_waitcnt lgkmcnt(12)
  v_mfma_f32_16x16x32_bf16 v[48:51], v[104:107], v[152:155], v[48:51]
  ds_read_b64_tr_b16 v[100:101], v17 offset:0
  ds_read_b64_tr_b16 v[102:103], v17 offset:4096
  v_mfma_f32_16x16x32_bf16 v[52:55], v[104:107], v[156:159], v[52:55]
  s_waitcnt lgkmcnt(12)
  v_mfma_f32_16x16x32_bf16 v[56:59], v[108:111], v[152:155], v[56:59]
  ds_read_b64_tr_b16 v[104:105], v18 offset:0
  ds_read_b64_tr_b16 v[106:107], v18 offset:4096
  v_mfma_f32_16x16x32_bf16 v[60:63], v[108:111], v[156:159], v[60:63]
  s_waitcnt lgkmcnt(12)
  v_mfma_f32_16x16x32_bf16 v[64:67], v[112:115], v[152:155], v[64:67]
  ds_read_b64_tr_b16 v[108:109], v19 offset:0
  ds_read_b64_tr_b16 v[110:111], v19 offset:4096
  v_mfma_f32_16x16x32_bf16 v[68:71], v[112:115], v[156:159], v[68:71]
  s_waitcnt lgkmcnt(12)
  v_mfma_f32_16x16x32_bf16 v[72:75], v[116:119], v[152:155], v[72:75]
  ds_read_b64_tr_b16 v[112:113], v20 offset:0
  ds_read_b64_tr_b16 v[114:115], v20 offset:4096
  v_mfma_f32_16x16x32_bf16 v[76:79], v[116:119], v[156:159], v[76:79]
  s_waitcnt lgkmcnt(12)
  v_mfma_f32_16x16x32_bf16 v[80:83], v[120:123], v[152:155], v[80:83]
  ds_read_b64_tr_b16 v[116:117], v21 offset:0
  ds_read_b64_tr_b16 v[118:119], v21 offset:4096
  v_mfma_f32_16x16x32_bf16 v[84:87], v[120:123], v[156:159], v[84:87]
  s_waitcnt lgkmcnt(12)
  v_mfma_f32_16x16x32_bf16 v[88:91], v[124:127], v[152:155], v[88:91]
  ds_read_b64_tr_b16 v[120:121], v22 offset:0
  ds_read_b64_tr_b16 v[122:123], v22 offset:4096
  v_mfma_f32_16x16x32_bf16 v[92:95], v[124:127], v[156:159], v[92:95]
  s_waitcnt lgkmcnt(12)
  s_waitcnt vmcnt(16)
  v_mfma_f32_16x16x32_bf16 v[32:35], v[96:99], v[160:163], v[32:35]
  ds_read_b64_tr_b16 v[124:125], v23 offset:0
  ds_read_b64_tr_b16 v[126:127], v23 offset:4096
  v_mfma_f32_16x16x32_bf16 v[36:39], v[96:99], v[164:167], v[36:39]
  s_waitcnt lgkmcnt(12)
  v_mfma_f32_16x16x32_bf16 v[40:43], v[100:103], v[160:163], v[40:43]
  ds_read_b64_tr_b16 v[96:97], v16 offset:8192
  ds_read_b64_tr_b16 v[98:99], v16 offset:12288
  v_mfma_f32_16x16x32_bf16 v[44:47], v[100:103], v[164:167], v[44:47]
  buffer_load_dwordx4 v[152:155], v4, s[4:7], s46 offen offset:1024 sc1
  buffer_load_dwordx4 v[156:159], v5, s[4:7], s46 offen offset:1024 sc1
  s_add_u32 s46, s46, 2048
  s_waitcnt lgkmcnt(12)
  v_mfma_f32_16x16x32_bf16 v[48:51], v[104:107], v[160:163], v[48:51]
  ds_read_b64_tr_b16 v[100:101], v17 offset:8192
  ds_read_b64_tr_b16 v[102:103], v17 offset:12288
  v_mfma_f32_16x16x32_bf16 v[52:55], v[104:107], v[164:167], v[52:55]
  s_waitcnt lgkmcnt(12)
  v_mfma_f32_16x16x32_bf16 v[56:59], v[108:111], v[160:163], v[56:59]
  ds_read_b64_tr_b16 v[104:105], v18 offset:8192
  ds_read_b64_tr_b16 v[106:107], v18 offset:12288
  v_mfma_f32_16x16x32_bf16 v[60:63], v[108:111], v[164:167], v[60:63]
  s_waitcnt lgkmcnt(12)
  v_mfma_f32_16x16x32_bf16 v[64:67], v[112:115], v[160:163], v[64:67]
  ds_read_b64_tr_b16 v[108:109], v19 offset:8192
  ds_read_b64_tr_b16 v[110:111], v19 offset:12288
  v_mfma_f32_16x16x32_bf16 v[68:71], v[112:115], v[164:167], v[68:71]
  s_waitcnt lgkmcnt(12)
  v_mfma_f32_16x16x32_bf16 v[72:75], v[116:119], v[160:163], v[72:75]
  ds_read_b64_tr_b16 v[112:113], v20 offset:8192
  ds_read_b64_tr_b16 v[114:115], v20 offset:12288
  v_mfma_f32_16x16x32_bf16 v[76:79], v[116:119], v[164:167], v[76:79]
  s_waitcnt lgkmcnt(12)
  v_mfma_f32_16x16x32_bf16 v[80:83], v[120:123], v[160:163], v[80:83]
  ds_read_b64_tr_b16 v[116:117], v21 offset:8192
  ds_read_b64_tr_b16 v[118:119], v21 offset:12288
  v_mfma_f32_16x16x32_bf16 v[84:87], v[120:123], v[164:167], v[84:87]
  s_waitcnt lgkmcnt(12)
  v_mfma_f32_16x16x32_bf16 v[88:91], v[124:127], v[160:163], v[88:91]
  ds_read_b64_tr_b16 v[120:121], v22 offset:8192
  ds_read_b64_tr_b16 v[122:123], v22 offset:12288
  v_mfma_f32_16x16x32_bf16 v[92:95], v[124:127], v[164:167], v[92:95]
  s_waitcnt lgkmcnt(12)
  s_waitcnt vmcnt(16)
  v_mfma_f32_16x16x32_bf16 v[32:35], v[96:99], v[168:171], v[32:35]
  ds_read_b64_tr_b16 v[124:125], v23 offset:8192
  ds_read_b64_tr_b16 v[126:127], v23 offset:12288
  v_mfma_f32_16x16x32_bf16 v[36:39], v[96:99], v[172:175], v[36:39]
  s_waitcnt lgkmcnt(12)
  v_mfma_f32_16x16x32_bf16 v[40:43], v[100:103], v[168:171], v[40:43]
  s_barrier
  ds_read_b64_tr_b16 v[96:97], v16 offset:16384
  ds_read_b64_tr_b16 v[98:99], v16 offset:20480
  v_mfma_f32_16x16x32_bf16 v[44:47], v[100:103], v[172:175], v[44:47]
  buffer_load_dwordx4 v[160:163], v4, s[4:7], s46 offen offset:0 sc1
  buffer_load_dwordx4 v[164:167], v5, s[4:7], s46 offen offset:0 sc1
  s_waitcnt lgkmcnt(12)
  v_mfma_f32_16x16x32_bf16 v[48:51], v[104:107], v[168:171], v[48:51]
  ds_read_b64_tr_b16 v[100:101], v17 offset:16384
  ds_read_b64_tr_b16 v[102:103], v17 offset:20480
  v_mfma_f32_16x16x32_bf16 v[52:55], v[104:107], v[172:175], v[52:55]
  s_waitcnt lgkmcnt(12)
  v_mfma_f32_16x16x32_bf16 v[56:59], v[108:111], v[168:171], v[56:59]
  ds_read_b64_tr_b16 v[104:105], v18 offset:16384
  ds_read_b64_tr_b16 v[106:107], v18 offset:20480
  v_mfma_f32_16x16x32_bf16 v[60:63], v[108:111], v[172:175], v[60:63]
  s_waitcnt lgkmcnt(12)
  v_mfma_f32_16x16x32_bf16 v[64:67], v[112:115], v[168:171], v[64:67]
  ds_read_b64_tr_b16 v[108:109], v19 offset:16384
  ds_read_b64_tr_b16 v[110:111], v19 offset:20480
  v_mfma_f32_16x16x32_bf16 v[68:71], v[112:115], v[172:175], v[68:71]
  s_waitcnt lgkmcnt(12)
  v_mfma_f32_16x16x32_bf16 v[72:75], v[116:119], v[168:171], v[72:75]
  ds_read_b64_tr_b16 v[112:113], v20 offset:16384
  ds_read_b64_tr_b16 v[114:115], v20 offset:20480
  v_mfma_f32_16x16x32_bf16 v[76:79], v[116:119], v[172:175], v[76:79]
  s_waitcnt lgkmcnt(12)
  v_mfma_f32_16x16x32_bf16 v[80:83], v[120:123], v[168:171], v[80:83]
  ds_read_b64_tr_b16 v[116:117], v21 offset:16384
  ds_read_b64_tr_b16 v[118:119], v21 offset:20480
  v_mfma_f32_16x16x32_bf16 v[84:87], v[120:123], v[172:175], v[84:87]
  s_waitcnt lgkmcnt(12)
  v_mfma_f32_16x16x32_bf16 v[88:91], v[124:127], v[168:171], v[88:91]
  ds_read_b64_tr_b16 v[120:121], v22 offset:16384
  ds_read_b64_tr_b16 v[122:123], v22 offset:20480
  v_mfma_f32_16x16x32_bf16 v[92:95], v[124:127], v[172:175], v[92:95]
  s_waitcnt lgkmcnt(12)
  s_waitcnt vmcnt(16)
  v_mfma_f32_16x16x32_bf16 v[32:35], v[96:99], v[176:179], v[32:35]
  ds_read_b64_tr_b16 v[124:125], v23 offset:16384
  ds_read_b64_tr_b16 v[126:127], v23 offset:20480
  v_mfma_f32_16x16x32_bf16 v[36:39], v[96:99], v[180:183], v[36:39]
  s_waitcnt lgkmcnt(12)
  v_mfma_f32_16x16x32_bf16 v[40:43], v[100:103], v[176:179], v[40:43]
  ds_read_b64_tr_b16 v[96:97], v16 offset:24576
  ds_read_b64_tr_b16 v[98:99], v16 offset:28672
  v_mfma_f32_16x16x32_bf16 v[44:47], v[100:103], v[180:183], v[44:47]
  buffer_load_dwordx4 v[168:171], v4, s[4:7], s46 offen offset:1024 sc1
  buffer_load_dwordx4 v[172:175], v5, s[4:7], s46 offen offset:1024 sc1
  s_add_u32 s46, s46, 2048
  s_waitcnt lgkmcnt(12)
  v_mfma_f32_16x16x32_bf16 v[48:51], v[104:107], v[176:179], v[48:51]
  ds_read_b64_tr_b16 v[100:101], v17 offset:24576
  ds_read_b64_tr_b16 v[102:103], v17 offset:28672
  v_mfma_f32_16x16x32_bf16 v[52:55], v[104:107], v[180:183], v[52:55]
  s_waitcnt lgkmcnt(12)
  v_mfma_f32_16x16x32_bf16 v[56:59], v[108:111], v[176:179], v[56:59]
  ds_read_b64_tr_b16 v[104:105], v18 offset:24576
  ds_read_b64_tr_b16 v[106:107], v18 offset:28672
  v_mfma_f32_16x16x32_bf16 v[60:63], v[108:111], v[180:183], v[60:63]
  s_waitcnt lgkmcnt(12)
  v_mfma_f32_16x16x32_bf16 v[64:67], v[112:115], v[176:179], v[64:67]
  ds_read_b64_tr_b16 v[108:109], v19 offset:24576
  ds_read_b64_tr_b16 v[110:111], v19 offset:28672
  v_mfma_f32_16x16x32_bf16 v[68:71], v[112:115], v[180:183], v[68:71]
  s_waitcnt lgkmcnt(12)
  v_mfma_f32_16x16x32_bf16 v[72:75], v[116:119], v[176:179], v[72:75]
  ds_read_b64_tr_b16 v[112:113], v20 offset:24576
  ds_read_b64_tr_b16 v[114:115], v20 offset:28672
  v_mfma_f32_16x16x32_bf16 v[76:79], v[116:119], v[180:183], v[76:79]
  s_waitcnt lgkmcnt(12)
  v_mfma_f32_16x16x32_bf16 v[80:83], v[120:123], v[176:179], v[80:83]
  ds_read_b64_tr_b16 v[116:117], v21 offset:24576
  ds_read_b64_tr_b16 v[118:119], v21 offset:28672
  v_mfma_f32_16x16x32_bf16 v[84:87], v[120:123], v[180:183], v[84:87]
  s_waitcnt lgkmcnt(12)
  v_mfma_f32_16x16x32_bf16 v[88:91], v[124:127], v[176:179], v[88:91]
  ds_read_b64_tr_b16 v[120:121], v22 offset:24576
  ds_read_b64_tr_b16 v[122:123], v22 offset:28672
  v_mfma_f32_16x16x32_bf16 v[92:95], v[124:127], v[180:183], v[92:95]
  s_waitcnt lgkmcnt(12)
  s_waitcnt vmcnt(16)
  v_mfma_f32_16x16x32_bf16 v[32:35], v[96:99], v[184:187], v[32:35]
  ds_read_b64_tr_b16 v[124:125], v23 offset:24576
  ds_read_b64_tr_b16 v[126:127], v23 offset:28672
  v_mfma_f32_16x16x32_bf16 v[36:39], v[96:99], v[188:191], v[36:39]
  s_waitcnt lgkmcnt(12)
  v_mfma_f32_16x16x32_bf16 v[40:43], v[100:103], v[184:187], v[40:43]
  s_barrier
  ds_read_b64_tr_b16 v[96:97], v8 offset:0
  ds_read_b64_tr_b16 v[98:99], v8 offset:4096
  v_mfma_f32_16x16x32_bf16 v[44:47], v[100:103], v[188:191], v[44:47]
  s_mov_b32 s44, 262144
  buffer_load_dwordx2 v[208:209], v24, s[16:19], s44 offen offset:0 sc1
  buffer_load_dwordx2 v[210:211], v24, s[16:19], s44 offen offset:128 sc1
  buffer_load_dwordx4 v[212:215], v6, s[12:15], 0 offen offset:0 sc1
  buffer_load_dwordx4 v[216:219], v6, s[12:15], 0 offen offset:1024 sc1
  buffer_load_dwordx4 v[220:223], v7, s[12:15], 0 offen offset:0 sc1
  buffer_load_dwordx4 v[224:227], v7, s[12:15], 0 offen offset:1024 sc1
  s_waitcnt lgkmcnt(12)
  v_mfma_f32_16x16x32_bf16 v[48:51], v[104:107], v[184:187], v[48:51]
  ds_read_b64_tr_b16 v[100:101], v9 offset:0
  ds_read_b64_tr_b16 v[102:103], v9 offset:4096
  v_mfma_f32_16x16x32_bf16 v[52:55], v[104:107], v[188:191], v[52:55]
  s_waitcnt lgkmcnt(12)
  v_mfma_f32_16x16x32_bf16 v[56:59], v[108:111], v[184:187], v[56:59]
  ds_read_b64_tr_b16 v[104:105], v10 offset:0
  ds_read_b64_tr_b16 v[106:107], v10 offset:4096
  v_mfma_f32_16x16x32_bf16 v[60:63], v[108:111], v[188:191], v[60:63]
  s_waitcnt lgkmcnt(12)
  v_mfma_f32_16x16x32_bf16 v[64:67], v[112:115], v[184:187], v[64:67]
  ds_read_b64_tr_b16 v[108:109], v11 offset:0
  ds_read_b64_tr_b16 v[110:111], v11 offset:4096
  v_mfma_f32_16x16x32_bf16 v[68:71], v[112:115], v[188:191], v[68:71]
  s_waitcnt lgkmcnt(12)
  v_mfma_f32_16x16x32_bf16 v[72:75], v[116:119], v[184:187], v[72:75]
  ds_read_b64_tr_b16 v[112:113], v12 offset:0
  ds_read_b64_tr_b16 v[114:115], v12 offset:4096
  v_mfma_f32_16x16x32_bf16 v[76:79], v[116:119], v[188:191], v[76:79]
  s_waitcnt lgkmcnt(12)
  v_mfma_f32_16x16x32_bf16 v[80:83], v[120:123], v[184:187], v[80:83]
  ds_read_b64_tr_b16 v[116:117], v13 offset:0
  ds_read_b64_tr_b16 v[118:119], v13 offset:4096
  v_mfma_f32_16x16x32_bf16 v[84:87], v[120:123], v[188:191], v[84:87]
  s_waitcnt lgkmcnt(12)
  v_mfma_f32_16x16x32_bf16 v[88:91], v[124:127], v[184:187], v[88:91]
  ds_read_b64_tr_b16 v[120:121], v14 offset:0
  ds_read_b64_tr_b16 v[122:123], v14 offset:4096
  v_mfma_f32_16x16x32_bf16 v[92:95], v[124:127], v[188:191], v[92:95]
  s_waitcnt lgkmcnt(12)
  s_waitcnt vmcnt(20)
  v_mfma_f32_16x16x32_bf16 v[32:35], v[96:99], v[192:195], v[32:35]
  ds_read_b64_tr_b16 v[124:125], v15 offset:0
  ds_read_b64_tr_b16 v[126:127], v15 offset:4096
  v_mfma_f32_16x16x32_bf16 v[36:39], v[96:99], v[196:199], v[36:39]
  s_waitcnt lgkmcnt(12)
  v_mfma_f32_16x16x32_bf16 v[40:43], v[100:103], v[192:195], v[40:43]
  ds_read_b64_tr_b16 v[96:97], v8 offset:8192
  ds_read_b64_tr_b16 v[98:99], v8 offset:12288
  v_mfma_f32_16x16x32_bf16 v[44:47], v[100:103], v[196:199], v[44:47]
  s_waitcnt lgkmcnt(12)
  v_mfma_f32_16x16x32_bf16 v[48:51], v[104:107], v[192:195], v[48:51]
  ds_read_b64_tr_b16 v[100:101], v9 offset:8192
  ds_read_b64_tr_b16 v[102:103], v9 offset:12288
  v_mfma_f32_16x16x32_bf16 v[52:55], v[104:107], v[196:199], v[52:55]
  s_waitcnt lgkmcnt(12)
  v_mfma_f32_16x16x32_bf16 v[56:59], v[108:111], v[192:195], v[56:59]
  ds_read_b64_tr_b16 v[104:105], v10 offset:8192
  ds_read_b64_tr_b16 v[106:107], v10 offset:12288
  v_mfma_f32_16x16x32_bf16 v[60:63], v[108:111], v[196:199], v[60:63]
  s_waitcnt lgkmcnt(12)
  v_mfma_f32_16x16x32_bf16 v[64:67], v[112:115], v[192:195], v[64:67]
  ds_read_b64_tr_b16 v[108:109], v11 offset:8192
  ds_read_b64_tr_b16 v[110:111], v11 offset:12288
  v_mfma_f32_16x16x32_bf16 v[68:71], v[112:115], v[196:199], v[68:71]
  s_waitcnt lgkmcnt(12)
  v_mfma_f32_16x16x32_bf16 v[72:75], v[116:119], v[192:195], v[72:75]
  ds_read_b64_tr_b16 v[112:113], v12 offset:8192
  ds_read_b64_tr_b16 v[114:115], v12 offset:12288
  v_mfma_f32_16x16x32_bf16 v[76:79], v[116:119], v[196:199], v[76:79]
  s_waitcnt lgkmcnt(12)
  v_mfma_f32_16x16x32_bf16 v[80:83], v[120:123], v[192:195], v[80:83]
  ds_read_b64_tr_b16 v[116:117], v13 offset:8192
  ds_read_b64_tr_b16 v[118:119], v13 offset:12288
  v_mfma_f32_16x16x32_bf16 v[84:87], v[120:123], v[196:199], v[84:87]
  s_waitcnt lgkmcnt(12)
  v_mfma_f32_16x16x32_bf16 v[88:91], v[124:127], v[192:195], v[88:91]
  ds_read_b64_tr_b16 v[120:121], v14 offset:8192
  ds_read_b64_tr_b16 v[122:123], v14 offset:12288
  v_mfma_f32_16x16x32_bf16 v[92:95], v[124:127], v[196:199], v[92:95]
  s_waitcnt lgkmcnt(12)
  s_waitcnt vmcnt(18)
  v_mfma_f32_16x16x32_bf16 v[32:35], v[96:99], v[200:203], v[32:35]
  ds_read_b64_tr_b16 v[124:125], v15 offset:8192
  ds_read_b64_tr_b16 v[126:127], v15 offset:12288
  v_mfma_f32_16x16x32_bf16 v[36:39], v[96:99], v[204:207], v[36:39]
  s_waitcnt lgkmcnt(12)
  v_mfma_f32_16x16x32_bf16 v[40:43], v[100:103], v[200:203], v[40:43]
  s_barrier
  ds_read_b64_tr_b16 v[96:97], v12 offset:16384
  ds_read_b64_tr_b16 v[98:99], v12 offset:20480
  v_mfma_f32_16x16x32_bf16 v[44:47], v[100:103], v[204:207], v[44:47]
  s_waitcnt lgkmcnt(12)
  v_mfma_f32_16x16x32_bf16 v[48:51], v[104:107], v[200:203], v[48:51]
  ds_read_b64_tr_b16 v[100:101], v13 offset:16384
  ds_read_b64_tr_b16 v[102:103], v13 offset:20480
  v_mfma_f32_16x16x32_bf16 v[52:55], v[104:107], v[204:207], v[52:55]
  s_waitcnt lgkmcnt(12)
  v_mfma_f32_16x16x32_bf16 v[56:59], v[108:111], v[200:203], v[56:59]
  ds_read_b64_tr_b16 v[104:105], v14 offset:16384
  ds_read_b64_tr_b16 v[106:107], v14 offset:20480
  v_mfma_f32_16x16x32_bf16 v[60:63], v[108:111], v[204:207], v[60:63]
  s_waitcnt lgkmcnt(12)
  v_mfma_f32_16x16x32_bf16 v[64:67], v[112:115], v[200:203], v[64:67]
  ds_read_b64_tr_b16 v[108:109], v15 offset:16384
  ds_read_b64_tr_b16 v[110:111], v15 offset:20480
  v_mfma_f32_16x16x32_bf16 v[68:71], v[112:115], v[204:207], v[68:71]
  s_waitcnt lgkmcnt(12)
  v_mfma_f32_16x16x32_bf16 v[72:75], v[116:119], v[200:203], v[72:75]
  ds_read_b64_tr_b16 v[112:113], v12 offset:24576
  ds_read_b64_tr_b16 v[114:115], v12 offset:28672
  v_mfma_f32_16x16x32_bf16 v[76:79], v[116:119], v[204:207], v[76:79]
  s_waitcnt lgkmcnt(12)
  v_mfma_f32_16x16x32_bf16 v[80:83], v[120:123], v[200:203], v[80:83]
  ds_read_b64_tr_b16 v[116:117], v13 offset:24576
  ds_read_b64_tr_b16 v[118:119], v13 offset:28672
  v_mfma_f32_16x16x32_bf16 v[84:87], v[120:123], v[204:207], v[84:87]
  s_waitcnt lgkmcnt(12)
  v_mfma_f32_16x16x32_bf16 v[88:91], v[124:127], v[200:203], v[88:91]
  ds_read_b64_tr_b16 v[120:121], v14 offset:24576
  ds_read_b64_tr_b16 v[122:123], v14 offset:28672
  v_mfma_f32_16x16x32_bf16 v[92:95], v[124:127], v[204:207], v[92:95]
  s_waitcnt lgkmcnt(12)
  s_waitcnt vmcnt(16)
  v_mfma_f32_16x16x32_bf16 v[64:67], v[96:99], v[128:131], v[64:67]
  ds_read_b64_tr_b16 v[124:125], v15 offset:24576
  ds_read_b64_tr_b16 v[126:127], v15 offset:28672
  v_mfma_f32_16x16x32_bf16 v[68:71], v[96:99], v[132:135], v[68:71]
  s_waitcnt lgkmcnt(12)
  v_mfma_f32_16x16x32_bf16 v[72:75], v[100:103], v[128:131], v[72:75]
  s_barrier
  ds_read_b64_tr_b16 v[96:97], v12 offset:32768
  ds_read_b64_tr_b16 v[98:99], v12 offset:36864
  v_mfma_f32_16x16x32_bf16 v[76:79], v[100:103], v[132:135], v[76:79]
  s_waitcnt lgkmcnt(12)
  v_mfma_f32_16x16x32_bf16 v[80:83], v[104:107], v[128:131], v[80:83]
  ds_read_b64_tr_b16 v[100:101], v13 offset:32768
  ds_read_b64_tr_b16 v[102:103], v13 offset:36864
  v_mfma_f32_16x16x32_bf16 v[84:87], v[104:107], v[132:135], v[84:87]
  s_waitcnt lgkmcnt(12)
  v_mfma_f32_16x16x32_bf16 v[88:91], v[108:111], v[128:131], v[88:91]
  ds_read_b64_tr_b16 v[104:105], v14 offset:32768
  ds_read_b64_tr_b16 v[106:107], v14 offset:36864
  v_mfma_f32_16x16x32_bf16 v[92:95], v[108:111], v[132:135], v[92:95]
  s_waitcnt lgkmcnt(12)
  s_waitcnt vmcnt(14)
  v_mfma_f32_16x16x32_bf16 v[64:67], v[112:115], v[136:139], v[64:67]
  ds_read_b64_tr_b16 v[108:109], v15 offset:32768
  ds_read_b64_tr_b16 v[110:111], v15 offset:36864
  v_mfma_f32_16x16x32_bf16 v[68:71], v[112:115], v[140:143], v[68:71]
  s_waitcnt lgkmcnt(12)
  v_mfma_f32_16x16x32_bf16 v[72:75], v[116:119], v[136:139], v[72:75]
  ds_read_b64_tr_b16 v[112:113], v12 offset:40960
  ds_read_b64_tr_b16 v[114:115], v12 offset:45056
  v_mfma_f32_16x16x32_bf16 v[76:79], v[116:119], v[140:143], v[76:79]
  s_waitcnt lgkmcnt(12)
  v_mfma_f32_16x16x32_bf16 v[80:83], v[120:123], v[136:139], v[80:83]
  ds_read_b64_tr_b16 v[116:117], v13 offset:40960
  ds_read_b64_tr_b16 v[118:119], v13 offset:45056
  v_mfma_f32_16x16x32_bf16 v[84:87], v[120:123], v[140:143], v[84:87]
  s_waitcnt lgkmcnt(12)
  v_mfma_f32_16x16x32_bf16 v[88:91], v[124:127], v[136:139], v[88:91]
  ds_read_b64_tr_b16 v[120:121], v14 offset:40960
  ds_read_b64_tr_b16 v[122:123], v14 offset:45056
  v_mfma_f32_16x16x32_bf16 v[92:95], v[124:127], v[140:143], v[92:95]
  s_waitcnt lgkmcnt(12)
  s_waitcnt vmcnt(12)
  v_mfma_f32_16x16x32_bf16 v[64:67], v[96:99], v[144:147], v[64:67]
  ds_read_b64_tr_b16 v[124:125], v15 offset:40960
  ds_read_b64_tr_b16 v[126:127], v15 offset:45056
  v_mfma_f32_16x16x32_bf16 v[68:71], v[96:99], v[148:151], v[68:71]
  s_waitcnt lgkmcnt(12)
  v_mfma_f32_16x16x32_bf16 v[72:75], v[100:103], v[144:147], v[72:75]
  s_barrier
  ds_read_b64_tr_b16 v[96:97], v12 offset:49152
  ds_read_b64_tr_b16 v[98:99], v12 offset:53248
  v_mfma_f32_16x16x32_bf16 v[76:79], v[100:103], v[148:151], v[76:79]
  s_waitcnt lgkmcnt(12)
  v_mfma_f32_16x16x32_bf16 v[80:83], v[104:107], v[144:147], v[80:83]
  ds_read_b64_tr_b16 v[100:101], v13 offset:49152
  ds_read_b64_tr_b16 v[102:103], v13 offset:53248
  v_mfma_f32_16x16x32_bf16 v[84:87], v[104:107], v[148:151], v[84:87]
  s_waitcnt lgkmcnt(12)
  v_mfma_f32_16x16x32_bf16 v[88:91], v[108:111], v[144:147], v[88:91]
  ds_read_b64_tr_b16 v[104:105], v14 offset:49152
  ds_read_b64_tr_b16 v[106:107], v14 offset:53248
  v_mfma_f32_16x16x32_bf16 v[92:95], v[108:111], v[148:151], v[92:95]
  s_waitcnt lgkmcnt(12)
  s_waitcnt vmcnt(10)
  v_mfma_f32_16x16x32_bf16 v[64:67], v[112:115], v[152:155], v[64:67]
  ds_read_b64_tr_b16 v[108:109], v15 offset:49152
  ds_read_b64_tr_b16 v[110:111], v15 offset:53248
  v_mfma_f32_16x16x32_bf16 v[68:71], v[112:115], v[156:159], v[68:71]
  s_waitcnt lgkmcnt(12)
  v_mfma_f32_16x16x32_bf16 v[72:75], v[116:119], v[152:155], v[72:75]
  ds_read_b64_tr_b16 v[112:113], v12 offset:57344
  ds_read_b64_tr_b16 v[114:115], v12 offset:61440
  v_mfma_f32_16x16x32_bf16 v[76:79], v[116:119], v[156:159], v[76:79]
  s_waitcnt lgkmcnt(12)
  v_mfma_f32_16x16x32_bf16 v[80:83], v[120:123], v[152:155], v[80:83]
  ds_read_b64_tr_b16 v[116:117], v13 offset:57344
  ds_read_b64_tr_b16 v[118:119], v13 offset:61440
  v_mfma_f32_16x16x32_bf16 v[84:87], v[120:123], v[156:159], v[84:87]
  s_waitcnt lgkmcnt(12)
  v_mfma_f32_16x16x32_bf16 v[88:91], v[124:127], v[152:155], v[88:91]
  ds_read_b64_tr_b16 v[120:121], v14 offset:57344
  ds_read_b64_tr_b16 v[122:123], v14 offset:61440
  v_mfma_f32_16x16x32_bf16 v[92:95], v[124:127], v[156:159], v[92:95]
  s_waitcnt lgkmcnt(12)
  s_waitcnt vmcnt(8)
  v_mfma_f32_16x16x32_bf16 v[64:67], v[96:99], v[160:163], v[64:67]
  ds_read_b64_tr_b16 v[124:125], v15 offset:57344
  ds_read_b64_tr_b16 v[126:127], v15 offset:61440
  v_mfma_f32_16x16x32_bf16 v[68:71], v[96:99], v[164:167], v[68:71]
  s_waitcnt lgkmcnt(12)
  v_mfma_f32_16x16x32_bf16 v[72:75], v[100:103], v[160:163], v[72:75]
  ds_read_b64_tr_b16 v[96:97], v8 offset:16384
  ds_read_b64_tr_b16 v[98:99], v8 offset:20480
  v_mfma_f32_16x16x32_bf16 v[76:79], v[100:103], v[164:167], v[76:79]
  s_waitcnt lgkmcnt(12)
  v_mfma_f32_16x16x32_bf16 v[80:83], v[104:107], v[160:163], v[80:83]
  ds_read_b64_tr_b16 v[100:101], v9 offset:16384
  ds_read_b64_tr_b16 v[102:103], v9 offset:20480
  v_mfma_f32_16x16x32_bf16 v[84:87], v[104:107], v[164:167], v[84:87]
  s_waitcnt lgkmcnt(12)
  v_mfma_f32_16x16x32_bf16 v[88:91], v[108:111], v[160:163], v[88:91]
  ds_read_b64_tr_b16 v[104:105], v10 offset:16384
  ds_read_b64_tr_b16 v[106:107], v10 offset:20480
  v_mfma_f32_16x16x32_bf16 v[92:95], v[108:111], v[164:167], v[92:95]
  s_waitcnt lgkmcnt(12)
  s_waitcnt vmcnt(6)
  v_mfma_f32_16x16x32_bf16 v[64:67], v[112:115], v[168:171], v[64:67]
  ds_read_b64_tr_b16 v[108:109], v11 offset:16384
  ds_read_b64_tr_b16 v[110:111], v11 offset:20480
  v_mfma_f32_16x16x32_bf16 v[68:71], v[112:115], v[172:175], v[68:71]
  s_waitcnt lgkmcnt(12)
  v_mfma_f32_16x16x32_bf16 v[72:75], v[116:119], v[168:171], v[72:75]
  ds_read_b64_tr_b16 v[112:113], v8 offset:24576
  ds_read_b64_tr_b16 v[114:115], v8 offset:28672
  v_mfma_f32_16x16x32_bf16 v[76:79], v[116:119], v[172:175], v[76:79]
  s_waitcnt lgkmcnt(12)
  v_mfma_f32_16x16x32_bf16 v[80:83], v[120:123], v[168:171], v[80:83]
  ds_read_b64_tr_b16 v[116:117], v9 offset:24576
  ds_read_b64_tr_b16 v[118:119], v9 offset:28672
  v_mfma_f32_16x16x32_bf16 v[84:87], v[120:123], v[172:175], v[84:87]
  s_waitcnt lgkmcnt(12)
  v_mfma_f32_16x16x32_bf16 v[88:91], v[124:127], v[168:171], v[88:91]
  ds_read_b64_tr_b16 v[120:121], v10 offset:24576
  ds_read_b64_tr_b16 v[122:123], v10 offset:28672
  v_mfma_f32_16x16x32_bf16 v[92:95], v[124:127], v[172:175], v[92:95]
  s_waitcnt lgkmcnt(12)
  v_mfma_f32_16x16x32_bf16 v[32:35], v[96:99], v[128:131], v[32:35]
  ds_read_b64_tr_b16 v[124:125], v11 offset:24576
  ds_read_b64_tr_b16 v[126:127], v11 offset:28672
  v_mfma_f32_16x16x32_bf16 v[36:39], v[96:99], v[132:135], v[36:39]
  s_waitcnt lgkmcnt(12)
  v_mfma_f32_16x16x32_bf16 v[40:43], v[100:103], v[128:131], v[40:43]
  ds_read_b64_tr_b16 v[96:97], v8 offset:32768
  ds_read_b64_tr_b16 v[98:99], v8 offset:36864
  v_mfma_f32_16x16x32_bf16 v[44:47], v[100:103], v[132:135], v[44:47]
  s_lshl_b32 s24, s2, 2
  s_add_u32 s24, s24, s20
  s_lshl_b32 s25, s24, 13
  v_lshl_add_u32 v28, v3, 4, s25
  s_xor_b32 s25, s25, 32768
  v_lshl_add_u32 v29, v3, 4, s25
  s_lshl_b32 s60, s24, 7
  s_add_u32 s60, s60, 851968
  s_xor_b32 s24, s24, 4
  s_lshl_b32 s61, s24, 7
  s_add_u32 s61, s61, 851968
  s_movk_i32 s44, 4096
  v_cvt_pk_bf16_f32 v64, v64, v65
  v_cvt_pk_bf16_f32 v65, v66, v67
  v_cvt_pk_bf16_f32 v66, v68, v69
  v_cvt_pk_bf16_f32 v67, v70, v71
  v_cvt_pk_bf16_f32 v68, v72, v73
  v_cvt_pk_bf16_f32 v69, v74, v75
  v_cvt_pk_bf16_f32 v70, v76, v77
  v_cvt_pk_bf16_f32 v71, v78, v79
  v_cvt_pk_bf16_f32 v72, v80, v81
  v_cvt_pk_bf16_f32 v73, v82, v83
  v_cvt_pk_bf16_f32 v74, v84, v85
  v_cvt_pk_bf16_f32 v75, v86, v87
  v_cvt_pk_bf16_f32 v76, v88, v89
  v_cvt_pk_bf16_f32 v77, v90, v91
  v_cvt_pk_bf16_f32 v78, v92, v93
  v_cvt_pk_bf16_f32 v79, v94, v95
  buffer_store_dwordx4 v[64:67], v28, s[52:55], 0 offen offset:0 sc1
  buffer_store_dwordx4 v[68:71], v28, s[52:55], 0 offen offset:1024 sc1
  buffer_store_dwordx4 v[72:75], v28, s[52:55], 0 offen offset:2048 sc1
  buffer_store_dwordx4 v[76:79], v28, s[52:55], 0 offen offset:3072 sc1
  s_waitcnt lgkmcnt(12)
  v_mfma_f32_16x16x32_bf16 v[48:51], v[104:107], v[128:131], v[48:51]
  ds_read_b64_tr_b16 v[100:101], v9 offset:32768
  ds_read_b64_tr_b16 v[102:103], v9 offset:36864
  v_mfma_f32_16x16x32_bf16 v[52:55], v[104:107], v[132:135], v[52:55]
  s_waitcnt lgkmcnt(12)
  v_mfma_f32_16x16x32_bf16 v[56:59], v[108:111], v[128:131], v[56:59]
  ds_read_b64_tr_b16 v[104:105], v10 offset:32768
  ds_read_b64_tr_b16 v[106:107], v10 offset:36864
  v_mfma_f32_16x16x32_bf16 v[60:63], v[108:111], v[132:135], v[60:63]
  s_waitcnt lgkmcnt(12)
  v_mfma_f32_16x16x32_bf16 v[32:35], v[112:115], v[136:139], v[32:35]
  ds_read_b64_tr_b16 v[108:109], v11 offset:32768
  ds_read_b64_tr_b16 v[110:111], v11 offset:36864
  v_mfma_f32_16x16x32_bf16 v[36:39], v[112:115], v[140:143], v[36:39]
  s_waitcnt lgkmcnt(12)
  v_mfma_f32_16x16x32_bf16 v[40:43], v[116:119], v[136:139], v[40:43]
  ds_read_b64_tr_b16 v[112:113], v8 offset:40960
  ds_read_b64_tr_b16 v[114:115], v8 offset:45056
  v_mfma_f32_16x16x32_bf16 v[44:47], v[116:119], v[140:143], v[44:47]
  s_waitcnt lgkmcnt(12)
  v_mfma_f32_16x16x32_bf16 v[48:51], v[120:123], v[136:139], v[48:51]
  ds_read_b64_tr_b16 v[116:117], v9 offset:40960
  ds_read_b64_tr_b16 v[118:119], v9 offset:45056
  v_mfma_f32_16x16x32_bf16 v[52:55], v[120:123], v[140:143], v[52:55]
  s_waitcnt lgkmcnt(12)
  v_mfma_f32_16x16x32_bf16 v[56:59], v[124:127], v[136:139], v[56:59]
  ds_read_b64_tr_b16 v[120:121], v10 offset:40960
  ds_read_b64_tr_b16 v[122:123], v10 offset:45056
  v_mfma_f32_16x16x32_bf16 v[60:63], v[124:127], v[140:143], v[60:63]
  s_waitcnt lgkmcnt(12)
  v_mfma_f32_16x16x32_bf16 v[32:35], v[96:99], v[144:147], v[32:35]
  ds_read_b64_tr_b16 v[124:125], v11 offset:40960
  ds_read_b64_tr_b16 v[126:127], v11 offset:45056
  v_mfma_f32_16x16x32_bf16 v[36:39], v[96:99], v[148:151], v[36:39]
  s_waitcnt lgkmcnt(12)
  v_mfma_f32_16x16x32_bf16 v[40:43], v[100:103], v[144:147], v[40:43]
  ds_read_b64_tr_b16 v[96:97], v8 offset:49152
  ds_read_b64_tr_b16 v[98:99], v8 offset:53248
  v_mfma_f32_16x16x32_bf16 v[44:47], v[100:103], v[148:151], v[44:47]
  s_waitcnt lgkmcnt(12)
  v_mfma_f32_16x16x32_bf16 v[48:51], v[104:107], v[144:147], v[48:51]
  ds_read_b64_tr_b16 v[100:101], v9 offset:49152
  ds_read_b64_tr_b16 v[102:103], v9 offset:53248
  v_mfma_f32_16x16x32_bf16 v[52:55], v[104:107], v[148:151], v[52:55]
  s_waitcnt lgkmcnt(12)
  v_mfma_f32_16x16x32_bf16 v[56:59], v[108:111], v[144:147], v[56:59]
  ds_read_b64_tr_b16 v[104:105], v10 offset:49152
  ds_read_b64_tr_b16 v[106:107], v10 offset:53248
  v_mfma_f32_16x16x32_bf16 v[60:63], v[108:111], v[148:151], v[60:63]
  s_waitcnt lgkmcnt(12)
  v_mfma_f32_16x16x32_bf16 v[32:35], v[112:115], v[152:155], v[32:35]
  ds_read_b64_tr_b16 v[108:109], v11 offset:49152
  ds_read_b64_tr_b16 v[110:111], v11 offset:53248
  v_mfma_f32_16x16x32_bf16 v[36:39], v[112:115], v[156:159], v[36:39]
  s_waitcnt lgkmcnt(12)
  v_mfma_f32_16x16x32_bf16 v[40:43], v[116:119], v[152:155], v[40:43]
  ds_read_b64_tr_b16 v[112:113], v8 offset:57344
  ds_read_b64_tr_b16 v[114:115], v8 offset:61440
  v_mfma_f32_16x16x32_bf16 v[44:47], v[116:119], v[156:159], v[44:47]
  s_waitcnt lgkmcnt(12)
  v_mfma_f32_16x16x32_bf16 v[48:51], v[120:123], v[152:155], v[48:51]
  ds_read_b64_tr_b16 v[116:117], v9 offset:57344
  ds_read_b64_tr_b16 v[118:119], v9 offset:61440
  v_mfma_f32_16x16x32_bf16 v[52:55], v[120:123], v[156:159], v[52:55]
  s_waitcnt lgkmcnt(12)
  v_mfma_f32_16x16x32_bf16 v[56:59], v[124:127], v[152:155], v[56:59]
  ds_read_b64_tr_b16 v[120:121], v10 offset:57344
  ds_read_b64_tr_b16 v[122:123], v10 offset:61440
  v_mfma_f32_16x16x32_bf16 v[60:63], v[124:127], v[156:159], v[60:63]
  s_waitcnt lgkmcnt(12)
  v_mfma_f32_16x16x32_bf16 v[32:35], v[96:99], v[160:163], v[32:35]
  ds_read_b64_tr_b16 v[124:125], v11 offset:57344
  ds_read_b64_tr_b16 v[126:127], v11 offset:61440
  v_mfma_f32_16x16x32_bf16 v[36:39], v[96:99], v[164:167], v[36:39]
  s_waitcnt lgkmcnt(12)
  v_mfma_f32_16x16x32_bf16 v[40:43], v[100:103], v[160:163], v[40:43]
  v_mfma_f32_16x16x32_bf16 v[44:47], v[100:103], v[164:167], v[44:47]
  s_waitcnt lgkmcnt(10)
  v_mfma_f32_16x16x32_bf16 v[48:51], v[104:107], v[160:163], v[48:51]
  v_mfma_f32_16x16x32_bf16 v[52:55], v[104:107], v[164:167], v[52:55]
  s_waitcnt lgkmcnt(8)
  v_mfma_f32_16x16x32_bf16 v[56:59], v[108:111], v[160:163], v[56:59]
  v_mfma_f32_16x16x32_bf16 v[60:63], v[108:111], v[164:167], v[60:63]
  s_waitcnt lgkmcnt(6)
  v_mfma_f32_16x16x32_bf16 v[32:35], v[112:115], v[168:171], v[32:35]
  v_mfma_f32_16x16x32_bf16 v[36:39], v[112:115], v[172:175], v[36:39]
  s_waitcnt lgkmcnt(4)
  v_mfma_f32_16x16x32_bf16 v[40:43], v[116:119], v[168:171], v[40:43]
  v_mfma_f32_16x16x32_bf16 v[44:47], v[116:119], v[172:175], v[44:47]
  s_waitcnt lgkmcnt(2)
  v_mfma_f32_16x16x32_bf16 v[48:51], v[120:123], v[168:171], v[48:51]
  v_mfma_f32_16x16x32_bf16 v[52:55], v[120:123], v[172:175], v[52:55]
  s_waitcnt lgkmcnt(0)
  v_mfma_f32_16x16x32_bf16 v[56:59], v[124:127], v[168:171], v[56:59]
  v_mfma_f32_16x16x32_bf16 v[60:63], v[124:127], v[172:175], v[60:63]
g3_cwend:
g4_epi:
  s_waitcnt vmcnt(0)
  v_lshlrev_b32 v30, 22, v3
  v_mov_b32 v31, 1
  buffer_store_dword v31, v30, s[16:19], s60 offen sc1
  buffer_load_dword v2, v1, s[16:19], s61 offen sc1
  v_and_b32 v16, 15, v3
  v_lshlrev_b32 v17, 7, v16
  v_bfe_u32 v18, v3, 4, 1
  v_lshl_add_u32 v17, v18, 3, v17
  v_add_u32 v17, s26, v17
  v_lshrrev_b32 v16, 1, v16
  v_lshrrev_b32 v18, 5, v3
  v_xor_b32 v16, v16, v18
  v_xor_b32 v18, 0, v16
  v_lshl_add_u32 v8, v18, 4, v17
  v_xor_b32 v18, 2, v16
  v_lshl_add_u32 v9, v18, 4, v17
  v_xor_b32 v18, 4, v16
  v_lshl_add_u32 v10, v18, 4, v17
  v_xor_b32 v18, 6, v16
  v_lshl_add_u32 v11, v18, 4, v17
  ds_read_b64 v[96:97], v8 offset:0
  ds_read_b64 v[98:99], v8 offset:2048
  ds_read_b64 v[100:101], v9 offset:0
  ds_read_b64 v[102:103], v9 offset:2048
  ds_read_b64 v[104:105], v10 offset:0
  ds_read_b64 v[106:107], v10 offset:2048
  ds_read_b64 v[108:109], v11 offset:0
  ds_read_b64 v[110:111], v11 offset:2048
  v_lshrrev_b32 v5, 2, v3
  v_lshlrev_b32 v5, 6, v5
  v_and_b32 v16, 3, v3
  v_lshl_add_u32 v5, v16, 3, v5
  v_add_u32 v5, s26, v5
  v_bfe_u32 v16, v3, 4, 1
  v_lshl_add_u32 v14, v16, 5, v5
  v_xor_b32 v16, 1, v16
  v_lshl_add_u32 v15, v16, 5, v5
  ds_read_b64_tr_b16 v[112:113], v14 offset:4096
  ds_read_b64_tr_b16 v[114:115], v15 offset:4096
  ds_read_b64_tr_b16 v[116:117], v14 offset:5120
  ds_read_b64_tr_b16 v[118:119], v15 offset:5120
  ds_read_b64_tr_b16 v[120:121], v14 offset:6144
  ds_read_b64_tr_b16 v[122:123], v15 offset:6144
  ds_read_b64_tr_b16 v[124:125], v14 offset:7168
  ds_read_b64_tr_b16 v[126:127], v15 offset:7168
  v_lshl_add_u32 v4, v3, 4, s26
  v_lshrrev_b32 v16, 3, v3
  v_and_b32 v17, 7, v3
  v_lshrrev_b32 v18, 4, v3
  v_xor_b32 v18, v18, v17
  s_lshl_b32 s24, s23, 4
  v_add_u32 v19, s24, v16
  v_lshlrev_b32 v19, 11, v19
  s_lshl_b32 s24, s59, 7
  v_add_u32 v19, s24, v19
  v_lshl_add_u32 v12, v18, 4, v19
  v_xor_b32 v18, 4, v18
  v_lshl_add_u32 v13, v18, 4, v19
  v_mul_f32 v208, v208, v209
  v_sub_f32 v208, 0, v208
  v_mul_f32 v210, v210, v211
  v_sub_f32 v210, 0, v210
  v_lshlrev_b32 v160, 16, v212
  v_and_b32 v161, 0xffff0000, v212
  v_lshlrev_b32 v162, 16, v213
  v_and_b32 v163, 0xffff0000, v213
  v_lshlrev_b32 v164, 16, v220
  v_and_b32 v165, 0xffff0000, v220
  v_lshlrev_b32 v166, 16, v221
  v_and_b32 v167, 0xffff0000, v221
  v_pk_add_f32 v[32:33], v[32:33], v[160:161]
  v_pk_add_f32 v[34:35], v[34:35], v[162:163]
  v_pk_add_f32 v[36:37], v[36:37], v[164:165]
  v_pk_add_f32 v[38:39], v[38:39], v[166:167]
  v_lshlrev_b32 v168, 16, v214
  v_and_b32 v169, 0xffff0000, v214
  v_lshlrev_b32 v170, 16, v215
  v_and_b32 v171, 0xffff0000, v215
  v_lshlrev_b32 v172, 16, v222
  v_and_b32 v173, 0xffff0000, v222
  v_lshlrev_b32 v174, 16, v223
  v_and_b32 v175, 0xffff0000, v223
  v_pk_add_f32 v[40:41], v[40:41], v[168:169]
  v_pk_add_f32 v[42:43], v[42:43], v[170:171]
  v_pk_add_f32 v[44:45], v[44:45], v[172:173]
  v_pk_add_f32 v[46:47], v[46:47], v[174:175]
  v_lshlrev_b32 v176, 16, v216
  v_and_b32 v177, 0xffff0000, v216
  v_lshlrev_b32 v178, 16, v217
  v_and_b32 v179, 0xffff0000, v217
  v_lshlrev_b32 v180, 16, v224
  v_and_b32 v181, 0xffff0000, v224
  v_lshlrev_b32 v182, 16, v225
  v_and_b32 v183, 0xffff0000, v225
  v_pk_add_f32 v[48:49], v[48:49], v[176:177]
  v_pk_add_f32 v[50:51], v[50:51], v[178:179]
  v_pk_add_f32 v[52:53], v[52:53], v[180:181]
  v_pk_add_f32 v[54:55], v[54:55], v[182:183]
  v_lshlrev_b32 v184, 16, v218
  v_and_b32 v185, 0xffff0000, v218
  v_lshlrev_b32 v186, 16, v219
  v_and_b32 v187, 0xffff0000, v219
  v_lshlrev_b32 v188, 16, v226
  v_and_b32 v189, 0xffff0000, v226
  v_lshlrev_b32 v190, 16, v227
  v_and_b32 v191, 0xffff0000, v227
  v_pk_add_f32 v[56:57], v[56:57], v[184:185]
  v_pk_add_f32 v[58:59], v[58:59], v[186:187]
  v_pk_add_f32 v[60:61], v[60:61], v[188:189]
  v_pk_add_f32 v[62:63], v[62:63], v[190:191]
  s_waitcnt lgkmcnt(6)
  v_lshlrev_b32 v128, 16, v96
  v_and_b32 v129, 0xffff0000, v96
  v_lshlrev_b32 v130, 16, v97
  v_and_b32 v131, 0xffff0000, v97
  v_lshlrev_b32 v132, 16, v98
  v_and_b32 v133, 0xffff0000, v98
  v_lshlrev_b32 v134, 16, v99
  v_and_b32 v135, 0xffff0000, v99
  v_lshlrev_b32 v192, 16, v112
  v_and_b32 v193, 0xffff0000, v112
  v_lshlrev_b32 v194, 16, v113
  v_and_b32 v195, 0xffff0000, v113
  v_lshlrev_b32 v196, 16, v114
  v_and_b32 v197, 0xffff0000, v114
  v_lshlrev_b32 v198, 16, v115
  v_and_b32 v199, 0xffff0000, v115
  v_pk_fma_f32 v[160:161], v[128:129], v[208:209], v[208:209] op_sel:[0,1,0] op_sel_hi:[1,1,0]
  v_pk_fma_f32 v[162:163], v[130:131], v[208:209], v[208:209] op_sel:[0,1,0] op_sel_hi:[1,1,0]
  v_pk_fma_f32 v[164:165], v[132:133], v[210:211], v[210:211] op_sel:[0,1,0] op_sel_hi:[1,1,0]
  v_pk_fma_f32 v[166:167], v[134:135], v[210:211], v[210:211] op_sel:[0,1,0] op_sel_hi:[1,1,0]
  v_pk_mul_f32 v[160:161], v[160:161], v[192:193]
  v_pk_mul_f32 v[162:163], v[162:163], v[194:195]
  v_pk_mul_f32 v[164:165], v[164:165], v[196:197]
  v_pk_mul_f32 v[166:167], v[166:167], v[198:199]
  s_waitcnt lgkmcnt(4)
  v_lshlrev_b32 v136, 16, v100
  v_and_b32 v137, 0xffff0000, v100
  v_lshlrev_b32 v138, 16, v101
  v_and_b32 v139, 0xffff0000, v101
  v_lshlrev_b32 v140, 16, v102
  v_and_b32 v141, 0xffff0000, v102
  v_lshlrev_b32 v142, 16, v103
  v_and_b32 v143, 0xffff0000, v103
  v_lshlrev_b32 v192, 16, v116
  v_and_b32 v193, 0xffff0000, v116
  v_lshlrev_b32 v194, 16, v117
  v_and_b32 v195, 0xffff0000, v117
  v_lshlrev_b32 v196, 16, v118
  v_and_b32 v197, 0xffff0000, v118
  v_lshlrev_b32 v198, 16, v119
  v_and_b32 v199, 0xffff0000, v119
  v_pk_fma_f32 v[168:169], v[136:137], v[208:209], v[208:209] op_sel:[0,1,0] op_sel_hi:[1,1,0]
  v_pk_fma_f32 v[170:171], v[138:139], v[208:209], v[208:209] op_sel:[0,1,0] op_sel_hi:[1,1,0]
  v_pk_fma_f32 v[172:173], v[140:141], v[210:211], v[210:211] op_sel:[0,1,0] op_sel_hi:[1,1,0]
  v_pk_fma_f32 v[174:175], v[142:143], v[210:211], v[210:211] op_sel:[0,1,0] op_sel_hi:[1,1,0]
  v_pk_mul_f32 v[168:169], v[168:169], v[192:193]
  v_pk_mul_f32 v[170:171], v[170:171], v[194:195]
  v_pk_mul_f32 v[172:173], v[172:173], v[196:197]
  v_pk_mul_f32 v[174:175], v[174:175], v[198:199]
  s_waitcnt lgkmcnt(2)
  v_lshlrev_b32 v144, 16, v104
  v_and_b32 v145, 0xffff0000, v104
  v_lshlrev_b32 v146, 16, v105
  v_and_b32 v147, 0xffff0000, v105
  v_lshlrev_b32 v148, 16, v106
  v_and_b32 v149, 0xffff0000, v106
  v_lshlrev_b32 v150, 16, v107
  v_and_b32 v151, 0xffff0000, v107
  v_lshlrev_b32 v192, 16, v120
  v_and_b32 v193, 0xffff0000, v120
  v_lshlrev_b32 v194, 16, v121
  v_and_b32 v195, 0xffff0000, v121
  v_lshlrev_b32 v196, 16, v122
  v_and_b32 v197, 0xffff0000, v122
  v_lshlrev_b32 v198, 16, v123
  v_and_b32 v199, 0xffff0000, v123
  v_pk_fma_f32 v[176:177], v[144:145], v[208:209], v[208:209] op_sel:[0,1,0] op_sel_hi:[1,1,0]
  v_pk_fma_f32 v[178:179], v[146:147], v[208:209], v[208:209] op_sel:[0,1,0] op_sel_hi:[1,1,0]
  v_pk_fma_f32 v[180:181], v[148:149], v[210:211], v[210:211] op_sel:[0,1,0] op_sel_hi:[1,1,0]
  v_pk_fma_f32 v[182:183], v[150:151], v[210:211], v[210:211] op_sel:[0,1,0] op_sel_hi:[1,1,0]
  v_pk_mul_f32 v[176:177], v[176:177], v[192:193]
  v_pk_mul_f32 v[178:179], v[178:179], v[194:195]
  v_pk_mul_f32 v[180:181], v[180:181], v[196:197]
  v_pk_mul_f32 v[182:183], v[182:183], v[198:199]
  s_waitcnt lgkmcnt(0)
  v_lshlrev_b32 v152, 16, v108
  v_and_b32 v153, 0xffff0000, v108
  v_lshlrev_b32 v154, 16, v109
  v_and_b32 v155, 0xffff0000, v109
  v_lshlrev_b32 v156, 16, v110
  v_and_b32 v157, 0xffff0000, v110
  v_lshlrev_b32 v158, 16, v111
  v_and_b32 v159, 0xffff0000, v111
  v_lshlrev_b32 v192, 16, v124
  v_and_b32 v193, 0xffff0000, v124
  v_lshlrev_b32 v194, 16, v125
  v_and_b32 v195, 0xffff0000, v125
  v_lshlrev_b32 v196, 16, v126
  v_and_b32 v197, 0xffff0000, v126
  v_lshlrev_b32 v198, 16, v127
  v_and_b32 v199, 0xffff0000, v127
  v_pk_fma_f32 v[184:185], v[152:153], v[208:209], v[208:209] op_sel:[0,1,0] op_sel_hi:[1,1,0]
  v_pk_fma_f32 v[186:187], v[154:155], v[208:209], v[208:209] op_sel:[0,1,0] op_sel_hi:[1,1,0]
  v_pk_fma_f32 v[188:189], v[156:157], v[210:211], v[210:211] op_sel:[0,1,0] op_sel_hi:[1,1,0]
  v_pk_fma_f32 v[190:191], v[158:159], v[210:211], v[210:211] op_sel:[0,1,0] op_sel_hi:[1,1,0]
  v_pk_mul_f32 v[184:185], v[184:185], v[192:193]
  v_pk_mul_f32 v[186:187], v[186:187], v[194:195]
  v_pk_mul_f32 v[188:189], v[188:189], v[196:197]
  v_pk_mul_f32 v[190:191], v[190:191], v[198:199]
  s_mov_b32 s62, 0xbfb8aa3b
  s_mov_b32 s63, 0xbfb8aa3b
  s_waitcnt vmcnt(0)
  s_mov_b32 s57, 0
gc_fsp8:
  v_readfirstlane_b32 s56, v2
  s_nop 0
  s_cmp_ge_u32 s56, 1
  s_cbranch_scc1 gc_fok7
  s_add_u32 s57, s57, 1
  s_cmp_ge_u32 s57, 262144
  s_cbranch_scc1 gc_fok7
  s_sleep 2
  buffer_load_dword v2, v1, s[16:19], s61 offen sc1
  s_waitcnt vmcnt(0)
  s_branch gc_fsp8
gc_fok7:
  buffer_load_dwordx4 v[212:215], v29, s[52:55], 0 offen offset:0 sc1
  buffer_load_dwordx4 v[216:219], v29, s[52:55], 0 offen offset:1024 sc1
  buffer_load_dwordx4 v[220:223], v29, s[52:55], 0 offen offset:2048 sc1
  buffer_load_dwordx4 v[224:227], v29, s[52:55], 0 offen offset:3072 sc1
  s_waitcnt vmcnt(3)
  v_lshlrev_b32 v64, 16, v212
  v_and_b32 v65, 0xffff0000, v212
  v_lshlrev_b32 v66, 16, v213
  v_and_b32 v67, 0xffff0000, v213
  v_lshlrev_b32 v68, 16, v214
  v_and_b32 v69, 0xffff0000, v214
  v_lshlrev_b32 v70, 16, v215
  v_and_b32 v71, 0xffff0000, v215
  v_pk_add_f32 v[32:33], v[32:33], v[64:65]
  v_pk_add_f32 v[34:35], v[34:35], v[66:67]
  v_pk_add_f32 v[36:37], v[36:37], v[68:69]
  v_pk_add_f32 v[38:39], v[38:39], v[70:71]
  v_pk_mul_f32 v[64:65], v[32:33], s[62:63]
  v_pk_mul_f32 v[66:67], v[34:35], s[62:63]
  v_pk_mul_f32 v[68:69], v[36:37], s[62:63]
  v_pk_mul_f32 v[70:71], v[38:39], s[62:63]
  v_exp_f32 v64, v64
  v_exp_f32 v65, v65
  v_exp_f32 v66, v66
  v_exp_f32 v67, v67
  v_exp_f32 v68, v68
  v_exp_f32 v69, v69
  v_exp_f32 v70, v70
  v_exp_f32 v71, v71
  v_pk_mul_f32 v[32:33], v[32:33], v[160:161]
  v_pk_mul_f32 v[34:35], v[34:35], v[162:163]
  v_pk_mul_f32 v[36:37], v[36:37], v[164:165]
  v_pk_mul_f32 v[38:39], v[38:39], v[166:167]
  v_pk_add_f32 v[64:65], v[64:65], 1.0 op_sel_hi:[1,0]
  v_pk_add_f32 v[66:67], v[66:67], 1.0 op_sel_hi:[1,0]
  v_pk_add_f32 v[68:69], v[68:69], 1.0 op_sel_hi:[1,0]
  v_pk_add_f32 v[70:71], v[70:71], 1.0 op_sel_hi:[1,0]
  v_rcp_f32 v64, v64
  v_rcp_f32 v65, v65
  v_rcp_f32 v66, v66
  v_rcp_f32 v67, v67
  v_rcp_f32 v68, v68
  v_rcp_f32 v69, v69
  v_rcp_f32 v70, v70
  v_rcp_f32 v71, v71
  s_nop 0
  v_pk_fma_f32 v[32:33], v[32:33], v[64:65], v[128:129]
  v_pk_fma_f32 v[34:35], v[34:35], v[66:67], v[130:131]
  v_pk_fma_f32 v[36:37], v[36:37], v[68:69], v[132:133]
  v_pk_fma_f32 v[38:39], v[38:39], v[70:71], v[134:135]
  v_cvt_pk_bf16_f32 v96, v32, v33
  v_cvt_pk_bf16_f32 v97, v34, v35
  v_cvt_pk_bf16_f32 v98, v36, v37
  v_cvt_pk_bf16_f32 v99, v38, v39
  ds_write_b64 v8, v[96:97] offset:0
  ds_write_b64 v8, v[98:99] offset:2048
  s_waitcnt vmcnt(2)
  v_lshlrev_b32 v72, 16, v216
  v_and_b32 v73, 0xffff0000, v216
  v_lshlrev_b32 v74, 16, v217
  v_and_b32 v75, 0xffff0000, v217
  v_lshlrev_b32 v76, 16, v218
  v_and_b32 v77, 0xffff0000, v218
  v_lshlrev_b32 v78, 16, v219
  v_and_b32 v79, 0xffff0000, v219
  v_pk_add_f32 v[40:41], v[40:41], v[72:73]
  v_pk_add_f32 v[42:43], v[42:43], v[74:75]
  v_pk_add_f32 v[44:45], v[44:45], v[76:77]
  v_pk_add_f32 v[46:47], v[46:47], v[78:79]
  v_pk_mul_f32 v[72:73], v[40:41], s[62:63]
  v_pk_mul_f32 v[74:75], v[42:43], s[62:63]
  v_pk_mul_f32 v[76:77], v[44:45], s[62:63]
  v_pk_mul_f32 v[78:79], v[46:47], s[62:63]
  v_exp_f32 v72, v72
  v_exp_f32 v73, v73
  v_exp_f32 v74, v74
  v_exp_f32 v75, v75
  v_exp_f32 v76, v76
  v_exp_f32 v77, v77
  v_exp_f32 v78, v78
  v_exp_f32 v79, v79
  v_pk_mul_f32 v[40:41], v[40:41], v[168:169]
  v_pk_mul_f32 v[42:43], v[42:43], v[170:171]
  v_pk_mul_f32 v[44:45], v[44:45], v[172:173]
  v_pk_mul_f32 v[46:47], v[46:47], v[174:175]
  v_pk_add_f32 v[72:73], v[72:73], 1.0 op_sel_hi:[1,0]
  v_pk_add_f32 v[74:75], v[74:75], 1.0 op_sel_hi:[1,0]
  v_pk_add_f32 v[76:77], v[76:77], 1.0 op_sel_hi:[1,0]
  v_pk_add_f32 v[78:79], v[78:79], 1.0 op_sel_hi:[1,0]
  v_rcp_f32 v72, v72
  v_rcp_f32 v73, v73
  v_rcp_f32 v74, v74
  v_rcp_f32 v75, v75
  v_rcp_f32 v76, v76
  v_rcp_f32 v77, v77
  v_rcp_f32 v78, v78
  v_rcp_f32 v79, v79
  s_nop 0
  v_pk_fma_f32 v[40:41], v[40:41], v[72:73], v[136:137]
  v_pk_fma_f32 v[42:43], v[42:43], v[74:75], v[138:139]
  v_pk_fma_f32 v[44:45], v[44:45], v[76:77], v[140:141]
  v_pk_fma_f32 v[46:47], v[46:47], v[78:79], v[142:143]
  v_cvt_pk_bf16_f32 v100, v40, v41
  v_cvt_pk_bf16_f32 v101, v42, v43
  v_cvt_pk_bf16_f32 v102, v44, v45
  v_cvt_pk_bf16_f32 v103, v46, v47
  ds_write_b64 v9, v[100:101] offset:0
  ds_write_b64 v9, v[102:103] offset:2048
  s_waitcnt vmcnt(1)
  v_lshlrev_b32 v80, 16, v220
  v_and_b32 v81, 0xffff0000, v220
  v_lshlrev_b32 v82, 16, v221
  v_and_b32 v83, 0xffff0000, v221
  v_lshlrev_b32 v84, 16, v222
  v_and_b32 v85, 0xffff0000, v222
  v_lshlrev_b32 v86, 16, v223
  v_and_b32 v87, 0xffff0000, v223
  v_pk_add_f32 v[48:49], v[48:49], v[80:81]
  v_pk_add_f32 v[50:51], v[50:51], v[82:83]
  v_pk_add_f32 v[52:53], v[52:53], v[84:85]
  v_pk_add_f32 v[54:55], v[54:55], v[86:87]
  v_pk_mul_f32 v[80:81], v[48:49], s[62:63]
  v_pk_mul_f32 v[82:83], v[50:51], s[62:63]
  v_pk_mul_f32 v[84:85], v[52:53], s[62:63]
  v_pk_mul_f32 v[86:87], v[54:55], s[62:63]
  v_exp_f32 v80, v80
  v_exp_f32 v81, v81
  v_exp_f32 v82, v82
  v_exp_f32 v83, v83
  v_exp_f32 v84, v84
  v_exp_f32 v85, v85
  v_exp_f32 v86, v86
  v_exp_f32 v87, v87
  v_pk_mul_f32 v[48:49], v[48:49], v[176:177]
  v_pk_mul_f32 v[50:51], v[50:51], v[178:179]
  v_pk_mul_f32 v[52:53], v[52:53], v[180:181]
  v_pk_mul_f32 v[54:55], v[54:55], v[182:183]
  v_pk_add_f32 v[80:81], v[80:81], 1.0 op_sel_hi:[1,0]
  v_pk_add_f32 v[82:83], v[82:83], 1.0 op_sel_hi:[1,0]
  v_pk_add_f32 v[84:85], v[84:85], 1.0 op_sel_hi:[1,0]
  v_pk_add_f32 v[86:87], v[86:87], 1.0 op_sel_hi:[1,0]
  v_rcp_f32 v80, v80
  v_rcp_f32 v81, v81
  v_rcp_f32 v82, v82
  v_rcp_f32 v83, v83
  v_rcp_f32 v84, v84
  v_rcp_f32 v85, v85
  v_rcp_f32 v86, v86
  v_rcp_f32 v87, v87
  s_nop 0
  v_pk_fma_f32 v[48:49], v[48:49], v[80:81], v[144:145]
  v_pk_fma_f32 v[50:51], v[50:51], v[82:83], v[146:147]
  v_pk_fma_f32 v[52:53], v[52:53], v[84:85], v[148:149]
  v_pk_fma_f32 v[54:55], v[54:55], v[86:87], v[150:151]
  v_cvt_pk_bf16_f32 v104, v48, v49
  v_cvt_pk_bf16_f32 v105, v50, v51
  v_cvt_pk_bf16_f32 v106, v52, v53
  v_cvt_pk_bf16_f32 v107, v54, v55
  ds_write_b64 v10, v[104:105] offset:0
  ds_write_b64 v10, v[106:107] offset:2048
  s_waitcnt vmcnt(0)
  v_lshlrev_b32 v88, 16, v224
  v_and_b32 v89, 0xffff0000, v224
  v_lshlrev_b32 v90, 16, v225
  v_and_b32 v91, 0xffff0000, v225
  v_lshlrev_b32 v92, 16, v226
  v_and_b32 v93, 0xffff0000, v226
  v_lshlrev_b32 v94, 16, v227
  v_and_b32 v95, 0xffff0000, v227
  v_pk_add_f32 v[56:57], v[56:57], v[88:89]
  v_pk_add_f32 v[58:59], v[58:59], v[90:91]
  v_pk_add_f32 v[60:61], v[60:61], v[92:93]
  v_pk_add_f32 v[62:63], v[62:63], v[94:95]
  v_pk_mul_f32 v[88:89], v[56:57], s[62:63]
  v_pk_mul_f32 v[90:91], v[58:59], s[62:63]
  v_pk_mul_f32 v[92:93], v[60:61], s[62:63]
  v_pk_mul_f32 v[94:95], v[62:63], s[62:63]
  v_exp_f32 v88, v88
  v_exp_f32 v89, v89
  v_exp_f32 v90, v90
  v_exp_f32 v91, v91
  v_exp_f32 v92, v92
  v_exp_f32 v93, v93
  v_exp_f32 v94, v94
  v_exp_f32 v95, v95
  v_pk_mul_f32 v[56:57], v[56:57], v[184:185]
  v_pk_mul_f32 v[58:59], v[58:59], v[186:187]
  v_pk_mul_f32 v[60:61], v[60:61], v[188:189]
  v_pk_mul_f32 v[62:63], v[62:63], v[190:191]
  v_pk_add_f32 v[88:89], v[88:89], 1.0 op_sel_hi:[1,0]
  v_pk_add_f32 v[90:91], v[90:91], 1.0 op_sel_hi:[1,0]
  v_pk_add_f32 v[92:93], v[92:93], 1.0 op_sel_hi:[1,0]
  v_pk_add_f32 v[94:95], v[94:95], 1.0 op_sel_hi:[1,0]
  v_rcp_f32 v88, v88
  v_rcp_f32 v89, v89
  v_rcp_f32 v90, v90
  v_rcp_f32 v91, v91
  v_rcp_f32 v92, v92
  v_rcp_f32 v93, v93
  v_rcp_f32 v94, v94
  v_rcp_f32 v95, v95
  s_nop 0
  v_pk_fma_f32 v[56:57], v[56:57], v[88:89], v[152:153]
  v_pk_fma_f32 v[58:59], v[58:59], v[90:91], v[154:155]
  v_pk_fma_f32 v[60:61], v[60:61], v[92:93], v[156:157]
  v_pk_fma_f32 v[62:63], v[62:63], v[94:95], v[158:159]
  v_cvt_pk_bf16_f32 v108, v56, v57
  v_cvt_pk_bf16_f32 v109, v58, v59
  v_cvt_pk_bf16_f32 v110, v60, v61
  v_cvt_pk_bf16_f32 v111, v62, v63
  ds_write_b64 v11, v[108:109] offset:0
  ds_write_b64 v11, v[110:111] offset:2048
  ds_read_b128 v[112:115], v4 offset:0
  ds_read_b128 v[116:119], v4 offset:1024
  ds_read_b128 v[120:123], v4 offset:2048
  ds_read_b128 v[124:127], v4 offset:3072
  s_waitcnt lgkmcnt(3)
  s_mov_b32 s44, 0
  buffer_store_dwordx4 v[112:115], v12, s[48:51], s44 offen sc1
  s_waitcnt lgkmcnt(2)
  s_mov_b32 s44, 16384
  buffer_store_dwordx4 v[116:119], v13, s[48:51], s44 offen sc1
  s_waitcnt lgkmcnt(1)
  s_mov_b32 s44, 32768
  buffer_store_dwordx4 v[120:123], v12, s[48:51], s44 offen sc1
  s_waitcnt lgkmcnt(0)
  s_mov_b32 s44, 49152
  buffer_store_dwordx4 v[124:127], v13, s[48:51], s44 offen sc1
  s_endpgm
g4_cwend:
g1_l:
  s_load_dwordx4 s[28:31], s[0:1], 56
  s_load_dwordx4 s[40:43], s[0:1], 96
  s_load_dwordx2 s[32:33], s[0:1], 0
  s_and_b32 s24, s2, 7
  s_lshr_b32 s25, s2, 3
  s_and_b32 s25, s25, 15
  s_lshr_b32 s21, s24, 1
  s_lshl_b32 s21, s21, 2
  s_lshr_b32 s22, s25, 2
  s_add_u32 s21, s21, s22
  s_and_b32 s22, s24, 1
  s_lshl_b32 s22, s22, 2
  s_and_b32 s25, s25, 3
  s_add_u32 s22, s22, s25
  v_lshrrev_b32 v2, 6, v0
  v_and_b32 v3, 63, v0
  v_readfirstlane_b32 s100, v2
  s_nop 0
  s_and_b32 s20, s100, 3
  s_lshr_b32 s3, s100, 2
  s_lshl_b32 s23, s21, 3
  s_lshl_b32 s24, s20, 1
  s_add_u32 s23, s23, s24
  s_lshr_b32 s24, s22, 2
  s_add_u32 s24, s24, 1
  s_sub_u32 s25, 0, s24
  s_bitcmp1_b32 s22, 1
  s_cselect_b32 s34, s24, s25
  s_lshl_b32 s24, s23, 4
  s_add_u32 s35, s24, s34
  s_mul_i32 s26, s20, 16384
  s_add_u32 s26, s26, 65536
  s_add_u32 s24, s21, s22
  s_and_b32 s24, s24, 3
  s_lshl_b32 s47, s24, 19
  s_lshl_b32 s46, s24, 9
  v_lshrrev_b32 v28, 4, v3
  v_and_b32 v29, 15, v3
  v_lshlrev_b32 v30, 1, v28
  v_xor_b32 v29, v29, v30
  s_lshl_b32 s24, s20, 4
  v_add_u32 v28, s24, v28
  v_lshlrev_b32 v28, 11, v28
  s_lshl_b32 s24, s22, 8
  v_add_u32 v28, s24, v28
  v_lshl_add_u32 v30, v29, 4, v28
  v_xor_b32 v29, 8, v29
  v_lshl_add_u32 v31, v29, 4, v28
  v_add_u32 v4, 0, v30
  v_add_u32 v5, 7168, v30
  v_add_u32 v6, 14336, v31
  v_add_u32 v7, 21504, v31
  v_lshrrev_b32 v28, 3, v3
  v_and_b32 v29, 7, v3
  v_lshrrev_b32 v30, 4, v3
  v_xor_b32 v29, v29, v30
  v_add_u32 v28, s35, v28
  v_lshlrev_b32 v28, 11, v28
  v_lshl_add_u32 v30, v29, 4, v28
  v_xor_b32 v29, 4, v29
  v_lshl_add_u32 v31, v29, 4, v28
  v_add_u32 v8, 0, v30
  v_add_u32 v9, 15360, v31
  v_add_u32 v10, 30720, v30
  v_add_u32 v11, 46080, v31
  s_lshl_b32 s27, s20, 12
  s_waitcnt lgkmcnt(0)
  s_mov_b32 s8, s28
  s_mov_b32 s9, s29
  s_mov_b32 s10, 2097152
  s_mov_b32 s11, 0x20000
  s_mov_b32 s4, s32
  s_mov_b32 s5, s33
  s_mov_b32 s6, 4194304
  s_mov_b32 s7, 0x20000
  s_getpc_b64 s[72:73]
gl_pc1:
  s_add_u32 s72, s72, recurrent_scan__ssm_conv_h3__mixer_s_mlp__prompt_kernel-gl_pc1
  s_addc_u32 s73, s73, -1
  s_mov_b32 s74, code_end-recurrent_scan__ssm_conv_h3__mixer_s_mlp__prompt_kernel
  s_mov_b32 s75, 0x20000
  s_lshr_b32 s24, s2, 3
  s_and_b32 s24, s24, 31
  s_mul_i32 s24, s24, 4096
  s_cmp_lg_u32 s20, 3
  s_cselect_b32 s74, 0, s74
  v_cmp_gt_u32 vcc, 32, v3
  v_lshlrev_b32 v20, 7, v3
  v_mov_b32 v21, 0x80000000
  v_cndmask_b32 v20, v21, v20, vcc
  buffer_load_dword v255, v20, s[72:75], s24 offen
  s_add_u32 m0, s27, 0
  s_nop 0
  buffer_load_dwordx4 v4, s[8:11], s47 offen offset:0 lds
  buffer_load_dwordx4 v5, s[8:11], s47 offen offset:1024 lds
  buffer_load_dwordx4 v6, s[8:11], s47 offen offset:2048 lds
  buffer_load_dwordx4 v7, s[8:11], s47 offen offset:3072 lds
  s_add_u32 s47, s47, 131072
  s_and_b32 s47, s47, 2097151
  s_add_u32 m0, s26, 0
  s_nop 0
  buffer_load_dwordx4 v8, s[4:7], s46 offen offset:0 lds
  buffer_load_dwordx4 v9, s[4:7], s46 offen offset:1024 lds
  buffer_load_dwordx4 v10, s[4:7], s46 offen offset:2048 lds
  buffer_load_dwordx4 v11, s[4:7], s46 offen offset:3072 lds
  s_add_u32 s46, s46, 128
  s_and_b32 s46, s46, 2047
  s_add_u32 m0, s27, 16384
  s_nop 0
  buffer_load_dwordx4 v4, s[8:11], s47 offen offset:0 lds
  buffer_load_dwordx4 v5, s[8:11], s47 offen offset:1024 lds
  buffer_load_dwordx4 v6, s[8:11], s47 offen offset:2048 lds
  buffer_load_dwordx4 v7, s[8:11], s47 offen offset:3072 lds
  s_add_u32 s47, s47, 131072
  s_and_b32 s47, s47, 2097151
  s_add_u32 m0, s26, 4096
  s_nop 0
  buffer_load_dwordx4 v8, s[4:7], s46 offen offset:0 lds
  buffer_load_dwordx4 v9, s[4:7], s46 offen offset:1024 lds
  buffer_load_dwordx4 v10, s[4:7], s46 offen offset:2048 lds
  buffer_load_dwordx4 v11, s[4:7], s46 offen offset:3072 lds
  s_add_u32 s46, s46, 128
  s_and_b32 s46, s46, 2047
  s_add_u32 m0, s27, 32768
  s_nop 0
  buffer_load_dwordx4 v4, s[8:11], s47 offen offset:0 lds
  buffer_load_dwordx4 v5, s[8:11], s47 offen offset:1024 lds
  buffer_load_dwordx4 v6, s[8:11], s47 offen offset:2048 lds
  buffer_load_dwordx4 v7, s[8:11], s47 offen offset:3072 lds
  s_add_u32 s47, s47, 131072
  s_and_b32 s47, s47, 2097151
  s_add_u32 m0, s26, 8192
  s_nop 0
  buffer_load_dwordx4 v8, s[4:7], s46 offen offset:0 lds
  buffer_load_dwordx4 v9, s[4:7], s46 offen offset:1024 lds
  buffer_load_dwordx4 v10, s[4:7], s46 offen offset:2048 lds
  buffer_load_dwordx4 v11, s[4:7], s46 offen offset:3072 lds
  s_add_u32 s46, s46, 128
  s_and_b32 s46, s46, 2047
  s_add_u32 s16, s42, 33554432
  s_addc_u32 s17, s43, 0
  s_mov_b32 s18, 4194304
  s_mov_b32 s19, 0x20000
  s_mov_b32 s36, s40
  s_mov_b32 s37, s41
  s_mov_b32 s38, 256
  s_mov_b32 s39, 0x20000
  v_mov_b32 v1, 0
  v_and_b32 v12, 127, v0
  v_lshlrev_b32 v12, 2, v12
  s_lshl_b32 s24, s22, 9
  v_add_u32 v13, s24, v12
  s_waitcnt vmcnt(16)
  s_barrier
  s_add_u32 m0, s27, 49152
  s_nop 0
  buffer_load_dwordx4 v4, s[8:11], s47 offen offset:0 lds
  buffer_load_dwordx4 v5, s[8:11], s47 offen offset:1024 lds
  buffer_load_dwordx4 v6, s[8:11], s47 offen offset:2048 lds
  buffer_load_dwordx4 v7, s[8:11], s47 offen offset:3072 lds
  s_add_u32 s47, s47, 131072
  s_and_b32 s47, s47, 2097151
  s_add_u32 m0, s26, 12288
  s_nop 0
  buffer_load_dwordx4 v8, s[4:7], s46 offen offset:0 lds
  buffer_load_dwordx4 v9, s[4:7], s46 offen offset:1024 lds
  buffer_load_dwordx4 v10, s[4:7], s46 offen offset:2048 lds
  buffer_load_dwordx4 v11, s[4:7], s46 offen offset:3072 lds
  s_add_u32 s46, s46, 128
  s_and_b32 s46, s46, 2047
  s_waitcnt vmcnt(16)
  s_barrier
  s_waitcnt vmcnt(8)
  s_barrier
  s_add_u32 m0, s27, 0
  s_nop 0
  buffer_load_dwordx4 v4, s[8:11], s47 offen offset:0 lds
  buffer_load_dwordx4 v5, s[8:11], s47 offen offset:1024 lds
  buffer_load_dwordx4 v6, s[8:11], s47 offen offset:2048 lds
  buffer_load_dwordx4 v7, s[8:11], s47 offen offset:3072 lds
  s_add_u32 s47, s47, 131072
  s_and_b32 s47, s47, 2097151
  s_add_u32 m0, s26, 0
  s_nop 0
  buffer_load_dwordx4 v8, s[4:7], s46 offen offset:0 lds
  buffer_load_dwordx4 v9, s[4:7], s46 offen offset:1024 lds
  buffer_load_dwordx4 v10, s[4:7], s46 offen offset:2048 lds
  buffer_load_dwordx4 v11, s[4:7], s46 offen offset:3072 lds
  s_add_u32 s46, s46, 128
  s_and_b32 s46, s46, 2047
  s_waitcnt vmcnt(8)
  s_barrier
  s_add_u32 m0, s27, 16384
  s_nop 0
  buffer_load_dwordx4 v4, s[8:11], s47 offen offset:0 lds
  buffer_load_dwordx4 v5, s[8:11], s47 offen offset:1024 lds
  buffer_load_dwordx4 v6, s[8:11], s47 offen offset:2048 lds
  buffer_load_dwordx4 v7, s[8:11], s47 offen offset:3072 lds
  s_add_u32 s47, s47, 131072
  s_and_b32 s47, s47, 2097151
  s_add_u32 m0, s26, 4096
  s_nop 0
  buffer_load_dwordx4 v8, s[4:7], s46 offen offset:0 lds
  buffer_load_dwordx4 v9, s[4:7], s46 offen offset:1024 lds
  buffer_load_dwordx4 v10, s[4:7], s46 offen offset:2048 lds
  buffer_load_dwordx4 v11, s[4:7], s46 offen offset:3072 lds
  s_add_u32 s46, s46, 128
  s_and_b32 s46, s46, 2047
  s_waitcnt vmcnt(8)
  s_barrier
  s_add_u32 m0, s27, 32768
  s_nop 0
  buffer_load_dwordx4 v4, s[8:11], s47 offen offset:0 lds
  buffer_load_dwordx4 v5, s[8:11], s47 offen offset:1024 lds
  buffer_load_dwordx4 v6, s[8:11], s47 offen offset:2048 lds
  buffer_load_dwordx4 v7, s[8:11], s47 offen offset:3072 lds
  s_add_u32 s47, s47, 131072
  s_and_b32 s47, s47, 2097151
  s_add_u32 m0, s26, 8192
  s_nop 0
  buffer_load_dwordx4 v8, s[4:7], s46 offen offset:0 lds
  buffer_load_dwordx4 v9, s[4:7], s46 offen offset:1024 lds
  buffer_load_dwordx4 v10, s[4:7], s46 offen offset:2048 lds
  buffer_load_dwordx4 v11, s[4:7], s46 offen offset:3072 lds
  s_add_u32 s46, s46, 128
  s_and_b32 s46, s46, 2047
  s_waitcnt vmcnt(8)
  s_barrier
  s_add_u32 m0, s27, 49152
  s_nop 0
  buffer_load_dwordx4 v4, s[8:11], s47 offen offset:0 lds
  buffer_load_dwordx4 v5, s[8:11], s47 offen offset:1024 lds
  buffer_load_dwordx4 v6, s[8:11], s47 offen offset:2048 lds
  buffer_load_dwordx4 v7, s[8:11], s47 offen offset:3072 lds
  s_add_u32 s47, s47, 131072
  s_and_b32 s47, s47, 2097151
  s_add_u32 m0, s26, 12288
  s_nop 0
  buffer_load_dwordx4 v8, s[4:7], s46 offen offset:0 lds
  buffer_load_dwordx4 v9, s[4:7], s46 offen offset:1024 lds
  buffer_load_dwordx4 v10, s[4:7], s46 offen offset:2048 lds
  buffer_load_dwordx4 v11, s[4:7], s46 offen offset:3072 lds
  s_add_u32 s46, s46, 128
  s_and_b32 s46, s46, 2047
  s_waitcnt vmcnt(8)
  s_barrier
  s_add_u32 m0, s27, 0
  s_nop 0
  buffer_load_dwordx4 v4, s[8:11], s47 offen offset:0 lds
  buffer_load_dwordx4 v5, s[8:11], s47 offen offset:1024 lds
  buffer_load_dwordx4 v6, s[8:11], s47 offen offset:2048 lds
  buffer_load_dwordx4 v7, s[8:11], s47 offen offset:3072 lds
  s_add_u32 s47, s47, 131072
  s_and_b32 s47, s47, 2097151
  s_add_u32 m0, s26, 0
  s_nop 0
  buffer_load_dwordx4 v8, s[4:7], s46 offen offset:0 lds
  buffer_load_dwordx4 v9, s[4:7], s46 offen offset:1024 lds
  buffer_load_dwordx4 v10, s[4:7], s46 offen offset:2048 lds
  buffer_load_dwordx4 v11, s[4:7], s46 offen offset:3072 lds
  s_add_u32 s46, s46, 128
  s_and_b32 s46, s46, 2047
  s_waitcnt vmcnt(8)
  s_barrier
  s_add_u32 m0, s27, 16384
  s_nop 0
  buffer_load_dwordx4 v4, s[8:11], s47 offen offset:0 lds
  buffer_load_dwordx4 v5, s[8:11], s47 offen offset:1024 lds
  buffer_load_dwordx4 v6, s[8:11], s47 offen offset:2048 lds
  buffer_load_dwordx4 v7, s[8:11], s47 offen offset:3072 lds
  s_add_u32 s47, s47, 131072
  s_and_b32 s47, s47, 2097151
  s_add_u32 m0, s26, 4096
  s_nop 0
  buffer_load_dwordx4 v8, s[4:7], s46 offen offset:0 lds
  buffer_load_dwordx4 v9, s[4:7], s46 offen offset:1024 lds
  buffer_load_dwordx4 v10, s[4:7], s46 offen offset:2048 lds
  buffer_load_dwordx4 v11, s[4:7], s46 offen offset:3072 lds
  s_add_u32 s46, s46, 128
  s_and_b32 s46, s46, 2047
  s_waitcnt vmcnt(8)
  s_barrier
  s_add_u32 m0, s27, 32768
  s_nop 0
  buffer_load_dwordx4 v4, s[8:11], s47 offen offset:0 lds
  buffer_load_dwordx4 v5, s[8:11], s47 offen offset:1024 lds
  buffer_load_dwordx4 v6, s[8:11], s47 offen offset:2048 lds
  buffer_load_dwordx4 v7, s[8:11], s47 offen offset:3072 lds
  s_add_u32 s47, s47, 131072
  s_and_b32 s47, s47, 2097151
  s_add_u32 m0, s26, 8192
  s_nop 0
  buffer_load_dwordx4 v8, s[4:7], s46 offen offset:0 lds
  buffer_load_dwordx4 v9, s[4:7], s46 offen offset:1024 lds
  buffer_load_dwordx4 v10, s[4:7], s46 offen offset:2048 lds
  buffer_load_dwordx4 v11, s[4:7], s46 offen offset:3072 lds
  s_add_u32 s46, s46, 128
  s_and_b32 s46, s46, 2047
  s_waitcnt vmcnt(8)
  s_barrier
  s_add_u32 m0, s27, 49152
  s_nop 0
  buffer_load_dwordx4 v4, s[8:11], s47 offen offset:0 lds
  buffer_load_dwordx4 v5, s[8:11], s47 offen offset:1024 lds
  buffer_load_dwordx4 v6, s[8:11], s47 offen offset:2048 lds
  buffer_load_dwordx4 v7, s[8:11], s47 offen offset:3072 lds
  s_add_u32 s47, s47, 131072
  s_and_b32 s47, s47, 2097151
  s_add_u32 m0, s26, 12288
  s_nop 0
  buffer_load_dwordx4 v8, s[4:7], s46 offen offset:0 lds
  buffer_load_dwordx4 v9, s[4:7], s46 offen offset:1024 lds
  buffer_load_dwordx4 v10, s[4:7], s46 offen offset:2048 lds
  buffer_load_dwordx4 v11, s[4:7], s46 offen offset:3072 lds
  s_add_u32 s46, s46, 128
  s_and_b32 s46, s46, 2047
  s_getpc_b64 s[72:73]
gl_pc2:
  s_add_u32 s72, s72, g1_epi-gl_pc2
  s_addc_u32 s73, s73, -1
  s_mov_b32 s74, g1_cwend-g1_epi
  s_mov_b32 s75, 0x20000
  s_lshr_b32 s24, s2, 3
  s_and_b32 s24, s24, 15
  s_mul_i32 s24, s24, 3072
  s_cmp_lg_u32 s20, 3
  s_cselect_b32 s74, 0, s74
  v_cmp_gt_u32 vcc, 24, v3
  v_lshlrev_b32 v20, 7, v3
  v_mov_b32 v21, 0x80000000
  v_cndmask_b32 v20, v21, v20, vcc
  buffer_load_dword v255, v20, s[72:75], s24 offen
  s_getpc_b64 s[76:77]
gl_pc3:
  s_add_u32 s76, s76, g2_l-gl_pc3
  s_addc_u32 s77, s77, 0
  s_mov_b32 s78, g3_l-g2_l
  s_mov_b32 s79, 0x20000
  s_lshr_b32 s24, s2, 3
  s_and_b32 s24, s24, 15
  s_mul_i32 s24, s24, 512
  s_cmp_lg_u32 s20, 3
  s_cselect_b32 s78, 0, s78
  v_cmp_gt_u32 vcc, 4, v3
  v_lshlrev_b32 v22, 7, v3
  v_mov_b32 v23, 0x80000000
  v_cndmask_b32 v22, v23, v22, vcc
  buffer_load_dword v255, v22, s[76:79], s24 offen
  s_waitcnt vmcnt(10)
  s_barrier
  s_add_u32 m0, s27, 0
  s_nop 0
  buffer_load_dwordx4 v4, s[8:11], s47 offen offset:0 lds
  buffer_load_dwordx4 v5, s[8:11], s47 offen offset:1024 lds
  buffer_load_dwordx4 v6, s[8:11], s47 offen offset:2048 lds
  buffer_load_dwordx4 v7, s[8:11], s47 offen offset:3072 lds
  s_add_u32 s47, s47, 131072
  s_and_b32 s47, s47, 2097151
  s_add_u32 m0, s26, 0
  s_nop 0
  buffer_load_dwordx4 v8, s[4:7], s46 offen offset:0 lds
  buffer_load_dwordx4 v9, s[4:7], s46 offen offset:1024 lds
  buffer_load_dwordx4 v10, s[4:7], s46 offen offset:2048 lds
  buffer_load_dwordx4 v11, s[4:7], s46 offen offset:3072 lds
  s_add_u32 s46, s46, 128
  s_and_b32 s46, s46, 2047
  s_waitcnt vmcnt(10)
  s_barrier
  s_add_u32 m0, s27, 16384
  s_nop 0
  buffer_load_dwordx4 v4, s[8:11], s47 offen offset:0 lds
  buffer_load_dwordx4 v5, s[8:11], s47 offen offset:1024 lds
  buffer_load_dwordx4 v6, s[8:11], s47 offen offset:2048 lds
  buffer_load_dwordx4 v7, s[8:11], s47 offen offset:3072 lds
  s_add_u32 s47, s47, 131072
  s_and_b32 s47, s47, 2097151
  s_add_u32 m0, s26, 4096
  s_nop 0
  buffer_load_dwordx4 v8, s[4:7], s46 offen offset:0 lds
  buffer_load_dwordx4 v9, s[4:7], s46 offen offset:1024 lds
  buffer_load_dwordx4 v10, s[4:7], s46 offen offset:2048 lds
  buffer_load_dwordx4 v11, s[4:7], s46 offen offset:3072 lds
  s_add_u32 s46, s46, 128
  s_and_b32 s46, s46, 2047
  buffer_load_dword v2, v1, s[36:39], 0 offen sc1
  s_waitcnt vmcnt(9)
  s_barrier
  s_add_u32 m0, s27, 32768
  s_nop 0
  buffer_load_dwordx4 v4, s[8:11], s47 offen offset:0 lds
  buffer_load_dwordx4 v5, s[8:11], s47 offen offset:1024 lds
  buffer_load_dwordx4 v6, s[8:11], s47 offen offset:2048 lds
  buffer_load_dwordx4 v7, s[8:11], s47 offen offset:3072 lds
  s_add_u32 s47, s47, 131072
  s_and_b32 s47, s47, 2097151
  s_add_u32 m0, s26, 8192
  s_nop 0
  buffer_load_dwordx4 v8, s[4:7], s46 offen offset:0 lds
  buffer_load_dwordx4 v9, s[4:7], s46 offen offset:1024 lds
  buffer_load_dwordx4 v10, s[4:7], s46 offen offset:2048 lds
  buffer_load_dwordx4 v11, s[4:7], s46 offen offset:3072 lds
  s_add_u32 s46, s46, 128
  s_and_b32 s46, s46, 2047
  s_waitcnt vmcnt(9)
  s_barrier
  s_add_u32 m0, s27, 49152
  s_nop 0
  buffer_load_dwordx4 v4, s[8:11], s47 offen offset:0 lds
  buffer_load_dwordx4 v5, s[8:11], s47 offen offset:1024 lds
  buffer_load_dwordx4 v6, s[8:11], s47 offen offset:2048 lds
  buffer_load_dwordx4 v7, s[8:11], s47 offen offset:3072 lds
  s_add_u32 s47, s47, 131072
  s_and_b32 s47, s47, 2097151
  s_add_u32 m0, s26, 12288
  s_nop 0
  buffer_load_dwordx4 v8, s[4:7], s46 offen offset:0 lds
  buffer_load_dwordx4 v9, s[4:7], s46 offen offset:1024 lds
  buffer_load_dwordx4 v10, s[4:7], s46 offen offset:2048 lds
  buffer_load_dwordx4 v11, s[4:7], s46 offen offset:3072 lds
  s_add_u32 s46, s46, 128
  s_and_b32 s46, s46, 2047
  s_waitcnt vmcnt(16)
  s_mov_b32 s57, 0
gl_fsp5:
  v_readfirstlane_b32 s56, v2
  s_nop 0
  s_cmp_ge_u32 s56, 128
  s_cbranch_scc1 gl_fok4
  s_add_u32 s57, s57, 1
  s_cmp_ge_u32 s57, 262144
  s_cbranch_scc1 gl_fok4
  s_sleep 2
  buffer_load_dword v2, v1, s[36:39], 0 offen sc1
  s_waitcnt vmcnt(0)
  s_branch gl_fsp5
gl_fok4:
  s_mov_b32 s44, 655360
  buffer_load_dword v32, v13, s[16:19], s44 offen sc1
  s_mov_b32 s44, 659456
  buffer_load_dword v33, v13, s[16:19], s44 offen sc1
  s_mov_b32 s44, 663552
  buffer_load_dword v34, v13, s[16:19], s44 offen sc1
  s_mov_b32 s44, 667648
  buffer_load_dword v35, v13, s[16:19], s44 offen sc1
  s_mov_b32 s44, 671744
  buffer_load_dword v36, v13, s[16:19], s44 offen sc1
  s_mov_b32 s44, 675840
  buffer_load_dword v37, v13, s[16:19], s44 offen sc1
  s_mov_b32 s44, 679936
  buffer_load_dword v38, v13, s[16:19], s44 offen sc1
  s_mov_b32 s44, 684032
  buffer_load_dword v39, v13, s[16:19], s44 offen sc1
  s_mov_b32 s44, 688128
  buffer_load_dword v40, v13, s[16:19], s44 offen sc1
  s_mov_b32 s44, 692224
  buffer_load_dword v41, v13, s[16:19], s44 offen sc1
  s_mov_b32 s44, 696320
  buffer_load_dword v42, v13, s[16:19], s44 offen sc1
  s_mov_b32 s44, 700416
  buffer_load_dword v43, v13, s[16:19], s44 offen sc1
  s_mov_b32 s44, 704512
  buffer_load_dword v44, v13, s[16:19], s44 offen sc1
  s_mov_b32 s44, 708608
  buffer_load_dword v45, v13, s[16:19], s44 offen sc1
  s_mov_b32 s44, 712704
  buffer_load_dword v46, v13, s[16:19], s44 offen sc1
  s_mov_b32 s44, 716800
  buffer_load_dword v47, v13, s[16:19], s44 offen sc1
  s_waitcnt vmcnt(24)
  s_barrier
  s_waitcnt vmcnt(0)
  v_add_f32 v32, v32, v33
  v_add_f32 v32, v32, v34
  v_add_f32 v32, v32, v35
  v_add_f32 v32, v32, v36
  v_add_f32 v32, v32, v37
  v_add_f32 v32, v32, v38
  v_add_f32 v32, v32, v39
  v_add_f32 v32, v32, v40
  v_add_f32 v32, v32, v41
  v_add_f32 v32, v32, v42
  v_add_f32 v32, v32, v43
  v_add_f32 v32, v32, v44
  v_add_f32 v32, v32, v45
  v_add_f32 v32, v32, v46
  v_add_f32 v32, v32, v47
  v_add_u32 v12, 162816, v12
  ds_write_b32 v12, v32
  s_waitcnt lgkmcnt(0)
  s_barrier
  s_barrier
g2_l:
  s_load_dwordx4 s[28:31], s[0:1], 64
  s_load_dwordx4 s[40:43], s[0:1], 96
  s_load_dwordx2 s[32:33], s[0:1], 0
  s_and_b32 s24, s2, 7
  s_lshr_b32 s25, s2, 3
  s_and_b32 s25, s25, 15
  s_lshr_b32 s21, s24, 1
  s_lshl_b32 s21, s21, 2
  s_lshr_b32 s22, s25, 2
  s_add_u32 s21, s21, s22
  s_and_b32 s22, s24, 1
  s_lshl_b32 s22, s22, 2
  s_and_b32 s25, s25, 3
  s_add_u32 s22, s22, s25
  v_lshrrev_b32 v2, 6, v0
  v_and_b32 v3, 63, v0
  v_readfirstlane_b32 s100, v2
  s_nop 0
  s_and_b32 s20, s100, 3
  s_lshr_b32 s3, s100, 2
  s_lshl_b32 s23, s21, 3
  s_lshl_b32 s24, s20, 1
  s_add_u32 s23, s23, s24
  s_lshl_b32 s26, s20, 13
  s_add_u32 s26, s26, 131072
  s_mov_b32 s46, 0
  s_mov_b32 s47, 0
  v_lshrrev_b32 v28, 4, v3
  v_and_b32 v29, 15, v3
  v_lshlrev_b32 v30, 1, v28
  v_xor_b32 v29, v29, v30
  s_lshl_b32 s24, s20, 4
  v_add_u32 v28, s24, v28
  v_lshlrev_b32 v28, 11, v28
  s_lshl_b32 s24, s22, 8
  v_add_u32 v28, s24, v28
  v_lshl_add_u32 v30, v29, 4, v28
  v_xor_b32 v29, 8, v29
  v_lshl_add_u32 v31, v29, 4, v28
  v_add_u32 v4, 0, v30
  v_add_u32 v5, 7168, v31
  v_add_u32 v6, 14336, v30
  v_add_u32 v7, 21504, v31
  s_lshl_b32 s27, s20, 12
  s_waitcnt lgkmcnt(0)
  s_mov_b32 s8, s28
  s_mov_b32 s9, s29
  s_mov_b32 s10, 2097152
  s_mov_b32 s11, 0x20000
  s_mov_b32 s4, s32
  s_mov_b32 s5, s33
  s_mov_b32 s6, 4194304
  s_mov_b32 s7, 0x20000
  s_add_u32 m0, s27, 0
  s_nop 0
  buffer_load_dwordx4 v4, s[8:11], s47 offen offset:0 lds
  buffer_load_dwordx4 v5, s[8:11], s47 offen offset:1024 lds
  buffer_load_dwordx4 v6, s[8:11], s47 offen offset:2048 lds
  buffer_load_dwordx4 v7, s[8:11], s47 offen offset:3072 lds
  s_add_u32 s47, s47, 131072
  s_add_u32 m0, s27, 16384
  s_nop 0
  buffer_load_dwordx4 v4, s[8:11], s47 offen offset:0 lds
  buffer_load_dwordx4 v5, s[8:11], s47 offen offset:1024 lds
  buffer_load_dwordx4 v6, s[8:11], s47 offen offset:2048 lds
  buffer_load_dwordx4 v7, s[8:11], s47 offen offset:3072 lds
  s_add_u32 s47, s47, 131072
  s_add_u32 m0, s27, 32768
  s_nop 0
  buffer_load_dwordx4 v4, s[8:11], s47 offen offset:0 lds
  buffer_load_dwordx4 v5, s[8:11], s47 offen offset:1024 lds
  buffer_load_dwordx4 v6, s[8:11], s47 offen offset:2048 lds
  buffer_load_dwordx4 v7, s[8:11], s47 offen offset:3072 lds
  s_add_u32 s47, s47, 131072
  s_add_u32 m0, s27, 49152
  s_nop 0
  buffer_load_dwordx4 v4, s[8:11], s47 offen offset:0 lds
  buffer_load_dwordx4 v5, s[8:11], s47 offen offset:1024 lds
  buffer_load_dwordx4 v6, s[8:11], s47 offen offset:2048 lds
  buffer_load_dwordx4 v7, s[8:11], s47 offen offset:3072 lds
  s_add_u32 s47, s47, 131072
  s_add_u32 m0, s27, 65536
  s_nop 0
  buffer_load_dwordx4 v4, s[8:11], s47 offen offset:0 lds
  buffer_load_dwordx4 v5, s[8:11], s47 offen offset:1024 lds
  buffer_load_dwordx4 v6, s[8:11], s47 offen offset:2048 lds
  buffer_load_dwordx4 v7, s[8:11], s47 offen offset:3072 lds
  s_add_u32 s47, s47, 131072
  s_add_u32 m0, s27, 81920
  s_nop 0
  buffer_load_dwordx4 v4, s[8:11], s47 offen offset:0 lds
  buffer_load_dwordx4 v5, s[8:11], s47 offen offset:1024 lds
  buffer_load_dwordx4 v6, s[8:11], s47 offen offset:2048 lds
  buffer_load_dwordx4 v7, s[8:11], s47 offen offset:3072 lds
  s_add_u32 s47, s47, 131072
  s_lshl_b32 s35, s22, 1
  v_lshrrev_b32 v28, 3, v3
  v_and_b32 v29, 7, v3
  v_lshrrev_b32 v30, 4, v3
  v_xor_b32 v30, v30, v29
  s_lshl_b32 s24, s23, 4
  v_add_u32 v31, s24, v28
  v_lshlrev_b32 v31, 11, v31
  s_lshl_b32 s24, s35, 7
  v_add_u32 v31, s24, v31
  v_lshl_add_u32 v8, v30, 4, v31
  v_xor_b32 v30, 4, v30
  v_lshl_add_u32 v9, v30, 4, v31
  s_add_u32 m0, s26, 0
  s_mov_b32 s44, 0
  buffer_load_dwordx4 v8, s[4:7], s44 offen lds
  s_add_u32 m0, s26, 1024
  s_mov_b32 s44, 16384
  buffer_load_dwordx4 v9, s[4:7], s44 offen lds
  s_add_u32 m0, s26, 2048
  s_mov_b32 s44, 32768
  buffer_load_dwordx4 v8, s[4:7], s44 offen lds
  s_add_u32 m0, s26, 3072
  s_mov_b32 s44, 49152
  buffer_load_dwordx4 v9, s[4:7], s44 offen lds
  s_add_u32 m0, s26, 4096
  s_mov_b32 s44, 128
  buffer_load_dwordx4 v8, s[4:7], s44 offen lds
  s_add_u32 m0, s26, 5120
  s_mov_b32 s44, 16512
  buffer_load_dwordx4 v9, s[4:7], s44 offen lds
  s_add_u32 m0, s26, 6144
  s_mov_b32 s44, 32896
  buffer_load_dwordx4 v8, s[4:7], s44 offen lds
  s_add_u32 m0, s26, 7168
  s_mov_b32 s44, 49280
  buffer_load_dwordx4 v9, s[4:7], s44 offen lds
  s_waitcnt vmcnt(28)
  s_barrier
  s_waitcnt vmcnt(24)
  s_barrier
  s_waitcnt vmcnt(20)
  s_barrier
  s_add_u32 m0, s27, 0
  s_nop 0
  buffer_load_dwordx4 v4, s[8:11], s47 offen offset:0 lds
  buffer_load_dwordx4 v5, s[8:11], s47 offen offset:1024 lds
  buffer_load_dwordx4 v6, s[8:11], s47 offen offset:2048 lds
  buffer_load_dwordx4 v7, s[8:11], s47 offen offset:3072 lds
  s_add_u32 s47, s47, 131072
  s_waitcnt vmcnt(20)
  s_barrier
  s_add_u32 m0, s27, 16384
  s_nop 0
  buffer_load_dwordx4 v4, s[8:11], s47 offen offset:0 lds
  buffer_load_dwordx4 v5, s[8:11], s47 offen offset:1024 lds
  buffer_load_dwordx4 v6, s[8:11], s47 offen offset:2048 lds
  buffer_load_dwordx4 v7, s[8:11], s47 offen offset:3072 lds
  s_add_u32 s47, s47, 131072
  s_waitcnt vmcnt(20)
  s_barrier
  s_add_u32 m0, s27, 32768
  s_nop 0
  buffer_load_dwordx4 v4, s[8:11], s47 offen offset:0 lds
  buffer_load_dwordx4 v5, s[8:11], s47 offen offset:1024 lds
  buffer_load_dwordx4 v6, s[8:11], s47 offen offset:2048 lds
  buffer_load_dwordx4 v7, s[8:11], s47 offen offset:3072 lds
  s_add_u32 s47, s47, 131072
  s_waitcnt vmcnt(20)
  s_barrier
  s_add_u32 m0, s27, 49152
  s_nop 0
  buffer_load_dwordx4 v4, s[8:11], s47 offen offset:0 lds
  buffer_load_dwordx4 v5, s[8:11], s47 offen offset:1024 lds
  buffer_load_dwordx4 v6, s[8:11], s47 offen offset:2048 lds
  buffer_load_dwordx4 v7, s[8:11], s47 offen offset:3072 lds
  s_add_u32 s47, s47, 131072
  s_waitcnt vmcnt(12)
  s_barrier
  s_add_u32 m0, s27, 65536
  s_nop 0
  buffer_load_dwordx4 v4, s[8:11], s47 offen offset:0 lds
  buffer_load_dwordx4 v5, s[8:11], s47 offen offset:1024 lds
  buffer_load_dwordx4 v6, s[8:11], s47 offen offset:2048 lds
  buffer_load_dwordx4 v7, s[8:11], s47 offen offset:3072 lds
  s_add_u32 s47, s47, 131072
  s_waitcnt vmcnt(12)
  s_barrier
  s_add_u32 m0, s27, 81920
  s_nop 0
  buffer_load_dwordx4 v4, s[8:11], s47 offen offset:0 lds
  buffer_load_dwordx4 v5, s[8:11], s47 offen offset:1024 lds
  buffer_load_dwordx4 v6, s[8:11], s47 offen offset:2048 lds
  buffer_load_dwordx4 v7, s[8:11], s47 offen offset:3072 lds
  s_add_u32 s47, s47, 131072
  s_waitcnt vmcnt(12)
  s_barrier
  s_add_u32 m0, s27, 0
  s_nop 0
  buffer_load_dwordx4 v4, s[8:11], s47 offen offset:0 lds
  buffer_load_dwordx4 v5, s[8:11], s47 offen offset:1024 lds
  buffer_load_dwordx4 v6, s[8:11], s47 offen offset:2048 lds
  buffer_load_dwordx4 v7, s[8:11], s47 offen offset:3072 lds
  s_add_u32 s47, s47, 131072
  s_waitcnt vmcnt(12)
  s_barrier
  s_add_u32 m0, s27, 16384
  s_nop 0
  buffer_load_dwordx4 v4, s[8:11], s47 offen offset:0 lds
  buffer_load_dwordx4 v5, s[8:11], s47 offen offset:1024 lds
  buffer_load_dwordx4 v6, s[8:11], s47 offen offset:2048 lds
  buffer_load_dwordx4 v7, s[8:11], s47 offen offset:3072 lds
  s_add_u32 s47, s47, 131072
  s_getpc_b64 s[72:73]
gl_pc6:
  s_add_u32 s72, s72, g2_epi-gl_pc6
  s_addc_u32 s73, s73, -1
  s_mov_b32 s74, g2_cwend-g2_epi
  s_mov_b32 s75, 0x20000
  s_lshr_b32 s24, s2, 3
  s_and_b32 s24, s24, 15
  s_mul_i32 s24, s24, 3072
  s_cmp_lg_u32 s20, 3
  s_cselect_b32 s74, 0, s74
  v_cmp_gt_u32 vcc, 24, v3
  v_lshlrev_b32 v20, 7, v3
  v_mov_b32 v21, 0x80000000
  v_cndmask_b32 v20, v21, v20, vcc
  buffer_load_dword v255, v20, s[72:75], s24 offen
  s_getpc_b64 s[76:77]
gl_pc7:
  s_add_u32 s76, s76, g3_l-gl_pc7
  s_addc_u32 s77, s77, 0
  s_mov_b32 s78, g4_l-g3_l
  s_mov_b32 s79, 0x20000
  s_lshr_b32 s24, s2, 3
  s_and_b32 s24, s24, 15
  s_mul_i32 s24, s24, 512
  s_cmp_lg_u32 s20, 3
  s_cselect_b32 s78, 0, s78
  v_cmp_gt_u32 vcc, 4, v3
  v_lshlrev_b32 v22, 7, v3
  v_mov_b32 v23, 0x80000000
  v_cndmask_b32 v22, v23, v22, vcc
  buffer_load_dword v255, v22, s[76:79], s24 offen
  s_waitcnt vmcnt(14)
  s_barrier
  s_add_u32 m0, s27, 32768
  s_nop 0
  buffer_load_dwordx4 v4, s[8:11], s47 offen offset:0 lds
  buffer_load_dwordx4 v5, s[8:11], s47 offen offset:1024 lds
  buffer_load_dwordx4 v6, s[8:11], s47 offen offset:2048 lds
  buffer_load_dwordx4 v7, s[8:11], s47 offen offset:3072 lds
  s_add_u32 s47, s47, 131072
  s_waitcnt vmcnt(14)
  s_barrier
  s_add_u32 m0, s27, 49152
  s_nop 0
  buffer_load_dwordx4 v4, s[8:11], s47 offen offset:0 lds
  buffer_load_dwordx4 v5, s[8:11], s47 offen offset:1024 lds
  buffer_load_dwordx4 v6, s[8:11], s47 offen offset:2048 lds
  buffer_load_dwordx4 v7, s[8:11], s47 offen offset:3072 lds
  s_add_u32 s47, s47, 131072
  s_waitcnt vmcnt(14)
  s_barrier
  s_waitcnt vmcnt(10)
  s_barrier
  s_waitcnt vmcnt(4)
  s_barrier
  s_waitcnt vmcnt(0)
  s_barrier
  s_barrier
g3_l:
  s_load_dwordx4 s[28:31], s[0:1], 72
  s_load_dwordx2 s[42:43], s[0:1], 104
  s_and_b32 s24, s2, 7
  s_lshr_b32 s25, s2, 3
  s_and_b32 s25, s25, 31
  s_lshr_b32 s21, s24, 2
  s_lshl_b32 s21, s21, 3
  s_lshr_b32 s22, s25, 2
  s_add_u32 s21, s21, s22
  s_and_b32 s22, s24, 3
  s_lshl_b32 s22, s22, 2
  s_and_b32 s25, s25, 3
  s_add_u32 s22, s22, s25
  v_lshrrev_b32 v2, 6, v0
  v_and_b32 v3, 63, v0
  v_readfirstlane_b32 s100, v2
  s_nop 0
  s_and_b32 s20, s100, 3
  s_lshr_b32 s3, s100, 2
  s_lshl_b32 s23, s21, 3
  s_lshl_b32 s24, s20, 1
  s_add_u32 s23, s23, s24
  s_mul_i32 s24, s20, 448
  s_mul_i32 s25, s22, 448
  s_movk_i32 s26, 2341
  s_mul_i32 s27, s20, 7168
  s_mov_b32 s47, 0
  s_waitcnt lgkmcnt(0)
  s_mov_b32 s8, s28
  s_mov_b32 s9, s29
  s_mov_b32 s10, 7340032
  s_mov_b32 s11, 0x20000
  v_add_u32 v4, s24, v3
  v_mul_u32_u24 v5, s26, v4
  v_lshrrev_b32 v5, 16, v5
  v_mul_u32_u24 v6, 28, v5
  v_sub_u32 v6, v4, v6
  v_bfe_u32 v8, v5, 2, 1
  v_lshlrev_b32 v8, 1, v8
  v_xor_b32 v6, v6, v8
  v_mul_u32_u24 v5, 7168, v5
  v_lshl_add_u32 v5, v6, 4, v5
  v_add_u32 v16, s25, v5
  s_add_u32 m0, s27, 0
  s_nop 0
  buffer_load_dwordx4 v16, s[8:11], s47 offen offset:0 lds
  v_add_u32 v4, s24, v3
  v_add_u32 v4, 64, v4
  v_mul_u32_u24 v5, s26, v4
  v_lshrrev_b32 v5, 16, v5
  v_mul_u32_u24 v6, 28, v5
  v_sub_u32 v6, v4, v6
  v_bfe_u32 v8, v5, 2, 1
  v_lshlrev_b32 v8, 1, v8
  v_xor_b32 v6, v6, v8
  v_mul_u32_u24 v5, 7168, v5
  v_lshl_add_u32 v5, v6, 4, v5
  v_add_u32 v17, s25, v5
  v_subrev_u32 v17, 1024, v17
  buffer_load_dwordx4 v17, s[8:11], s47 offen offset:1024 lds
  v_add_u32 v4, s24, v3
  v_add_u32 v4, 128, v4
  v_mul_u32_u24 v5, s26, v4
  v_lshrrev_b32 v5, 16, v5
  v_mul_u32_u24 v6, 28, v5
  v_sub_u32 v6, v4, v6
  v_bfe_u32 v8, v5, 2, 1
  v_lshlrev_b32 v8, 1, v8
  v_xor_b32 v6, v6, v8
  v_mul_u32_u24 v5, 7168, v5
  v_lshl_add_u32 v5, v6, 4, v5
  v_add_u32 v18, s25, v5
  v_subrev_u32 v18, 2048, v18
  buffer_load_dwordx4 v18, s[8:11], s47 offen offset:2048 lds
  v_add_u32 v4, s24, v3
  v_add_u32 v4, 192, v4
  v_mul_u32_u24 v5, s26, v4
  v_lshrrev_b32 v5, 16, v5
  v_mul_u32_u24 v6, 28, v5
  v_sub_u32 v6, v4, v6
  v_bfe_u32 v8, v5, 2, 1
  v_lshlrev_b32 v8, 1, v8
  v_xor_b32 v6, v6, v8
  v_mul_u32_u24 v5, 7168, v5
  v_lshl_add_u32 v5, v6, 4, v5
  v_add_u32 v19, s25, v5
  v_subrev_u32 v19, 3072, v19
  buffer_load_dwordx4 v19, s[8:11], s47 offen offset:3072 lds
  v_add_u32 v4, s24, v3
  v_add_u32 v4, 256, v4
  v_mul_u32_u24 v5, s26, v4
  v_lshrrev_b32 v5, 16, v5
  v_mul_u32_u24 v6, 28, v5
  v_sub_u32 v6, v4, v6
  v_bfe_u32 v8, v5, 2, 1
  v_lshlrev_b32 v8, 1, v8
  v_xor_b32 v6, v6, v8
  v_mul_u32_u24 v5, 7168, v5
  v_lshl_add_u32 v5, v6, 4, v5
  v_add_u32 v20, s25, v5
  s_add_u32 m0, s27, 4096
  s_nop 0
  buffer_load_dwordx4 v20, s[8:11], s47 offen offset:0 lds
  v_add_u32 v4, s24, v3
  v_add_u32 v4, 320, v4
  v_mul_u32_u24 v5, s26, v4
  v_lshrrev_b32 v5, 16, v5
  v_mul_u32_u24 v6, 28, v5
  v_sub_u32 v6, v4, v6
  v_bfe_u32 v8, v5, 2, 1
  v_lshlrev_b32 v8, 1, v8
  v_xor_b32 v6, v6, v8
  v_mul_u32_u24 v5, 7168, v5
  v_lshl_add_u32 v5, v6, 4, v5
  v_add_u32 v21, s25, v5
  v_subrev_u32 v21, 1024, v21
  buffer_load_dwordx4 v21, s[8:11], s47 offen offset:1024 lds
  v_add_u32 v4, s24, v3
  v_add_u32 v4, 384, v4
  v_mul_u32_u24 v5, s26, v4
  v_lshrrev_b32 v5, 16, v5
  v_mul_u32_u24 v6, 28, v5
  v_sub_u32 v6, v4, v6
  v_bfe_u32 v8, v5, 2, 1
  v_lshlrev_b32 v8, 1, v8
  v_xor_b32 v6, v6, v8
  v_mul_u32_u24 v5, 7168, v5
  v_lshl_add_u32 v5, v6, 4, v5
  v_add_u32 v22, s25, v5
  v_subrev_u32 v22, 2048, v22
  buffer_load_dwordx4 v22, s[8:11], s47 offen offset:2048 lds
  s_add_u32 s47, s47, 458752
  s_add_u32 m0, s27, 28672
  s_nop 0
  buffer_load_dwordx4 v16, s[8:11], s47 offen offset:0 lds
  buffer_load_dwordx4 v17, s[8:11], s47 offen offset:1024 lds
  buffer_load_dwordx4 v18, s[8:11], s47 offen offset:2048 lds
  buffer_load_dwordx4 v19, s[8:11], s47 offen offset:3072 lds
  s_add_u32 m0, s27, 32768
  s_nop 0
  buffer_load_dwordx4 v20, s[8:11], s47 offen offset:0 lds
  buffer_load_dwordx4 v21, s[8:11], s47 offen offset:1024 lds
  buffer_load_dwordx4 v22, s[8:11], s47 offen offset:2048 lds
  s_add_u32 s47, s47, 458752
  s_add_u32 m0, s27, 57344
  s_nop 0
  buffer_load_dwordx4 v16, s[8:11], s47 offen offset:0 lds
  buffer_load_dwordx4 v17, s[8:11], s47 offen offset:1024 lds
  buffer_load_dwordx4 v18, s[8:11], s47 offen offset:2048 lds
  buffer_load_dwordx4 v19, s[8:11], s47 offen offset:3072 lds
  s_add_u32 m0, s27, 61440
  s_nop 0
  buffer_load_dwordx4 v20, s[8:11], s47 offen offset:0 lds
  buffer_load_dwordx4 v21, s[8:11], s47 offen offset:1024 lds
  buffer_load_dwordx4 v22, s[8:11], s47 offen offset:2048 lds
  s_add_u32 s47, s47, 458752
  s_add_u32 m0, s27, 86016
  s_nop 0
  buffer_load_dwordx4 v16, s[8:11], s47 offen offset:0 lds
  buffer_load_dwordx4 v17, s[8:11], s47 offen offset:1024 lds
  buffer_load_dwordx4 v18, s[8:11], s47 offen offset:2048 lds
  buffer_load_dwordx4 v19, s[8:11], s47 offen offset:3072 lds
  s_add_u32 m0, s27, 90112
  s_nop 0
  buffer_load_dwordx4 v20, s[8:11], s47 offen offset:0 lds
  buffer_load_dwordx4 v21, s[8:11], s47 offen offset:1024 lds
  buffer_load_dwordx4 v22, s[8:11], s47 offen offset:2048 lds
  s_add_u32 s47, s47, 458752
  s_add_u32 s16, s42, 33554432
  s_addc_u32 s17, s43, 0
  s_mov_b32 s18, 4194304
  s_mov_b32 s19, 0x20000
  s_mov_b32 s36, s30
  s_mov_b32 s37, s31
  s_mov_b32 s38, 7340032
  s_mov_b32 s39, 0x20000
  v_and_b32 v9, 255, v0
  v_lshlrev_b32 v9, 2, v9
  s_mul_i32 s25, s22, 896
  v_add_u32 v10, s25, v9
  v_add_u32 v9, 162816, v9
  s_waitcnt vmcnt(21)
  s_barrier
  s_add_u32 m0, s27, 114688
  s_nop 0
  buffer_load_dwordx4 v16, s[8:11], s47 offen offset:0 lds
  buffer_load_dwordx4 v17, s[8:11], s47 offen offset:1024 lds
  buffer_load_dwordx4 v18, s[8:11], s47 offen offset:2048 lds
  buffer_load_dwordx4 v19, s[8:11], s47 offen offset:3072 lds
  s_add_u32 m0, s27, 118784
  s_nop 0
  buffer_load_dwordx4 v20, s[8:11], s47 offen offset:0 lds
  buffer_load_dwordx4 v21, s[8:11], s47 offen offset:1024 lds
  buffer_load_dwordx4 v22, s[8:11], s47 offen offset:2048 lds
  s_add_u32 s47, s47, 458752
  s_waitcnt vmcnt(21)
  s_barrier
  s_waitcnt vmcnt(14)
  s_barrier
  s_add_u32 m0, s27, 0
  s_nop 0
  buffer_load_dwordx4 v16, s[8:11], s47 offen offset:0 lds
  buffer_load_dwordx4 v17, s[8:11], s47 offen offset:1024 lds
  buffer_load_dwordx4 v18, s[8:11], s47 offen offset:2048 lds
  buffer_load_dwordx4 v19, s[8:11], s47 offen offset:3072 lds
  s_add_u32 m0, s27, 4096
  s_nop 0
  buffer_load_dwordx4 v20, s[8:11], s47 offen offset:0 lds
  buffer_load_dwordx4 v21, s[8:11], s47 offen offset:1024 lds
  buffer_load_dwordx4 v22, s[8:11], s47 offen offset:2048 lds
  s_add_u32 s47, s47, 458752
  s_waitcnt vmcnt(14)
  s_barrier
  s_add_u32 m0, s27, 28672
  s_nop 0
  buffer_load_dwordx4 v16, s[8:11], s47 offen offset:0 lds
  buffer_load_dwordx4 v17, s[8:11], s47 offen offset:1024 lds
  buffer_load_dwordx4 v18, s[8:11], s47 offen offset:2048 lds
  buffer_load_dwordx4 v19, s[8:11], s47 offen offset:3072 lds
  s_add_u32 m0, s27, 32768
  s_nop 0
  buffer_load_dwordx4 v20, s[8:11], s47 offen offset:0 lds
  buffer_load_dwordx4 v21, s[8:11], s47 offen offset:1024 lds
  buffer_load_dwordx4 v22, s[8:11], s47 offen offset:2048 lds
  s_add_u32 s47, s47, 458752
  s_waitcnt vmcnt(14)
  s_barrier
  s_add_u32 m0, s27, 57344
  s_nop 0
  buffer_load_dwordx4 v16, s[8:11], s47 offen offset:0 lds
  buffer_load_dwordx4 v17, s[8:11], s47 offen offset:1024 lds
  buffer_load_dwordx4 v18, s[8:11], s47 offen offset:2048 lds
  buffer_load_dwordx4 v19, s[8:11], s47 offen offset:3072 lds
  s_add_u32 m0, s27, 61440
  s_nop 0
  buffer_load_dwordx4 v20, s[8:11], s47 offen offset:0 lds
  buffer_load_dwordx4 v21, s[8:11], s47 offen offset:1024 lds
  buffer_load_dwordx4 v22, s[8:11], s47 offen offset:2048 lds
  s_add_u32 s47, s47, 458752
  v_mov_b32 v1, 0
  s_mov_b32 s45, 829440
  buffer_load_dword v2, v1, s[16:19], s45 offen sc1
  s_waitcnt vmcnt(15)
  s_barrier
  s_add_u32 m0, s27, 86016
  s_nop 0
  buffer_load_dwordx4 v16, s[8:11], s47 offen offset:0 lds
  buffer_load_dwordx4 v17, s[8:11], s47 offen offset:1024 lds
  buffer_load_dwordx4 v18, s[8:11], s47 offen offset:2048 lds
  buffer_load_dwordx4 v19, s[8:11], s47 offen offset:3072 lds
  s_add_u32 m0, s27, 90112
  s_nop 0
  buffer_load_dwordx4 v20, s[8:11], s47 offen offset:0 lds
  buffer_load_dwordx4 v21, s[8:11], s47 offen offset:1024 lds
  buffer_load_dwordx4 v22, s[8:11], s47 offen offset:2048 lds
  s_add_u32 s47, s47, 458752
  s_waitcnt vmcnt(15)
  s_barrier
  s_add_u32 m0, s27, 114688
  s_nop 0
  buffer_load_dwordx4 v16, s[8:11], s47 offen offset:0 lds
  buffer_load_dwordx4 v17, s[8:11], s47 offen offset:1024 lds
  buffer_load_dwordx4 v18, s[8:11], s47 offen offset:2048 lds
  buffer_load_dwordx4 v19, s[8:11], s47 offen offset:3072 lds
  s_add_u32 m0, s27, 118784
  s_nop 0
  buffer_load_dwordx4 v20, s[8:11], s47 offen offset:0 lds
  buffer_load_dwordx4 v21, s[8:11], s47 offen offset:1024 lds
  buffer_load_dwordx4 v22, s[8:11], s47 offen offset:2048 lds
  s_add_u32 s47, s47, 458752
  s_waitcnt vmcnt(15)
  s_barrier
  s_add_u32 m0, s27, 0
  s_nop 0
  buffer_load_dwordx4 v16, s[8:11], s47 offen offset:0 lds
  buffer_load_dwordx4 v17, s[8:11], s47 offen offset:1024 lds
  buffer_load_dwordx4 v18, s[8:11], s47 offen offset:2048 lds
  buffer_load_dwordx4 v19, s[8:11], s47 offen offset:3072 lds
  s_add_u32 m0, s27, 4096
  s_nop 0
  buffer_load_dwordx4 v20, s[8:11], s47 offen offset:0 lds
  buffer_load_dwordx4 v21, s[8:11], s47 offen offset:1024 lds
  buffer_load_dwordx4 v22, s[8:11], s47 offen offset:2048 lds
  s_add_u32 s47, s47, 458752
  s_waitcnt vmcnt(14)
  s_barrier
  s_add_u32 m0, s27, 28672
  s_nop 0
  buffer_load_dwordx4 v16, s[8:11], s47 offen offset:0 lds
  buffer_load_dwordx4 v17, s[8:11], s47 offen offset:1024 lds
  buffer_load_dwordx4 v18, s[8:11], s47 offen offset:2048 lds
  buffer_load_dwordx4 v19, s[8:11], s47 offen offset:3072 lds
  s_add_u32 m0, s27, 32768
  s_nop 0
  buffer_load_dwordx4 v20, s[8:11], s47 offen offset:0 lds
  buffer_load_dwordx4 v21, s[8:11], s47 offen offset:1024 lds
  buffer_load_dwordx4 v22, s[8:11], s47 offen offset:2048 lds
  s_add_u32 s47, s47, 458752
  s_mov_b32 s57, 0
gl_fsp9:
  v_readfirstlane_b32 s56, v2
  s_nop 0
  s_cmp_ge_u32 s56, 128
  s_cbranch_scc1 gl_fok8
  s_add_u32 s57, s57, 1
  s_cmp_ge_u32 s57, 262144
  s_cbranch_scc1 gl_fok8
  s_sleep 2
  buffer_load_dword v2, v1, s[16:19], s45 offen sc1
  s_waitcnt vmcnt(0)
  s_branch gl_fsp9
gl_fok8:
  s_mov_b32 s26, 524288
  buffer_load_dword v32, v10, s[16:19], s26 offen sc1
  s_mov_b32 s26, 538624
  buffer_load_dword v33, v10, s[16:19], s26 offen sc1
  s_mov_b32 s26, 552960
  buffer_load_dword v34, v10, s[16:19], s26 offen sc1
  s_mov_b32 s26, 567296
  buffer_load_dword v35, v10, s[16:19], s26 offen sc1
  s_mov_b32 s26, 581632
  buffer_load_dword v36, v10, s[16:19], s26 offen sc1
  s_mov_b32 s26, 595968
  buffer_load_dword v37, v10, s[16:19], s26 offen sc1
  s_mov_b32 s26, 610304
  buffer_load_dword v38, v10, s[16:19], s26 offen sc1
  s_mov_b32 s26, 624640
  buffer_load_dword v39, v10, s[16:19], s26 offen sc1
  s_waitcnt vmcnt(22)
  s_barrier
  s_add_u32 m0, s27, 57344
  s_nop 0
  buffer_load_dwordx4 v16, s[8:11], s47 offen offset:0 lds
  buffer_load_dwordx4 v17, s[8:11], s47 offen offset:1024 lds
  buffer_load_dwordx4 v18, s[8:11], s47 offen offset:2048 lds
  buffer_load_dwordx4 v19, s[8:11], s47 offen offset:3072 lds
  s_add_u32 m0, s27, 61440
  s_nop 0
  buffer_load_dwordx4 v20, s[8:11], s47 offen offset:0 lds
  buffer_load_dwordx4 v21, s[8:11], s47 offen offset:1024 lds
  buffer_load_dwordx4 v22, s[8:11], s47 offen offset:2048 lds
  s_add_u32 s47, s47, 458752
  s_waitcnt vmcnt(22)
  s_barrier
  s_add_u32 m0, s27, 86016
  s_nop 0
  buffer_load_dwordx4 v16, s[8:11], s47 offen offset:0 lds
  buffer_load_dwordx4 v17, s[8:11], s47 offen offset:1024 lds
  buffer_load_dwordx4 v18, s[8:11], s47 offen offset:2048 lds
  buffer_load_dwordx4 v19, s[8:11], s47 offen offset:3072 lds
  s_add_u32 m0, s27, 90112
  s_nop 0
  buffer_load_dwordx4 v20, s[8:11], s47 offen offset:0 lds
  buffer_load_dwordx4 v21, s[8:11], s47 offen offset:1024 lds
  buffer_load_dwordx4 v22, s[8:11], s47 offen offset:2048 lds
  s_add_u32 s47, s47, 458752
  s_getpc_b64 s[72:73]
gl_pc10:
  s_add_u32 s72, s72, g3_epi-gl_pc10
  s_addc_u32 s73, s73, -1
  s_mov_b32 s74, g3_cwend-g3_epi
  s_mov_b32 s75, 0x20000
  s_lshr_b32 s24, s2, 3
  s_and_b32 s24, s24, 31
  s_mul_i32 s24, s24, 1024
  s_cmp_lg_u32 s20, 3
  s_cselect_b32 s74, 0, s74
  v_cmp_gt_u32 vcc, 8, v3
  v_lshlrev_b32 v12, 7, v3
  v_mov_b32 v13, 0x80000000
  v_cndmask_b32 v12, v13, v12, vcc
  buffer_load_dword v255, v12, s[72:75], s24 offen
  s_getpc_b64 s[76:77]
gl_pc11:
  s_add_u32 s76, s76, g4_l-gl_pc11
  s_addc_u32 s77, s77, 0
  s_mov_b32 s78, code_end-g4_l
  s_mov_b32 s79, 0x20000
  s_lshr_b32 s24, s2, 3
  s_and_b32 s24, s24, 31
  s_mul_i32 s24, s24, 256
  s_cmp_lg_u32 s20, 3
  s_cselect_b32 s78, 0, s78
  v_cmp_gt_u32 vcc, 2, v3
  v_lshlrev_b32 v14, 7, v3
  v_mov_b32 v15, 0x80000000
  v_cndmask_b32 v14, v15, v14, vcc
  buffer_load_dword v255, v14, s[76:79], s24 offen
  s_waitcnt vmcnt(24)
  s_barrier
  s_add_u32 m0, s27, 114688
  s_nop 0
  buffer_load_dwordx4 v16, s[8:11], s47 offen offset:0 lds
  buffer_load_dwordx4 v17, s[8:11], s47 offen offset:1024 lds
  buffer_load_dwordx4 v18, s[8:11], s47 offen offset:2048 lds
  buffer_load_dwordx4 v19, s[8:11], s47 offen offset:3072 lds
  s_add_u32 m0, s27, 118784
  s_nop 0
  buffer_load_dwordx4 v20, s[8:11], s47 offen offset:0 lds
  buffer_load_dwordx4 v21, s[8:11], s47 offen offset:1024 lds
  buffer_load_dwordx4 v22, s[8:11], s47 offen offset:2048 lds
  s_add_u32 s47, s47, 458752
  s_waitcnt vmcnt(23)
  v_add_f32 v32, v32, v33
  v_add_f32 v32, v32, v34
  v_add_f32 v32, v32, v35
  v_add_f32 v32, v32, v36
  v_add_f32 v32, v32, v37
  v_add_f32 v32, v32, v38
  v_add_f32 v32, v32, v39
  ds_write_b32 v9, v32
  s_waitcnt vmcnt(16)
  s_barrier
  s_add_u32 m0, s27, 0
  s_nop 0
  buffer_load_dwordx4 v16, s[8:11], s47 offen offset:0 lds
  buffer_load_dwordx4 v17, s[8:11], s47 offen offset:1024 lds
  buffer_load_dwordx4 v18, s[8:11], s47 offen offset:2048 lds
  buffer_load_dwordx4 v19, s[8:11], s47 offen offset:3072 lds
  s_add_u32 m0, s27, 4096
  s_nop 0
  buffer_load_dwordx4 v20, s[8:11], s47 offen offset:0 lds
  buffer_load_dwordx4 v21, s[8:11], s47 offen offset:1024 lds
  buffer_load_dwordx4 v22, s[8:11], s47 offen offset:2048 lds
  s_add_u32 s47, s47, 458752
  s_lshl_b32 s26, s20, 8
  s_add_u32 s26, s26, s2
  s_lshl_b32 s26, s26, 13
  v_lshl_add_u32 v4, v3, 7, s26
  buffer_load_dword v255, v4, s[36:39], 0 offen
  s_waitcnt vmcnt(17)
  s_barrier
  s_waitcnt vmcnt(8)
  s_barrier
  s_waitcnt vmcnt(1)
  s_waitcnt lgkmcnt(0)
  s_barrier
  s_barrier
g4_l:
  s_load_dwordx4 s[28:31], s[0:1], 80
  s_load_dwordx4 s[40:43], s[0:1], 96
  s_load_dwordx2 s[32:33], s[0:1], 0
  s_and_b32 s24, s2, 7
  s_lshr_b32 s25, s2, 3
  s_and_b32 s25, s25, 31
  s_lshr_b32 s21, s24, 1
  s_lshl_b32 s21, s21, 2
  s_lshr_b32 s22, s25, 3
  s_add_u32 s21, s21, s22
  s_and_b32 s22, s24, 1
  s_lshl_b32 s22, s22, 3
  s_and_b32 s25, s25, 7
  s_add_u32 s22, s22, s25
  s_lshr_b32 s58, s22, 3
  s_and_b32 s22, s22, 7
  s_lshl_b32 s59, s22, 1
  s_add_u32 s59, s59, s58
  v_lshrrev_b32 v2, 6, v0
  v_and_b32 v3, 63, v0
  v_readfirstlane_b32 s100, v2
  s_nop 0
  s_and_b32 s20, s100, 3
  s_lshr_b32 s3, s100, 2
  s_lshl_b32 s23, s21, 3
  s_lshl_b32 s24, s20, 1
  s_add_u32 s23, s23, s24
  s_lshl_b32 s26, s20, 13
  s_add_u32 s26, s26, 131072
  s_mov_b32 s46, 0
  s_mov_b32 s47, 0
  v_lshrrev_b32 v28, 4, v3
  v_and_b32 v29, 15, v3
  v_lshlrev_b32 v30, 1, v28
  v_xor_b32 v29, v29, v30
  s_lshl_b32 s24, s20, 4
  s_mul_i32 s25, s58, 1792
  s_add_u32 s24, s24, s25
  v_add_u32 v28, s24, v28
  v_lshlrev_b32 v28, 11, v28
  s_lshl_b32 s24, s22, 8
  v_add_u32 v28, s24, v28
  v_lshl_add_u32 v30, v29, 4, v28
  v_xor_b32 v29, 8, v29
  v_lshl_add_u32 v31, v29, 4, v28
  v_add_u32 v4, 0, v30
  v_add_u32 v5, 7168, v31
  v_add_u32 v6, 14336, v30
  v_add_u32 v7, 21504, v31
  s_lshl_b32 s27, s20, 12
  s_waitcnt lgkmcnt(0)
  s_mov_b32 s8, s28
  s_mov_b32 s9, s29
  s_mov_b32 s10, 7340032
  s_mov_b32 s11, 0x20000
  s_mov_b32 s4, s32
  s_mov_b32 s5, s33
  s_mov_b32 s6, 4194304
  s_mov_b32 s7, 0x20000
  s_add_u32 m0, s27, 0
  s_nop 0
  buffer_load_dwordx4 v4, s[8:11], s47 offen offset:0 lds
  buffer_load_dwordx4 v5, s[8:11], s47 offen offset:1024 lds
  buffer_load_dwordx4 v6, s[8:11], s47 offen offset:2048 lds
  buffer_load_dwordx4 v7, s[8:11], s47 offen offset:3072 lds
  s_add_u32 s47, s47, 131072
  s_add_u32 m0, s27, 16384
  s_nop 0
  buffer_load_dwordx4 v4, s[8:11], s47 offen offset:0 lds
  buffer_load_dwordx4 v5, s[8:11], s47 offen offset:1024 lds
  buffer_load_dwordx4 v6, s[8:11], s47 offen offset:2048 lds
  buffer_load_dwordx4 v7, s[8:11], s47 offen offset:3072 lds
  s_add_u32 s47, s47, 131072
  s_add_u32 m0, s27, 32768
  s_nop 0
  buffer_load_dwordx4 v4, s[8:11], s47 offen offset:0 lds
  buffer_load_dwordx4 v5, s[8:11], s47 offen offset:1024 lds
  buffer_load_dwordx4 v6, s[8:11], s47 offen offset:2048 lds
  buffer_load_dwordx4 v7, s[8:11], s47 offen offset:3072 lds
  s_add_u32 s47, s47, 131072
  s_add_u32 m0, s27, 49152
  s_nop 0
  buffer_load_dwordx4 v4, s[8:11], s47 offen offset:0 lds
  buffer_load_dwordx4 v5, s[8:11], s47 offen offset:1024 lds
  buffer_load_dwordx4 v6, s[8:11], s47 offen offset:2048 lds
  buffer_load_dwordx4 v7, s[8:11], s47 offen offset:3072 lds
  s_add_u32 s47, s47, 131072
  s_add_u32 m0, s27, 65536
  s_nop 0
  buffer_load_dwordx4 v4, s[8:11], s47 offen offset:0 lds
  buffer_load_dwordx4 v5, s[8:11], s47 offen offset:1024 lds
  buffer_load_dwordx4 v6, s[8:11], s47 offen offset:2048 lds
  buffer_load_dwordx4 v7, s[8:11], s47 offen offset:3072 lds
  s_add_u32 s47, s47, 131072
  s_add_u32 m0, s27, 81920
  s_nop 0
  buffer_load_dwordx4 v4, s[8:11], s47 offen offset:0 lds
  buffer_load_dwordx4 v5, s[8:11], s47 offen offset:1024 lds
  buffer_load_dwordx4 v6, s[8:11], s47 offen offset:2048 lds
  buffer_load_dwordx4 v7, s[8:11], s47 offen offset:3072 lds
  s_add_u32 s47, s47, 131072
  s_mov_b32 s35, s59
  v_lshrrev_b32 v28, 3, v3
  v_and_b32 v29, 7, v3
  v_lshrrev_b32 v30, 4, v3
  v_xor_b32 v30, v30, v29
  s_lshl_b32 s24, s23, 4
  v_add_u32 v31, s24, v28
  v_lshlrev_b32 v31, 11, v31
  s_lshl_b32 s24, s35, 7
  v_add_u32 v31, s24, v31
  v_lshl_add_u32 v8, v30, 4, v31
  v_xor_b32 v30, 4, v30
  v_lshl_add_u32 v9, v30, 4, v31
  s_add_u32 s36, s42, 29360128
  s_addc_u32 s37, s43, 0
  s_mov_b32 s38, 4194304
  s_mov_b32 s39, 0x20000
  s_add_u32 s16, s42, 33554432
  s_addc_u32 s17, s43, 0
  s_mov_b32 s18, 4194304
  s_mov_b32 s19, 0x20000
  v_mov_b32 v1, 0
  s_lshl_b32 s45, s59, 7
  s_add_u32 s45, s45, 827392
  v_lshrrev_b32 v28, 2, v3
  s_lshl_b32 s24, s59, 6
  v_add_u32 v28, s24, v28
  v_lshlrev_b32 v28, 12, v28
  v_bfe_u32 v29, v3, 4, 1
  v_lshlrev_b32 v29, 1, v29
  v_and_b32 v30, 3, v3
  v_xor_b32 v29, v29, v30
  v_lshl_add_u32 v28, v29, 4, v28
  s_lshl_b32 s24, s23, 5
  v_add_u32 v10, s24, v28
  buffer_load_dword v2, v1, s[16:19], s45 offen sc1
  s_add_u32 m0, s26, 0
  s_mov_b32 s44, 0
  buffer_load_dwordx4 v8, s[4:7], s44 offen lds
  s_add_u32 m0, s26, 1024
  s_mov_b32 s44, 16384
  buffer_load_dwordx4 v9, s[4:7], s44 offen lds
  s_add_u32 m0, s26, 2048
  s_mov_b32 s44, 32768
  buffer_load_dwordx4 v8, s[4:7], s44 offen lds
  s_add_u32 m0, s26, 3072
  s_mov_b32 s44, 49152
  buffer_load_dwordx4 v9, s[4:7], s44 offen lds
  s_waitcnt vmcnt(25)
  s_barrier
  s_waitcnt vmcnt(4)
  s_mov_b32 s57, 0
gl_fsp13:
  v_readfirstlane_b32 s56, v2
  s_nop 0
  s_cmp_ge_u32 s56, 64
  s_cbranch_scc1 gl_fok12
  s_add_u32 s57, s57, 1
  s_cmp_ge_u32 s57, 262144
  s_cbranch_scc1 gl_fok12
  s_sleep 2
  buffer_load_dword v2, v1, s[16:19], s45 offen sc1
  s_waitcnt vmcnt(0)
  s_branch gl_fsp13
gl_fok12:
  s_add_u32 m0, s26, 4096
  s_mov_b32 s44, 0
  buffer_load_dwordx4 v10, s[36:39], s44 offen sc1 lds
  s_barrier
  s_add_u32 m0, s26, 5120
  s_mov_b32 s44, 65536
  buffer_load_dwordx4 v10, s[36:39], s44 offen sc1 lds
  s_barrier
  s_add_u32 m0, s27, 0
  s_nop 0
  buffer_load_dwordx4 v4, s[8:11], s47 offen offset:0 lds
  buffer_load_dwordx4 v5, s[8:11], s47 offen offset:1024 lds
  buffer_load_dwordx4 v6, s[8:11], s47 offen offset:2048 lds
  buffer_load_dwordx4 v7, s[8:11], s47 offen offset:3072 lds
  s_add_u32 s47, s47, 131072
  s_add_u32 m0, s26, 6144
  s_mov_b32 s44, 131072
  buffer_load_dwordx4 v10, s[36:39], s44 offen sc1 lds
  s_barrier
  s_add_u32 m0, s27, 16384
  s_nop 0
  buffer_load_dwordx4 v4, s[8:11], s47 offen offset:0 lds
  buffer_load_dwordx4 v5, s[8:11], s47 offen offset:1024 lds
  buffer_load_dwordx4 v6, s[8:11], s47 offen offset:2048 lds
  buffer_load_dwordx4 v7, s[8:11], s47 offen offset:3072 lds
  s_add_u32 s47, s47, 131072
  s_add_u32 m0, s26, 7168
  s_mov_b32 s44, 196608
  buffer_load_dwordx4 v10, s[36:39], s44 offen sc1 lds
  s_barrier
  s_add_u32 m0, s27, 32768
  s_nop 0
  buffer_load_dwordx4 v4, s[8:11], s47 offen offset:0 lds
  buffer_load_dwordx4 v5, s[8:11], s47 offen offset:1024 lds
  buffer_load_dwordx4 v6, s[8:11], s47 offen offset:2048 lds
  buffer_load_dwordx4 v7, s[8:11], s47 offen offset:3072 lds
  s_add_u32 s47, s47, 131072
  s_barrier
  s_add_u32 m0, s27, 49152
  s_nop 0
  buffer_load_dwordx4 v4, s[8:11], s47 offen offset:0 lds
  buffer_load_dwordx4 v5, s[8:11], s47 offen offset:1024 lds
  buffer_load_dwordx4 v6, s[8:11], s47 offen offset:2048 lds
  buffer_load_dwordx4 v7, s[8:11], s47 offen offset:3072 lds
  s_add_u32 s47, s47, 131072
  s_waitcnt vmcnt(14)
  s_barrier
  s_add_u32 m0, s27, 65536
  s_nop 0
  buffer_load_dwordx4 v4, s[8:11], s47 offen offset:0 lds
  buffer_load_dwordx4 v5, s[8:11], s47 offen offset:1024 lds
  buffer_load_dwordx4 v6, s[8:11], s47 offen offset:2048 lds
  buffer_load_dwordx4 v7, s[8:11], s47 offen offset:3072 lds
  s_add_u32 s47, s47, 131072
  s_waitcnt vmcnt(13)
  s_mov_b32 s101, 2
lp_l1:
  s_barrier
  s_add_u32 m0, s27, 81920
  s_nop 0
  buffer_load_dwordx4 v4, s[8:11], s47 offen offset:0 lds
  buffer_load_dwordx4 v5, s[8:11], s47 offen offset:1024 lds
  buffer_load_dwordx4 v6, s[8:11], s47 offen offset:2048 lds
  buffer_load_dwordx4 v7, s[8:11], s47 offen offset:3072 lds
  s_add_u32 s47, s47, 131072
  s_waitcnt vmcnt(12)
  s_barrier
  s_add_u32 m0, s27, 0
  s_nop 0
  buffer_load_dwordx4 v4, s[8:11], s47 offen offset:0 lds
  buffer_load_dwordx4 v5, s[8:11], s47 offen offset:1024 lds
  buffer_load_dwordx4 v6, s[8:11], s47 offen offset:2048 lds
  buffer_load_dwordx4 v7, s[8:11], s47 offen offset:3072 lds
  s_add_u32 s47, s47, 131072
  s_waitcnt vmcnt(12)
  s_barrier
  s_add_u32 m0, s27, 16384
  s_nop 0
  buffer_load_dwordx4 v4, s[8:11], s47 offen offset:0 lds
  buffer_load_dwordx4 v5, s[8:11], s47 offen offset:1024 lds
  buffer_load_dwordx4 v6, s[8:11], s47 offen offset:2048 lds
  buffer_load_dwordx4 v7, s[8:11], s47 offen offset:3072 lds
  s_add_u32 s47, s47, 131072
  s_waitcnt vmcnt(12)
  s_barrier
  s_add_u32 m0, s27, 32768
  s_nop 0
  buffer_load_dwordx4 v4, s[8:11], s47 offen offset:0 lds
  buffer_load_dwordx4 v5, s[8:11], s47 offen offset:1024 lds
  buffer_load_dwordx4 v6, s[8:11], s47 offen offset:2048 lds
  buffer_load_dwordx4 v7, s[8:11], s47 offen offset:3072 lds
  s_add_u32 s47, s47, 131072
  s_waitcnt vmcnt(12)
  s_barrier
  s_add_u32 m0, s27, 49152
  s_nop 0
  buffer_load_dwordx4 v4, s[8:11], s47 offen offset:0 lds
  buffer_load_dwordx4 v5, s[8:11], s47 offen offset:1024 lds
  buffer_load_dwordx4 v6, s[8:11], s47 offen offset:2048 lds
  buffer_load_dwordx4 v7, s[8:11], s47 offen offset:3072 lds
  s_add_u32 s47, s47, 131072
  s_waitcnt vmcnt(12)
  s_barrier
  s_add_u32 m0, s27, 65536
  s_nop 0
  buffer_load_dwordx4 v4, s[8:11], s47 offen offset:0 lds
  buffer_load_dwordx4 v5, s[8:11], s47 offen offset:1024 lds
  buffer_load_dwordx4 v6, s[8:11], s47 offen offset:2048 lds
  buffer_load_dwordx4 v7, s[8:11], s47 offen offset:3072 lds
  s_add_u32 s47, s47, 131072
  s_waitcnt vmcnt(12)
  s_sub_u32 s101, s101, 1
  s_cmp_lg_u32 s101, 0
  s_cbranch_scc1 lp_l1
  s_barrier
  s_add_u32 m0, s27, 81920
  s_nop 0
  buffer_load_dwordx4 v4, s[8:11], s47 offen offset:0 lds
  buffer_load_dwordx4 v5, s[8:11], s47 offen offset:1024 lds
  buffer_load_dwordx4 v6, s[8:11], s47 offen offset:2048 lds
  buffer_load_dwordx4 v7, s[8:11], s47 offen offset:3072 lds
  s_add_u32 s47, s47, 131072
  s_waitcnt vmcnt(12)
  s_barrier
  s_add_u32 m0, s27, 0
  s_nop 0
  buffer_load_dwordx4 v4, s[8:11], s47 offen offset:0 lds
  buffer_load_dwordx4 v5, s[8:11], s47 offen offset:1024 lds
  buffer_load_dwordx4 v6, s[8:11], s47 offen offset:2048 lds
  buffer_load_dwordx4 v7, s[8:11], s47 offen offset:3072 lds
  s_add_u32 s47, s47, 131072
  s_waitcnt vmcnt(12)
  s_barrier
  s_add_u32 m0, s27, 16384
  s_nop 0
  buffer_load_dwordx4 v4, s[8:11], s47 offen offset:0 lds
  buffer_load_dwordx4 v5, s[8:11], s47 offen offset:1024 lds
  buffer_load_dwordx4 v6, s[8:11], s47 offen offset:2048 lds
  buffer_load_dwordx4 v7, s[8:11], s47 offen offset:3072 lds
  s_add_u32 s47, s47, 131072
  s_getpc_b64 s[72:73]
gl_pc14:
  s_add_u32 s72, s72, g4_epi-gl_pc14
  s_addc_u32 s73, s73, -1
  s_mov_b32 s74, g4_cwend-g4_epi
  s_mov_b32 s75, 0x20000
  s_lshr_b32 s24, s2, 3
  s_and_b32 s24, s24, 31
  s_mul_i32 s24, s24, 1024
  s_cmp_lg_u32 s20, 3
  s_cselect_b32 s74, 0, s74
  v_cmp_gt_u32 vcc, 8, v3
  v_lshlrev_b32 v20, 7, v3
  v_mov_b32 v21, 0x80000000
  v_cndmask_b32 v20, v21, v20, vcc
  buffer_load_dword v255, v20, s[72:75], s24 offen
  s_waitcnt vmcnt(13)
  s_barrier
  s_add_u32 m0, s27, 32768
  s_nop 0
  buffer_load_dwordx4 v4, s[8:11], s47 offen offset:0 lds
  buffer_load_dwordx4 v5, s[8:11], s47 offen offset:1024 lds
  buffer_load_dwordx4 v6, s[8:11], s47 offen offset:2048 lds
  buffer_load_dwordx4 v7, s[8:11], s47 offen offset:3072 lds
  s_add_u32 s47, s47, 131072
  s_waitcnt vmcnt(13)
  s_barrier
  s_add_u32 m0, s27, 49152
  s_nop 0
  buffer_load_dwordx4 v4, s[8:11], s47 offen offset:0 lds
  buffer_load_dwordx4 v5, s[8:11], s47 offen offset:1024 lds
  buffer_load_dwordx4 v6, s[8:11], s47 offen offset:2048 lds
  buffer_load_dwordx4 v7, s[8:11], s47 offen offset:3072 lds
  s_add_u32 s47, s47, 131072
  s_waitcnt vmcnt(13)
  s_barrier
  s_waitcnt vmcnt(9)
  s_barrier
  s_waitcnt vmcnt(4)
  s_barrier
  s_waitcnt vmcnt(0)
  s_barrier
  s_endpgm
code_end:
.section .rodata,"a"
.p2align 6
.amdhsa_kernel recurrent_scan__ssm_conv_h3__mixer_s_mlp__prompt_kernel
  .amdhsa_next_free_vgpr 256
  .amdhsa_next_free_sgpr 102
  .amdhsa_accum_offset 256
  .amdhsa_group_segment_fixed_size 0
  .amdhsa_kernarg_size 112
  .amdhsa_user_sgpr_count 2
  .amdhsa_user_sgpr_kernarg_segment_ptr 1
  .amdhsa_system_sgpr_workgroup_id_x 1
.end_amdhsa_kernel
```
